```python
import torch

def _softmax(x, axis=-1):
    return torch.softmax(x, dim=axis)
def _gelu(x):
    return torch.nn.functional.gelu(x, approximate="tanh")
def _silu(x):
    return torch.nn.functional.silu(x)
def _sigmoid(x):
    return torch.sigmoid(x)
def _layernorm(x, axis=-1, eps=1e-5):
    m = x.mean(dim=axis, keepdim=True)
    v = x.var(dim=axis, keepdim=True, unbiased=False)
    return (x - m) / torch.sqrt(v + eps)
def _scatter_add(tgt, idx, src, axis=0):
    return tgt.clone().index_add_(axis, idx, src)
def _segment_sum(src, seg, n):
    out = torch.zeros((n,) + src.shape[1:], dtype=src.dtype)
    return out.index_add_(0, seg, src)
def _pad(x, pw):
    flat = tuple(v for pair in reversed(pw) for v in pair)
    return torch.nn.functional.pad(x, flat)

kernel_name = 'parallel_sum__ssm_conv_h3__dense_activation_mish__prompt'

def setup_inputs():

    _w = (lambda a: (lambda t: t.to(torch.bfloat16) if t.is_floating_point() else t)(torch.as_tensor(a)))
    def _A_setup():
        B, S, D = 1, 2048, 576
        ks = 4
        return {
            "q": _w((lambda *s: torch.randn(*s, dtype=torch.bfloat16) * 0.05)(B, S, D)),
            "k": _w((lambda *s: torch.randn(*s, dtype=torch.bfloat16) * 0.2)(B, S, D)),
            "v": _w((lambda *s: torch.randn(*s, dtype=torch.bfloat16) * 0.2)(B, S, D)),
            "shift_k": _w((lambda *s: torch.randn(*s, dtype=torch.bfloat16) * 0.2)(D, ks) * 0.5),
            "ssm_k": _w((lambda *s: torch.randn(*s, dtype=torch.bfloat16) * 0.8)(D, S) * (1.0 / S ** 0.5)),
            "ssm_D": _w((lambda *s: torch.randn(*s, dtype=torch.bfloat16) * 0.2)(D)),
        }
    _A_in = _A_setup()

    def _B_setup():
        B, S, D, F = 1, 2048, 576, 4608
        return {
            "x": _w((lambda *s: torch.randn(*s, dtype=torch.bfloat16) * 0.05)(B, S, D)),
            "w1": _w((lambda *s: torch.randn(*s, dtype=torch.bfloat16) * 0.8)(D, F) * (D ** -0.5)),
            "b1": _w((lambda *s: torch.randn(*s, dtype=torch.bfloat16) * 0.2)(F)),
            "w2": _w((lambda *s: torch.randn(*s, dtype=torch.bfloat16) * 0.1)(F, D) * (F ** -0.5)),
        }
    _B_in = _B_setup()

    return {
        "A_q": _A_in["q"],
        "A_k": _A_in["k"],
        "A_v": _A_in["v"],
        "A_shift_k": _A_in["shift_k"],
        "A_ssm_k": _A_in["ssm_k"],
        "A_ssm_D": _A_in["ssm_D"],
        "B_x": _B_in["x"],
        "B_w1": _B_in["w1"],
        "B_b1": _B_in["b1"],
        "B_w2": _B_in["w2"],
    }

def reference(A_q, A_k, A_v, A_shift_k, A_ssm_k, A_ssm_D, B_x, B_w1, B_b1, B_w2):
    def _A_ref(q, k, v, shift_k, ssm_k, ssm_D):
        B, S, D = q.shape
        ks = shift_k.shape[-1]
        k_pad = _pad(k, ((0, 0), (ks - 1, 0), (0, 0)))
        k_shift = torch.zeros_like(k)
        for t in range(ks):
            k_shift = k_shift + k_pad[:, t:t + S, :] * shift_k[:, ks - 1 - t][None, None, :]
        kv = k_shift * v
        L = 2 * S
        kv_pad = _pad(kv, ((0, 0), (0, S), (0, 0)))
        kf_pad = _pad(ssm_k, ((0, 0), (0, S)))
        kv_f = (lambda x, axes=(-2,-1): torch.fft.rfft2(x.float(), dim=axes))(kv_pad[:, None, :, :], axes=(1, 2))
        kf_f = (lambda x, axes=(-2,-1): torch.fft.rfft2(x.float(), dim=axes))(kf_pad[:, None, :], axes=(1, 2))
        kf_f = (lambda x, *d: x.permute(*d))(kf_f, 1, 2, 0)
        y_f = kv_f * kf_f[None, :, :, :]
        y = (lambda x, s, axes=(-2,-1): torch.fft.irfft2(x, s=s, dim=axes).to(torch.bfloat16))(y_f, (1, L), axes=(1, 2))[:, 0, :S, :]
        y = y + kv * ssm_D[None, None, :]
        return q * y

    def _B_ref(x, w1, b1, w2):
        h = torch.einsum("bsd,df->bsf", x, w1) + b1
        sp = torch.log1p(torch.exp(-torch.abs(h))) + torch.where(h > 0, h, torch.zeros_like(h))
        act = h * torch.tanh(sp)
        return torch.einsum("bsf,fd->bsd", act, w2)

    x = A_q
    xn = _layernorm(x, axis=-1)
    return x + _A_ref(xn, A_k, A_v, A_shift_k, A_ssm_k, A_ssm_D) + _B_ref(xn, B_w1, B_b1, B_w2)
```

```asm
; @launch grid=(256,1,1) block=(512,1,1) lds=163840
.amdgcn_target "amdgcn-amd-amdhsa--gfx950"
.text
.globl parallel_sum__ssm_conv_h3__dense_activation_mish__prompt_kernel
.p2align 8
.type parallel_sum__ssm_conv_h3__dense_activation_mish__prompt_kernel,@function
parallel_sum__ssm_conv_h3__dense_activation_mish__prompt_kernel:
s_cmp_ge_u32 s2, 256
s_cbranch_scc1 Lk1_exit
s_load_dwordx16 s[16:31], s[0:1], 0
s_load_dwordx8 s[32:39], s[0:1], 64
s_load_dwordx2 s[40:41], s[0:1], 96
v_and_b32 v1, 63, v0
v_lshrrev_b32 v2, 6, v0
s_and_b32 s4, s2, 7
v_readfirstlane_b32 s3, v2
s_lshr_b32 s5, s2, 3
s_getpc_b64 s[10:11]
Lpc:
v_lshl_add_u32 v3, v0, 5, s5
v_lshlrev_b32 v3, 7, v3
v_cmp_gt_u32 vcc, Lk1_exit-Lpc, v3
s_and_saveexec_b64 s[12:13], vcc
s_cbranch_execz Lnocpf
global_load_dword v26, v3, s[10:11]
Lnocpf:
s_mov_b64 exec, s[12:13]
s_cmp_lt_u32 s5, 6
s_waitcnt lgkmcnt(0)
s_cbranch_scc1 Lconv
s_sub_u32 s5, s5, 6
s_mov_b32 s48, s30
s_and_b32 s49, s31, 0xffff
s_mov_b32 s50, 5308416
s_mov_b32 s51, 0x20000
s_mul_i32 s7, s3, 312
s_mul_i32 s8, s5, 12
s_add_u32 s7, s7, s8
v_add_u32 v28, s7, v1
v_lshrrev_b32 v29, 2, v28
v_and_b32 v30, 3, v28
v_mul_u32_u24 v29, 9216, v29
v_lshl_add_u32 v29, v30, 7, v29
s_mul_i32 s7, s4, 1152
s_mov_b64 exec, 0xfff
buffer_load_dword v26, v29, s[48:51], s7 offen
s_mov_b64 exec, -1
s_cmp_lt_u32 s3, 4
s_cbranch_scc1 LmlpP
s_mov_b32 s44, s16
s_and_b32 s45, s17, 0xffff
s_mov_b32 s46, 2359296
s_mov_b32 s47, 0x20000
s_and_b32 s18, s3, 3
v_lshrrev_b32 v28, 3, v1
v_lshrrev_b32 v29, 4, v1
s_and_b32 s7, s3, 1
s_lshl_b32 s7, s7, 2
v_or_b32 v29, s7, v29
v_and_b32 v30, 7, v1
v_xor_b32 v30, v30, v29
s_mul_i32 s7, s5, 79
v_add_u32 v28, s7, v28
v_mul_u32_u24 v60, 1152, v28
v_lshl_add_u32 v60, v30, 4, v60
s_add_u32 s12, s18, 0
s_mul_i32 s13, s12, 205
s_lshr_b32 s13, s13, 11
s_mul_i32 s14, s13, 10
s_sub_u32 s14, s12, s14
s_cmp_eq_u32 s14, 9
s_cselect_b32 exec_hi, 0xffffff, -1
s_mul_i32 s14, s14, 9216
s_lshl_b32 s13, s13, 7
s_lshl_b32 m0, s12, 10
s_add_u32 s14, s14, s13
buffer_load_dwordx4 v60, s[44:47], s14 offen lds
s_mov_b32 exec_hi, -1
s_add_u32 s12, s18, 4
s_mul_i32 s13, s12, 205
s_lshr_b32 s13, s13, 11
s_mul_i32 s14, s13, 10
s_sub_u32 s14, s12, s14
s_cmp_eq_u32 s14, 9
s_cselect_b32 exec_hi, 0xffffff, -1
s_mul_i32 s14, s14, 9216
s_lshl_b32 s13, s13, 7
s_lshl_b32 m0, s12, 10
s_add_u32 s14, s14, s13
buffer_load_dwordx4 v60, s[44:47], s14 offen lds
s_mov_b32 exec_hi, -1
s_add_u32 s12, s18, 8
s_mul_i32 s13, s12, 205
s_lshr_b32 s13, s13, 11
s_mul_i32 s14, s13, 10
s_sub_u32 s14, s12, s14
s_cmp_eq_u32 s14, 9
s_cselect_b32 exec_hi, 0xffffff, -1
s_mul_i32 s14, s14, 9216
s_lshl_b32 s13, s13, 7
s_lshl_b32 m0, s12, 10
s_add_u32 s14, s14, s13
buffer_load_dwordx4 v60, s[44:47], s14 offen lds
s_mov_b32 exec_hi, -1
s_add_u32 s12, s18, 12
s_mul_i32 s13, s12, 205
s_lshr_b32 s13, s13, 11
s_mul_i32 s14, s13, 10
s_sub_u32 s14, s12, s14
s_cmp_eq_u32 s14, 9
s_cselect_b32 exec_hi, 0xffffff, -1
s_mul_i32 s14, s14, 9216
s_lshl_b32 s13, s13, 7
s_lshl_b32 m0, s12, 10
s_add_u32 s14, s14, s13
buffer_load_dwordx4 v60, s[44:47], s14 offen lds
s_mov_b32 exec_hi, -1
s_add_u32 s12, s18, 16
s_mul_i32 s13, s12, 205
s_lshr_b32 s13, s13, 11
s_mul_i32 s14, s13, 10
s_sub_u32 s14, s12, s14
s_cmp_eq_u32 s14, 9
s_cselect_b32 exec_hi, 0xffffff, -1
s_mul_i32 s14, s14, 9216
s_lshl_b32 s13, s13, 7
s_lshl_b32 m0, s12, 10
s_add_u32 s14, s14, s13
buffer_load_dwordx4 v60, s[44:47], s14 offen lds
s_mov_b32 exec_hi, -1
s_add_u32 s12, s18, 20
s_mul_i32 s13, s12, 205
s_lshr_b32 s13, s13, 11
s_mul_i32 s14, s13, 10
s_sub_u32 s14, s12, s14
s_cmp_eq_u32 s14, 9
s_cselect_b32 exec_hi, 0xffffff, -1
s_mul_i32 s14, s14, 9216
s_lshl_b32 s13, s13, 7
s_lshl_b32 m0, s12, 10
s_add_u32 s14, s14, s13
buffer_load_dwordx4 v60, s[44:47], s14 offen lds
s_mov_b32 exec_hi, -1
s_add_u32 s12, s18, 24
s_mul_i32 s13, s12, 205
s_lshr_b32 s13, s13, 11
s_mul_i32 s14, s13, 10
s_sub_u32 s14, s12, s14
s_cmp_eq_u32 s14, 9
s_cselect_b32 exec_hi, 0xffffff, -1
s_mul_i32 s14, s14, 9216
s_lshl_b32 s13, s13, 7
s_lshl_b32 m0, s12, 10
s_add_u32 s14, s14, s13
buffer_load_dwordx4 v60, s[44:47], s14 offen lds
s_mov_b32 exec_hi, -1
s_add_u32 s12, s18, 28
s_mul_i32 s13, s12, 205
s_lshr_b32 s13, s13, 11
s_mul_i32 s14, s13, 10
s_sub_u32 s14, s12, s14
s_cmp_eq_u32 s14, 9
s_cselect_b32 exec_hi, 0xffffff, -1
s_mul_i32 s14, s14, 9216
s_lshl_b32 s13, s13, 7
s_lshl_b32 m0, s12, 10
s_add_u32 s14, s14, s13
buffer_load_dwordx4 v60, s[44:47], s14 offen lds
s_mov_b32 exec_hi, -1
s_barrier
s_mov_b32 s52, s34
s_and_b32 s53, s35, 0xffff
s_mov_b32 s54, 5308416
s_mov_b32 s55, 0x20000
s_mov_b32 s56, s32
s_and_b32 s57, s33, 0xffff
s_mov_b32 s58, 9216
s_mov_b32 s59, 0x20000
s_mov_b32 s60, s40
s_and_b32 s61, s41, 0xffff
s_mov_b32 s62, 33554432
s_mov_b32 s63, 0x20000
s_and_b32 s18, s3, 3
s_lshr_b32 s7, s3, 2
s_xor_b32 s7, s7, s4
s_and_b32 s7, s7, 1
s_xor_b32 s7, s7, 1
s_lshl_b32 s19, s7, 2
s_add_u32 s19, s19, s18
s_and_b32 s7, s4, 1
s_lshl_b32 s7, s7, 2
s_lshr_b32 s23, s4, 1
s_add_u32 s23, s23, s7
v_lshlrev_b32 v2, 4, v1
v_add_u32 v3, 46080, v2
s_lshl_b32 s6, s18, 14
s_add_u32 s6, s6, 92160
s_lshl_b32 s20, s18, 10
s_add_u32 s20, s20, 104448
v_lshrrev_b32 v28, 2, v1
v_and_b32 v30, 3, v1
v_lshlrev_b32 v29, 7, v28
v_lshl_add_u32 v29, v30, 3, v29
v_bfe_u32 v30, v1, 3, 2
v_lshl_add_u32 v29, v30, 5, v29
v_xor_b32 v6, 0, v29
v_add_u32 v6, s6, v6
v_xor_b32 v7, 32, v29
v_add_u32 v7, s6, v7
v_xor_b32 v8, 64, v29
v_add_u32 v8, s6, v8
v_xor_b32 v9, 96, v29
v_add_u32 v9, s6, v9
s_lshl_b32 s7, s18, 5
v_xor_b32 v10, s7, v29
v_add_u32 v10, 104448, v10
v_lshrrev_b32 v28, 3, v1
v_and_b32 v30, 7, v1
v_and_b32 v29, 6, v28
v_xor_b32 v30, v30, v29
v_mul_u32_u24 v31, 1152, v28
v_lshl_add_u32 v31, v30, 4, v31
s_mul_i32 s7, s4, 663552
s_lshl_b32 s8, s19, 7
s_add_u32 s8, s8, s7
v_add_u32 v13, s8, v31
v_add_u32 v14, 8192, v13
s_mul_i32 s8, s18, 9216
s_add_u32 s8, s8, s7
s_add_u32 s8, s8, 1024
v_add_u32 v15, s8, v31
v_and_b32 v29, 4, v28
v_add_u32 v29, v29, v28
v_mul_u32_u24 v31, 9216, v29
v_lshl_add_u32 v31, v30, 4, v31
s_mul_i32 s7, s4, 1152
s_lshl_b32 s8, s3, 7
s_add_u32 s8, s8, s7
v_add_u32 v11, s8, v31
v_add_u32 v12, 146432, v11
s_and_b32 s8, s18, 1
s_mul_i32 s8, s8, 147456
s_add_u32 s7, s7, s8
s_lshr_b32 s8, s18, 1
s_mul_i32 s8, s8, 36864
s_add_u32 s7, s7, s8
s_add_u32 s7, s7, 1024
v_add_u32 v15, s7, v31
s_and_b32 s7, s3, 4
s_add_u32 s7, s7, s3
s_mul_i32 s7, s7, 5120
v_add_u32 v16, s7, v2
s_lshr_b32 s7, s18, 1
s_mul_i32 s7, s7, 5120
s_and_b32 s8, s18, 1
s_lshl_b32 s8, s8, 3
s_add_u32 s7, s7, s8
s_add_u32 s7, s7, 81920
v_add_u32 v17, s7, v2
s_mul_i32 s7, s4, 2396160
s_mul_i32 s10, s5, 92160
s_add_u32 s7, s7, s10
s_lshl_b32 s10, s19, 11
s_add_u32 s10, s10, s7
v_add_u32 v18, s10, v2
s_lshl_b32 s10, s18, 9
s_add_u32 s10, s10, s7
s_add_u32 s10, s10, 16384
v_lshl_add_u32 v19, v1, 3, s10
s_mov_b32 s9, 1060439283
s_mov_b32 s100, 0
v_and_b32 v28, 3, v1
v_lshlrev_b32 v28, 2, v28
v_add_u32 v20, 163328, v28
v_add_u32 v21, 163344, v28
s_lshl_b32 s7, s3, 2
s_add_u32 s7, s7, 163328
v_mov_b32 v22, s7
v_and_b32 v28, 15, v1
v_lshrrev_b32 v29, 4, v1
v_lshrrev_b32 v30, 1, v28
v_xor_b32 v29, v29, v30
v_lshlrev_b32 v4, 7, v28
v_lshl_add_u32 v4, v29, 4, v4
v_xor_b32 v5, 64, v4
v_add_u32 v254, 51200, v4
v_add_u32 v255, 51200, v5
s_mov_b32 s15, 0x3f803f80
v_mov_b32 v36, 0
v_mov_b32 v37, 0
v_mov_b32 v38, 0
v_mov_b32 v39, 0
v_mov_b32 v40, 0
v_mov_b32 v41, 0
v_mov_b32 v42, 0
v_mov_b32 v43, 0
v_mov_b32 v44, 0
v_mov_b32 v45, 0
s_waitcnt vmcnt(7)
s_add_u32 s12, s18, 32
s_mul_i32 s13, s12, 205
s_lshr_b32 s13, s13, 11
s_mul_i32 s14, s13, 10
s_sub_u32 s14, s12, s14
s_cmp_eq_u32 s14, 9
s_cselect_b32 exec_hi, 0xffffff, -1
s_mul_i32 s14, s14, 9216
s_lshl_b32 s13, s13, 7
s_lshl_b32 m0, s12, 10
s_add_u32 s14, s14, s13
buffer_load_dwordx4 v60, s[44:47], s14 offen lds
s_mov_b32 exec_hi, -1
s_add_u32 s12, s18, 0
s_lshl_b32 s12, s12, 10
v_add_u32 v31, s12, v2
ds_read_b128 v[48:51], v31
s_waitcnt vmcnt(7)
s_add_u32 s12, s18, 36
s_mul_i32 s13, s12, 205
s_lshr_b32 s13, s13, 11
s_mul_i32 s14, s13, 10
s_sub_u32 s14, s12, s14
s_cmp_eq_u32 s14, 9
s_cselect_b32 exec_hi, 0xffffff, -1
s_mul_i32 s14, s14, 9216
s_lshl_b32 s13, s13, 7
s_lshl_b32 m0, s12, 10
s_add_u32 s14, s14, s13
buffer_load_dwordx4 v60, s[44:47], s14 offen lds
s_mov_b32 exec_hi, -1
s_add_u32 s12, s18, 4
s_lshl_b32 s12, s12, 10
v_add_u32 v31, s12, v2
ds_read_b128 v[52:55], v31
s_waitcnt lgkmcnt(1)
v_lshlrev_b32 v64, 16, v48
v_and_b32 v65, 0xffff0000, v48
v_lshlrev_b32 v66, 16, v49
v_and_b32 v67, 0xffff0000, v49
v_lshlrev_b32 v68, 16, v50
v_and_b32 v69, 0xffff0000, v50
v_lshlrev_b32 v70, 16, v51
v_and_b32 v71, 0xffff0000, v51
v_add_f32 v72, v64, v65
v_fmac_f32 v37, v64, v64
v_mul_f32 v73, v65, v65
v_add_f32 v74, v66, v67
v_fmac_f32 v37, v66, v66
v_fmac_f32 v73, v67, v67
v_add_f32 v72, v72, v74
v_add_f32 v74, v68, v69
v_fmac_f32 v37, v68, v68
v_fmac_f32 v73, v69, v69
v_add_f32 v72, v72, v74
v_add_f32 v74, v70, v71
v_fmac_f32 v37, v70, v70
v_fmac_f32 v73, v71, v71
v_add_f32 v72, v72, v74
v_add_f32 v36, v36, v72
v_add_f32 v37, v37, v73
s_waitcnt vmcnt(7)
v_mov_b32 v24, 1
ds_write_b32 v22, v24
s_add_u32 s12, s18, 40
s_mul_i32 s13, s12, 205
s_lshr_b32 s13, s13, 11
s_mul_i32 s14, s13, 10
s_sub_u32 s14, s12, s14
s_cmp_eq_u32 s14, 9
s_cselect_b32 exec_hi, 0xffffff, -1
s_mul_i32 s14, s14, 9216
s_lshl_b32 s13, s13, 7
s_lshl_b32 m0, s12, 10
s_add_u32 s14, s14, s13
buffer_load_dwordx4 v60, s[44:47], s14 offen lds
s_mov_b32 exec_hi, -1
s_add_u32 s12, s18, 8
s_lshl_b32 s12, s12, 10
v_add_u32 v31, s12, v2
ds_read_b128 v[48:51], v31
s_waitcnt lgkmcnt(2)
v_lshlrev_b32 v64, 16, v52
v_and_b32 v65, 0xffff0000, v52
v_lshlrev_b32 v66, 16, v53
v_and_b32 v67, 0xffff0000, v53
v_lshlrev_b32 v68, 16, v54
v_and_b32 v69, 0xffff0000, v54
v_lshlrev_b32 v70, 16, v55
v_and_b32 v71, 0xffff0000, v55
v_add_f32 v72, v64, v65
v_fmac_f32 v39, v64, v64
v_mul_f32 v73, v65, v65
v_add_f32 v74, v66, v67
v_fmac_f32 v39, v66, v66
v_fmac_f32 v73, v67, v67
v_add_f32 v72, v72, v74
v_add_f32 v74, v68, v69
v_fmac_f32 v39, v68, v68
v_fmac_f32 v73, v69, v69
v_add_f32 v72, v72, v74
v_add_f32 v74, v70, v71
v_fmac_f32 v39, v70, v70
v_fmac_f32 v73, v71, v71
v_add_f32 v72, v72, v74
v_add_f32 v38, v38, v72
v_add_f32 v39, v39, v73
s_waitcnt vmcnt(7)
s_add_u32 s12, s18, 44
s_mul_i32 s13, s12, 205
s_lshr_b32 s13, s13, 11
s_mul_i32 s14, s13, 10
s_sub_u32 s14, s12, s14
s_cmp_eq_u32 s14, 9
s_cselect_b32 exec_hi, 0xffffff, -1
s_mul_i32 s14, s14, 9216
s_lshl_b32 s13, s13, 7
s_lshl_b32 m0, s12, 10
s_add_u32 s14, s14, s13
buffer_load_dwordx4 v60, s[44:47], s14 offen lds
s_mov_b32 exec_hi, -1
s_add_u32 s12, s18, 12
s_lshl_b32 s12, s12, 10
v_add_u32 v31, s12, v2
ds_read_b128 v[52:55], v31
s_waitcnt lgkmcnt(1)
v_lshlrev_b32 v64, 16, v48
v_and_b32 v65, 0xffff0000, v48
v_lshlrev_b32 v66, 16, v49
v_and_b32 v67, 0xffff0000, v49
v_lshlrev_b32 v68, 16, v50
v_and_b32 v69, 0xffff0000, v50
v_lshlrev_b32 v70, 16, v51
v_and_b32 v71, 0xffff0000, v51
v_add_f32 v72, v64, v65
v_fmac_f32 v41, v64, v64
v_mul_f32 v73, v65, v65
v_add_f32 v74, v66, v67
v_fmac_f32 v41, v66, v66
v_fmac_f32 v73, v67, v67
v_add_f32 v72, v72, v74
v_add_f32 v74, v68, v69
v_fmac_f32 v41, v68, v68
v_fmac_f32 v73, v69, v69
v_add_f32 v72, v72, v74
v_add_f32 v74, v70, v71
v_fmac_f32 v41, v70, v70
v_fmac_f32 v73, v71, v71
v_add_f32 v72, v72, v74
v_add_f32 v40, v40, v72
v_add_f32 v41, v41, v73
s_waitcnt vmcnt(7)
v_mov_b32 v24, 2
ds_write_b32 v22, v24
s_add_u32 s12, s18, 48
s_mul_i32 s13, s12, 205
s_lshr_b32 s13, s13, 11
s_mul_i32 s14, s13, 10
s_sub_u32 s14, s12, s14
s_cmp_eq_u32 s14, 9
s_cselect_b32 exec_hi, 0xffffff, -1
s_mul_i32 s14, s14, 9216
s_lshl_b32 s13, s13, 7
s_lshl_b32 m0, s12, 10
s_add_u32 s14, s14, s13
buffer_load_dwordx4 v60, s[44:47], s14 offen lds
s_mov_b32 exec_hi, -1
s_add_u32 s12, s18, 16
s_lshl_b32 s12, s12, 10
v_add_u32 v31, s12, v2
ds_read_b128 v[48:51], v31
s_waitcnt lgkmcnt(2)
v_lshlrev_b32 v64, 16, v52
v_and_b32 v65, 0xffff0000, v52
v_lshlrev_b32 v66, 16, v53
v_and_b32 v67, 0xffff0000, v53
v_lshlrev_b32 v68, 16, v54
v_and_b32 v69, 0xffff0000, v54
v_lshlrev_b32 v70, 16, v55
v_and_b32 v71, 0xffff0000, v55
v_add_f32 v72, v64, v65
v_fmac_f32 v43, v64, v64
v_mul_f32 v73, v65, v65
v_add_f32 v74, v66, v67
v_fmac_f32 v43, v66, v66
v_fmac_f32 v73, v67, v67
v_add_f32 v72, v72, v74
v_add_f32 v74, v68, v69
v_fmac_f32 v43, v68, v68
v_fmac_f32 v73, v69, v69
v_add_f32 v72, v72, v74
v_add_f32 v74, v70, v71
v_fmac_f32 v43, v70, v70
v_fmac_f32 v73, v71, v71
v_add_f32 v72, v72, v74
v_add_f32 v42, v42, v72
v_add_f32 v43, v43, v73
s_waitcnt vmcnt(7)
s_add_u32 s12, s18, 52
s_mul_i32 s13, s12, 205
s_lshr_b32 s13, s13, 11
s_mul_i32 s14, s13, 10
s_sub_u32 s14, s12, s14
s_cmp_eq_u32 s14, 9
s_cselect_b32 exec_hi, 0xffffff, -1
s_mul_i32 s14, s14, 9216
s_lshl_b32 s13, s13, 7
s_lshl_b32 m0, s12, 10
s_add_u32 s14, s14, s13
buffer_load_dwordx4 v60, s[44:47], s14 offen lds
s_mov_b32 exec_hi, -1
s_add_u32 s12, s18, 20
s_lshl_b32 s12, s12, 10
v_add_u32 v31, s12, v2
ds_read_b128 v[52:55], v31
s_waitcnt lgkmcnt(1)
v_lshlrev_b32 v64, 16, v48
v_and_b32 v65, 0xffff0000, v48
v_lshlrev_b32 v66, 16, v49
v_and_b32 v67, 0xffff0000, v49
v_lshlrev_b32 v68, 16, v50
v_and_b32 v69, 0xffff0000, v50
v_lshlrev_b32 v70, 16, v51
v_and_b32 v71, 0xffff0000, v51
v_add_f32 v72, v64, v65
v_fmac_f32 v45, v64, v64
v_mul_f32 v73, v65, v65
v_add_f32 v74, v66, v67
v_fmac_f32 v45, v66, v66
v_fmac_f32 v73, v67, v67
v_add_f32 v72, v72, v74
v_add_f32 v74, v68, v69
v_fmac_f32 v45, v68, v68
v_fmac_f32 v73, v69, v69
v_add_f32 v72, v72, v74
v_add_f32 v74, v70, v71
v_fmac_f32 v45, v70, v70
v_fmac_f32 v73, v71, v71
v_add_f32 v72, v72, v74
v_add_f32 v44, v44, v72
v_add_f32 v45, v45, v73
s_waitcnt vmcnt(7)
s_add_u32 s12, s18, 56
s_mul_i32 s13, s12, 205
s_lshr_b32 s13, s13, 11
s_mul_i32 s14, s13, 10
s_sub_u32 s14, s12, s14
s_cmp_eq_u32 s14, 9
s_cselect_b32 exec_hi, 0xffffff, -1
s_mul_i32 s14, s14, 9216
s_lshl_b32 s13, s13, 7
s_lshl_b32 m0, s12, 10
s_add_u32 s14, s14, s13
buffer_load_dwordx4 v60, s[44:47], s14 offen lds
s_mov_b32 exec_hi, -1
s_add_u32 s12, s18, 24
s_lshl_b32 s12, s12, 10
v_add_u32 v31, s12, v2
ds_read_b128 v[48:51], v31
s_waitcnt lgkmcnt(1)
v_lshlrev_b32 v64, 16, v52
v_and_b32 v65, 0xffff0000, v52
v_lshlrev_b32 v66, 16, v53
v_and_b32 v67, 0xffff0000, v53
v_lshlrev_b32 v68, 16, v54
v_and_b32 v69, 0xffff0000, v54
v_lshlrev_b32 v70, 16, v55
v_and_b32 v71, 0xffff0000, v55
v_add_f32 v72, v64, v65
v_fmac_f32 v37, v64, v64
v_mul_f32 v73, v65, v65
v_add_f32 v74, v66, v67
v_fmac_f32 v37, v66, v66
v_fmac_f32 v73, v67, v67
v_add_f32 v72, v72, v74
v_add_f32 v74, v68, v69
v_fmac_f32 v37, v68, v68
v_fmac_f32 v73, v69, v69
v_add_f32 v72, v72, v74
v_add_f32 v74, v70, v71
v_fmac_f32 v37, v70, v70
v_fmac_f32 v73, v71, v71
v_add_f32 v72, v72, v74
v_add_f32 v36, v36, v72
v_add_f32 v37, v37, v73
s_waitcnt vmcnt(7)
v_mov_b32 v24, 3
ds_write_b32 v22, v24
s_add_u32 s12, s18, 60
s_mul_i32 s13, s12, 205
s_lshr_b32 s13, s13, 11
s_mul_i32 s14, s13, 10
s_sub_u32 s14, s12, s14
s_cmp_eq_u32 s14, 9
s_cselect_b32 exec_hi, 0xffffff, -1
s_mul_i32 s14, s14, 9216
s_lshl_b32 s13, s13, 7
s_lshl_b32 m0, s12, 10
s_add_u32 s14, s14, s13
buffer_load_dwordx4 v60, s[44:47], s14 offen lds
s_mov_b32 exec_hi, -1
s_add_u32 s12, s18, 28
s_lshl_b32 s12, s12, 10
v_add_u32 v31, s12, v2
ds_read_b128 v[52:55], v31
s_waitcnt lgkmcnt(2)
v_lshlrev_b32 v64, 16, v48
v_and_b32 v65, 0xffff0000, v48
v_lshlrev_b32 v66, 16, v49
v_and_b32 v67, 0xffff0000, v49
v_lshlrev_b32 v68, 16, v50
v_and_b32 v69, 0xffff0000, v50
v_lshlrev_b32 v70, 16, v51
v_and_b32 v71, 0xffff0000, v51
v_add_f32 v72, v64, v65
v_fmac_f32 v39, v64, v64
v_mul_f32 v73, v65, v65
v_add_f32 v74, v66, v67
v_fmac_f32 v39, v66, v66
v_fmac_f32 v73, v67, v67
v_add_f32 v72, v72, v74
v_add_f32 v74, v68, v69
v_fmac_f32 v39, v68, v68
v_fmac_f32 v73, v69, v69
v_add_f32 v72, v72, v74
v_add_f32 v74, v70, v71
v_fmac_f32 v39, v70, v70
v_fmac_f32 v73, v71, v71
v_add_f32 v72, v72, v74
v_add_f32 v38, v38, v72
v_add_f32 v39, v39, v73
s_waitcnt vmcnt(7)
s_add_u32 s12, s18, 64
s_mul_i32 s13, s12, 205
s_lshr_b32 s13, s13, 11
s_mul_i32 s14, s13, 10
s_sub_u32 s14, s12, s14
s_cmp_eq_u32 s14, 9
s_cselect_b32 exec_hi, 0xffffff, -1
s_mul_i32 s14, s14, 9216
s_lshl_b32 s13, s13, 7
s_lshl_b32 m0, s12, 10
s_add_u32 s14, s14, s13
buffer_load_dwordx4 v60, s[44:47], s14 offen lds
s_mov_b32 exec_hi, -1
s_add_u32 s12, s18, 32
s_lshl_b32 s12, s12, 10
v_add_u32 v31, s12, v2
ds_read_b128 v[48:51], v31
s_waitcnt lgkmcnt(1)
v_lshlrev_b32 v64, 16, v52
v_and_b32 v65, 0xffff0000, v52
v_lshlrev_b32 v66, 16, v53
v_and_b32 v67, 0xffff0000, v53
v_lshlrev_b32 v68, 16, v54
v_and_b32 v69, 0xffff0000, v54
v_lshlrev_b32 v70, 16, v55
v_and_b32 v71, 0xffff0000, v55
v_add_f32 v72, v64, v65
v_fmac_f32 v41, v64, v64
v_mul_f32 v73, v65, v65
v_add_f32 v74, v66, v67
v_fmac_f32 v41, v66, v66
v_fmac_f32 v73, v67, v67
v_add_f32 v72, v72, v74
v_add_f32 v74, v68, v69
v_fmac_f32 v41, v68, v68
v_fmac_f32 v73, v69, v69
v_add_f32 v72, v72, v74
v_add_f32 v74, v70, v71
v_fmac_f32 v41, v70, v70
v_fmac_f32 v73, v71, v71
v_add_f32 v72, v72, v74
v_add_f32 v40, v40, v72
v_add_f32 v41, v41, v73
s_waitcnt vmcnt(7)
v_mov_b32 v24, 4
ds_write_b32 v22, v24
s_add_u32 s12, s18, 68
s_mul_i32 s13, s12, 205
s_lshr_b32 s13, s13, 11
s_mul_i32 s14, s13, 10
s_sub_u32 s14, s12, s14
s_cmp_eq_u32 s14, 9
s_cselect_b32 exec_hi, 0xffffff, -1
s_mul_i32 s14, s14, 9216
s_lshl_b32 s13, s13, 7
s_lshl_b32 m0, s12, 10
s_add_u32 s14, s14, s13
buffer_load_dwordx4 v60, s[44:47], s14 offen lds
s_mov_b32 exec_hi, -1
s_add_u32 s12, s18, 36
s_lshl_b32 s12, s12, 10
v_add_u32 v31, s12, v2
ds_read_b128 v[52:55], v31
s_waitcnt lgkmcnt(2)
v_lshlrev_b32 v64, 16, v48
v_and_b32 v65, 0xffff0000, v48
v_lshlrev_b32 v66, 16, v49
v_and_b32 v67, 0xffff0000, v49
v_lshlrev_b32 v68, 16, v50
v_and_b32 v69, 0xffff0000, v50
v_lshlrev_b32 v70, 16, v51
v_and_b32 v71, 0xffff0000, v51
v_add_f32 v72, v64, v65
v_fmac_f32 v43, v64, v64
v_mul_f32 v73, v65, v65
v_add_f32 v74, v66, v67
v_fmac_f32 v43, v66, v66
v_fmac_f32 v73, v67, v67
v_add_f32 v72, v72, v74
v_add_f32 v74, v68, v69
v_fmac_f32 v43, v68, v68
v_fmac_f32 v73, v69, v69
v_add_f32 v72, v72, v74
v_add_f32 v74, v70, v71
v_fmac_f32 v43, v70, v70
v_fmac_f32 v73, v71, v71
v_add_f32 v72, v72, v74
v_add_f32 v42, v42, v72
v_add_f32 v43, v43, v73
s_waitcnt vmcnt(7)
s_add_u32 s12, s18, 72
s_mul_i32 s13, s12, 205
s_lshr_b32 s13, s13, 11
s_mul_i32 s14, s13, 10
s_sub_u32 s14, s12, s14
s_cmp_eq_u32 s14, 9
s_cselect_b32 exec_hi, 0xffffff, -1
s_mul_i32 s14, s14, 9216
s_lshl_b32 s13, s13, 7
s_lshl_b32 m0, s12, 10
s_add_u32 s14, s14, s13
buffer_load_dwordx4 v60, s[44:47], s14 offen lds
s_mov_b32 exec_hi, -1
s_add_u32 s12, s18, 40
s_lshl_b32 s12, s12, 10
v_add_u32 v31, s12, v2
ds_read_b128 v[48:51], v31
s_waitcnt lgkmcnt(1)
v_lshlrev_b32 v64, 16, v52
v_and_b32 v65, 0xffff0000, v52
v_lshlrev_b32 v66, 16, v53
v_and_b32 v67, 0xffff0000, v53
v_lshlrev_b32 v68, 16, v54
v_and_b32 v69, 0xffff0000, v54
v_lshlrev_b32 v70, 16, v55
v_and_b32 v71, 0xffff0000, v55
v_add_f32 v72, v64, v65
v_fmac_f32 v45, v64, v64
v_mul_f32 v73, v65, v65
v_add_f32 v74, v66, v67
v_fmac_f32 v45, v66, v66
v_fmac_f32 v73, v67, v67
v_add_f32 v72, v72, v74
v_add_f32 v74, v68, v69
v_fmac_f32 v45, v68, v68
v_fmac_f32 v73, v69, v69
v_add_f32 v72, v72, v74
v_add_f32 v74, v70, v71
v_fmac_f32 v45, v70, v70
v_fmac_f32 v73, v71, v71
v_add_f32 v72, v72, v74
v_add_f32 v44, v44, v72
v_add_f32 v45, v45, v73
s_waitcnt vmcnt(7)
s_add_u32 s12, s18, 76
s_mul_i32 s13, s12, 205
s_lshr_b32 s13, s13, 11
s_mul_i32 s14, s13, 10
s_sub_u32 s14, s12, s14
s_cmp_eq_u32 s14, 9
s_cselect_b32 exec_hi, 0xffffff, -1
s_mul_i32 s14, s14, 9216
s_lshl_b32 s13, s13, 7
s_lshl_b32 m0, s12, 10
s_add_u32 s14, s14, s13
buffer_load_dwordx4 v60, s[44:47], s14 offen lds
s_mov_b32 exec_hi, -1
s_add_u32 s12, s18, 44
s_lshl_b32 s12, s12, 10
v_add_u32 v31, s12, v2
ds_read_b128 v[52:55], v31
s_waitcnt lgkmcnt(1)
v_lshlrev_b32 v64, 16, v48
v_and_b32 v65, 0xffff0000, v48
v_lshlrev_b32 v66, 16, v49
v_and_b32 v67, 0xffff0000, v49
v_lshlrev_b32 v68, 16, v50
v_and_b32 v69, 0xffff0000, v50
v_lshlrev_b32 v70, 16, v51
v_and_b32 v71, 0xffff0000, v51
v_add_f32 v72, v64, v65
v_fmac_f32 v37, v64, v64
v_mul_f32 v73, v65, v65
v_add_f32 v74, v66, v67
v_fmac_f32 v37, v66, v66
v_fmac_f32 v73, v67, v67
v_add_f32 v72, v72, v74
v_add_f32 v74, v68, v69
v_fmac_f32 v37, v68, v68
v_fmac_f32 v73, v69, v69
v_add_f32 v72, v72, v74
v_add_f32 v74, v70, v71
v_fmac_f32 v37, v70, v70
v_fmac_f32 v73, v71, v71
v_add_f32 v72, v72, v74
v_add_f32 v36, v36, v72
v_add_f32 v37, v37, v73
s_waitcnt vmcnt(7)
v_mov_b32 v24, 5
ds_write_b32 v22, v24
s_add_u32 s12, s18, 80
s_mul_i32 s13, s12, 205
s_lshr_b32 s13, s13, 11
s_mul_i32 s14, s13, 10
s_sub_u32 s14, s12, s14
s_cmp_eq_u32 s14, 9
s_cselect_b32 exec_hi, 0xffffff, -1
s_mul_i32 s14, s14, 9216
s_lshl_b32 s13, s13, 7
s_lshl_b32 m0, s12, 10
s_add_u32 s14, s14, s13
buffer_load_dwordx4 v60, s[44:47], s14 offen lds
s_mov_b32 exec_hi, -1
s_add_u32 s12, s18, 48
s_lshl_b32 s12, s12, 10
v_add_u32 v31, s12, v2
ds_read_b128 v[48:51], v31
s_waitcnt lgkmcnt(2)
v_lshlrev_b32 v64, 16, v52
v_and_b32 v65, 0xffff0000, v52
v_lshlrev_b32 v66, 16, v53
v_and_b32 v67, 0xffff0000, v53
v_lshlrev_b32 v68, 16, v54
v_and_b32 v69, 0xffff0000, v54
v_lshlrev_b32 v70, 16, v55
v_and_b32 v71, 0xffff0000, v55
v_add_f32 v72, v64, v65
v_fmac_f32 v39, v64, v64
v_mul_f32 v73, v65, v65
v_add_f32 v74, v66, v67
v_fmac_f32 v39, v66, v66
v_fmac_f32 v73, v67, v67
v_add_f32 v72, v72, v74
v_add_f32 v74, v68, v69
v_fmac_f32 v39, v68, v68
v_fmac_f32 v73, v69, v69
v_add_f32 v72, v72, v74
v_add_f32 v74, v70, v71
v_fmac_f32 v39, v70, v70
v_fmac_f32 v73, v71, v71
v_add_f32 v72, v72, v74
v_add_f32 v38, v38, v72
v_add_f32 v39, v39, v73
s_waitcnt vmcnt(7)
s_add_u32 s12, s18, 84
s_mul_i32 s13, s12, 205
s_lshr_b32 s13, s13, 11
s_mul_i32 s14, s13, 10
s_sub_u32 s14, s12, s14
s_cmp_eq_u32 s14, 9
s_cselect_b32 exec_hi, 0xffffff, -1
s_mul_i32 s14, s14, 9216
s_lshl_b32 s13, s13, 7
s_lshl_b32 m0, s12, 10
s_add_u32 s14, s14, s13
buffer_load_dwordx4 v60, s[44:47], s14 offen lds
s_mov_b32 exec_hi, -1
s_add_u32 s12, s18, 52
s_lshl_b32 s12, s12, 10
v_add_u32 v31, s12, v2
ds_read_b128 v[52:55], v31
s_waitcnt lgkmcnt(1)
v_lshlrev_b32 v64, 16, v48
v_and_b32 v65, 0xffff0000, v48
v_lshlrev_b32 v66, 16, v49
v_and_b32 v67, 0xffff0000, v49
v_lshlrev_b32 v68, 16, v50
v_and_b32 v69, 0xffff0000, v50
v_lshlrev_b32 v70, 16, v51
v_and_b32 v71, 0xffff0000, v51
v_add_f32 v72, v64, v65
v_fmac_f32 v41, v64, v64
v_mul_f32 v73, v65, v65
v_add_f32 v74, v66, v67
v_fmac_f32 v41, v66, v66
v_fmac_f32 v73, v67, v67
v_add_f32 v72, v72, v74
v_add_f32 v74, v68, v69
v_fmac_f32 v41, v68, v68
v_fmac_f32 v73, v69, v69
v_add_f32 v72, v72, v74
v_add_f32 v74, v70, v71
v_fmac_f32 v41, v70, v70
v_fmac_f32 v73, v71, v71
v_add_f32 v72, v72, v74
v_add_f32 v40, v40, v72
v_add_f32 v41, v41, v73
s_waitcnt vmcnt(7)
v_mov_b32 v24, 6
ds_write_b32 v22, v24
s_add_u32 s12, s18, 88
s_cmp_ge_u32 s12, 90
s_cselect_b32 s13, 4, 0
s_sub_u32 s12, s12, s13
s_mul_i32 s13, s12, 205
s_lshr_b32 s13, s13, 11
s_mul_i32 s14, s13, 10
s_sub_u32 s14, s12, s14
s_cmp_eq_u32 s14, 9
s_cselect_b32 exec_hi, 0xffffff, -1
s_mul_i32 s14, s14, 9216
s_lshl_b32 s13, s13, 7
s_lshl_b32 m0, s12, 10
s_add_u32 s14, s14, s13
buffer_load_dwordx4 v60, s[44:47], s14 offen lds
s_mov_b32 exec_hi, -1
s_add_u32 s12, s18, 56
s_lshl_b32 s12, s12, 10
v_add_u32 v31, s12, v2
ds_read_b128 v[48:51], v31
s_waitcnt lgkmcnt(2)
v_lshlrev_b32 v64, 16, v52
v_and_b32 v65, 0xffff0000, v52
v_lshlrev_b32 v66, 16, v53
v_and_b32 v67, 0xffff0000, v53
v_lshlrev_b32 v68, 16, v54
v_and_b32 v69, 0xffff0000, v54
v_lshlrev_b32 v70, 16, v55
v_and_b32 v71, 0xffff0000, v55
v_add_f32 v72, v64, v65
v_fmac_f32 v43, v64, v64
v_mul_f32 v73, v65, v65
v_add_f32 v74, v66, v67
v_fmac_f32 v43, v66, v66
v_fmac_f32 v73, v67, v67
v_add_f32 v72, v72, v74
v_add_f32 v74, v68, v69
v_fmac_f32 v43, v68, v68
v_fmac_f32 v73, v69, v69
v_add_f32 v72, v72, v74
v_add_f32 v74, v70, v71
v_fmac_f32 v43, v70, v70
v_fmac_f32 v73, v71, v71
v_add_f32 v72, v72, v74
v_add_f32 v42, v42, v72
v_add_f32 v43, v43, v73
s_waitcnt vmcnt(7)
v_lshrrev_b32 v31, 4, v1
s_mul_i32 s7, s4, 1152
v_lshl_add_u32 v29, v31, 3, s7
s_lshl_b32 s8, s3, 7
buffer_load_dwordx2 v[216:217], v29, s[56:59], s8 offen offset:0
buffer_load_dwordx2 v[218:219], v29, s[56:59], s8 offen offset:32
buffer_load_dwordx2 v[220:221], v29, s[56:59], s8 offen offset:64
buffer_load_dwordx2 v[222:223], v29, s[56:59], s8 offen offset:96
s_lshl_b32 s8, s18, 5
buffer_load_dwordx2 v[224:225], v29, s[56:59], s8 offen offset:1024
s_mul_i32 s7, s18, 728
s_mul_i32 s8, s5, 28
s_add_u32 s7, s7, s8
v_add_u32 v28, s7, v1
v_mul_u32_u24 v29, 13108, v28
v_lshrrev_b32 v29, 16, v29
v_mul_u32_u24 v30, 5, v29
v_sub_u32 v30, v28, v30
v_mul_u32_u24 v29, 9216, v29
v_lshl_add_u32 v29, v30, 7, v29
s_mul_i32 s7, s4, 1152
s_add_u32 s7, s7, 512
s_mov_b64 exec, 0xfffffff
buffer_load_dword v26, v29, s[48:51], s7 offen
s_mov_b64 exec, -1
s_add_u32 s12, s18, 60
s_lshl_b32 s12, s12, 10
v_add_u32 v31, s12, v2
ds_read_b128 v[52:55], v31
s_waitcnt lgkmcnt(1)
v_lshlrev_b32 v64, 16, v48
v_and_b32 v65, 0xffff0000, v48
v_lshlrev_b32 v66, 16, v49
v_and_b32 v67, 0xffff0000, v49
v_lshlrev_b32 v68, 16, v50
v_and_b32 v69, 0xffff0000, v50
v_lshlrev_b32 v70, 16, v51
v_and_b32 v71, 0xffff0000, v51
v_add_f32 v72, v64, v65
v_fmac_f32 v45, v64, v64
v_mul_f32 v73, v65, v65
v_add_f32 v74, v66, v67
v_fmac_f32 v45, v66, v66
v_fmac_f32 v73, v67, v67
v_add_f32 v72, v72, v74
v_add_f32 v74, v68, v69
v_fmac_f32 v45, v68, v68
v_fmac_f32 v73, v69, v69
v_add_f32 v72, v72, v74
v_add_f32 v74, v70, v71
v_fmac_f32 v45, v70, v70
v_fmac_f32 v73, v71, v71
v_add_f32 v72, v72, v74
v_add_f32 v44, v44, v72
v_add_f32 v45, v45, v73
s_waitcnt vmcnt(12)
s_add_u32 s12, s18, 64
s_lshl_b32 s12, s12, 10
v_add_u32 v31, s12, v2
ds_read_b128 v[48:51], v31
s_waitcnt lgkmcnt(1)
v_lshlrev_b32 v64, 16, v52
v_and_b32 v65, 0xffff0000, v52
v_lshlrev_b32 v66, 16, v53
v_and_b32 v67, 0xffff0000, v53
v_lshlrev_b32 v68, 16, v54
v_and_b32 v69, 0xffff0000, v54
v_lshlrev_b32 v70, 16, v55
v_and_b32 v71, 0xffff0000, v55
v_add_f32 v72, v64, v65
v_fmac_f32 v37, v64, v64
v_mul_f32 v73, v65, v65
v_add_f32 v74, v66, v67
v_fmac_f32 v37, v66, v66
v_fmac_f32 v73, v67, v67
v_add_f32 v72, v72, v74
v_add_f32 v74, v68, v69
v_fmac_f32 v37, v68, v68
v_fmac_f32 v73, v69, v69
v_add_f32 v72, v72, v74
v_add_f32 v74, v70, v71
v_fmac_f32 v37, v70, v70
v_fmac_f32 v73, v71, v71
v_add_f32 v72, v72, v74
v_add_f32 v36, v36, v72
v_add_f32 v37, v37, v73
s_waitcnt vmcnt(11)
v_mov_b32 v24, 7
ds_write_b32 v22, v24
s_add_u32 s12, s18, 68
s_lshl_b32 s12, s12, 10
v_add_u32 v31, s12, v2
ds_read_b128 v[52:55], v31
s_waitcnt lgkmcnt(2)
v_lshlrev_b32 v64, 16, v48
v_and_b32 v65, 0xffff0000, v48
v_lshlrev_b32 v66, 16, v49
v_and_b32 v67, 0xffff0000, v49
v_lshlrev_b32 v68, 16, v50
v_and_b32 v69, 0xffff0000, v50
v_lshlrev_b32 v70, 16, v51
v_and_b32 v71, 0xffff0000, v51
v_add_f32 v72, v64, v65
v_fmac_f32 v39, v64, v64
v_mul_f32 v73, v65, v65
v_add_f32 v74, v66, v67
v_fmac_f32 v39, v66, v66
v_fmac_f32 v73, v67, v67
v_add_f32 v72, v72, v74
v_add_f32 v74, v68, v69
v_fmac_f32 v39, v68, v68
v_fmac_f32 v73, v69, v69
v_add_f32 v72, v72, v74
v_add_f32 v74, v70, v71
v_fmac_f32 v39, v70, v70
v_fmac_f32 v73, v71, v71
v_add_f32 v72, v72, v74
v_add_f32 v38, v38, v72
v_add_f32 v39, v39, v73
s_waitcnt vmcnt(10)
s_add_u32 s12, s18, 72
s_lshl_b32 s12, s12, 10
v_add_u32 v31, s12, v2
ds_read_b128 v[48:51], v31
s_waitcnt lgkmcnt(1)
v_lshlrev_b32 v64, 16, v52
v_and_b32 v65, 0xffff0000, v52
v_lshlrev_b32 v66, 16, v53
v_and_b32 v67, 0xffff0000, v53
v_lshlrev_b32 v68, 16, v54
v_and_b32 v69, 0xffff0000, v54
v_lshlrev_b32 v70, 16, v55
v_and_b32 v71, 0xffff0000, v55
v_add_f32 v72, v64, v65
v_fmac_f32 v41, v64, v64
v_mul_f32 v73, v65, v65
v_add_f32 v74, v66, v67
v_fmac_f32 v41, v66, v66
v_fmac_f32 v73, v67, v67
v_add_f32 v72, v72, v74
v_add_f32 v74, v68, v69
v_fmac_f32 v41, v68, v68
v_fmac_f32 v73, v69, v69
v_add_f32 v72, v72, v74
v_add_f32 v74, v70, v71
v_fmac_f32 v41, v70, v70
v_fmac_f32 v73, v71, v71
v_add_f32 v72, v72, v74
v_add_f32 v40, v40, v72
v_add_f32 v41, v41, v73
s_waitcnt vmcnt(9)
v_mov_b32 v24, 8
ds_write_b32 v22, v24
s_add_u32 s12, s18, 76
s_lshl_b32 s12, s12, 10
v_add_u32 v31, s12, v2
ds_read_b128 v[52:55], v31
s_waitcnt lgkmcnt(2)
v_lshlrev_b32 v64, 16, v48
v_and_b32 v65, 0xffff0000, v48
v_lshlrev_b32 v66, 16, v49
v_and_b32 v67, 0xffff0000, v49
v_lshlrev_b32 v68, 16, v50
v_and_b32 v69, 0xffff0000, v50
v_lshlrev_b32 v70, 16, v51
v_and_b32 v71, 0xffff0000, v51
v_add_f32 v72, v64, v65
v_fmac_f32 v43, v64, v64
v_mul_f32 v73, v65, v65
v_add_f32 v74, v66, v67
v_fmac_f32 v43, v66, v66
v_fmac_f32 v73, v67, v67
v_add_f32 v72, v72, v74
v_add_f32 v74, v68, v69
v_fmac_f32 v43, v68, v68
v_fmac_f32 v73, v69, v69
v_add_f32 v72, v72, v74
v_add_f32 v74, v70, v71
v_fmac_f32 v43, v70, v70
v_fmac_f32 v73, v71, v71
v_add_f32 v72, v72, v74
v_add_f32 v42, v42, v72
v_add_f32 v43, v43, v73
s_waitcnt vmcnt(8)
s_add_u32 s12, s18, 80
s_lshl_b32 s12, s12, 10
v_add_u32 v31, s12, v2
ds_read_b128 v[48:51], v31
s_waitcnt lgkmcnt(1)
v_lshlrev_b32 v64, 16, v52
v_and_b32 v65, 0xffff0000, v52
v_lshlrev_b32 v66, 16, v53
v_and_b32 v67, 0xffff0000, v53
v_lshlrev_b32 v68, 16, v54
v_and_b32 v69, 0xffff0000, v54
v_lshlrev_b32 v70, 16, v55
v_and_b32 v71, 0xffff0000, v55
v_add_f32 v72, v64, v65
v_fmac_f32 v45, v64, v64
v_mul_f32 v73, v65, v65
v_add_f32 v74, v66, v67
v_fmac_f32 v45, v66, v66
v_fmac_f32 v73, v67, v67
v_add_f32 v72, v72, v74
v_add_f32 v74, v68, v69
v_fmac_f32 v45, v68, v68
v_fmac_f32 v73, v69, v69
v_add_f32 v72, v72, v74
v_add_f32 v74, v70, v71
v_fmac_f32 v45, v70, v70
v_fmac_f32 v73, v71, v71
v_add_f32 v72, v72, v74
v_add_f32 v44, v44, v72
v_add_f32 v45, v45, v73
s_waitcnt vmcnt(7)
s_add_u32 s12, s18, 84
s_lshl_b32 s12, s12, 10
v_add_u32 v31, s12, v2
ds_read_b128 v[52:55], v31
s_waitcnt lgkmcnt(1)
v_lshlrev_b32 v64, 16, v48
v_and_b32 v65, 0xffff0000, v48
v_lshlrev_b32 v66, 16, v49
v_and_b32 v67, 0xffff0000, v49
v_lshlrev_b32 v68, 16, v50
v_and_b32 v69, 0xffff0000, v50
v_lshlrev_b32 v70, 16, v51
v_and_b32 v71, 0xffff0000, v51
v_add_f32 v72, v64, v65
v_fmac_f32 v37, v64, v64
v_mul_f32 v73, v65, v65
v_add_f32 v74, v66, v67
v_fmac_f32 v37, v66, v66
v_fmac_f32 v73, v67, v67
v_add_f32 v72, v72, v74
v_add_f32 v74, v68, v69
v_fmac_f32 v37, v68, v68
v_fmac_f32 v73, v69, v69
v_add_f32 v72, v72, v74
v_add_f32 v74, v70, v71
v_fmac_f32 v37, v70, v70
v_fmac_f32 v73, v71, v71
v_add_f32 v72, v72, v74
v_add_f32 v36, v36, v72
v_add_f32 v37, v37, v73
s_waitcnt vmcnt(6)
v_mov_b32 v24, 9
ds_write_b32 v22, v24
s_add_u32 s12, s18, 88
s_cmp_ge_u32 s12, 90
s_cselect_b32 s13, 4, 0
s_sub_u32 s12, s12, s13
s_lshl_b32 s12, s12, 10
v_add_u32 v31, s12, v2
ds_read_b128 v[48:51], v31
s_waitcnt lgkmcnt(2)
v_lshlrev_b32 v64, 16, v52
v_and_b32 v65, 0xffff0000, v52
v_lshlrev_b32 v66, 16, v53
v_and_b32 v67, 0xffff0000, v53
v_lshlrev_b32 v68, 16, v54
v_and_b32 v69, 0xffff0000, v54
v_lshlrev_b32 v70, 16, v55
v_and_b32 v71, 0xffff0000, v55
v_add_f32 v72, v64, v65
v_fmac_f32 v39, v64, v64
v_mul_f32 v73, v65, v65
v_add_f32 v74, v66, v67
v_fmac_f32 v39, v66, v66
v_fmac_f32 v73, v67, v67
v_add_f32 v72, v72, v74
v_add_f32 v74, v68, v69
v_fmac_f32 v39, v68, v68
v_fmac_f32 v73, v69, v69
v_add_f32 v72, v72, v74
v_add_f32 v74, v70, v71
v_fmac_f32 v39, v70, v70
v_fmac_f32 v73, v71, v71
v_add_f32 v72, v72, v74
v_add_f32 v38, v38, v72
v_add_f32 v39, v39, v73
s_waitcnt lgkmcnt(0)
s_cmp_ge_u32 s18, 2
s_cbranch_scc1 Lst22
v_lshlrev_b32 v64, 16, v48
v_and_b32 v65, 0xffff0000, v48
v_lshlrev_b32 v66, 16, v49
v_and_b32 v67, 0xffff0000, v49
v_lshlrev_b32 v68, 16, v50
v_and_b32 v69, 0xffff0000, v50
v_lshlrev_b32 v70, 16, v51
v_and_b32 v71, 0xffff0000, v51
v_add_f32 v72, v64, v65
v_fmac_f32 v41, v64, v64
v_mul_f32 v73, v65, v65
v_add_f32 v74, v66, v67
v_fmac_f32 v41, v66, v66
v_fmac_f32 v73, v67, v67
v_add_f32 v72, v72, v74
v_add_f32 v74, v68, v69
v_fmac_f32 v41, v68, v68
v_fmac_f32 v73, v69, v69
v_add_f32 v72, v72, v74
v_add_f32 v74, v70, v71
v_fmac_f32 v41, v70, v70
v_fmac_f32 v73, v71, v71
v_add_f32 v72, v72, v74
v_add_f32 v40, v40, v72
v_add_f32 v41, v41, v73
Lst22:
s_nop 2
v_add_f32_dpp v36, v36, v36 quad_perm:[1,0,3,2] row_mask:0xf bank_mask:0xf
v_add_f32_dpp v37, v37, v37 quad_perm:[1,0,3,2] row_mask:0xf bank_mask:0xf
v_add_f32_dpp v38, v38, v38 quad_perm:[1,0,3,2] row_mask:0xf bank_mask:0xf
v_add_f32_dpp v39, v39, v39 quad_perm:[1,0,3,2] row_mask:0xf bank_mask:0xf
v_add_f32_dpp v40, v40, v40 quad_perm:[1,0,3,2] row_mask:0xf bank_mask:0xf
v_add_f32_dpp v41, v41, v41 quad_perm:[1,0,3,2] row_mask:0xf bank_mask:0xf
v_add_f32_dpp v42, v42, v42 quad_perm:[1,0,3,2] row_mask:0xf bank_mask:0xf
v_add_f32_dpp v43, v43, v43 quad_perm:[1,0,3,2] row_mask:0xf bank_mask:0xf
v_add_f32_dpp v44, v44, v44 quad_perm:[1,0,3,2] row_mask:0xf bank_mask:0xf
v_add_f32_dpp v45, v45, v45 quad_perm:[1,0,3,2] row_mask:0xf bank_mask:0xf
v_add_f32_dpp v36, v36, v36 quad_perm:[2,3,0,1] row_mask:0xf bank_mask:0xf
v_add_f32_dpp v37, v37, v37 quad_perm:[2,3,0,1] row_mask:0xf bank_mask:0xf
v_add_f32_dpp v38, v38, v38 quad_perm:[2,3,0,1] row_mask:0xf bank_mask:0xf
v_add_f32_dpp v39, v39, v39 quad_perm:[2,3,0,1] row_mask:0xf bank_mask:0xf
v_add_f32_dpp v40, v40, v40 quad_perm:[2,3,0,1] row_mask:0xf bank_mask:0xf
v_add_f32_dpp v41, v41, v41 quad_perm:[2,3,0,1] row_mask:0xf bank_mask:0xf
v_add_f32_dpp v42, v42, v42 quad_perm:[2,3,0,1] row_mask:0xf bank_mask:0xf
v_add_f32_dpp v43, v43, v43 quad_perm:[2,3,0,1] row_mask:0xf bank_mask:0xf
v_add_f32_dpp v44, v44, v44 quad_perm:[2,3,0,1] row_mask:0xf bank_mask:0xf
v_add_f32_dpp v45, v45, v45 quad_perm:[2,3,0,1] row_mask:0xf bank_mask:0xf
v_add_f32_dpp v36, v36, v36 row_half_mirror row_mask:0xf bank_mask:0xf
v_add_f32_dpp v37, v37, v37 row_half_mirror row_mask:0xf bank_mask:0xf
v_add_f32_dpp v38, v38, v38 row_half_mirror row_mask:0xf bank_mask:0xf
v_add_f32_dpp v39, v39, v39 row_half_mirror row_mask:0xf bank_mask:0xf
v_add_f32_dpp v40, v40, v40 row_half_mirror row_mask:0xf bank_mask:0xf
v_add_f32_dpp v41, v41, v41 row_half_mirror row_mask:0xf bank_mask:0xf
v_add_f32_dpp v42, v42, v42 row_half_mirror row_mask:0xf bank_mask:0xf
v_add_f32_dpp v43, v43, v43 row_half_mirror row_mask:0xf bank_mask:0xf
v_add_f32_dpp v44, v44, v44 row_half_mirror row_mask:0xf bank_mask:0xf
v_add_f32_dpp v45, v45, v45 row_half_mirror row_mask:0xf bank_mask:0xf
v_lshrrev_b32 v28, 3, v1
v_lshlrev_b32 v28, 4, v28
s_lshr_b32 s7, s18, 1
s_lshl_b32 s7, s7, 3
s_add_u32 s7, s7, 161792
v_add_u32 v28, s7, v28
s_add_u32 s12, s18, 0
s_cmp_ge_u32 s12, 10
s_cselect_b32 s13, 10, 0
s_sub_u32 s12, s12, s13
s_lshl_b32 s12, s12, 7
v_add_u32 v29, s12, v28
ds_write_b64 v29, v[36:37]
s_add_u32 s12, s18, 4
s_cmp_ge_u32 s12, 10
s_cselect_b32 s13, 10, 0
s_sub_u32 s12, s12, s13
s_lshl_b32 s12, s12, 7
v_add_u32 v29, s12, v28
ds_write_b64 v29, v[38:39]
s_add_u32 s12, s18, 8
s_cmp_ge_u32 s12, 10
s_cselect_b32 s13, 10, 0
s_sub_u32 s12, s12, s13
s_lshl_b32 s12, s12, 7
v_add_u32 v29, s12, v28
ds_write_b64 v29, v[40:41]
s_add_u32 s12, s18, 12
s_cmp_ge_u32 s12, 10
s_cselect_b32 s13, 10, 0
s_sub_u32 s12, s12, s13
s_lshl_b32 s12, s12, 7
v_add_u32 v29, s12, v28
ds_write_b64 v29, v[42:43]
s_add_u32 s12, s18, 16
s_cmp_ge_u32 s12, 10
s_cselect_b32 s13, 10, 0
s_sub_u32 s12, s12, s13
s_lshl_b32 s12, s12, 7
v_add_u32 v29, s12, v28
ds_write_b64 v29, v[44:45]
s_waitcnt lgkmcnt(0)
v_mov_b32 v24, 10
ds_write_b32 v22, v24
v_mov_b32 v112, -1
v_mov_b32 v113, -1
v_mov_b32 v114, -1
v_mov_b32 v115, -1
s_add_u32 s64, s4, 2
s_and_b32 s64, s64, 7
s_mul_i32 s64, s64, 2396160
s_add_u32 s65, s4, 4
s_and_b32 s65, s65, 7
s_mul_i32 s65, s65, 2396160
s_add_u32 s66, s4, 6
s_and_b32 s66, s66, 7
s_mul_i32 s66, s66, 2396160
s_add_u32 s13, s18, 0
s_lshl_b32 s14, s23, 1
s_cmp_ge_u32 s13, 5
s_cselect_b32 s7, 5, 0
s_addc_u32 s14, s14, 0
s_sub_u32 s15, s13, s7
s_mul_i32 s12, s5, 5
s_add_u32 s12, s12, s15
s_mul_i32 s12, s12, 18432
s_lshl_b32 s8, s14, 10
s_add_u32 s12, s12, s8
s_add_u32 s7, s12, s64
buffer_store_dwordx4 v[112:115], v2, s[60:63], s7 offen sc1
s_add_u32 s7, s12, s65
buffer_store_dwordx4 v[112:115], v2, s[60:63], s7 offen sc1
s_add_u32 s7, s12, s66
buffer_store_dwordx4 v[112:115], v2, s[60:63], s7 offen sc1
s_add_u32 s13, s18, 4
s_lshl_b32 s14, s23, 1
s_cmp_ge_u32 s13, 5
s_cselect_b32 s7, 5, 0
s_addc_u32 s14, s14, 0
s_sub_u32 s15, s13, s7
s_mul_i32 s12, s5, 5
s_add_u32 s12, s12, s15
s_mul_i32 s12, s12, 18432
s_lshl_b32 s8, s14, 10
s_add_u32 s12, s12, s8
s_add_u32 s7, s12, s64
buffer_store_dwordx4 v[112:115], v2, s[60:63], s7 offen sc1
s_add_u32 s7, s12, s65
buffer_store_dwordx4 v[112:115], v2, s[60:63], s7 offen sc1
s_add_u32 s7, s12, s66
buffer_store_dwordx4 v[112:115], v2, s[60:63], s7 offen sc1
s_add_u32 s13, s18, 8
s_lshl_b32 s14, s23, 1
s_cmp_ge_u32 s13, 5
s_cselect_b32 s7, 5, 0
s_addc_u32 s14, s14, 0
s_sub_u32 s15, s13, s7
s_mul_i32 s12, s5, 5
s_add_u32 s12, s12, s15
s_mul_i32 s12, s12, 18432
s_lshl_b32 s8, s14, 10
s_add_u32 s12, s12, s8
s_cmp_ge_u32 s13, 10
s_cselect_b32 s12, 0x40000000, s12
s_add_u32 s7, s12, s64
buffer_store_dwordx4 v[112:115], v2, s[60:63], s7 offen sc1
s_add_u32 s7, s12, s65
buffer_store_dwordx4 v[112:115], v2, s[60:63], s7 offen sc1
s_add_u32 s7, s12, s66
buffer_store_dwordx4 v[112:115], v2, s[60:63], s7 offen sc1
ds_read_b32 v27, v21
s_waitcnt lgkmcnt(0)
v_cmp_gt_u32 vcc, 10, v27
s_cbranch_vccnz LwQst
LrQst:
v_and_b32 v28, 15, v1
v_lshlrev_b32 v28, 4, v28
v_add_u32 v28, 161792, v28
ds_read_b128 v[56:59], v28 offset:0
ds_read_b128 v[60:63], v28 offset:256
ds_read_b128 v[64:67], v28 offset:512
ds_read_b128 v[68:71], v28 offset:768
ds_read_b128 v[72:75], v28 offset:1024
s_waitcnt lgkmcnt(4)
v_add_f32 v56, v56, v58
v_add_f32 v57, v57, v59
v_mul_f32 v56, 0x3ae38e39, v56
v_mul_f32 v57, 0x3ae38e39, v57
v_fma_f32 v57, -v56, v56, v57
v_max_f32 v57, 0, v57
v_cvt_pk_bf16_f32 v58, v56, v57
v_and_b32 v57, 0xffff0000, v58
v_add_f32 v57, 0x3727c5ac, v57
v_cvt_pk_bf16_f32 v57, v57, v57
v_and_b32 v57, 0xffff0000, v57
v_sqrt_f32 v57, v57
v_lshlrev_b32 v233, 16, v58
v_cvt_pk_bf16_f32 v57, v57, v57
v_and_b32 v57, 0xffff0000, v57
v_rcp_f32 v228, v57
s_waitcnt lgkmcnt(3)
v_add_f32 v60, v60, v62
v_add_f32 v61, v61, v63
v_mul_f32 v60, 0x3ae38e39, v60
v_mul_f32 v61, 0x3ae38e39, v61
v_fma_f32 v61, -v60, v60, v61
v_max_f32 v61, 0, v61
v_cvt_pk_bf16_f32 v62, v60, v61
v_and_b32 v61, 0xffff0000, v62
v_add_f32 v61, 0x3727c5ac, v61
v_cvt_pk_bf16_f32 v61, v61, v61
v_and_b32 v61, 0xffff0000, v61
v_sqrt_f32 v61, v61
v_lshlrev_b32 v234, 16, v62
v_cvt_pk_bf16_f32 v61, v61, v61
v_and_b32 v61, 0xffff0000, v61
v_rcp_f32 v229, v61
s_waitcnt lgkmcnt(2)
v_add_f32 v64, v64, v66
v_add_f32 v65, v65, v67
v_mul_f32 v64, 0x3ae38e39, v64
v_mul_f32 v65, 0x3ae38e39, v65
v_fma_f32 v65, -v64, v64, v65
v_max_f32 v65, 0, v65
v_cvt_pk_bf16_f32 v66, v64, v65
v_and_b32 v65, 0xffff0000, v66
v_add_f32 v65, 0x3727c5ac, v65
v_cvt_pk_bf16_f32 v65, v65, v65
v_and_b32 v65, 0xffff0000, v65
v_sqrt_f32 v65, v65
v_lshlrev_b32 v235, 16, v66
v_cvt_pk_bf16_f32 v65, v65, v65
v_and_b32 v65, 0xffff0000, v65
v_rcp_f32 v230, v65
s_waitcnt lgkmcnt(1)
v_add_f32 v68, v68, v70
v_add_f32 v69, v69, v71
v_mul_f32 v68, 0x3ae38e39, v68
v_mul_f32 v69, 0x3ae38e39, v69
v_fma_f32 v69, -v68, v68, v69
v_max_f32 v69, 0, v69
v_cvt_pk_bf16_f32 v70, v68, v69
v_and_b32 v69, 0xffff0000, v70
v_add_f32 v69, 0x3727c5ac, v69
v_cvt_pk_bf16_f32 v69, v69, v69
v_and_b32 v69, 0xffff0000, v69
v_sqrt_f32 v69, v69
v_lshlrev_b32 v236, 16, v70
v_cvt_pk_bf16_f32 v69, v69, v69
v_and_b32 v69, 0xffff0000, v69
v_rcp_f32 v231, v69
s_waitcnt lgkmcnt(0)
v_add_f32 v72, v72, v74
v_add_f32 v73, v73, v75
v_mul_f32 v72, 0x3ae38e39, v72
v_mul_f32 v73, 0x3ae38e39, v73
v_fma_f32 v73, -v72, v72, v73
v_max_f32 v73, 0, v73
v_cvt_pk_bf16_f32 v74, v72, v73
v_and_b32 v73, 0xffff0000, v74
v_add_f32 v73, 0x3727c5ac, v73
v_cvt_pk_bf16_f32 v73, v73, v73
v_and_b32 v73, 0xffff0000, v73
v_sqrt_f32 v73, v73
v_lshlrev_b32 v237, 16, v74
v_cvt_pk_bf16_f32 v73, v73, v73
v_and_b32 v73, 0xffff0000, v73
v_rcp_f32 v232, v73
v_mul_f32 v228, 0x3fb8aa3b, v228
v_mul_f32 v233, v233, v228
v_mul_f32 v229, 0x3fb8aa3b, v229
v_mul_f32 v234, v234, v229
v_mul_f32 v230, 0x3fb8aa3b, v230
v_mul_f32 v235, v235, v230
v_mul_f32 v231, 0x3fb8aa3b, v231
v_mul_f32 v236, v236, v231
v_mul_f32 v232, 0x3fb8aa3b, v232
v_mul_f32 v237, v237, v232
ds_read_b32 v27, v20
s_waitcnt lgkmcnt(0)
v_cmp_gt_u32 vcc, 1, v27
s_cbranch_vccnz LwQo
LrQo:
s_add_u32 m0, s6, 8192
s_mov_b32 s11, 0
buffer_load_dwordx4 v11, s[48:51], s11 offen lds
buffer_load_dwordx4 v12, s[48:51], s11 offen offset:1024 lds
s_add_u32 m0, s6, 10240
s_mov_b32 s11, 36864
buffer_load_dwordx4 v11, s[48:51], s11 offen lds
buffer_load_dwordx4 v12, s[48:51], s11 offen offset:1024 lds
s_add_u32 m0, s20, 0
s_mov_b32 s11, 0
buffer_load_dwordx4 v15, s[48:51], s11 offen lds
s_add_u32 m0, s20, 16384
s_mov_b32 s11, 294912
buffer_load_dwordx4 v15, s[48:51], s11 offen lds
s_add_u32 m0, s20, 32768
s_mov_b32 s11, 589824
buffer_load_dwordx4 v15, s[48:51], s11 offen lds
s_add_u32 m0, s20, 49152
s_mov_b32 s11, 884736
buffer_load_dwordx4 v15, s[48:51], s11 offen lds
s_add_u32 m0, s20, 53248
s_mov_b32 s11, 1179648
buffer_load_dwordx4 v15, s[48:51], s11 offen lds
ds_read_b128 v[36:39], v4 offset:0
ds_read_b128 v[40:43], v4 offset:2048
ds_read_b128 v[44:47], v4 offset:4096
ds_read_b128 v[48:51], v4 offset:6144
ds_read_b128 v[52:55], v4 offset:8192
s_waitcnt vmcnt(7)
ds_read_b64_tr_b16 v[76:77], v6 offset:8192
ds_read_b64_tr_b16 v[80:81], v7 offset:8192
ds_read_b64_tr_b16 v[84:85], v8 offset:8192
ds_read_b64_tr_b16 v[88:89], v9 offset:8192
s_waitcnt vmcnt(5)
ds_read_b64_tr_b16 v[78:79], v6 offset:10240
ds_read_b64_tr_b16 v[82:83], v7 offset:10240
ds_read_b64_tr_b16 v[86:87], v8 offset:10240
ds_read_b64_tr_b16 v[90:91], v9 offset:10240
s_add_u32 m0, s6, 8192
s_mov_b32 s11, 294912
s_waitcnt lgkmcnt(4)
buffer_load_dwordx4 v11, s[48:51], s11 offen lds
buffer_load_dwordx4 v12, s[48:51], s11 offen offset:1024 lds
s_add_u32 m0, s6, 10240
s_mov_b32 s11, 331776
s_waitcnt lgkmcnt(0)
buffer_load_dwordx4 v11, s[48:51], s11 offen lds
buffer_load_dwordx4 v12, s[48:51], s11 offen offset:1024 lds
s_waitcnt vmcnt(4)
v_mov_b32 v24, 11
ds_write_b32 v22, v24
ds_read_b32 v27, v21
s_waitcnt lgkmcnt(0)
v_cmp_gt_u32 vcc, 11, v27
s_cbranch_vccnz LwQr
LrQr:
ds_read_b64_tr_b16 v[92:93], v10 offset:0
ds_read_b64_tr_b16 v[94:95], v10 offset:2048
s_waitcnt lgkmcnt(0)
v_mov_b32 v24, 12
ds_write_b32 v22, v24
ds_read_b32 v27, v20
s_waitcnt lgkmcnt(0)
v_cmp_gt_u32 vcc, 2, v27
s_cbranch_vccnz LwQs
LrQs:
s_add_u32 m0, s6, 4096
s_mov_b32 s11, 589824
buffer_load_dwordx4 v11, s[48:51], s11 offen lds
buffer_load_dwordx4 v12, s[48:51], s11 offen offset:1024 lds
s_add_u32 m0, s6, 6144
s_mov_b32 s11, 626688
buffer_load_dwordx4 v11, s[48:51], s11 offen lds
buffer_load_dwordx4 v12, s[48:51], s11 offen offset:1024 lds
s_setprio 2
v_mfma_f32_16x16x32_bf16 v[116:119], v[76:79], v[36:39], 0
s_waitcnt vmcnt(6)
ds_read_b64_tr_b16 v[96:97], v6 offset:8192
v_mfma_f32_16x16x32_bf16 v[120:123], v[76:79], v[40:43], 0
ds_read_b64_tr_b16 v[100:101], v7 offset:8192
v_mfma_f32_16x16x32_bf16 v[124:127], v[76:79], v[44:47], 0
v_mfma_f32_16x16x32_bf16 v[128:131], v[76:79], v[48:51], 0
ds_read_b64_tr_b16 v[104:105], v8 offset:8192
v_mfma_f32_16x16x32_bf16 v[132:135], v[76:79], v[52:55], 0
ds_read_b64_tr_b16 v[108:109], v9 offset:8192
v_mfma_f32_16x16x32_bf16 v[152:155], v[80:83], v[52:55], 0
ds_read_b64_tr_b16 v[112:113], v10 offset:16384
v_mfma_f32_16x16x32_bf16 v[148:151], v[80:83], v[48:51], 0
ds_read_b64_tr_b16 v[114:115], v10 offset:18432
v_mfma_f32_16x16x32_bf16 v[144:147], v[80:83], v[44:47], 0
v_mfma_f32_16x16x32_bf16 v[140:143], v[80:83], v[40:43], 0
ds_read_b128 v[56:59], v5 offset:0
s_add_u32 m0, s6, 8192
v_mfma_f32_16x16x32_bf16 v[136:139], v[80:83], v[36:39], 0
ds_read_b128 v[60:63], v5 offset:2048
s_mov_b32 s11, 884736
v_mfma_f32_16x16x32_bf16 v[156:159], v[84:87], v[36:39], 0
ds_read_b32 v23, v21
v_mfma_f32_16x16x32_bf16 v[160:163], v[84:87], v[40:43], 0
ds_read_b128 v[64:67], v5 offset:4096
v_mov_b32 v24, 13
v_mfma_f32_16x16x32_bf16 v[164:167], v[84:87], v[44:47], 0
s_waitcnt lgkmcnt(5)
buffer_load_dwordx4 v11, s[48:51], s11 offen lds
v_mfma_f32_16x16x32_bf16 v[168:171], v[84:87], v[48:51], 0
s_waitcnt lgkmcnt(4)
ds_write_b32 v22, v24
v_mfma_f32_16x16x32_bf16 v[172:175], v[84:87], v[52:55], 0
s_waitcnt vmcnt(5)
ds_read_b64_tr_b16 v[98:99], v6 offset:10240
v_mfma_f32_16x16x32_bf16 v[192:195], v[88:91], v[52:55], 0
ds_read_b64_tr_b16 v[102:103], v7 offset:10240
v_mfma_f32_16x16x32_bf16 v[188:191], v[88:91], v[48:51], 0
ds_read_b64_tr_b16 v[106:107], v8 offset:10240
v_mfma_f32_16x16x32_bf16 v[184:187], v[88:91], v[44:47], 0
buffer_load_dwordx4 v12, s[48:51], s11 offen offset:1024 lds
v_mfma_f32_16x16x32_bf16 v[180:183], v[88:91], v[40:43], 0
ds_read_b64_tr_b16 v[110:111], v9 offset:10240
s_add_u32 m0, s20, 0
v_mfma_f32_16x16x32_bf16 v[176:179], v[88:91], v[36:39], 0
ds_read_b128 v[68:71], v5 offset:6144
s_waitcnt lgkmcnt(6)
v_cmp_gt_u32 vcc, 12, v23
v_mfma_f32_16x16x32_bf16 v[196:199], v[92:95], v[36:39], 0
ds_read_b128 v[72:75], v5 offset:8192
s_mov_b32 s11, 1474560
v_mfma_f32_16x16x32_bf16 v[200:203], v[92:95], v[40:43], 0
s_cbranch_vccnz LwQo0
LrQo0:
v_mfma_f32_16x16x32_bf16 v[204:207], v[92:95], v[44:47], 0
buffer_load_dwordx4 v15, s[48:51], s11 offen lds
v_mfma_f32_16x16x32_bf16 v[208:211], v[92:95], v[48:51], 0
s_add_u32 m0, s6, 10240
s_mov_b32 s11, 921600
v_mfma_f32_16x16x32_bf16 v[212:215], v[92:95], v[52:55], 0
s_waitcnt lgkmcnt(3)
v_mfma_f32_16x16x32_bf16 v[116:119], v[96:99], v[56:59], v[116:119]
s_waitcnt vmcnt(5)
ds_read_b64_tr_b16 v[76:77], v6 offset:4096
v_mfma_f32_16x16x32_bf16 v[120:123], v[96:99], v[60:63], v[120:123]
ds_read_b64_tr_b16 v[80:81], v7 offset:4096
v_mfma_f32_16x16x32_bf16 v[124:127], v[96:99], v[64:67], v[124:127]
s_waitcnt lgkmcnt(2)
buffer_load_dwordx4 v11, s[48:51], s11 offen lds
v_mfma_f32_16x16x32_bf16 v[128:131], v[96:99], v[68:71], v[128:131]
ds_read_b64_tr_b16 v[84:85], v8 offset:4096
v_mfma_f32_16x16x32_bf16 v[132:135], v[96:99], v[72:75], v[132:135]
ds_read_b64_tr_b16 v[88:89], v9 offset:4096
v_mfma_f32_16x16x32_bf16 v[152:155], v[100:103], v[72:75], v[152:155]
ds_read_b64_tr_b16 v[92:93], v10 offset:32768
v_mfma_f32_16x16x32_bf16 v[148:151], v[100:103], v[68:71], v[148:151]
ds_read_b64_tr_b16 v[94:95], v10 offset:34816
v_mfma_f32_16x16x32_bf16 v[144:147], v[100:103], v[64:67], v[144:147]
buffer_load_dwordx4 v12, s[48:51], s11 offen offset:1024 lds
v_mfma_f32_16x16x32_bf16 v[140:143], v[100:103], v[60:63], v[140:143]
ds_read_b128 v[36:39], v4 offset:10240
s_add_u32 m0, s6, 4096
v_mfma_f32_16x16x32_bf16 v[136:139], v[100:103], v[56:59], v[136:139]
ds_read_b128 v[40:43], v4 offset:12288
s_mov_b32 s11, 1179648
v_mfma_f32_16x16x32_bf16 v[156:159], v[104:107], v[56:59], v[156:159]
ds_read_b32 v23, v21
v_mfma_f32_16x16x32_bf16 v[160:163], v[104:107], v[60:63], v[160:163]
ds_read_b128 v[44:47], v4 offset:14336
v_mov_b32 v24, 14
v_mfma_f32_16x16x32_bf16 v[164:167], v[104:107], v[64:67], v[164:167]
s_waitcnt lgkmcnt(5)
buffer_load_dwordx4 v11, s[48:51], s11 offen lds
v_mfma_f32_16x16x32_bf16 v[168:171], v[104:107], v[68:71], v[168:171]
s_waitcnt lgkmcnt(4)
ds_write_b32 v22, v24
v_mfma_f32_16x16x32_bf16 v[172:175], v[104:107], v[72:75], v[172:175]
s_waitcnt vmcnt(6)
ds_read_b64_tr_b16 v[78:79], v6 offset:6144
v_mfma_f32_16x16x32_bf16 v[192:195], v[108:111], v[72:75], v[192:195]
ds_read_b64_tr_b16 v[82:83], v7 offset:6144
v_mfma_f32_16x16x32_bf16 v[188:191], v[108:111], v[68:71], v[188:191]
ds_read_b64_tr_b16 v[86:87], v8 offset:6144
v_mfma_f32_16x16x32_bf16 v[184:187], v[108:111], v[64:67], v[184:187]
buffer_load_dwordx4 v12, s[48:51], s11 offen offset:1024 lds
v_mfma_f32_16x16x32_bf16 v[180:183], v[108:111], v[60:63], v[180:183]
ds_read_b64_tr_b16 v[90:91], v9 offset:6144
s_add_u32 m0, s20, 16384
v_mfma_f32_16x16x32_bf16 v[176:179], v[108:111], v[56:59], v[176:179]
ds_read_b128 v[48:51], v4 offset:16384
s_waitcnt lgkmcnt(6)
v_cmp_gt_u32 vcc, 13, v23
v_mfma_f32_16x16x32_bf16 v[196:199], v[112:115], v[56:59], v[196:199]
ds_read_b128 v[52:55], v4 offset:18432
s_mov_b32 s11, 1769472
v_mfma_f32_16x16x32_bf16 v[200:203], v[112:115], v[60:63], v[200:203]
s_cbranch_vccnz LwQo1
LrQo1:
v_mfma_f32_16x16x32_bf16 v[204:207], v[112:115], v[64:67], v[204:207]
buffer_load_dwordx4 v15, s[48:51], s11 offen lds
v_mfma_f32_16x16x32_bf16 v[208:211], v[112:115], v[68:71], v[208:211]
s_add_u32 m0, s6, 6144
s_mov_b32 s11, 1216512
v_mfma_f32_16x16x32_bf16 v[212:215], v[112:115], v[72:75], v[212:215]
s_waitcnt lgkmcnt(3)
v_mfma_f32_16x16x32_bf16 v[116:119], v[76:79], v[36:39], v[116:119]
s_waitcnt vmcnt(6)
ds_read_b64_tr_b16 v[96:97], v6 offset:8192
v_mfma_f32_16x16x32_bf16 v[120:123], v[76:79], v[40:43], v[120:123]
ds_read_b64_tr_b16 v[100:101], v7 offset:8192
v_mfma_f32_16x16x32_bf16 v[124:127], v[76:79], v[44:47], v[124:127]
s_waitcnt lgkmcnt(2)
buffer_load_dwordx4 v11, s[48:51], s11 offen lds
v_mfma_f32_16x16x32_bf16 v[128:131], v[76:79], v[48:51], v[128:131]
ds_read_b64_tr_b16 v[104:105], v8 offset:8192
v_mfma_f32_16x16x32_bf16 v[132:135], v[76:79], v[52:55], v[132:135]
ds_read_b64_tr_b16 v[108:109], v9 offset:8192
v_mfma_f32_16x16x32_bf16 v[152:155], v[80:83], v[52:55], v[152:155]
ds_read_b64_tr_b16 v[112:113], v10 offset:49152
v_mfma_f32_16x16x32_bf16 v[148:151], v[80:83], v[48:51], v[148:151]
ds_read_b64_tr_b16 v[114:115], v10 offset:51200
v_mfma_f32_16x16x32_bf16 v[144:147], v[80:83], v[44:47], v[144:147]
buffer_load_dwordx4 v12, s[48:51], s11 offen offset:1024 lds
v_mfma_f32_16x16x32_bf16 v[140:143], v[80:83], v[40:43], v[140:143]
ds_read_b128 v[56:59], v5 offset:10240
s_add_u32 m0, s6, 8192
v_mfma_f32_16x16x32_bf16 v[136:139], v[80:83], v[36:39], v[136:139]
ds_read_b128 v[60:63], v5 offset:12288
s_mov_b32 s11, 1474560
v_mfma_f32_16x16x32_bf16 v[156:159], v[84:87], v[36:39], v[156:159]
ds_read_b32 v23, v21
v_mfma_f32_16x16x32_bf16 v[160:163], v[84:87], v[40:43], v[160:163]
ds_read_b128 v[64:67], v5 offset:14336
v_mov_b32 v24, 15
v_mfma_f32_16x16x32_bf16 v[164:167], v[84:87], v[44:47], v[164:167]
s_waitcnt lgkmcnt(5)
buffer_load_dwordx4 v11, s[48:51], s11 offen lds
v_mfma_f32_16x16x32_bf16 v[168:171], v[84:87], v[48:51], v[168:171]
s_waitcnt vmcnt(8) lgkmcnt(4)
ds_write_b32 v22, v24
v_mfma_f32_16x16x32_bf16 v[172:175], v[84:87], v[52:55], v[172:175]
s_waitcnt vmcnt(6)
ds_read_b64_tr_b16 v[98:99], v6 offset:10240
v_mfma_f32_16x16x32_bf16 v[192:195], v[88:91], v[52:55], v[192:195]
ds_read_b64_tr_b16 v[102:103], v7 offset:10240
v_mfma_f32_16x16x32_bf16 v[188:191], v[88:91], v[48:51], v[188:191]
ds_read_b64_tr_b16 v[106:107], v8 offset:10240
v_mfma_f32_16x16x32_bf16 v[184:187], v[88:91], v[44:47], v[184:187]
buffer_load_dwordx4 v12, s[48:51], s11 offen offset:1024 lds
v_mfma_f32_16x16x32_bf16 v[180:183], v[88:91], v[40:43], v[180:183]
ds_read_b64_tr_b16 v[110:111], v9 offset:10240
s_add_u32 m0, s20, 32768
v_mfma_f32_16x16x32_bf16 v[176:179], v[88:91], v[36:39], v[176:179]
ds_read_b128 v[68:71], v5 offset:16384
s_waitcnt lgkmcnt(6)
v_cmp_gt_u32 vcc, 14, v23
v_mfma_f32_16x16x32_bf16 v[196:199], v[92:95], v[36:39], v[196:199]
ds_read_b128 v[72:75], v5 offset:18432
s_mov_b32 s11, 2064384
v_mfma_f32_16x16x32_bf16 v[200:203], v[92:95], v[40:43], v[200:203]
s_cbranch_vccnz LwQo2
LrQo2:
v_mfma_f32_16x16x32_bf16 v[204:207], v[92:95], v[44:47], v[204:207]
buffer_load_dwordx4 v15, s[48:51], s11 offen lds
v_mfma_f32_16x16x32_bf16 v[208:211], v[92:95], v[48:51], v[208:211]
s_add_u32 m0, s6, 10240
s_mov_b32 s11, 1511424
v_mfma_f32_16x16x32_bf16 v[212:215], v[92:95], v[52:55], v[212:215]
s_waitcnt lgkmcnt(3)
v_mfma_f32_16x16x32_bf16 v[116:119], v[96:99], v[56:59], v[116:119]
s_waitcnt vmcnt(6)
ds_read_b64_tr_b16 v[76:77], v6 offset:4096
v_mfma_f32_16x16x32_bf16 v[120:123], v[96:99], v[60:63], v[120:123]
ds_read_b64_tr_b16 v[80:81], v7 offset:4096
v_mfma_f32_16x16x32_bf16 v[124:127], v[96:99], v[64:67], v[124:127]
s_waitcnt lgkmcnt(2)
buffer_load_dwordx4 v11, s[48:51], s11 offen lds
v_mfma_f32_16x16x32_bf16 v[128:131], v[96:99], v[68:71], v[128:131]
ds_read_b64_tr_b16 v[84:85], v8 offset:4096
v_mfma_f32_16x16x32_bf16 v[132:135], v[96:99], v[72:75], v[132:135]
ds_read_b64_tr_b16 v[88:89], v9 offset:4096
v_mfma_f32_16x16x32_bf16 v[152:155], v[100:103], v[72:75], v[152:155]
ds_read_b64_tr_b16 v[92:93], v10 offset:53248
v_mfma_f32_16x16x32_bf16 v[148:151], v[100:103], v[68:71], v[148:151]
ds_read_b64_tr_b16 v[94:95], v10 offset:55296
v_mfma_f32_16x16x32_bf16 v[144:147], v[100:103], v[64:67], v[144:147]
buffer_load_dwordx4 v12, s[48:51], s11 offen offset:1024 lds
v_mfma_f32_16x16x32_bf16 v[140:143], v[100:103], v[60:63], v[140:143]
ds_read_b128 v[36:39], v4 offset:20480
s_add_u32 m0, s6, 4096
v_mfma_f32_16x16x32_bf16 v[136:139], v[100:103], v[56:59], v[136:139]
ds_read_b128 v[40:43], v4 offset:22528
s_mov_b32 s11, 1769472
v_mfma_f32_16x16x32_bf16 v[156:159], v[104:107], v[56:59], v[156:159]
ds_read_b32 v23, v21
v_mfma_f32_16x16x32_bf16 v[160:163], v[104:107], v[60:63], v[160:163]
ds_read_b128 v[44:47], v4 offset:24576
v_mov_b32 v24, 16
v_mfma_f32_16x16x32_bf16 v[164:167], v[104:107], v[64:67], v[164:167]
s_waitcnt lgkmcnt(5)
buffer_load_dwordx4 v11, s[48:51], s11 offen lds
v_mfma_f32_16x16x32_bf16 v[168:171], v[104:107], v[68:71], v[168:171]
s_waitcnt vmcnt(8) lgkmcnt(4)
ds_write_b32 v22, v24
v_mfma_f32_16x16x32_bf16 v[172:175], v[104:107], v[72:75], v[172:175]
s_waitcnt vmcnt(6)
ds_read_b64_tr_b16 v[78:79], v6 offset:6144
v_mfma_f32_16x16x32_bf16 v[192:195], v[108:111], v[72:75], v[192:195]
ds_read_b64_tr_b16 v[82:83], v7 offset:6144
v_mfma_f32_16x16x32_bf16 v[188:191], v[108:111], v[68:71], v[188:191]
ds_read_b64_tr_b16 v[86:87], v8 offset:6144
v_mfma_f32_16x16x32_bf16 v[184:187], v[108:111], v[64:67], v[184:187]
buffer_load_dwordx4 v12, s[48:51], s11 offen offset:1024 lds
v_mfma_f32_16x16x32_bf16 v[180:183], v[108:111], v[60:63], v[180:183]
ds_read_b64_tr_b16 v[90:91], v9 offset:6144
s_add_u32 m0, s20, 49152
v_mfma_f32_16x16x32_bf16 v[176:179], v[108:111], v[56:59], v[176:179]
ds_read_b128 v[48:51], v4 offset:26624
s_waitcnt lgkmcnt(6)
v_cmp_gt_u32 vcc, 15, v23
v_mfma_f32_16x16x32_bf16 v[196:199], v[112:115], v[56:59], v[196:199]
ds_read_b128 v[52:55], v4 offset:28672
s_mov_b32 s11, 2359296
v_mfma_f32_16x16x32_bf16 v[200:203], v[112:115], v[60:63], v[200:203]
s_cbranch_vccnz LwQo3
LrQo3:
v_mfma_f32_16x16x32_bf16 v[204:207], v[112:115], v[64:67], v[204:207]
buffer_load_dwordx4 v15, s[48:51], s11 offen lds
v_mfma_f32_16x16x32_bf16 v[208:211], v[112:115], v[68:71], v[208:211]
s_add_u32 m0, s6, 6144
s_mov_b32 s11, 1806336
v_mfma_f32_16x16x32_bf16 v[212:215], v[112:115], v[72:75], v[212:215]
s_waitcnt lgkmcnt(3)
v_mfma_f32_16x16x32_bf16 v[116:119], v[76:79], v[36:39], v[116:119]
s_waitcnt vmcnt(6)
ds_read_b64_tr_b16 v[96:97], v6 offset:8192
v_mfma_f32_16x16x32_bf16 v[120:123], v[76:79], v[40:43], v[120:123]
ds_read_b64_tr_b16 v[100:101], v7 offset:8192
v_mfma_f32_16x16x32_bf16 v[124:127], v[76:79], v[44:47], v[124:127]
s_waitcnt lgkmcnt(2)
buffer_load_dwordx4 v11, s[48:51], s11 offen lds
v_mfma_f32_16x16x32_bf16 v[128:131], v[76:79], v[48:51], v[128:131]
ds_read_b64_tr_b16 v[104:105], v8 offset:8192
v_mfma_f32_16x16x32_bf16 v[132:135], v[76:79], v[52:55], v[132:135]
ds_read_b64_tr_b16 v[108:109], v9 offset:8192
v_mfma_f32_16x16x32_bf16 v[152:155], v[80:83], v[52:55], v[152:155]
ds_read_b64_tr_b16 v[112:113], v10 offset:0
v_mfma_f32_16x16x32_bf16 v[148:151], v[80:83], v[48:51], v[148:151]
ds_read_b64_tr_b16 v[114:115], v10 offset:2048
v_mfma_f32_16x16x32_bf16 v[144:147], v[80:83], v[44:47], v[144:147]
buffer_load_dwordx4 v12, s[48:51], s11 offen offset:1024 lds
v_mfma_f32_16x16x32_bf16 v[140:143], v[80:83], v[40:43], v[140:143]
ds_read_b128 v[56:59], v5 offset:20480
s_add_u32 m0, s6, 8192
v_mfma_f32_16x16x32_bf16 v[136:139], v[80:83], v[36:39], v[136:139]
ds_read_b128 v[60:63], v5 offset:22528
s_mov_b32 s11, 2064384
v_mfma_f32_16x16x32_bf16 v[156:159], v[84:87], v[36:39], v[156:159]
ds_read_b32 v23, v21
v_mfma_f32_16x16x32_bf16 v[160:163], v[84:87], v[40:43], v[160:163]
ds_read_b128 v[64:67], v5 offset:24576
v_mov_b32 v24, 17
v_mfma_f32_16x16x32_bf16 v[164:167], v[84:87], v[44:47], v[164:167]
s_waitcnt lgkmcnt(5)
buffer_load_dwordx4 v11, s[48:51], s11 offen lds
v_mfma_f32_16x16x32_bf16 v[168:171], v[84:87], v[48:51], v[168:171]
s_waitcnt vmcnt(8) lgkmcnt(4)
ds_write_b32 v22, v24
v_mfma_f32_16x16x32_bf16 v[172:175], v[84:87], v[52:55], v[172:175]
s_waitcnt vmcnt(6)
ds_read_b64_tr_b16 v[98:99], v6 offset:10240
v_mfma_f32_16x16x32_bf16 v[192:195], v[88:91], v[52:55], v[192:195]
ds_read_b64_tr_b16 v[102:103], v7 offset:10240
v_mfma_f32_16x16x32_bf16 v[188:191], v[88:91], v[48:51], v[188:191]
ds_read_b64_tr_b16 v[106:107], v8 offset:10240
v_mfma_f32_16x16x32_bf16 v[184:187], v[88:91], v[44:47], v[184:187]
buffer_load_dwordx4 v12, s[48:51], s11 offen offset:1024 lds
v_mfma_f32_16x16x32_bf16 v[180:183], v[88:91], v[40:43], v[180:183]
ds_read_b64_tr_b16 v[110:111], v9 offset:10240
s_add_u32 m0, s20, 53248
v_mfma_f32_16x16x32_bf16 v[176:179], v[88:91], v[36:39], v[176:179]
ds_read_b128 v[68:71], v5 offset:26624
s_waitcnt lgkmcnt(6)
v_cmp_gt_u32 vcc, 16, v23
v_mfma_f32_16x16x32_bf16 v[196:199], v[92:95], v[36:39], v[196:199]
ds_read_b128 v[72:75], v5 offset:28672
s_mov_b32 s11, 2654208
v_mfma_f32_16x16x32_bf16 v[200:203], v[92:95], v[40:43], v[200:203]
s_cbranch_vccnz LwQo4
LrQo4:
v_mfma_f32_16x16x32_bf16 v[204:207], v[92:95], v[44:47], v[204:207]
buffer_load_dwordx4 v15, s[48:51], s11 offen lds
v_mfma_f32_16x16x32_bf16 v[208:211], v[92:95], v[48:51], v[208:211]
s_add_u32 m0, s6, 10240
s_mov_b32 s11, 2101248
v_mfma_f32_16x16x32_bf16 v[212:215], v[92:95], v[52:55], v[212:215]
s_waitcnt lgkmcnt(3)
v_mfma_f32_16x16x32_bf16 v[116:119], v[96:99], v[56:59], v[116:119]
s_waitcnt vmcnt(6)
ds_read_b64_tr_b16 v[76:77], v6 offset:4096
v_mfma_f32_16x16x32_bf16 v[120:123], v[96:99], v[60:63], v[120:123]
ds_read_b64_tr_b16 v[80:81], v7 offset:4096
v_mfma_f32_16x16x32_bf16 v[124:127], v[96:99], v[64:67], v[124:127]
s_waitcnt lgkmcnt(2)
buffer_load_dwordx4 v11, s[48:51], s11 offen lds
v_mfma_f32_16x16x32_bf16 v[128:131], v[96:99], v[68:71], v[128:131]
ds_read_b64_tr_b16 v[84:85], v8 offset:4096
v_mfma_f32_16x16x32_bf16 v[132:135], v[96:99], v[72:75], v[132:135]
ds_read_b64_tr_b16 v[88:89], v9 offset:4096
v_mfma_f32_16x16x32_bf16 v[152:155], v[100:103], v[72:75], v[152:155]
ds_read_b64_tr_b16 v[92:93], v10 offset:16384
v_mfma_f32_16x16x32_bf16 v[148:151], v[100:103], v[68:71], v[148:151]
ds_read_b64_tr_b16 v[94:95], v10 offset:18432
v_mfma_f32_16x16x32_bf16 v[144:147], v[100:103], v[64:67], v[144:147]
buffer_load_dwordx4 v12, s[48:51], s11 offen offset:1024 lds
v_mfma_f32_16x16x32_bf16 v[140:143], v[100:103], v[60:63], v[140:143]
ds_read_b128 v[36:39], v4 offset:30720
s_add_u32 m0, s6, 4096
v_mfma_f32_16x16x32_bf16 v[136:139], v[100:103], v[56:59], v[136:139]
ds_read_b128 v[40:43], v4 offset:32768
s_mov_b32 s11, 2359296
v_mfma_f32_16x16x32_bf16 v[156:159], v[104:107], v[56:59], v[156:159]
ds_read_b32 v23, v21
v_mfma_f32_16x16x32_bf16 v[160:163], v[104:107], v[60:63], v[160:163]
ds_read_b128 v[44:47], v4 offset:34816
v_mov_b32 v24, 18
v_mfma_f32_16x16x32_bf16 v[164:167], v[104:107], v[64:67], v[164:167]
s_waitcnt lgkmcnt(5)
buffer_load_dwordx4 v11, s[48:51], s11 offen lds
v_mfma_f32_16x16x32_bf16 v[168:171], v[104:107], v[68:71], v[168:171]
s_waitcnt vmcnt(8) lgkmcnt(4)
ds_write_b32 v22, v24
v_mfma_f32_16x16x32_bf16 v[172:175], v[104:107], v[72:75], v[172:175]
s_waitcnt vmcnt(6)
ds_read_b64_tr_b16 v[78:79], v6 offset:6144
v_mfma_f32_16x16x32_bf16 v[192:195], v[108:111], v[72:75], v[192:195]
ds_read_b64_tr_b16 v[82:83], v7 offset:6144
v_mfma_f32_16x16x32_bf16 v[188:191], v[108:111], v[68:71], v[188:191]
ds_read_b64_tr_b16 v[86:87], v8 offset:6144
v_mfma_f32_16x16x32_bf16 v[184:187], v[108:111], v[64:67], v[184:187]
buffer_load_dwordx4 v12, s[48:51], s11 offen offset:1024 lds
v_mfma_f32_16x16x32_bf16 v[180:183], v[108:111], v[60:63], v[180:183]
ds_read_b64_tr_b16 v[90:91], v9 offset:6144
s_add_u32 m0, s20, 0
v_mfma_f32_16x16x32_bf16 v[176:179], v[108:111], v[56:59], v[176:179]
ds_read_b128 v[48:51], v4 offset:36864
s_waitcnt lgkmcnt(6)
v_cmp_gt_u32 vcc, 17, v23
v_mfma_f32_16x16x32_bf16 v[196:199], v[112:115], v[56:59], v[196:199]
ds_read_b128 v[52:55], v4 offset:38912
s_mov_b32 s11, 2949120
v_mfma_f32_16x16x32_bf16 v[200:203], v[112:115], v[60:63], v[200:203]
s_cbranch_vccnz LwQo5
LrQo5:
v_mfma_f32_16x16x32_bf16 v[204:207], v[112:115], v[64:67], v[204:207]
buffer_load_dwordx4 v15, s[48:51], s11 offen lds
v_mfma_f32_16x16x32_bf16 v[208:211], v[112:115], v[68:71], v[208:211]
s_add_u32 m0, s6, 6144
s_mov_b32 s11, 2396160
v_mfma_f32_16x16x32_bf16 v[212:215], v[112:115], v[72:75], v[212:215]
s_waitcnt lgkmcnt(3)
v_mfma_f32_16x16x32_bf16 v[116:119], v[76:79], v[36:39], v[116:119]
s_waitcnt vmcnt(6)
ds_read_b64_tr_b16 v[96:97], v6 offset:8192
v_mfma_f32_16x16x32_bf16 v[120:123], v[76:79], v[40:43], v[120:123]
ds_read_b64_tr_b16 v[100:101], v7 offset:8192
v_mfma_f32_16x16x32_bf16 v[124:127], v[76:79], v[44:47], v[124:127]
s_waitcnt lgkmcnt(2)
buffer_load_dwordx4 v11, s[48:51], s11 offen lds
v_mfma_f32_16x16x32_bf16 v[128:131], v[76:79], v[48:51], v[128:131]
ds_read_b64_tr_b16 v[104:105], v8 offset:8192
v_mfma_f32_16x16x32_bf16 v[132:135], v[76:79], v[52:55], v[132:135]
ds_read_b64_tr_b16 v[108:109], v9 offset:8192
v_mfma_f32_16x16x32_bf16 v[152:155], v[80:83], v[52:55], v[152:155]
ds_read_b64_tr_b16 v[112:113], v10 offset:32768
v_mfma_f32_16x16x32_bf16 v[148:151], v[80:83], v[48:51], v[148:151]
ds_read_b64_tr_b16 v[114:115], v10 offset:34816
v_mfma_f32_16x16x32_bf16 v[144:147], v[80:83], v[44:47], v[144:147]
buffer_load_dwordx4 v12, s[48:51], s11 offen offset:1024 lds
v_mfma_f32_16x16x32_bf16 v[140:143], v[80:83], v[40:43], v[140:143]
ds_read_b128 v[56:59], v5 offset:30720
s_add_u32 m0, s6, 8192
v_mfma_f32_16x16x32_bf16 v[136:139], v[80:83], v[36:39], v[136:139]
ds_read_b128 v[60:63], v5 offset:32768
s_mov_b32 s11, 2654208
v_mfma_f32_16x16x32_bf16 v[156:159], v[84:87], v[36:39], v[156:159]
ds_read_b32 v23, v21
v_mfma_f32_16x16x32_bf16 v[160:163], v[84:87], v[40:43], v[160:163]
ds_read_b128 v[64:67], v5 offset:34816
v_mov_b32 v24, 19
v_mfma_f32_16x16x32_bf16 v[164:167], v[84:87], v[44:47], v[164:167]
s_waitcnt lgkmcnt(5)
buffer_load_dwordx4 v11, s[48:51], s11 offen lds
v_mfma_f32_16x16x32_bf16 v[168:171], v[84:87], v[48:51], v[168:171]
s_waitcnt vmcnt(8) lgkmcnt(4)
ds_write_b32 v22, v24
v_mfma_f32_16x16x32_bf16 v[172:175], v[84:87], v[52:55], v[172:175]
s_waitcnt vmcnt(6)
ds_read_b64_tr_b16 v[98:99], v6 offset:10240
v_mfma_f32_16x16x32_bf16 v[192:195], v[88:91], v[52:55], v[192:195]
ds_read_b64_tr_b16 v[102:103], v7 offset:10240
v_mfma_f32_16x16x32_bf16 v[188:191], v[88:91], v[48:51], v[188:191]
ds_read_b64_tr_b16 v[106:107], v8 offset:10240
v_mfma_f32_16x16x32_bf16 v[184:187], v[88:91], v[44:47], v[184:187]
buffer_load_dwordx4 v12, s[48:51], s11 offen offset:1024 lds
v_mfma_f32_16x16x32_bf16 v[180:183], v[88:91], v[40:43], v[180:183]
ds_read_b64_tr_b16 v[110:111], v9 offset:10240
s_add_u32 m0, s20, 16384
v_mfma_f32_16x16x32_bf16 v[176:179], v[88:91], v[36:39], v[176:179]
ds_read_b128 v[68:71], v5 offset:36864
s_waitcnt lgkmcnt(6)
v_cmp_gt_u32 vcc, 18, v23
v_mfma_f32_16x16x32_bf16 v[196:199], v[92:95], v[36:39], v[196:199]
ds_read_b128 v[72:75], v5 offset:38912
s_mov_b32 s11, 3244032
v_mfma_f32_16x16x32_bf16 v[200:203], v[92:95], v[40:43], v[200:203]
s_cbranch_vccnz LwQo6
LrQo6:
v_mfma_f32_16x16x32_bf16 v[204:207], v[92:95], v[44:47], v[204:207]
buffer_load_dwordx4 v15, s[48:51], s11 offen lds
v_mfma_f32_16x16x32_bf16 v[208:211], v[92:95], v[48:51], v[208:211]
s_add_u32 m0, s6, 10240
s_mov_b32 s11, 2691072
v_mfma_f32_16x16x32_bf16 v[212:215], v[92:95], v[52:55], v[212:215]
s_waitcnt lgkmcnt(3)
v_mfma_f32_16x16x32_bf16 v[116:119], v[96:99], v[56:59], v[116:119]
s_waitcnt vmcnt(6)
ds_read_b64_tr_b16 v[76:77], v6 offset:4096
v_mfma_f32_16x16x32_bf16 v[120:123], v[96:99], v[60:63], v[120:123]
ds_read_b64_tr_b16 v[80:81], v7 offset:4096
v_mfma_f32_16x16x32_bf16 v[124:127], v[96:99], v[64:67], v[124:127]
s_waitcnt lgkmcnt(2)
buffer_load_dwordx4 v11, s[48:51], s11 offen lds
v_mfma_f32_16x16x32_bf16 v[128:131], v[96:99], v[68:71], v[128:131]
ds_read_b64_tr_b16 v[84:85], v8 offset:4096
v_mfma_f32_16x16x32_bf16 v[132:135], v[96:99], v[72:75], v[132:135]
ds_read_b64_tr_b16 v[88:89], v9 offset:4096
v_mfma_f32_16x16x32_bf16 v[152:155], v[100:103], v[72:75], v[152:155]
ds_read_b64_tr_b16 v[92:93], v10 offset:49152
v_mfma_f32_16x16x32_bf16 v[148:151], v[100:103], v[68:71], v[148:151]
ds_read_b64_tr_b16 v[94:95], v10 offset:51200
v_mfma_f32_16x16x32_bf16 v[144:147], v[100:103], v[64:67], v[144:147]
buffer_load_dwordx4 v12, s[48:51], s11 offen offset:1024 lds
v_mfma_f32_16x16x32_bf16 v[140:143], v[100:103], v[60:63], v[140:143]
ds_read_b128 v[36:39], v4 offset:40960
s_add_u32 m0, s6, 4096
v_mfma_f32_16x16x32_bf16 v[136:139], v[100:103], v[56:59], v[136:139]
ds_read_b128 v[40:43], v4 offset:43008
s_mov_b32 s11, 2949120
v_mfma_f32_16x16x32_bf16 v[156:159], v[104:107], v[56:59], v[156:159]
ds_read_b32 v23, v21
v_mfma_f32_16x16x32_bf16 v[160:163], v[104:107], v[60:63], v[160:163]
ds_read_b128 v[44:47], v4 offset:45056
v_mov_b32 v24, 20
v_mfma_f32_16x16x32_bf16 v[164:167], v[104:107], v[64:67], v[164:167]
s_waitcnt lgkmcnt(5)
buffer_load_dwordx4 v11, s[48:51], s11 offen lds
v_mfma_f32_16x16x32_bf16 v[168:171], v[104:107], v[68:71], v[168:171]
s_waitcnt vmcnt(8) lgkmcnt(4)
ds_write_b32 v22, v24
v_mfma_f32_16x16x32_bf16 v[172:175], v[104:107], v[72:75], v[172:175]
s_waitcnt vmcnt(6)
ds_read_b64_tr_b16 v[78:79], v6 offset:6144
v_mfma_f32_16x16x32_bf16 v[192:195], v[108:111], v[72:75], v[192:195]
ds_read_b64_tr_b16 v[82:83], v7 offset:6144
v_mfma_f32_16x16x32_bf16 v[188:191], v[108:111], v[68:71], v[188:191]
ds_read_b64_tr_b16 v[86:87], v8 offset:6144
v_mfma_f32_16x16x32_bf16 v[184:187], v[108:111], v[64:67], v[184:187]
buffer_load_dwordx4 v12, s[48:51], s11 offen offset:1024 lds
v_mfma_f32_16x16x32_bf16 v[180:183], v[108:111], v[60:63], v[180:183]
ds_read_b64_tr_b16 v[90:91], v9 offset:6144
s_add_u32 m0, s20, 32768
v_mfma_f32_16x16x32_bf16 v[176:179], v[108:111], v[56:59], v[176:179]
ds_read_b128 v[48:51], v4 offset:47104
s_waitcnt lgkmcnt(6)
v_cmp_gt_u32 vcc, 19, v23
v_mfma_f32_16x16x32_bf16 v[196:199], v[112:115], v[56:59], v[196:199]
ds_read_b128 v[52:55], v4 offset:49152
s_mov_b32 s11, 3538944
v_mfma_f32_16x16x32_bf16 v[200:203], v[112:115], v[60:63], v[200:203]
s_cbranch_vccnz LwQo7
LrQo7:
v_mfma_f32_16x16x32_bf16 v[204:207], v[112:115], v[64:67], v[204:207]
buffer_load_dwordx4 v15, s[48:51], s11 offen lds
v_mfma_f32_16x16x32_bf16 v[208:211], v[112:115], v[68:71], v[208:211]
s_add_u32 m0, s6, 6144
s_mov_b32 s11, 2985984
v_mfma_f32_16x16x32_bf16 v[212:215], v[112:115], v[72:75], v[212:215]
s_waitcnt lgkmcnt(3)
v_mfma_f32_16x16x32_bf16 v[116:119], v[76:79], v[36:39], v[116:119]
s_waitcnt vmcnt(6)
ds_read_b64_tr_b16 v[96:97], v6 offset:8192
v_mfma_f32_16x16x32_bf16 v[120:123], v[76:79], v[40:43], v[120:123]
ds_read_b64_tr_b16 v[100:101], v7 offset:8192
v_mfma_f32_16x16x32_bf16 v[124:127], v[76:79], v[44:47], v[124:127]
s_waitcnt lgkmcnt(2)
buffer_load_dwordx4 v11, s[48:51], s11 offen lds
v_mfma_f32_16x16x32_bf16 v[128:131], v[76:79], v[48:51], v[128:131]
ds_read_b64_tr_b16 v[104:105], v8 offset:8192
v_mfma_f32_16x16x32_bf16 v[132:135], v[76:79], v[52:55], v[132:135]
ds_read_b64_tr_b16 v[108:109], v9 offset:8192
v_mfma_f32_16x16x32_bf16 v[152:155], v[80:83], v[52:55], v[152:155]
ds_read_b64_tr_b16 v[112:113], v10 offset:53248
v_mfma_f32_16x16x32_bf16 v[148:151], v[80:83], v[48:51], v[148:151]
ds_read_b64_tr_b16 v[114:115], v10 offset:55296
v_mfma_f32_16x16x32_bf16 v[144:147], v[80:83], v[44:47], v[144:147]
buffer_load_dwordx4 v12, s[48:51], s11 offen offset:1024 lds
v_mfma_f32_16x16x32_bf16 v[140:143], v[80:83], v[40:43], v[140:143]
ds_read_b128 v[56:59], v5 offset:40960
s_add_u32 m0, s6, 8192
v_mfma_f32_16x16x32_bf16 v[136:139], v[80:83], v[36:39], v[136:139]
ds_read_b128 v[60:63], v5 offset:43008
s_mov_b32 s11, 3244032
v_mfma_f32_16x16x32_bf16 v[156:159], v[84:87], v[36:39], v[156:159]
ds_read_b32 v23, v21
v_mfma_f32_16x16x32_bf16 v[160:163], v[84:87], v[40:43], v[160:163]
ds_read_b128 v[64:67], v5 offset:45056
v_mov_b32 v24, 21
v_mfma_f32_16x16x32_bf16 v[164:167], v[84:87], v[44:47], v[164:167]
s_waitcnt lgkmcnt(5)
buffer_load_dwordx4 v11, s[48:51], s11 offen lds
v_mfma_f32_16x16x32_bf16 v[168:171], v[84:87], v[48:51], v[168:171]
s_waitcnt vmcnt(8) lgkmcnt(4)
ds_write_b32 v22, v24
v_mfma_f32_16x16x32_bf16 v[172:175], v[84:87], v[52:55], v[172:175]
s_waitcnt vmcnt(6)
ds_read_b64_tr_b16 v[98:99], v6 offset:10240
v_mfma_f32_16x16x32_bf16 v[192:195], v[88:91], v[52:55], v[192:195]
ds_read_b64_tr_b16 v[102:103], v7 offset:10240
v_mfma_f32_16x16x32_bf16 v[188:191], v[88:91], v[48:51], v[188:191]
ds_read_b64_tr_b16 v[106:107], v8 offset:10240
v_mfma_f32_16x16x32_bf16 v[184:187], v[88:91], v[44:47], v[184:187]
buffer_load_dwordx4 v12, s[48:51], s11 offen offset:1024 lds
v_mfma_f32_16x16x32_bf16 v[180:183], v[88:91], v[40:43], v[180:183]
ds_read_b64_tr_b16 v[110:111], v9 offset:10240
s_add_u32 m0, s20, 49152
v_mfma_f32_16x16x32_bf16 v[176:179], v[88:91], v[36:39], v[176:179]
ds_read_b128 v[68:71], v5 offset:47104
s_waitcnt lgkmcnt(6)
v_cmp_gt_u32 vcc, 20, v23
v_mfma_f32_16x16x32_bf16 v[196:199], v[92:95], v[36:39], v[196:199]
ds_read_b128 v[72:75], v5 offset:49152
s_mov_b32 s11, 3833856
v_mfma_f32_16x16x32_bf16 v[200:203], v[92:95], v[40:43], v[200:203]
s_cbranch_vccnz LwQo8
LrQo8:
v_mfma_f32_16x16x32_bf16 v[204:207], v[92:95], v[44:47], v[204:207]
buffer_load_dwordx4 v15, s[48:51], s11 offen lds
v_mfma_f32_16x16x32_bf16 v[208:211], v[92:95], v[48:51], v[208:211]
s_add_u32 m0, s6, 10240
s_mov_b32 s11, 3280896
v_mfma_f32_16x16x32_bf16 v[212:215], v[92:95], v[52:55], v[212:215]
s_waitcnt lgkmcnt(3)
v_mfma_f32_16x16x32_bf16 v[116:119], v[96:99], v[56:59], v[116:119]
s_waitcnt vmcnt(6)
ds_read_b64_tr_b16 v[76:77], v6 offset:4096
v_mfma_f32_16x16x32_bf16 v[120:123], v[96:99], v[60:63], v[120:123]
ds_read_b64_tr_b16 v[80:81], v7 offset:4096
v_mfma_f32_16x16x32_bf16 v[124:127], v[96:99], v[64:67], v[124:127]
s_waitcnt lgkmcnt(2)
buffer_load_dwordx4 v11, s[48:51], s11 offen lds
v_mfma_f32_16x16x32_bf16 v[128:131], v[96:99], v[68:71], v[128:131]
ds_read_b64_tr_b16 v[84:85], v8 offset:4096
v_mfma_f32_16x16x32_bf16 v[132:135], v[96:99], v[72:75], v[132:135]
ds_read_b64_tr_b16 v[88:89], v9 offset:4096
v_mfma_f32_16x16x32_bf16 v[152:155], v[100:103], v[72:75], v[152:155]
ds_read_b64_tr_b16 v[92:93], v10 offset:0
v_mfma_f32_16x16x32_bf16 v[148:151], v[100:103], v[68:71], v[148:151]
ds_read_b64_tr_b16 v[94:95], v10 offset:2048
v_mfma_f32_16x16x32_bf16 v[144:147], v[100:103], v[64:67], v[144:147]
buffer_load_dwordx4 v12, s[48:51], s11 offen offset:1024 lds
v_mfma_f32_16x16x32_bf16 v[140:143], v[100:103], v[60:63], v[140:143]
ds_read_b128 v[36:39], v254 offset:0
s_add_u32 m0, s6, 4096
v_mfma_f32_16x16x32_bf16 v[136:139], v[100:103], v[56:59], v[136:139]
ds_read_b128 v[40:43], v254 offset:2048
s_mov_b32 s11, 3538944
v_mfma_f32_16x16x32_bf16 v[156:159], v[104:107], v[56:59], v[156:159]
ds_read_b32 v23, v21
v_mfma_f32_16x16x32_bf16 v[160:163], v[104:107], v[60:63], v[160:163]
ds_read_b128 v[44:47], v254 offset:4096
v_mov_b32 v24, 22
v_mfma_f32_16x16x32_bf16 v[164:167], v[104:107], v[64:67], v[164:167]
s_waitcnt lgkmcnt(5)
buffer_load_dwordx4 v11, s[48:51], s11 offen lds
v_mfma_f32_16x16x32_bf16 v[168:171], v[104:107], v[68:71], v[168:171]
s_waitcnt vmcnt(8) lgkmcnt(4)
ds_write_b32 v22, v24
v_mfma_f32_16x16x32_bf16 v[172:175], v[104:107], v[72:75], v[172:175]
s_waitcnt vmcnt(6)
ds_read_b64_tr_b16 v[78:79], v6 offset:6144
v_mfma_f32_16x16x32_bf16 v[192:195], v[108:111], v[72:75], v[192:195]
ds_read_b64_tr_b16 v[82:83], v7 offset:6144
v_mfma_f32_16x16x32_bf16 v[188:191], v[108:111], v[68:71], v[188:191]
ds_read_b64_tr_b16 v[86:87], v8 offset:6144
v_mfma_f32_16x16x32_bf16 v[184:187], v[108:111], v[64:67], v[184:187]
buffer_load_dwordx4 v12, s[48:51], s11 offen offset:1024 lds
v_mfma_f32_16x16x32_bf16 v[180:183], v[108:111], v[60:63], v[180:183]
ds_read_b64_tr_b16 v[90:91], v9 offset:6144
s_add_u32 m0, s20, 53248
v_mfma_f32_16x16x32_bf16 v[176:179], v[108:111], v[56:59], v[176:179]
ds_read_b128 v[48:51], v254 offset:6144
s_waitcnt lgkmcnt(6)
v_cmp_gt_u32 vcc, 21, v23
v_mfma_f32_16x16x32_bf16 v[196:199], v[112:115], v[56:59], v[196:199]
ds_read_b128 v[52:55], v254 offset:8192
s_mov_b32 s11, 4128768
v_mfma_f32_16x16x32_bf16 v[200:203], v[112:115], v[60:63], v[200:203]
s_cbranch_vccnz LwQo9
LrQo9:
v_mfma_f32_16x16x32_bf16 v[204:207], v[112:115], v[64:67], v[204:207]
buffer_load_dwordx4 v15, s[48:51], s11 offen lds
v_mfma_f32_16x16x32_bf16 v[208:211], v[112:115], v[68:71], v[208:211]
s_add_u32 m0, s6, 6144
s_mov_b32 s11, 3575808
v_mfma_f32_16x16x32_bf16 v[212:215], v[112:115], v[72:75], v[212:215]
s_waitcnt lgkmcnt(3)
v_mfma_f32_16x16x32_bf16 v[116:119], v[76:79], v[36:39], v[116:119]
s_waitcnt vmcnt(6)
ds_read_b64_tr_b16 v[96:97], v6 offset:8192
v_mfma_f32_16x16x32_bf16 v[120:123], v[76:79], v[40:43], v[120:123]
ds_read_b64_tr_b16 v[100:101], v7 offset:8192
v_mfma_f32_16x16x32_bf16 v[124:127], v[76:79], v[44:47], v[124:127]
s_waitcnt lgkmcnt(2)
buffer_load_dwordx4 v11, s[48:51], s11 offen lds
v_mfma_f32_16x16x32_bf16 v[128:131], v[76:79], v[48:51], v[128:131]
ds_read_b64_tr_b16 v[104:105], v8 offset:8192
v_mfma_f32_16x16x32_bf16 v[132:135], v[76:79], v[52:55], v[132:135]
ds_read_b64_tr_b16 v[108:109], v9 offset:8192
v_mfma_f32_16x16x32_bf16 v[152:155], v[80:83], v[52:55], v[152:155]
ds_read_b64_tr_b16 v[112:113], v10 offset:16384
v_mfma_f32_16x16x32_bf16 v[148:151], v[80:83], v[48:51], v[148:151]
ds_read_b64_tr_b16 v[114:115], v10 offset:18432
v_mfma_f32_16x16x32_bf16 v[144:147], v[80:83], v[44:47], v[144:147]
buffer_load_dwordx4 v12, s[48:51], s11 offen offset:1024 lds
v_mfma_f32_16x16x32_bf16 v[140:143], v[80:83], v[40:43], v[140:143]
ds_read_b128 v[56:59], v255 offset:0
s_add_u32 m0, s6, 8192
v_mfma_f32_16x16x32_bf16 v[136:139], v[80:83], v[36:39], v[136:139]
ds_read_b128 v[60:63], v255 offset:2048
s_mov_b32 s11, 3833856
v_mfma_f32_16x16x32_bf16 v[156:159], v[84:87], v[36:39], v[156:159]
ds_read_b32 v23, v21
v_mfma_f32_16x16x32_bf16 v[160:163], v[84:87], v[40:43], v[160:163]
ds_read_b128 v[64:67], v255 offset:4096
v_mov_b32 v24, 23
v_mfma_f32_16x16x32_bf16 v[164:167], v[84:87], v[44:47], v[164:167]
s_waitcnt lgkmcnt(5)
buffer_load_dwordx4 v11, s[48:51], s11 offen lds
v_mfma_f32_16x16x32_bf16 v[168:171], v[84:87], v[48:51], v[168:171]
s_waitcnt vmcnt(8) lgkmcnt(4)
ds_write_b32 v22, v24
v_mfma_f32_16x16x32_bf16 v[172:175], v[84:87], v[52:55], v[172:175]
s_waitcnt vmcnt(6)
ds_read_b64_tr_b16 v[98:99], v6 offset:10240
v_mfma_f32_16x16x32_bf16 v[192:195], v[88:91], v[52:55], v[192:195]
ds_read_b64_tr_b16 v[102:103], v7 offset:10240
v_mfma_f32_16x16x32_bf16 v[188:191], v[88:91], v[48:51], v[188:191]
ds_read_b64_tr_b16 v[106:107], v8 offset:10240
v_mfma_f32_16x16x32_bf16 v[184:187], v[88:91], v[44:47], v[184:187]
buffer_load_dwordx4 v12, s[48:51], s11 offen offset:1024 lds
v_mfma_f32_16x16x32_bf16 v[180:183], v[88:91], v[40:43], v[180:183]
ds_read_b64_tr_b16 v[110:111], v9 offset:10240
s_add_u32 m0, s20, 0
v_mfma_f32_16x16x32_bf16 v[176:179], v[88:91], v[36:39], v[176:179]
ds_read_b128 v[68:71], v255 offset:6144
s_waitcnt lgkmcnt(6)
v_cmp_gt_u32 vcc, 22, v23
v_mfma_f32_16x16x32_bf16 v[196:199], v[92:95], v[36:39], v[196:199]
ds_read_b128 v[72:75], v255 offset:8192
s_mov_b32 s11, 4423680
v_mfma_f32_16x16x32_bf16 v[200:203], v[92:95], v[40:43], v[200:203]
s_cbranch_vccnz LwQo10
LrQo10:
v_mfma_f32_16x16x32_bf16 v[204:207], v[92:95], v[44:47], v[204:207]
buffer_load_dwordx4 v15, s[48:51], s11 offen lds
v_mfma_f32_16x16x32_bf16 v[208:211], v[92:95], v[48:51], v[208:211]
s_add_u32 m0, s6, 10240
s_mov_b32 s11, 3870720
v_mfma_f32_16x16x32_bf16 v[212:215], v[92:95], v[52:55], v[212:215]
s_waitcnt lgkmcnt(3)
v_mfma_f32_16x16x32_bf16 v[116:119], v[96:99], v[56:59], v[116:119]
s_waitcnt vmcnt(6)
ds_read_b64_tr_b16 v[76:77], v6 offset:4096
v_mfma_f32_16x16x32_bf16 v[120:123], v[96:99], v[60:63], v[120:123]
ds_read_b64_tr_b16 v[80:81], v7 offset:4096
v_mfma_f32_16x16x32_bf16 v[124:127], v[96:99], v[64:67], v[124:127]
s_waitcnt lgkmcnt(2)
buffer_load_dwordx4 v11, s[48:51], s11 offen lds
v_mfma_f32_16x16x32_bf16 v[128:131], v[96:99], v[68:71], v[128:131]
ds_read_b64_tr_b16 v[84:85], v8 offset:4096
v_mfma_f32_16x16x32_bf16 v[132:135], v[96:99], v[72:75], v[132:135]
ds_read_b64_tr_b16 v[88:89], v9 offset:4096
v_mfma_f32_16x16x32_bf16 v[152:155], v[100:103], v[72:75], v[152:155]
ds_read_b64_tr_b16 v[92:93], v10 offset:32768
v_mfma_f32_16x16x32_bf16 v[148:151], v[100:103], v[68:71], v[148:151]
ds_read_b64_tr_b16 v[94:95], v10 offset:34816
v_mfma_f32_16x16x32_bf16 v[144:147], v[100:103], v[64:67], v[144:147]
buffer_load_dwordx4 v12, s[48:51], s11 offen offset:1024 lds
v_mfma_f32_16x16x32_bf16 v[140:143], v[100:103], v[60:63], v[140:143]
ds_read_b128 v[36:39], v254 offset:10240
s_add_u32 m0, s6, 4096
v_mfma_f32_16x16x32_bf16 v[136:139], v[100:103], v[56:59], v[136:139]
ds_read_b128 v[40:43], v254 offset:12288
s_mov_b32 s11, 4128768
v_mfma_f32_16x16x32_bf16 v[156:159], v[104:107], v[56:59], v[156:159]
ds_read_b32 v23, v21
v_mfma_f32_16x16x32_bf16 v[160:163], v[104:107], v[60:63], v[160:163]
ds_read_b128 v[44:47], v254 offset:14336
v_mov_b32 v24, 24
v_mfma_f32_16x16x32_bf16 v[164:167], v[104:107], v[64:67], v[164:167]
s_waitcnt lgkmcnt(5)
buffer_load_dwordx4 v11, s[48:51], s11 offen lds
v_mfma_f32_16x16x32_bf16 v[168:171], v[104:107], v[68:71], v[168:171]
s_waitcnt vmcnt(8) lgkmcnt(4)
ds_write_b32 v22, v24
v_mfma_f32_16x16x32_bf16 v[172:175], v[104:107], v[72:75], v[172:175]
s_waitcnt vmcnt(6)
ds_read_b64_tr_b16 v[78:79], v6 offset:6144
v_mfma_f32_16x16x32_bf16 v[192:195], v[108:111], v[72:75], v[192:195]
ds_read_b64_tr_b16 v[82:83], v7 offset:6144
v_mfma_f32_16x16x32_bf16 v[188:191], v[108:111], v[68:71], v[188:191]
ds_read_b64_tr_b16 v[86:87], v8 offset:6144
v_mfma_f32_16x16x32_bf16 v[184:187], v[108:111], v[64:67], v[184:187]
buffer_load_dwordx4 v12, s[48:51], s11 offen offset:1024 lds
v_mfma_f32_16x16x32_bf16 v[180:183], v[108:111], v[60:63], v[180:183]
ds_read_b64_tr_b16 v[90:91], v9 offset:6144
s_add_u32 m0, s20, 16384
v_mfma_f32_16x16x32_bf16 v[176:179], v[108:111], v[56:59], v[176:179]
ds_read_b128 v[48:51], v254 offset:16384
s_waitcnt lgkmcnt(6)
v_cmp_gt_u32 vcc, 23, v23
v_mfma_f32_16x16x32_bf16 v[196:199], v[112:115], v[56:59], v[196:199]
ds_read_b128 v[52:55], v254 offset:18432
s_mov_b32 s11, 4718592
v_mfma_f32_16x16x32_bf16 v[200:203], v[112:115], v[60:63], v[200:203]
s_cbranch_vccnz LwQo11
LrQo11:
v_mfma_f32_16x16x32_bf16 v[204:207], v[112:115], v[64:67], v[204:207]
buffer_load_dwordx4 v15, s[48:51], s11 offen lds
v_mfma_f32_16x16x32_bf16 v[208:211], v[112:115], v[68:71], v[208:211]
s_add_u32 m0, s6, 6144
s_mov_b32 s11, 4165632
v_mfma_f32_16x16x32_bf16 v[212:215], v[112:115], v[72:75], v[212:215]
s_waitcnt lgkmcnt(3)
v_mfma_f32_16x16x32_bf16 v[116:119], v[76:79], v[36:39], v[116:119]
s_waitcnt vmcnt(6)
ds_read_b64_tr_b16 v[96:97], v6 offset:8192
v_mfma_f32_16x16x32_bf16 v[120:123], v[76:79], v[40:43], v[120:123]
ds_read_b64_tr_b16 v[100:101], v7 offset:8192
v_mfma_f32_16x16x32_bf16 v[124:127], v[76:79], v[44:47], v[124:127]
s_waitcnt lgkmcnt(2)
buffer_load_dwordx4 v11, s[48:51], s11 offen lds
v_mfma_f32_16x16x32_bf16 v[128:131], v[76:79], v[48:51], v[128:131]
ds_read_b64_tr_b16 v[104:105], v8 offset:8192
v_mfma_f32_16x16x32_bf16 v[132:135], v[76:79], v[52:55], v[132:135]
ds_read_b64_tr_b16 v[108:109], v9 offset:8192
v_mfma_f32_16x16x32_bf16 v[152:155], v[80:83], v[52:55], v[152:155]
ds_read_b64_tr_b16 v[112:113], v10 offset:49152
v_mfma_f32_16x16x32_bf16 v[148:151], v[80:83], v[48:51], v[148:151]
ds_read_b64_tr_b16 v[114:115], v10 offset:51200
v_mfma_f32_16x16x32_bf16 v[144:147], v[80:83], v[44:47], v[144:147]
buffer_load_dwordx4 v12, s[48:51], s11 offen offset:1024 lds
v_mfma_f32_16x16x32_bf16 v[140:143], v[80:83], v[40:43], v[140:143]
ds_read_b128 v[56:59], v255 offset:10240
s_add_u32 m0, s6, 8192
v_mfma_f32_16x16x32_bf16 v[136:139], v[80:83], v[36:39], v[136:139]
ds_read_b128 v[60:63], v255 offset:12288
s_mov_b32 s11, 4423680
v_mfma_f32_16x16x32_bf16 v[156:159], v[84:87], v[36:39], v[156:159]
ds_read_b32 v23, v21
v_mfma_f32_16x16x32_bf16 v[160:163], v[84:87], v[40:43], v[160:163]
ds_read_b128 v[64:67], v255 offset:14336
v_mov_b32 v24, 25
v_mfma_f32_16x16x32_bf16 v[164:167], v[84:87], v[44:47], v[164:167]
s_waitcnt lgkmcnt(5)
buffer_load_dwordx4 v11, s[48:51], s11 offen lds
v_mfma_f32_16x16x32_bf16 v[168:171], v[84:87], v[48:51], v[168:171]
s_waitcnt vmcnt(8) lgkmcnt(4)
ds_write_b32 v22, v24
v_mfma_f32_16x16x32_bf16 v[172:175], v[84:87], v[52:55], v[172:175]
s_waitcnt vmcnt(6)
ds_read_b64_tr_b16 v[98:99], v6 offset:10240
v_mfma_f32_16x16x32_bf16 v[192:195], v[88:91], v[52:55], v[192:195]
ds_read_b64_tr_b16 v[102:103], v7 offset:10240
v_mfma_f32_16x16x32_bf16 v[188:191], v[88:91], v[48:51], v[188:191]
ds_read_b64_tr_b16 v[106:107], v8 offset:10240
v_mfma_f32_16x16x32_bf16 v[184:187], v[88:91], v[44:47], v[184:187]
buffer_load_dwordx4 v12, s[48:51], s11 offen offset:1024 lds
v_mfma_f32_16x16x32_bf16 v[180:183], v[88:91], v[40:43], v[180:183]
ds_read_b64_tr_b16 v[110:111], v9 offset:10240
s_add_u32 m0, s20, 32768
v_mfma_f32_16x16x32_bf16 v[176:179], v[88:91], v[36:39], v[176:179]
ds_read_b128 v[68:71], v255 offset:16384
s_waitcnt lgkmcnt(6)
v_cmp_gt_u32 vcc, 24, v23
v_mfma_f32_16x16x32_bf16 v[196:199], v[92:95], v[36:39], v[196:199]
ds_read_b128 v[72:75], v255 offset:18432
s_mov_b32 s11, 5013504
v_mfma_f32_16x16x32_bf16 v[200:203], v[92:95], v[40:43], v[200:203]
s_cbranch_vccnz LwQo12
LrQo12:
v_mfma_f32_16x16x32_bf16 v[204:207], v[92:95], v[44:47], v[204:207]
buffer_load_dwordx4 v15, s[48:51], s11 offen lds
v_mfma_f32_16x16x32_bf16 v[208:211], v[92:95], v[48:51], v[208:211]
s_add_u32 m0, s6, 10240
s_mov_b32 s11, 4460544
v_mfma_f32_16x16x32_bf16 v[212:215], v[92:95], v[52:55], v[212:215]
s_waitcnt lgkmcnt(3)
v_mfma_f32_16x16x32_bf16 v[116:119], v[96:99], v[56:59], v[116:119]
s_waitcnt vmcnt(6)
ds_read_b64_tr_b16 v[76:77], v6 offset:4096
v_mfma_f32_16x16x32_bf16 v[120:123], v[96:99], v[60:63], v[120:123]
ds_read_b64_tr_b16 v[80:81], v7 offset:4096
v_mfma_f32_16x16x32_bf16 v[124:127], v[96:99], v[64:67], v[124:127]
s_waitcnt lgkmcnt(2)
buffer_load_dwordx4 v11, s[48:51], s11 offen lds
v_mfma_f32_16x16x32_bf16 v[128:131], v[96:99], v[68:71], v[128:131]
ds_read_b64_tr_b16 v[84:85], v8 offset:4096
v_mfma_f32_16x16x32_bf16 v[132:135], v[96:99], v[72:75], v[132:135]
ds_read_b64_tr_b16 v[88:89], v9 offset:4096
v_mfma_f32_16x16x32_bf16 v[152:155], v[100:103], v[72:75], v[152:155]
ds_read_b64_tr_b16 v[92:93], v10 offset:53248
v_mfma_f32_16x16x32_bf16 v[148:151], v[100:103], v[68:71], v[148:151]
ds_read_b64_tr_b16 v[94:95], v10 offset:55296
v_mfma_f32_16x16x32_bf16 v[144:147], v[100:103], v[64:67], v[144:147]
buffer_load_dwordx4 v12, s[48:51], s11 offen offset:1024 lds
v_mfma_f32_16x16x32_bf16 v[140:143], v[100:103], v[60:63], v[140:143]
ds_read_b128 v[36:39], v254 offset:20480
s_add_u32 m0, s6, 4096
v_mfma_f32_16x16x32_bf16 v[136:139], v[100:103], v[56:59], v[136:139]
ds_read_b128 v[40:43], v254 offset:22528
s_mov_b32 s11, 4718592
v_mfma_f32_16x16x32_bf16 v[156:159], v[104:107], v[56:59], v[156:159]
ds_read_b32 v23, v21
v_mfma_f32_16x16x32_bf16 v[160:163], v[104:107], v[60:63], v[160:163]
ds_read_b128 v[44:47], v254 offset:24576
v_mov_b32 v24, 26
v_mfma_f32_16x16x32_bf16 v[164:167], v[104:107], v[64:67], v[164:167]
s_waitcnt lgkmcnt(5)
buffer_load_dwordx4 v11, s[48:51], s11 offen lds
v_mfma_f32_16x16x32_bf16 v[168:171], v[104:107], v[68:71], v[168:171]
s_waitcnt vmcnt(8) lgkmcnt(4)
ds_write_b32 v22, v24
v_mfma_f32_16x16x32_bf16 v[172:175], v[104:107], v[72:75], v[172:175]
s_waitcnt vmcnt(6)
ds_read_b64_tr_b16 v[78:79], v6 offset:6144
v_mfma_f32_16x16x32_bf16 v[192:195], v[108:111], v[72:75], v[192:195]
ds_read_b64_tr_b16 v[82:83], v7 offset:6144
v_mfma_f32_16x16x32_bf16 v[188:191], v[108:111], v[68:71], v[188:191]
ds_read_b64_tr_b16 v[86:87], v8 offset:6144
v_mfma_f32_16x16x32_bf16 v[184:187], v[108:111], v[64:67], v[184:187]
buffer_load_dwordx4 v12, s[48:51], s11 offen offset:1024 lds
v_mfma_f32_16x16x32_bf16 v[180:183], v[108:111], v[60:63], v[180:183]
ds_read_b64_tr_b16 v[90:91], v9 offset:6144
v_mfma_f32_16x16x32_bf16 v[176:179], v[108:111], v[56:59], v[176:179]
ds_read_b128 v[48:51], v254 offset:26624
s_waitcnt lgkmcnt(6)
v_cmp_gt_u32 vcc, 25, v23
v_mfma_f32_16x16x32_bf16 v[196:199], v[112:115], v[56:59], v[196:199]
ds_read_b128 v[52:55], v254 offset:28672
v_mfma_f32_16x16x32_bf16 v[200:203], v[112:115], v[60:63], v[200:203]
s_cbranch_vccnz LwQo13
LrQo13:
v_mfma_f32_16x16x32_bf16 v[204:207], v[112:115], v[64:67], v[204:207]
v_mfma_f32_16x16x32_bf16 v[208:211], v[112:115], v[68:71], v[208:211]
s_add_u32 m0, s6, 6144
s_mov_b32 s11, 4755456
v_mfma_f32_16x16x32_bf16 v[212:215], v[112:115], v[72:75], v[212:215]
s_waitcnt lgkmcnt(3)
v_mfma_f32_16x16x32_bf16 v[116:119], v[76:79], v[36:39], v[116:119]
s_waitcnt vmcnt(5)
ds_read_b64_tr_b16 v[96:97], v6 offset:8192
v_mfma_f32_16x16x32_bf16 v[120:123], v[76:79], v[40:43], v[120:123]
ds_read_b64_tr_b16 v[100:101], v7 offset:8192
v_mfma_f32_16x16x32_bf16 v[124:127], v[76:79], v[44:47], v[124:127]
s_waitcnt lgkmcnt(2)
buffer_load_dwordx4 v11, s[48:51], s11 offen lds
v_mfma_f32_16x16x32_bf16 v[128:131], v[76:79], v[48:51], v[128:131]
ds_read_b64_tr_b16 v[104:105], v8 offset:8192
v_mfma_f32_16x16x32_bf16 v[132:135], v[76:79], v[52:55], v[132:135]
ds_read_b64_tr_b16 v[108:109], v9 offset:8192
v_mfma_f32_16x16x32_bf16 v[152:155], v[80:83], v[52:55], v[152:155]
ds_read_b64_tr_b16 v[112:113], v10 offset:0
v_mfma_f32_16x16x32_bf16 v[148:151], v[80:83], v[48:51], v[148:151]
ds_read_b64_tr_b16 v[114:115], v10 offset:2048
v_mfma_f32_16x16x32_bf16 v[144:147], v[80:83], v[44:47], v[144:147]
buffer_load_dwordx4 v12, s[48:51], s11 offen offset:1024 lds
v_mfma_f32_16x16x32_bf16 v[140:143], v[80:83], v[40:43], v[140:143]
ds_read_b128 v[56:59], v255 offset:20480
s_add_u32 m0, s6, 8192
v_mfma_f32_16x16x32_bf16 v[136:139], v[80:83], v[36:39], v[136:139]
ds_read_b128 v[60:63], v255 offset:22528
s_mov_b32 s11, 5013504
v_mfma_f32_16x16x32_bf16 v[156:159], v[84:87], v[36:39], v[156:159]
ds_read_b32 v23, v21
v_mfma_f32_16x16x32_bf16 v[160:163], v[84:87], v[40:43], v[160:163]
ds_read_b128 v[64:67], v255 offset:24576
v_mov_b32 v24, 27
v_mfma_f32_16x16x32_bf16 v[164:167], v[84:87], v[44:47], v[164:167]
s_waitcnt lgkmcnt(5)
buffer_load_dwordx4 v11, s[48:51], s11 offen lds
v_mfma_f32_16x16x32_bf16 v[168:171], v[84:87], v[48:51], v[168:171]
s_waitcnt vmcnt(7) lgkmcnt(4)
ds_write_b32 v22, v24
v_mfma_f32_16x16x32_bf16 v[172:175], v[84:87], v[52:55], v[172:175]
s_waitcnt vmcnt(5)
ds_read_b64_tr_b16 v[98:99], v6 offset:10240
v_mfma_f32_16x16x32_bf16 v[192:195], v[88:91], v[52:55], v[192:195]
ds_read_b64_tr_b16 v[102:103], v7 offset:10240
v_mfma_f32_16x16x32_bf16 v[188:191], v[88:91], v[48:51], v[188:191]
ds_read_b64_tr_b16 v[106:107], v8 offset:10240
v_mfma_f32_16x16x32_bf16 v[184:187], v[88:91], v[44:47], v[184:187]
buffer_load_dwordx4 v12, s[48:51], s11 offen offset:1024 lds
v_mfma_f32_16x16x32_bf16 v[180:183], v[88:91], v[40:43], v[180:183]
ds_read_b64_tr_b16 v[110:111], v9 offset:10240
v_mfma_f32_16x16x32_bf16 v[176:179], v[88:91], v[36:39], v[176:179]
ds_read_b128 v[68:71], v255 offset:26624
s_waitcnt lgkmcnt(6)
v_cmp_gt_u32 vcc, 26, v23
v_mfma_f32_16x16x32_bf16 v[196:199], v[92:95], v[36:39], v[196:199]
ds_read_b128 v[72:75], v255 offset:28672
v_mfma_f32_16x16x32_bf16 v[200:203], v[92:95], v[40:43], v[200:203]
s_cbranch_vccnz LwQo14
LrQo14:
v_mfma_f32_16x16x32_bf16 v[204:207], v[92:95], v[44:47], v[204:207]
v_mfma_f32_16x16x32_bf16 v[208:211], v[92:95], v[48:51], v[208:211]
s_add_u32 m0, s6, 10240
s_mov_b32 s11, 5050368
v_mfma_f32_16x16x32_bf16 v[212:215], v[92:95], v[52:55], v[212:215]
s_waitcnt lgkmcnt(3)
v_mfma_f32_16x16x32_bf16 v[116:119], v[96:99], v[56:59], v[116:119]
s_waitcnt vmcnt(4)
ds_read_b64_tr_b16 v[76:77], v6 offset:4096
v_mfma_f32_16x16x32_bf16 v[120:123], v[96:99], v[60:63], v[120:123]
ds_read_b64_tr_b16 v[80:81], v7 offset:4096
v_mfma_f32_16x16x32_bf16 v[124:127], v[96:99], v[64:67], v[124:127]
s_waitcnt lgkmcnt(2)
buffer_load_dwordx4 v11, s[48:51], s11 offen lds
v_mfma_f32_16x16x32_bf16 v[128:131], v[96:99], v[68:71], v[128:131]
ds_read_b64_tr_b16 v[84:85], v8 offset:4096
v_mfma_f32_16x16x32_bf16 v[132:135], v[96:99], v[72:75], v[132:135]
ds_read_b64_tr_b16 v[88:89], v9 offset:4096
v_mfma_f32_16x16x32_bf16 v[152:155], v[100:103], v[72:75], v[152:155]
ds_read_b64_tr_b16 v[92:93], v10 offset:16384
v_mfma_f32_16x16x32_bf16 v[148:151], v[100:103], v[68:71], v[148:151]
ds_read_b64_tr_b16 v[94:95], v10 offset:18432
v_mfma_f32_16x16x32_bf16 v[144:147], v[100:103], v[64:67], v[144:147]
buffer_load_dwordx4 v12, s[48:51], s11 offen offset:1024 lds
v_mfma_f32_16x16x32_bf16 v[140:143], v[100:103], v[60:63], v[140:143]
ds_read_b128 v[36:39], v254 offset:30720
v_mfma_f32_16x16x32_bf16 v[136:139], v[100:103], v[56:59], v[136:139]
ds_read_b128 v[40:43], v254 offset:32768
v_mfma_f32_16x16x32_bf16 v[156:159], v[104:107], v[56:59], v[156:159]
ds_read_b32 v23, v21
v_mfma_f32_16x16x32_bf16 v[160:163], v[104:107], v[60:63], v[160:163]
ds_read_b128 v[44:47], v254 offset:34816
v_mov_b32 v24, 28
v_mfma_f32_16x16x32_bf16 v[164:167], v[104:107], v[64:67], v[164:167]
v_mfma_f32_16x16x32_bf16 v[168:171], v[104:107], v[68:71], v[168:171]
s_waitcnt lgkmcnt(4)
ds_write_b32 v22, v24
v_mfma_f32_16x16x32_bf16 v[172:175], v[104:107], v[72:75], v[172:175]
s_waitcnt vmcnt(4)
ds_read_b64_tr_b16 v[78:79], v6 offset:6144
v_mfma_f32_16x16x32_bf16 v[192:195], v[108:111], v[72:75], v[192:195]
ds_read_b64_tr_b16 v[82:83], v7 offset:6144
v_mfma_f32_16x16x32_bf16 v[188:191], v[108:111], v[68:71], v[188:191]
ds_read_b64_tr_b16 v[86:87], v8 offset:6144
v_mfma_f32_16x16x32_bf16 v[184:187], v[108:111], v[64:67], v[184:187]
v_mfma_f32_16x16x32_bf16 v[180:183], v[108:111], v[60:63], v[180:183]
ds_read_b64_tr_b16 v[90:91], v9 offset:6144
v_mfma_f32_16x16x32_bf16 v[176:179], v[108:111], v[56:59], v[176:179]
ds_read_b128 v[48:51], v254 offset:36864
s_waitcnt lgkmcnt(6)
v_cmp_gt_u32 vcc, 27, v23
v_mfma_f32_16x16x32_bf16 v[196:199], v[112:115], v[56:59], v[196:199]
ds_read_b128 v[52:55], v254 offset:38912
v_mfma_f32_16x16x32_bf16 v[200:203], v[112:115], v[60:63], v[200:203]
s_cbranch_vccnz LwQo15
LrQo15:
v_mfma_f32_16x16x32_bf16 v[204:207], v[112:115], v[64:67], v[204:207]
v_mfma_f32_16x16x32_bf16 v[208:211], v[112:115], v[68:71], v[208:211]
v_mfma_f32_16x16x32_bf16 v[212:215], v[112:115], v[72:75], v[212:215]
s_waitcnt lgkmcnt(3)
v_mfma_f32_16x16x32_bf16 v[116:119], v[76:79], v[36:39], v[116:119]
s_waitcnt vmcnt(2)
ds_read_b64_tr_b16 v[96:97], v6 offset:8192
v_mfma_f32_16x16x32_bf16 v[120:123], v[76:79], v[40:43], v[120:123]
ds_read_b64_tr_b16 v[100:101], v7 offset:8192
v_mfma_f32_16x16x32_bf16 v[124:127], v[76:79], v[44:47], v[124:127]
s_waitcnt lgkmcnt(2)
v_mfma_f32_16x16x32_bf16 v[128:131], v[76:79], v[48:51], v[128:131]
ds_read_b64_tr_b16 v[104:105], v8 offset:8192
v_mfma_f32_16x16x32_bf16 v[132:135], v[76:79], v[52:55], v[132:135]
ds_read_b64_tr_b16 v[108:109], v9 offset:8192
v_mfma_f32_16x16x32_bf16 v[152:155], v[80:83], v[52:55], v[152:155]
ds_read_b64_tr_b16 v[112:113], v10 offset:32768
v_mfma_f32_16x16x32_bf16 v[148:151], v[80:83], v[48:51], v[148:151]
ds_read_b64_tr_b16 v[114:115], v10 offset:34816
v_mfma_f32_16x16x32_bf16 v[144:147], v[80:83], v[44:47], v[144:147]
v_mfma_f32_16x16x32_bf16 v[140:143], v[80:83], v[40:43], v[140:143]
ds_read_b128 v[56:59], v255 offset:30720
s_add_u32 m0, s6, 8192
v_mfma_f32_16x16x32_bf16 v[136:139], v[80:83], v[36:39], v[136:139]
ds_read_b128 v[60:63], v255 offset:32768
s_mov_b32 s11, 0
v_mfma_f32_16x16x32_bf16 v[156:159], v[84:87], v[36:39], v[156:159]
v_mfma_f32_16x16x32_bf16 v[160:163], v[84:87], v[40:43], v[160:163]
ds_read_b128 v[64:67], v255 offset:34816
v_mov_b32 v24, 29
v_mfma_f32_16x16x32_bf16 v[164:167], v[84:87], v[44:47], v[164:167]
s_waitcnt lgkmcnt(4)
buffer_load_dwordx4 v13, s[52:55], s11 offen lds
v_mfma_f32_16x16x32_bf16 v[168:171], v[84:87], v[48:51], v[168:171]
s_waitcnt lgkmcnt(3)
ds_write_b32 v22, v24
v_mfma_f32_16x16x32_bf16 v[172:175], v[84:87], v[52:55], v[172:175]
s_waitcnt vmcnt(1)
ds_read_b64_tr_b16 v[98:99], v6 offset:10240
v_mfma_f32_16x16x32_bf16 v[192:195], v[88:91], v[52:55], v[192:195]
ds_read_b64_tr_b16 v[102:103], v7 offset:10240
v_mfma_f32_16x16x32_bf16 v[188:191], v[88:91], v[48:51], v[188:191]
ds_read_b64_tr_b16 v[106:107], v8 offset:10240
v_mfma_f32_16x16x32_bf16 v[184:187], v[88:91], v[44:47], v[184:187]
buffer_load_dwordx4 v14, s[52:55], s11 offen offset:1024 lds
v_mfma_f32_16x16x32_bf16 v[180:183], v[88:91], v[40:43], v[180:183]
ds_read_b64_tr_b16 v[110:111], v9 offset:10240
v_mfma_f32_16x16x32_bf16 v[176:179], v[88:91], v[36:39], v[176:179]
ds_read_b128 v[68:71], v255 offset:36864
v_mfma_f32_16x16x32_bf16 v[196:199], v[92:95], v[36:39], v[196:199]
ds_read_b128 v[72:75], v255 offset:38912
v_mfma_f32_16x16x32_bf16 v[200:203], v[92:95], v[40:43], v[200:203]
v_mfma_f32_16x16x32_bf16 v[204:207], v[92:95], v[44:47], v[204:207]
v_mfma_f32_16x16x32_bf16 v[208:211], v[92:95], v[48:51], v[208:211]
s_add_u32 m0, s6, 10240
s_mov_b32 s11, 18432
v_mfma_f32_16x16x32_bf16 v[212:215], v[92:95], v[52:55], v[212:215]
s_waitcnt lgkmcnt(3)
v_mfma_f32_16x16x32_bf16 v[116:119], v[96:99], v[56:59], v[116:119]
v_mfma_f32_16x16x32_bf16 v[120:123], v[96:99], v[60:63], v[120:123]
v_mfma_f32_16x16x32_bf16 v[124:127], v[96:99], v[64:67], v[124:127]
s_waitcnt lgkmcnt(0)
buffer_load_dwordx4 v13, s[52:55], s11 offen lds
v_mfma_f32_16x16x32_bf16 v[128:131], v[96:99], v[68:71], v[128:131]
v_mfma_f32_16x16x32_bf16 v[132:135], v[96:99], v[72:75], v[132:135]
v_mfma_f32_16x16x32_bf16 v[152:155], v[100:103], v[72:75], v[152:155]
v_mfma_f32_16x16x32_bf16 v[148:151], v[100:103], v[68:71], v[148:151]
v_mfma_f32_16x16x32_bf16 v[144:147], v[100:103], v[64:67], v[144:147]
buffer_load_dwordx4 v14, s[52:55], s11 offen offset:1024 lds
v_mfma_f32_16x16x32_bf16 v[140:143], v[100:103], v[60:63], v[140:143]
v_mfma_f32_16x16x32_bf16 v[136:139], v[100:103], v[56:59], v[136:139]
v_mfma_f32_16x16x32_bf16 v[156:159], v[104:107], v[56:59], v[156:159]
v_mfma_f32_16x16x32_bf16 v[160:163], v[104:107], v[60:63], v[160:163]
v_mov_b32 v24, 30
v_mfma_f32_16x16x32_bf16 v[164:167], v[104:107], v[64:67], v[164:167]
v_mfma_f32_16x16x32_bf16 v[168:171], v[104:107], v[68:71], v[168:171]
ds_write_b32 v22, v24
v_mfma_f32_16x16x32_bf16 v[172:175], v[104:107], v[72:75], v[172:175]
v_mfma_f32_16x16x32_bf16 v[192:195], v[108:111], v[72:75], v[192:195]
v_mfma_f32_16x16x32_bf16 v[188:191], v[108:111], v[68:71], v[188:191]
v_mfma_f32_16x16x32_bf16 v[184:187], v[108:111], v[64:67], v[184:187]
v_mfma_f32_16x16x32_bf16 v[180:183], v[108:111], v[60:63], v[180:183]
v_mfma_f32_16x16x32_bf16 v[176:179], v[108:111], v[56:59], v[176:179]
v_mfma_f32_16x16x32_bf16 v[196:199], v[112:115], v[56:59], v[196:199]
v_mfma_f32_16x16x32_bf16 v[200:203], v[112:115], v[60:63], v[200:203]
v_mfma_f32_16x16x32_bf16 v[204:207], v[112:115], v[64:67], v[204:207]
v_mfma_f32_16x16x32_bf16 v[208:211], v[112:115], v[68:71], v[208:211]
v_mfma_f32_16x16x32_bf16 v[212:215], v[112:115], v[72:75], v[212:215]
s_setprio 0
s_nop 7
v_mov_b32_dpp v238, v132 row_newbcast:15 row_mask:0xf bank_mask:0xf
v_mov_b32_dpp v239, v133 row_newbcast:15 row_mask:0xf bank_mask:0xf
v_mov_b32_dpp v240, v134 row_newbcast:15 row_mask:0xf bank_mask:0xf
v_mov_b32_dpp v241, v135 row_newbcast:15 row_mask:0xf bank_mask:0xf
v_lshlrev_b32 v242, 16, v216
v_and_b32 v243, 0xffff0000, v216
v_lshlrev_b32 v244, 16, v217
v_and_b32 v245, 0xffff0000, v217
v_mul_f32 v242, 0x3fb8aa3b, v242
v_mul_f32 v243, 0x3fb8aa3b, v243
v_mul_f32 v244, 0x3fb8aa3b, v244
v_mul_f32 v245, 0x3fb8aa3b, v245
v_mov_b32_dpp v246, v152 row_newbcast:15 row_mask:0xf bank_mask:0xf
v_mov_b32_dpp v247, v153 row_newbcast:15 row_mask:0xf bank_mask:0xf
v_mov_b32_dpp v248, v154 row_newbcast:15 row_mask:0xf bank_mask:0xf
v_mov_b32_dpp v249, v155 row_newbcast:15 row_mask:0xf bank_mask:0xf
v_lshlrev_b32 v250, 16, v218
v_and_b32 v251, 0xffff0000, v218
v_lshlrev_b32 v252, 16, v219
v_and_b32 v253, 0xffff0000, v219
v_mul_f32 v250, 0x3fb8aa3b, v250
v_mul_f32 v251, 0x3fb8aa3b, v251
v_mul_f32 v252, 0x3fb8aa3b, v252
v_mul_f32 v253, 0x3fb8aa3b, v253
v_fma_f32 v28, -v238, v233, v242
v_fma_f32 v29, -v239, v233, v243
v_fma_f32 v30, -v240, v233, v244
v_fma_f32 v31, -v241, v233, v245
v_fma_f32 v116, v116, v228, v28
v_fma_f32 v117, v117, v228, v29
v_fma_f32 v118, v118, v228, v30
v_fma_f32 v119, v119, v228, v31
v_exp_f32 v28, v116
v_exp_f32 v29, v117
v_exp_f32 v30, v118
v_exp_f32 v31, v119
v_fma_f32 v28, v28, s9, s9
v_fma_f32 v29, v29, s9, s9
v_fma_f32 v30, v30, s9, s9
v_fma_f32 v31, v31, s9, s9
v_fma_f32 v28, v28, v28, 0.5
v_fma_f32 v29, v29, v29, 0.5
v_fma_f32 v30, v30, v30, 0.5
v_fma_f32 v31, v31, v31, 0.5
v_rcp_f32 v28, v28
v_rcp_f32 v29, v29
v_rcp_f32 v30, v30
v_rcp_f32 v31, v31
v_fma_f32 v28, -v116, v28, v116
v_fma_f32 v29, -v117, v29, v117
v_fma_f32 v30, -v118, v30, v118
v_fma_f32 v31, -v119, v31, v119
v_cvt_pk_bf16_f32 v116, v28, v29
v_cvt_pk_bf16_f32 v117, v30, v31
v_fma_f32 v32, -v246, v233, v250
v_fma_f32 v33, -v247, v233, v251
v_fma_f32 v34, -v248, v233, v252
v_fma_f32 v35, -v249, v233, v253
v_fma_f32 v136, v136, v228, v32
v_fma_f32 v137, v137, v228, v33
v_fma_f32 v138, v138, v228, v34
v_fma_f32 v139, v139, v228, v35
v_exp_f32 v32, v136
v_exp_f32 v33, v137
v_exp_f32 v34, v138
v_exp_f32 v35, v139
v_fma_f32 v32, v32, s9, s9
v_fma_f32 v33, v33, s9, s9
v_fma_f32 v34, v34, s9, s9
v_fma_f32 v35, v35, s9, s9
v_fma_f32 v32, v32, v32, 0.5
v_fma_f32 v33, v33, v33, 0.5
v_fma_f32 v34, v34, v34, 0.5
v_fma_f32 v35, v35, v35, 0.5
v_rcp_f32 v32, v32
v_rcp_f32 v33, v33
v_rcp_f32 v34, v34
v_rcp_f32 v35, v35
v_fma_f32 v32, -v136, v32, v136
v_fma_f32 v33, -v137, v33, v137
v_fma_f32 v34, -v138, v34, v138
v_fma_f32 v35, -v139, v35, v139
v_cvt_pk_bf16_f32 v118, v32, v33
v_cvt_pk_bf16_f32 v119, v34, v35
v_fma_f32 v28, -v238, v234, v242
v_fma_f32 v29, -v239, v234, v243
v_fma_f32 v30, -v240, v234, v244
v_fma_f32 v31, -v241, v234, v245
v_fma_f32 v120, v120, v229, v28
v_fma_f32 v121, v121, v229, v29
v_fma_f32 v122, v122, v229, v30
v_fma_f32 v123, v123, v229, v31
v_exp_f32 v28, v120
v_exp_f32 v29, v121
v_exp_f32 v30, v122
v_exp_f32 v31, v123
v_fma_f32 v28, v28, s9, s9
v_fma_f32 v29, v29, s9, s9
v_fma_f32 v30, v30, s9, s9
v_fma_f32 v31, v31, s9, s9
v_fma_f32 v28, v28, v28, 0.5
v_fma_f32 v29, v29, v29, 0.5
v_fma_f32 v30, v30, v30, 0.5
v_fma_f32 v31, v31, v31, 0.5
v_rcp_f32 v28, v28
v_rcp_f32 v29, v29
v_rcp_f32 v30, v30
v_rcp_f32 v31, v31
v_fma_f32 v28, -v120, v28, v120
v_fma_f32 v29, -v121, v29, v121
v_fma_f32 v30, -v122, v30, v122
v_fma_f32 v31, -v123, v31, v123
v_cvt_pk_bf16_f32 v120, v28, v29
v_cvt_pk_bf16_f32 v121, v30, v31
v_fma_f32 v32, -v246, v234, v250
v_fma_f32 v33, -v247, v234, v251
v_fma_f32 v34, -v248, v234, v252
v_fma_f32 v35, -v249, v234, v253
v_fma_f32 v140, v140, v229, v32
v_fma_f32 v141, v141, v229, v33
v_fma_f32 v142, v142, v229, v34
v_fma_f32 v143, v143, v229, v35
v_exp_f32 v32, v140
v_exp_f32 v33, v141
v_exp_f32 v34, v142
v_exp_f32 v35, v143
v_fma_f32 v32, v32, s9, s9
v_fma_f32 v33, v33, s9, s9
v_fma_f32 v34, v34, s9, s9
v_fma_f32 v35, v35, s9, s9
v_fma_f32 v32, v32, v32, 0.5
v_fma_f32 v33, v33, v33, 0.5
v_fma_f32 v34, v34, v34, 0.5
v_fma_f32 v35, v35, v35, 0.5
v_rcp_f32 v32, v32
v_rcp_f32 v33, v33
v_rcp_f32 v34, v34
v_rcp_f32 v35, v35
v_fma_f32 v32, -v140, v32, v140
v_fma_f32 v33, -v141, v33, v141
v_fma_f32 v34, -v142, v34, v142
v_fma_f32 v35, -v143, v35, v143
v_cvt_pk_bf16_f32 v122, v32, v33
v_cvt_pk_bf16_f32 v123, v34, v35
ds_read_b32 v27, v21
s_waitcnt lgkmcnt(0)
v_cmp_gt_u32 vcc, 30, v27
s_cbranch_vccnz LwQa
LrQa:
ds_read_b32 v27, v20
s_waitcnt lgkmcnt(0)
v_cmp_gt_u32 vcc, 3, v27
s_cbranch_vccnz LwQp
LrQp:
ds_write_b128 v16, v[116:119] offset:0
ds_write_b128 v16, v[120:123] offset:1024
v_fma_f32 v28, -v238, v235, v242
v_fma_f32 v29, -v239, v235, v243
v_fma_f32 v30, -v240, v235, v244
v_fma_f32 v31, -v241, v235, v245
v_fma_f32 v124, v124, v230, v28
v_fma_f32 v125, v125, v230, v29
v_fma_f32 v126, v126, v230, v30
v_fma_f32 v127, v127, v230, v31
v_exp_f32 v28, v124
v_exp_f32 v29, v125
v_exp_f32 v30, v126
v_exp_f32 v31, v127
v_fma_f32 v28, v28, s9, s9
v_fma_f32 v29, v29, s9, s9
v_fma_f32 v30, v30, s9, s9
v_fma_f32 v31, v31, s9, s9
v_fma_f32 v28, v28, v28, 0.5
v_fma_f32 v29, v29, v29, 0.5
v_fma_f32 v30, v30, v30, 0.5
v_fma_f32 v31, v31, v31, 0.5
v_rcp_f32 v28, v28
v_rcp_f32 v29, v29
v_rcp_f32 v30, v30
v_rcp_f32 v31, v31
v_fma_f32 v28, -v124, v28, v124
v_fma_f32 v29, -v125, v29, v125
v_fma_f32 v30, -v126, v30, v126
v_fma_f32 v31, -v127, v31, v127
v_cvt_pk_bf16_f32 v124, v28, v29
v_cvt_pk_bf16_f32 v125, v30, v31
v_fma_f32 v32, -v246, v235, v250
v_fma_f32 v33, -v247, v235, v251
v_fma_f32 v34, -v248, v235, v252
v_fma_f32 v35, -v249, v235, v253
v_fma_f32 v144, v144, v230, v32
v_fma_f32 v145, v145, v230, v33
v_fma_f32 v146, v146, v230, v34
v_fma_f32 v147, v147, v230, v35
v_exp_f32 v32, v144
v_exp_f32 v33, v145
v_exp_f32 v34, v146
v_exp_f32 v35, v147
v_fma_f32 v32, v32, s9, s9
v_fma_f32 v33, v33, s9, s9
v_fma_f32 v34, v34, s9, s9
v_fma_f32 v35, v35, s9, s9
v_fma_f32 v32, v32, v32, 0.5
v_fma_f32 v33, v33, v33, 0.5
v_fma_f32 v34, v34, v34, 0.5
v_fma_f32 v35, v35, v35, 0.5
v_rcp_f32 v32, v32
v_rcp_f32 v33, v33
v_rcp_f32 v34, v34
v_rcp_f32 v35, v35
v_fma_f32 v32, -v144, v32, v144
v_fma_f32 v33, -v145, v33, v145
v_fma_f32 v34, -v146, v34, v146
v_fma_f32 v35, -v147, v35, v147
v_cvt_pk_bf16_f32 v126, v32, v33
v_cvt_pk_bf16_f32 v127, v34, v35
ds_write_b128 v16, v[124:127] offset:2048
v_fma_f32 v28, -v238, v236, v242
v_fma_f32 v29, -v239, v236, v243
v_fma_f32 v30, -v240, v236, v244
v_fma_f32 v31, -v241, v236, v245
v_fma_f32 v128, v128, v231, v28
v_fma_f32 v129, v129, v231, v29
v_fma_f32 v130, v130, v231, v30
v_fma_f32 v131, v131, v231, v31
v_exp_f32 v28, v128
v_exp_f32 v29, v129
v_exp_f32 v30, v130
v_exp_f32 v31, v131
v_fma_f32 v28, v28, s9, s9
v_fma_f32 v29, v29, s9, s9
v_fma_f32 v30, v30, s9, s9
v_fma_f32 v31, v31, s9, s9
v_fma_f32 v28, v28, v28, 0.5
v_fma_f32 v29, v29, v29, 0.5
v_fma_f32 v30, v30, v30, 0.5
v_fma_f32 v31, v31, v31, 0.5
v_rcp_f32 v28, v28
v_rcp_f32 v29, v29
v_rcp_f32 v30, v30
v_rcp_f32 v31, v31
v_fma_f32 v28, -v128, v28, v128
v_fma_f32 v29, -v129, v29, v129
v_fma_f32 v30, -v130, v30, v130
v_fma_f32 v31, -v131, v31, v131
v_cvt_pk_bf16_f32 v128, v28, v29
v_cvt_pk_bf16_f32 v129, v30, v31
v_fma_f32 v32, -v246, v236, v250
v_fma_f32 v33, -v247, v236, v251
v_fma_f32 v34, -v248, v236, v252
v_fma_f32 v35, -v249, v236, v253
v_fma_f32 v148, v148, v231, v32
v_fma_f32 v149, v149, v231, v33
v_fma_f32 v150, v150, v231, v34
v_fma_f32 v151, v151, v231, v35
v_exp_f32 v32, v148
v_exp_f32 v33, v149
v_exp_f32 v34, v150
v_exp_f32 v35, v151
v_fma_f32 v32, v32, s9, s9
v_fma_f32 v33, v33, s9, s9
v_fma_f32 v34, v34, s9, s9
v_fma_f32 v35, v35, s9, s9
v_fma_f32 v32, v32, v32, 0.5
v_fma_f32 v33, v33, v33, 0.5
v_fma_f32 v34, v34, v34, 0.5
v_fma_f32 v35, v35, v35, 0.5
v_rcp_f32 v32, v32
v_rcp_f32 v33, v33
v_rcp_f32 v34, v34
v_rcp_f32 v35, v35
v_fma_f32 v32, -v148, v32, v148
v_fma_f32 v33, -v149, v33, v149
v_fma_f32 v34, -v150, v34, v150
v_fma_f32 v35, -v151, v35, v151
v_cvt_pk_bf16_f32 v130, v32, v33
v_cvt_pk_bf16_f32 v131, v34, v35
ds_write_b128 v16, v[128:131] offset:3072
v_fma_f32 v28, -v238, v237, v242
v_fma_f32 v29, -v239, v237, v243
v_fma_f32 v30, -v240, v237, v244
v_fma_f32 v31, -v241, v237, v245
v_fma_f32 v132, v132, v232, v28
v_fma_f32 v133, v133, v232, v29
v_fma_f32 v134, v134, v232, v30
v_fma_f32 v135, v135, v232, v31
v_exp_f32 v28, v132
v_exp_f32 v29, v133
v_exp_f32 v30, v134
v_exp_f32 v31, v135
v_fma_f32 v28, v28, s9, s9
v_fma_f32 v29, v29, s9, s9
v_fma_f32 v30, v30, s9, s9
v_fma_f32 v31, v31, s9, s9
v_fma_f32 v28, v28, v28, 0.5
v_fma_f32 v29, v29, v29, 0.5
v_fma_f32 v30, v30, v30, 0.5
v_fma_f32 v31, v31, v31, 0.5
v_rcp_f32 v28, v28
v_rcp_f32 v29, v29
v_rcp_f32 v30, v30
v_rcp_f32 v31, v31
v_fma_f32 v28, -v132, v28, v132
v_fma_f32 v29, -v133, v29, v133
v_fma_f32 v30, -v134, v30, v134
v_fma_f32 v31, -v135, v31, v135
v_cvt_pk_bf16_f32 v132, v28, v29
v_cvt_pk_bf16_f32 v133, v30, v31
v_fma_f32 v32, -v246, v237, v250
v_fma_f32 v33, -v247, v237, v251
v_fma_f32 v34, -v248, v237, v252
v_fma_f32 v35, -v249, v237, v253
v_fma_f32 v152, v152, v232, v32
v_fma_f32 v153, v153, v232, v33
v_fma_f32 v154, v154, v232, v34
v_fma_f32 v155, v155, v232, v35
v_exp_f32 v32, v152
v_exp_f32 v33, v153
v_exp_f32 v34, v154
v_exp_f32 v35, v155
v_fma_f32 v32, v32, s9, s9
v_fma_f32 v33, v33, s9, s9
v_fma_f32 v34, v34, s9, s9
v_fma_f32 v35, v35, s9, s9
v_fma_f32 v32, v32, v32, 0.5
v_fma_f32 v33, v33, v33, 0.5
v_fma_f32 v34, v34, v34, 0.5
v_fma_f32 v35, v35, v35, 0.5
v_rcp_f32 v32, v32
v_rcp_f32 v33, v33
v_rcp_f32 v34, v34
v_rcp_f32 v35, v35
v_fma_f32 v32, -v152, v32, v152
v_fma_f32 v33, -v153, v33, v153
v_fma_f32 v34, -v154, v34, v154
v_fma_f32 v35, -v155, v35, v155
v_cvt_pk_bf16_f32 v134, v32, v33
v_cvt_pk_bf16_f32 v135, v34, v35
ds_write_b128 v16, v[132:135] offset:4096
s_waitcnt lgkmcnt(0)
v_mov_b32 v24, 31
ds_write_b32 v22, v24
v_mov_b32_dpp v238, v172 row_newbcast:15 row_mask:0xf bank_mask:0xf
v_mov_b32_dpp v239, v173 row_newbcast:15 row_mask:0xf bank_mask:0xf
v_mov_b32_dpp v240, v174 row_newbcast:15 row_mask:0xf bank_mask:0xf
v_mov_b32_dpp v241, v175 row_newbcast:15 row_mask:0xf bank_mask:0xf
v_lshlrev_b32 v242, 16, v220
v_and_b32 v243, 0xffff0000, v220
v_lshlrev_b32 v244, 16, v221
v_and_b32 v245, 0xffff0000, v221
v_mul_f32 v242, 0x3fb8aa3b, v242
v_mul_f32 v243, 0x3fb8aa3b, v243
v_mul_f32 v244, 0x3fb8aa3b, v244
v_mul_f32 v245, 0x3fb8aa3b, v245
v_mov_b32_dpp v246, v192 row_newbcast:15 row_mask:0xf bank_mask:0xf
v_mov_b32_dpp v247, v193 row_newbcast:15 row_mask:0xf bank_mask:0xf
v_mov_b32_dpp v248, v194 row_newbcast:15 row_mask:0xf bank_mask:0xf
v_mov_b32_dpp v249, v195 row_newbcast:15 row_mask:0xf bank_mask:0xf
v_lshlrev_b32 v250, 16, v222
v_and_b32 v251, 0xffff0000, v222
v_lshlrev_b32 v252, 16, v223
v_and_b32 v253, 0xffff0000, v223
v_mul_f32 v250, 0x3fb8aa3b, v250
v_mul_f32 v251, 0x3fb8aa3b, v251
v_mul_f32 v252, 0x3fb8aa3b, v252
v_mul_f32 v253, 0x3fb8aa3b, v253
v_fma_f32 v28, -v238, v233, v242
v_fma_f32 v29, -v239, v233, v243
v_fma_f32 v30, -v240, v233, v244
v_fma_f32 v31, -v241, v233, v245
v_fma_f32 v156, v156, v228, v28
v_fma_f32 v157, v157, v228, v29
v_fma_f32 v158, v158, v228, v30
v_fma_f32 v159, v159, v228, v31
v_exp_f32 v28, v156
v_exp_f32 v29, v157
v_exp_f32 v30, v158
v_exp_f32 v31, v159
v_fma_f32 v28, v28, s9, s9
v_fma_f32 v29, v29, s9, s9
v_fma_f32 v30, v30, s9, s9
v_fma_f32 v31, v31, s9, s9
v_fma_f32 v28, v28, v28, 0.5
v_fma_f32 v29, v29, v29, 0.5
v_fma_f32 v30, v30, v30, 0.5
v_fma_f32 v31, v31, v31, 0.5
v_rcp_f32 v28, v28
v_rcp_f32 v29, v29
v_rcp_f32 v30, v30
v_rcp_f32 v31, v31
v_fma_f32 v28, -v156, v28, v156
v_fma_f32 v29, -v157, v29, v157
v_fma_f32 v30, -v158, v30, v158
v_fma_f32 v31, -v159, v31, v159
v_cvt_pk_bf16_f32 v156, v28, v29
v_cvt_pk_bf16_f32 v157, v30, v31
v_fma_f32 v32, -v246, v233, v250
v_fma_f32 v33, -v247, v233, v251
v_fma_f32 v34, -v248, v233, v252
v_fma_f32 v35, -v249, v233, v253
v_fma_f32 v176, v176, v228, v32
v_fma_f32 v177, v177, v228, v33
v_fma_f32 v178, v178, v228, v34
v_fma_f32 v179, v179, v228, v35
v_exp_f32 v32, v176
v_exp_f32 v33, v177
v_exp_f32 v34, v178
v_exp_f32 v35, v179
v_fma_f32 v32, v32, s9, s9
v_fma_f32 v33, v33, s9, s9
v_fma_f32 v34, v34, s9, s9
v_fma_f32 v35, v35, s9, s9
v_fma_f32 v32, v32, v32, 0.5
v_fma_f32 v33, v33, v33, 0.5
v_fma_f32 v34, v34, v34, 0.5
v_fma_f32 v35, v35, v35, 0.5
v_rcp_f32 v32, v32
v_rcp_f32 v33, v33
v_rcp_f32 v34, v34
v_rcp_f32 v35, v35
v_fma_f32 v32, -v176, v32, v176
v_fma_f32 v33, -v177, v33, v177
v_fma_f32 v34, -v178, v34, v178
v_fma_f32 v35, -v179, v35, v179
v_cvt_pk_bf16_f32 v158, v32, v33
v_cvt_pk_bf16_f32 v159, v34, v35
ds_write_b128 v16, v[156:159] offset:20480
v_fma_f32 v28, -v238, v234, v242
v_fma_f32 v29, -v239, v234, v243
v_fma_f32 v30, -v240, v234, v244
v_fma_f32 v31, -v241, v234, v245
v_fma_f32 v160, v160, v229, v28
v_fma_f32 v161, v161, v229, v29
v_fma_f32 v162, v162, v229, v30
v_fma_f32 v163, v163, v229, v31
v_exp_f32 v28, v160
v_exp_f32 v29, v161
v_exp_f32 v30, v162
v_exp_f32 v31, v163
v_fma_f32 v28, v28, s9, s9
v_fma_f32 v29, v29, s9, s9
v_fma_f32 v30, v30, s9, s9
v_fma_f32 v31, v31, s9, s9
v_fma_f32 v28, v28, v28, 0.5
v_fma_f32 v29, v29, v29, 0.5
v_fma_f32 v30, v30, v30, 0.5
v_fma_f32 v31, v31, v31, 0.5
v_rcp_f32 v28, v28
v_rcp_f32 v29, v29
v_rcp_f32 v30, v30
v_rcp_f32 v31, v31
v_fma_f32 v28, -v160, v28, v160
v_fma_f32 v29, -v161, v29, v161
v_fma_f32 v30, -v162, v30, v162
v_fma_f32 v31, -v163, v31, v163
v_cvt_pk_bf16_f32 v160, v28, v29
v_cvt_pk_bf16_f32 v161, v30, v31
v_fma_f32 v32, -v246, v234, v250
v_fma_f32 v33, -v247, v234, v251
v_fma_f32 v34, -v248, v234, v252
v_fma_f32 v35, -v249, v234, v253
v_fma_f32 v180, v180, v229, v32
v_fma_f32 v181, v181, v229, v33
v_fma_f32 v182, v182, v229, v34
v_fma_f32 v183, v183, v229, v35
v_exp_f32 v32, v180
v_exp_f32 v33, v181
v_exp_f32 v34, v182
v_exp_f32 v35, v183
v_fma_f32 v32, v32, s9, s9
v_fma_f32 v33, v33, s9, s9
v_fma_f32 v34, v34, s9, s9
v_fma_f32 v35, v35, s9, s9
v_fma_f32 v32, v32, v32, 0.5
v_fma_f32 v33, v33, v33, 0.5
v_fma_f32 v34, v34, v34, 0.5
v_fma_f32 v35, v35, v35, 0.5
v_rcp_f32 v32, v32
v_rcp_f32 v33, v33
v_rcp_f32 v34, v34
v_rcp_f32 v35, v35
v_fma_f32 v32, -v180, v32, v180
v_fma_f32 v33, -v181, v33, v181
v_fma_f32 v34, -v182, v34, v182
v_fma_f32 v35, -v183, v35, v183
v_cvt_pk_bf16_f32 v162, v32, v33
v_cvt_pk_bf16_f32 v163, v34, v35
ds_write_b128 v16, v[160:163] offset:21504
v_fma_f32 v28, -v238, v235, v242
v_fma_f32 v29, -v239, v235, v243
v_fma_f32 v30, -v240, v235, v244
v_fma_f32 v31, -v241, v235, v245
v_fma_f32 v164, v164, v230, v28
v_fma_f32 v165, v165, v230, v29
v_fma_f32 v166, v166, v230, v30
v_fma_f32 v167, v167, v230, v31
v_exp_f32 v28, v164
v_exp_f32 v29, v165
v_exp_f32 v30, v166
v_exp_f32 v31, v167
v_fma_f32 v28, v28, s9, s9
v_fma_f32 v29, v29, s9, s9
v_fma_f32 v30, v30, s9, s9
v_fma_f32 v31, v31, s9, s9
v_fma_f32 v28, v28, v28, 0.5
v_fma_f32 v29, v29, v29, 0.5
v_fma_f32 v30, v30, v30, 0.5
v_fma_f32 v31, v31, v31, 0.5
v_rcp_f32 v28, v28
v_rcp_f32 v29, v29
v_rcp_f32 v30, v30
v_rcp_f32 v31, v31
v_fma_f32 v28, -v164, v28, v164
v_fma_f32 v29, -v165, v29, v165
v_fma_f32 v30, -v166, v30, v166
v_fma_f32 v31, -v167, v31, v167
v_cvt_pk_bf16_f32 v164, v28, v29
v_cvt_pk_bf16_f32 v165, v30, v31
v_fma_f32 v32, -v246, v235, v250
v_fma_f32 v33, -v247, v235, v251
v_fma_f32 v34, -v248, v235, v252
v_fma_f32 v35, -v249, v235, v253
v_fma_f32 v184, v184, v230, v32
v_fma_f32 v185, v185, v230, v33
v_fma_f32 v186, v186, v230, v34
v_fma_f32 v187, v187, v230, v35
v_exp_f32 v32, v184
v_exp_f32 v33, v185
v_exp_f32 v34, v186
v_exp_f32 v35, v187
v_fma_f32 v32, v32, s9, s9
v_fma_f32 v33, v33, s9, s9
v_fma_f32 v34, v34, s9, s9
v_fma_f32 v35, v35, s9, s9
v_fma_f32 v32, v32, v32, 0.5
v_fma_f32 v33, v33, v33, 0.5
v_fma_f32 v34, v34, v34, 0.5
v_fma_f32 v35, v35, v35, 0.5
v_rcp_f32 v32, v32
v_rcp_f32 v33, v33
v_rcp_f32 v34, v34
v_rcp_f32 v35, v35
v_fma_f32 v32, -v184, v32, v184
v_fma_f32 v33, -v185, v33, v185
v_fma_f32 v34, -v186, v34, v186
v_fma_f32 v35, -v187, v35, v187
v_cvt_pk_bf16_f32 v166, v32, v33
v_cvt_pk_bf16_f32 v167, v34, v35
ds_write_b128 v16, v[164:167] offset:22528
v_fma_f32 v28, -v238, v236, v242
v_fma_f32 v29, -v239, v236, v243
v_fma_f32 v30, -v240, v236, v244
v_fma_f32 v31, -v241, v236, v245
v_fma_f32 v168, v168, v231, v28
v_fma_f32 v169, v169, v231, v29
v_fma_f32 v170, v170, v231, v30
v_fma_f32 v171, v171, v231, v31
v_exp_f32 v28, v168
v_exp_f32 v29, v169
v_exp_f32 v30, v170
v_exp_f32 v31, v171
v_fma_f32 v28, v28, s9, s9
v_fma_f32 v29, v29, s9, s9
v_fma_f32 v30, v30, s9, s9
v_fma_f32 v31, v31, s9, s9
v_fma_f32 v28, v28, v28, 0.5
v_fma_f32 v29, v29, v29, 0.5
v_fma_f32 v30, v30, v30, 0.5
v_fma_f32 v31, v31, v31, 0.5
v_rcp_f32 v28, v28
v_rcp_f32 v29, v29
v_rcp_f32 v30, v30
v_rcp_f32 v31, v31
v_fma_f32 v28, -v168, v28, v168
v_fma_f32 v29, -v169, v29, v169
v_fma_f32 v30, -v170, v30, v170
v_fma_f32 v31, -v171, v31, v171
v_cvt_pk_bf16_f32 v168, v28, v29
v_cvt_pk_bf16_f32 v169, v30, v31
v_fma_f32 v32, -v246, v236, v250
v_fma_f32 v33, -v247, v236, v251
v_fma_f32 v34, -v248, v236, v252
v_fma_f32 v35, -v249, v236, v253
v_fma_f32 v188, v188, v231, v32
v_fma_f32 v189, v189, v231, v33
v_fma_f32 v190, v190, v231, v34
v_fma_f32 v191, v191, v231, v35
v_exp_f32 v32, v188
v_exp_f32 v33, v189
v_exp_f32 v34, v190
v_exp_f32 v35, v191
v_fma_f32 v32, v32, s9, s9
v_fma_f32 v33, v33, s9, s9
v_fma_f32 v34, v34, s9, s9
v_fma_f32 v35, v35, s9, s9
v_fma_f32 v32, v32, v32, 0.5
v_fma_f32 v33, v33, v33, 0.5
v_fma_f32 v34, v34, v34, 0.5
v_fma_f32 v35, v35, v35, 0.5
v_rcp_f32 v32, v32
v_rcp_f32 v33, v33
v_rcp_f32 v34, v34
v_rcp_f32 v35, v35
v_fma_f32 v32, -v188, v32, v188
v_fma_f32 v33, -v189, v33, v189
v_fma_f32 v34, -v190, v34, v190
v_fma_f32 v35, -v191, v35, v191
v_cvt_pk_bf16_f32 v170, v32, v33
v_cvt_pk_bf16_f32 v171, v34, v35
ds_write_b128 v16, v[168:171] offset:23552
v_fma_f32 v28, -v238, v237, v242
v_fma_f32 v29, -v239, v237, v243
v_fma_f32 v30, -v240, v237, v244
v_fma_f32 v31, -v241, v237, v245
v_fma_f32 v172, v172, v232, v28
v_fma_f32 v173, v173, v232, v29
v_fma_f32 v174, v174, v232, v30
v_fma_f32 v175, v175, v232, v31
v_exp_f32 v28, v172
v_exp_f32 v29, v173
v_exp_f32 v30, v174
v_exp_f32 v31, v175
v_fma_f32 v28, v28, s9, s9
v_fma_f32 v29, v29, s9, s9
v_fma_f32 v30, v30, s9, s9
v_fma_f32 v31, v31, s9, s9
v_fma_f32 v28, v28, v28, 0.5
v_fma_f32 v29, v29, v29, 0.5
v_fma_f32 v30, v30, v30, 0.5
v_fma_f32 v31, v31, v31, 0.5
v_rcp_f32 v28, v28
v_rcp_f32 v29, v29
v_rcp_f32 v30, v30
v_rcp_f32 v31, v31
v_fma_f32 v28, -v172, v28, v172
v_fma_f32 v29, -v173, v29, v173
v_fma_f32 v30, -v174, v30, v174
v_fma_f32 v31, -v175, v31, v175
v_cvt_pk_bf16_f32 v172, v28, v29
v_cvt_pk_bf16_f32 v173, v30, v31
v_fma_f32 v32, -v246, v237, v250
v_fma_f32 v33, -v247, v237, v251
v_fma_f32 v34, -v248, v237, v252
v_fma_f32 v35, -v249, v237, v253
v_fma_f32 v192, v192, v232, v32
v_fma_f32 v193, v193, v232, v33
v_fma_f32 v194, v194, v232, v34
v_fma_f32 v195, v195, v232, v35
v_exp_f32 v32, v192
v_exp_f32 v33, v193
v_exp_f32 v34, v194
v_exp_f32 v35, v195
v_fma_f32 v32, v32, s9, s9
v_fma_f32 v33, v33, s9, s9
v_fma_f32 v34, v34, s9, s9
v_fma_f32 v35, v35, s9, s9
v_fma_f32 v32, v32, v32, 0.5
v_fma_f32 v33, v33, v33, 0.5
v_fma_f32 v34, v34, v34, 0.5
v_fma_f32 v35, v35, v35, 0.5
v_rcp_f32 v32, v32
v_rcp_f32 v33, v33
v_rcp_f32 v34, v34
v_rcp_f32 v35, v35
v_fma_f32 v32, -v192, v32, v192
v_fma_f32 v33, -v193, v33, v193
v_fma_f32 v34, -v194, v34, v194
v_fma_f32 v35, -v195, v35, v195
v_cvt_pk_bf16_f32 v174, v32, v33
v_cvt_pk_bf16_f32 v175, v34, v35
ds_write_b128 v16, v[172:175] offset:24576
s_waitcnt lgkmcnt(0)
v_mov_b32 v24, 32
ds_write_b32 v22, v24
v_mov_b32_dpp v238, v212 row_newbcast:15 row_mask:0xf bank_mask:0xf
v_mov_b32_dpp v239, v213 row_newbcast:15 row_mask:0xf bank_mask:0xf
v_mov_b32_dpp v240, v214 row_newbcast:15 row_mask:0xf bank_mask:0xf
v_mov_b32_dpp v241, v215 row_newbcast:15 row_mask:0xf bank_mask:0xf
v_lshlrev_b32 v242, 16, v224
v_and_b32 v243, 0xffff0000, v224
v_lshlrev_b32 v244, 16, v225
v_and_b32 v245, 0xffff0000, v225
v_mul_f32 v242, 0x3fb8aa3b, v242
v_mul_f32 v243, 0x3fb8aa3b, v243
v_mul_f32 v244, 0x3fb8aa3b, v244
v_mul_f32 v245, 0x3fb8aa3b, v245
v_fma_f32 v28, -v238, v233, v242
v_fma_f32 v29, -v239, v233, v243
v_fma_f32 v30, -v240, v233, v244
v_fma_f32 v31, -v241, v233, v245
v_fma_f32 v196, v196, v228, v28
v_fma_f32 v197, v197, v228, v29
v_fma_f32 v198, v198, v228, v30
v_fma_f32 v199, v199, v228, v31
v_exp_f32 v28, v196
v_exp_f32 v29, v197
v_exp_f32 v30, v198
v_exp_f32 v31, v199
v_fma_f32 v28, v28, s9, s9
v_fma_f32 v29, v29, s9, s9
v_fma_f32 v30, v30, s9, s9
v_fma_f32 v31, v31, s9, s9
v_fma_f32 v28, v28, v28, 0.5
v_fma_f32 v29, v29, v29, 0.5
v_fma_f32 v30, v30, v30, 0.5
v_fma_f32 v31, v31, v31, 0.5
v_rcp_f32 v28, v28
v_rcp_f32 v29, v29
v_rcp_f32 v30, v30
v_rcp_f32 v31, v31
v_fma_f32 v28, -v196, v28, v196
v_fma_f32 v29, -v197, v29, v197
v_fma_f32 v30, -v198, v30, v198
v_fma_f32 v31, -v199, v31, v199
v_cvt_pk_bf16_f32 v196, v28, v29
v_cvt_pk_bf16_f32 v197, v30, v31
ds_write_b64 v17, v[196:197] offset:0
v_fma_f32 v32, -v238, v234, v242
v_fma_f32 v33, -v239, v234, v243
v_fma_f32 v34, -v240, v234, v244
v_fma_f32 v35, -v241, v234, v245
v_fma_f32 v200, v200, v229, v32
v_fma_f32 v201, v201, v229, v33
v_fma_f32 v202, v202, v229, v34
v_fma_f32 v203, v203, v229, v35
v_exp_f32 v32, v200
v_exp_f32 v33, v201
v_exp_f32 v34, v202
v_exp_f32 v35, v203
v_fma_f32 v32, v32, s9, s9
v_fma_f32 v33, v33, s9, s9
v_fma_f32 v34, v34, s9, s9
v_fma_f32 v35, v35, s9, s9
v_fma_f32 v32, v32, v32, 0.5
v_fma_f32 v33, v33, v33, 0.5
v_fma_f32 v34, v34, v34, 0.5
v_fma_f32 v35, v35, v35, 0.5
v_rcp_f32 v32, v32
v_rcp_f32 v33, v33
v_rcp_f32 v34, v34
v_rcp_f32 v35, v35
v_fma_f32 v32, -v200, v32, v200
v_fma_f32 v33, -v201, v33, v201
v_fma_f32 v34, -v202, v34, v202
v_fma_f32 v35, -v203, v35, v203
v_cvt_pk_bf16_f32 v200, v32, v33
v_cvt_pk_bf16_f32 v201, v34, v35
ds_write_b64 v17, v[200:201] offset:1024
v_fma_f32 v28, -v238, v235, v242
v_fma_f32 v29, -v239, v235, v243
v_fma_f32 v30, -v240, v235, v244
v_fma_f32 v31, -v241, v235, v245
v_fma_f32 v204, v204, v230, v28
v_fma_f32 v205, v205, v230, v29
v_fma_f32 v206, v206, v230, v30
v_fma_f32 v207, v207, v230, v31
v_exp_f32 v28, v204
v_exp_f32 v29, v205
v_exp_f32 v30, v206
v_exp_f32 v31, v207
v_fma_f32 v28, v28, s9, s9
v_fma_f32 v29, v29, s9, s9
v_fma_f32 v30, v30, s9, s9
v_fma_f32 v31, v31, s9, s9
v_fma_f32 v28, v28, v28, 0.5
v_fma_f32 v29, v29, v29, 0.5
v_fma_f32 v30, v30, v30, 0.5
v_fma_f32 v31, v31, v31, 0.5
v_rcp_f32 v28, v28
v_rcp_f32 v29, v29
v_rcp_f32 v30, v30
v_rcp_f32 v31, v31
v_fma_f32 v28, -v204, v28, v204
v_fma_f32 v29, -v205, v29, v205
v_fma_f32 v30, -v206, v30, v206
v_fma_f32 v31, -v207, v31, v207
v_cvt_pk_bf16_f32 v204, v28, v29
v_cvt_pk_bf16_f32 v205, v30, v31
ds_write_b64 v17, v[204:205] offset:2048
v_fma_f32 v32, -v238, v236, v242
v_fma_f32 v33, -v239, v236, v243
v_fma_f32 v34, -v240, v236, v244
v_fma_f32 v35, -v241, v236, v245
v_fma_f32 v208, v208, v231, v32
v_fma_f32 v209, v209, v231, v33
v_fma_f32 v210, v210, v231, v34
v_fma_f32 v211, v211, v231, v35
v_exp_f32 v32, v208
v_exp_f32 v33, v209
v_exp_f32 v34, v210
v_exp_f32 v35, v211
v_fma_f32 v32, v32, s9, s9
v_fma_f32 v33, v33, s9, s9
v_fma_f32 v34, v34, s9, s9
v_fma_f32 v35, v35, s9, s9
v_fma_f32 v32, v32, v32, 0.5
v_fma_f32 v33, v33, v33, 0.5
v_fma_f32 v34, v34, v34, 0.5
v_fma_f32 v35, v35, v35, 0.5
v_rcp_f32 v32, v32
v_rcp_f32 v33, v33
v_rcp_f32 v34, v34
v_rcp_f32 v35, v35
v_fma_f32 v32, -v208, v32, v208
v_fma_f32 v33, -v209, v33, v209
v_fma_f32 v34, -v210, v34, v210
v_fma_f32 v35, -v211, v35, v211
v_cvt_pk_bf16_f32 v208, v32, v33
v_cvt_pk_bf16_f32 v209, v34, v35
ds_write_b64 v17, v[208:209] offset:3072
v_fma_f32 v28, -v238, v237, v242
v_fma_f32 v29, -v239, v237, v243
v_fma_f32 v30, -v240, v237, v244
v_fma_f32 v31, -v241, v237, v245
v_fma_f32 v212, v212, v232, v28
v_fma_f32 v213, v213, v232, v29
v_fma_f32 v214, v214, v232, v30
v_fma_f32 v215, v215, v232, v31
v_exp_f32 v28, v212
v_exp_f32 v29, v213
v_exp_f32 v30, v214
v_exp_f32 v31, v215
v_fma_f32 v28, v28, s9, s9
v_fma_f32 v29, v29, s9, s9
v_fma_f32 v30, v30, s9, s9
v_fma_f32 v31, v31, s9, s9
v_fma_f32 v28, v28, v28, 0.5
v_fma_f32 v29, v29, v29, 0.5
v_fma_f32 v30, v30, v30, 0.5
v_fma_f32 v31, v31, v31, 0.5
v_rcp_f32 v28, v28
v_rcp_f32 v29, v29
v_rcp_f32 v30, v30
v_rcp_f32 v31, v31
v_fma_f32 v28, -v212, v28, v212
v_fma_f32 v29, -v213, v29, v213
v_fma_f32 v30, -v214, v30, v214
v_fma_f32 v31, -v215, v31, v215
v_cvt_pk_bf16_f32 v212, v28, v29
v_cvt_pk_bf16_f32 v213, v30, v31
ds_write_b64 v17, v[212:213] offset:4096
s_waitcnt lgkmcnt(0)
v_mov_b32 v24, 33
ds_write_b32 v22, v24
s_waitcnt vmcnt(2)
ds_read_b64_tr_b16 v[76:77], v6 offset:8192
ds_read_b64_tr_b16 v[80:81], v7 offset:8192
ds_read_b64_tr_b16 v[84:85], v8 offset:8192
ds_read_b64_tr_b16 v[88:89], v9 offset:8192
s_waitcnt vmcnt(0)
ds_read_b64_tr_b16 v[78:79], v6 offset:10240
ds_read_b64_tr_b16 v[82:83], v7 offset:10240
ds_read_b64_tr_b16 v[86:87], v8 offset:10240
ds_read_b64_tr_b16 v[90:91], v9 offset:10240
s_add_u32 m0, s6, 8192
s_mov_b32 s11, 73728
s_waitcnt lgkmcnt(4)
buffer_load_dwordx4 v13, s[52:55], s11 offen lds
buffer_load_dwordx4 v14, s[52:55], s11 offen offset:1024 lds
s_add_u32 m0, s6, 10240
s_mov_b32 s11, 92160
s_waitcnt lgkmcnt(0)
buffer_load_dwordx4 v13, s[52:55], s11 offen lds
buffer_load_dwordx4 v14, s[52:55], s11 offen offset:1024 lds
ds_read_b32 v27, v21
s_waitcnt lgkmcnt(0)
v_cmp_gt_u32 vcc, 33, v27
s_cbranch_vccnz LwQc
LrQc:
ds_read_b32 v27, v20
s_waitcnt lgkmcnt(0)
v_cmp_gt_u32 vcc, 4, v27
s_cbranch_vccnz LwQd
LrQd:
ds_read_b128 v[36:39], v2 offset:0
ds_read_b128 v[40:43], v2 offset:1024
ds_read_b128 v[44:47], v2 offset:2048
ds_read_b128 v[48:51], v2 offset:3072
ds_read_b128 v[52:55], v2 offset:4096
ds_read_b32 v27, v20
s_waitcnt lgkmcnt(0)
v_cmp_gt_u32 vcc, 23, v27
s_cbranch_vccnz LwQb
LrQb:
s_add_u32 m0, s6, 4096
s_mov_b32 s11, 147456
buffer_load_dwordx4 v13, s[52:55], s11 offen lds
buffer_load_dwordx4 v14, s[52:55], s11 offen offset:1024 lds
s_add_u32 m0, s6, 6144
s_mov_b32 s11, 165888
buffer_load_dwordx4 v13, s[52:55], s11 offen lds
buffer_load_dwordx4 v14, s[52:55], s11 offen offset:1024 lds
s_setprio 1
v_mfma_f32_16x16x32_bf16 v[116:119], v[76:79], v[36:39], 0
s_waitcnt vmcnt(6)
ds_read_b64_tr_b16 v[96:97], v6 offset:8192
v_mfma_f32_16x16x32_bf16 v[120:123], v[76:79], v[40:43], 0
ds_read_b64_tr_b16 v[100:101], v7 offset:8192
v_mfma_f32_16x16x32_bf16 v[124:127], v[76:79], v[44:47], 0
v_mfma_f32_16x16x32_bf16 v[128:131], v[76:79], v[48:51], 0
ds_read_b64_tr_b16 v[104:105], v8 offset:8192
v_mfma_f32_16x16x32_bf16 v[132:135], v[76:79], v[52:55], 0
ds_read_b64_tr_b16 v[108:109], v9 offset:8192
v_mfma_f32_16x16x32_bf16 v[152:155], v[80:83], v[52:55], 0
ds_read_b128 v[56:59], v2 offset:5120
v_mfma_f32_16x16x32_bf16 v[148:151], v[80:83], v[48:51], 0
ds_read_b128 v[60:63], v2 offset:6144
v_mfma_f32_16x16x32_bf16 v[144:147], v[80:83], v[44:47], 0
v_mfma_f32_16x16x32_bf16 v[140:143], v[80:83], v[40:43], 0
ds_read_b128 v[64:67], v2 offset:7168
s_add_u32 m0, s6, 8192
v_mfma_f32_16x16x32_bf16 v[136:139], v[80:83], v[36:39], 0
ds_read_b128 v[68:71], v2 offset:8192
s_mov_b32 s11, 221184
v_mfma_f32_16x16x32_bf16 v[156:159], v[84:87], v[36:39], 0
s_waitcnt vmcnt(4)
ds_read_b64_tr_b16 v[98:99], v6 offset:10240
v_mfma_f32_16x16x32_bf16 v[160:163], v[84:87], v[40:43], 0
ds_read_b64_tr_b16 v[102:103], v7 offset:10240
v_mfma_f32_16x16x32_bf16 v[164:167], v[84:87], v[44:47], 0
s_waitcnt lgkmcnt(5)
buffer_load_dwordx4 v13, s[52:55], s11 offen lds
v_mfma_f32_16x16x32_bf16 v[168:171], v[84:87], v[48:51], 0
ds_read_b64_tr_b16 v[106:107], v8 offset:10240
v_mfma_f32_16x16x32_bf16 v[172:175], v[84:87], v[52:55], 0
ds_read_b64_tr_b16 v[110:111], v9 offset:10240
v_mfma_f32_16x16x32_bf16 v[192:195], v[88:91], v[52:55], 0
ds_read_b128 v[72:75], v2 offset:9216
v_mfma_f32_16x16x32_bf16 v[188:191], v[88:91], v[48:51], 0
v_mfma_f32_16x16x32_bf16 v[184:187], v[88:91], v[44:47], 0
buffer_load_dwordx4 v14, s[52:55], s11 offen offset:1024 lds
v_mfma_f32_16x16x32_bf16 v[180:183], v[88:91], v[40:43], 0
s_add_u32 m0, s6, 10240
v_mfma_f32_16x16x32_bf16 v[176:179], v[88:91], v[36:39], 0
s_waitcnt lgkmcnt(3)
s_mov_b32 s11, 239616
v_mfma_f32_16x16x32_bf16 v[116:119], v[96:99], v[56:59], v[116:119]
s_waitcnt vmcnt(4)
ds_read_b64_tr_b16 v[76:77], v6 offset:4096
v_mfma_f32_16x16x32_bf16 v[120:123], v[96:99], v[60:63], v[120:123]
ds_read_b64_tr_b16 v[80:81], v7 offset:4096
v_mfma_f32_16x16x32_bf16 v[124:127], v[96:99], v[64:67], v[124:127]
s_waitcnt lgkmcnt(2)
buffer_load_dwordx4 v13, s[52:55], s11 offen lds
v_mfma_f32_16x16x32_bf16 v[128:131], v[96:99], v[68:71], v[128:131]
ds_read_b64_tr_b16 v[84:85], v8 offset:4096
v_mfma_f32_16x16x32_bf16 v[132:135], v[96:99], v[72:75], v[132:135]
ds_read_b64_tr_b16 v[88:89], v9 offset:4096
v_mfma_f32_16x16x32_bf16 v[152:155], v[100:103], v[72:75], v[152:155]
ds_read_b128 v[36:39], v2 offset:10240
v_mfma_f32_16x16x32_bf16 v[148:151], v[100:103], v[68:71], v[148:151]
ds_read_b128 v[40:43], v2 offset:11264
v_mfma_f32_16x16x32_bf16 v[144:147], v[100:103], v[64:67], v[144:147]
buffer_load_dwordx4 v14, s[52:55], s11 offen offset:1024 lds
v_mfma_f32_16x16x32_bf16 v[140:143], v[100:103], v[60:63], v[140:143]
ds_read_b128 v[44:47], v2 offset:12288
s_add_u32 m0, s6, 4096
v_mfma_f32_16x16x32_bf16 v[136:139], v[100:103], v[56:59], v[136:139]
ds_read_b128 v[48:51], v2 offset:13312
s_mov_b32 s11, 36864
v_mfma_f32_16x16x32_bf16 v[156:159], v[104:107], v[56:59], v[156:159]
s_waitcnt vmcnt(4)
ds_read_b64_tr_b16 v[78:79], v6 offset:6144
v_mfma_f32_16x16x32_bf16 v[160:163], v[104:107], v[60:63], v[160:163]
ds_read_b64_tr_b16 v[82:83], v7 offset:6144
v_mfma_f32_16x16x32_bf16 v[164:167], v[104:107], v[64:67], v[164:167]
s_waitcnt lgkmcnt(5)
buffer_load_dwordx4 v13, s[52:55], s11 offen lds
v_mfma_f32_16x16x32_bf16 v[168:171], v[104:107], v[68:71], v[168:171]
ds_read_b64_tr_b16 v[86:87], v8 offset:6144
v_mfma_f32_16x16x32_bf16 v[172:175], v[104:107], v[72:75], v[172:175]
ds_read_b64_tr_b16 v[90:91], v9 offset:6144
v_mfma_f32_16x16x32_bf16 v[192:195], v[108:111], v[72:75], v[192:195]
ds_read_b128 v[52:55], v2 offset:14336
v_mfma_f32_16x16x32_bf16 v[188:191], v[108:111], v[68:71], v[188:191]
v_mfma_f32_16x16x32_bf16 v[184:187], v[108:111], v[64:67], v[184:187]
buffer_load_dwordx4 v14, s[52:55], s11 offen offset:1024 lds
v_mfma_f32_16x16x32_bf16 v[180:183], v[108:111], v[60:63], v[180:183]
s_add_u32 m0, s6, 6144
v_mfma_f32_16x16x32_bf16 v[176:179], v[108:111], v[56:59], v[176:179]
s_waitcnt lgkmcnt(3)
s_mov_b32 s11, 55296
v_mfma_f32_16x16x32_bf16 v[116:119], v[76:79], v[36:39], v[116:119]
s_waitcnt vmcnt(4)
ds_read_b64_tr_b16 v[96:97], v6 offset:8192
v_mfma_f32_16x16x32_bf16 v[120:123], v[76:79], v[40:43], v[120:123]
ds_read_b64_tr_b16 v[100:101], v7 offset:8192
v_mfma_f32_16x16x32_bf16 v[124:127], v[76:79], v[44:47], v[124:127]
s_waitcnt lgkmcnt(2)
buffer_load_dwordx4 v13, s[52:55], s11 offen lds
v_mfma_f32_16x16x32_bf16 v[128:131], v[76:79], v[48:51], v[128:131]
ds_read_b64_tr_b16 v[104:105], v8 offset:8192
v_mfma_f32_16x16x32_bf16 v[132:135], v[76:79], v[52:55], v[132:135]
ds_read_b64_tr_b16 v[108:109], v9 offset:8192
v_mfma_f32_16x16x32_bf16 v[152:155], v[80:83], v[52:55], v[152:155]
ds_read_b128 v[56:59], v2 offset:15360
v_mfma_f32_16x16x32_bf16 v[148:151], v[80:83], v[48:51], v[148:151]
ds_read_b128 v[60:63], v2 offset:16384
v_mfma_f32_16x16x32_bf16 v[144:147], v[80:83], v[44:47], v[144:147]
buffer_load_dwordx4 v14, s[52:55], s11 offen offset:1024 lds
v_mfma_f32_16x16x32_bf16 v[140:143], v[80:83], v[40:43], v[140:143]
ds_read_b128 v[64:67], v2 offset:17408
s_add_u32 m0, s6, 8192
v_mfma_f32_16x16x32_bf16 v[136:139], v[80:83], v[36:39], v[136:139]
ds_read_b128 v[68:71], v2 offset:18432
s_mov_b32 s11, 110592
v_mfma_f32_16x16x32_bf16 v[156:159], v[84:87], v[36:39], v[156:159]
s_waitcnt vmcnt(4)
ds_read_b64_tr_b16 v[98:99], v6 offset:10240
v_mfma_f32_16x16x32_bf16 v[160:163], v[84:87], v[40:43], v[160:163]
ds_read_b64_tr_b16 v[102:103], v7 offset:10240
v_mfma_f32_16x16x32_bf16 v[164:167], v[84:87], v[44:47], v[164:167]
s_waitcnt lgkmcnt(5)
buffer_load_dwordx4 v13, s[52:55], s11 offen lds
v_mfma_f32_16x16x32_bf16 v[168:171], v[84:87], v[48:51], v[168:171]
ds_read_b64_tr_b16 v[106:107], v8 offset:10240
v_mfma_f32_16x16x32_bf16 v[172:175], v[84:87], v[52:55], v[172:175]
ds_read_b64_tr_b16 v[110:111], v9 offset:10240
v_mfma_f32_16x16x32_bf16 v[192:195], v[88:91], v[52:55], v[192:195]
ds_read_b128 v[72:75], v2 offset:19456
v_mfma_f32_16x16x32_bf16 v[188:191], v[88:91], v[48:51], v[188:191]
v_mfma_f32_16x16x32_bf16 v[184:187], v[88:91], v[44:47], v[184:187]
buffer_load_dwordx4 v14, s[52:55], s11 offen offset:1024 lds
v_mfma_f32_16x16x32_bf16 v[180:183], v[88:91], v[40:43], v[180:183]
s_add_u32 m0, s6, 10240
v_mfma_f32_16x16x32_bf16 v[176:179], v[88:91], v[36:39], v[176:179]
s_waitcnt lgkmcnt(3)
s_mov_b32 s11, 129024
v_mfma_f32_16x16x32_bf16 v[116:119], v[96:99], v[56:59], v[116:119]
s_waitcnt vmcnt(4)
ds_read_b64_tr_b16 v[76:77], v6 offset:4096
v_mfma_f32_16x16x32_bf16 v[120:123], v[96:99], v[60:63], v[120:123]
ds_read_b64_tr_b16 v[80:81], v7 offset:4096
v_mfma_f32_16x16x32_bf16 v[124:127], v[96:99], v[64:67], v[124:127]
s_waitcnt lgkmcnt(2)
buffer_load_dwordx4 v13, s[52:55], s11 offen lds
v_mfma_f32_16x16x32_bf16 v[128:131], v[96:99], v[68:71], v[128:131]
ds_read_b64_tr_b16 v[84:85], v8 offset:4096
v_mfma_f32_16x16x32_bf16 v[132:135], v[96:99], v[72:75], v[132:135]
ds_read_b64_tr_b16 v[88:89], v9 offset:4096
v_mfma_f32_16x16x32_bf16 v[152:155], v[100:103], v[72:75], v[152:155]
ds_read_b128 v[36:39], v2 offset:20480
v_mfma_f32_16x16x32_bf16 v[148:151], v[100:103], v[68:71], v[148:151]
ds_read_b128 v[40:43], v2 offset:21504
v_mfma_f32_16x16x32_bf16 v[144:147], v[100:103], v[64:67], v[144:147]
buffer_load_dwordx4 v14, s[52:55], s11 offen offset:1024 lds
v_mfma_f32_16x16x32_bf16 v[140:143], v[100:103], v[60:63], v[140:143]
ds_read_b128 v[44:47], v2 offset:22528
s_add_u32 m0, s6, 4096
v_mfma_f32_16x16x32_bf16 v[136:139], v[100:103], v[56:59], v[136:139]
ds_read_b128 v[48:51], v2 offset:23552
s_mov_b32 s11, 184320
v_mfma_f32_16x16x32_bf16 v[156:159], v[104:107], v[56:59], v[156:159]
s_waitcnt vmcnt(4)
ds_read_b64_tr_b16 v[78:79], v6 offset:6144
v_mfma_f32_16x16x32_bf16 v[160:163], v[104:107], v[60:63], v[160:163]
ds_read_b64_tr_b16 v[82:83], v7 offset:6144
v_mfma_f32_16x16x32_bf16 v[164:167], v[104:107], v[64:67], v[164:167]
s_waitcnt lgkmcnt(5)
buffer_load_dwordx4 v13, s[52:55], s11 offen lds
v_mfma_f32_16x16x32_bf16 v[168:171], v[104:107], v[68:71], v[168:171]
ds_read_b64_tr_b16 v[86:87], v8 offset:6144
v_mfma_f32_16x16x32_bf16 v[172:175], v[104:107], v[72:75], v[172:175]
ds_read_b64_tr_b16 v[90:91], v9 offset:6144
v_mfma_f32_16x16x32_bf16 v[192:195], v[108:111], v[72:75], v[192:195]
ds_read_b128 v[52:55], v2 offset:24576
v_mfma_f32_16x16x32_bf16 v[188:191], v[108:111], v[68:71], v[188:191]
v_mfma_f32_16x16x32_bf16 v[184:187], v[108:111], v[64:67], v[184:187]
buffer_load_dwordx4 v14, s[52:55], s11 offen offset:1024 lds
v_mfma_f32_16x16x32_bf16 v[180:183], v[108:111], v[60:63], v[180:183]
s_add_u32 m0, s6, 6144
v_mfma_f32_16x16x32_bf16 v[176:179], v[108:111], v[56:59], v[176:179]
s_waitcnt lgkmcnt(3)
s_mov_b32 s11, 202752
v_mfma_f32_16x16x32_bf16 v[116:119], v[76:79], v[36:39], v[116:119]
s_waitcnt vmcnt(4)
ds_read_b64_tr_b16 v[96:97], v6 offset:8192
v_mfma_f32_16x16x32_bf16 v[120:123], v[76:79], v[40:43], v[120:123]
ds_read_b64_tr_b16 v[100:101], v7 offset:8192
v_mfma_f32_16x16x32_bf16 v[124:127], v[76:79], v[44:47], v[124:127]
s_waitcnt lgkmcnt(2)
buffer_load_dwordx4 v13, s[52:55], s11 offen lds
v_mfma_f32_16x16x32_bf16 v[128:131], v[76:79], v[48:51], v[128:131]
ds_read_b64_tr_b16 v[104:105], v8 offset:8192
v_mfma_f32_16x16x32_bf16 v[132:135], v[76:79], v[52:55], v[132:135]
ds_read_b64_tr_b16 v[108:109], v9 offset:8192
v_mfma_f32_16x16x32_bf16 v[152:155], v[80:83], v[52:55], v[152:155]
ds_read_b128 v[56:59], v2 offset:25600
v_mfma_f32_16x16x32_bf16 v[148:151], v[80:83], v[48:51], v[148:151]
ds_read_b128 v[60:63], v2 offset:26624
v_mfma_f32_16x16x32_bf16 v[144:147], v[80:83], v[44:47], v[144:147]
buffer_load_dwordx4 v14, s[52:55], s11 offen offset:1024 lds
v_mfma_f32_16x16x32_bf16 v[140:143], v[80:83], v[40:43], v[140:143]
ds_read_b128 v[64:67], v2 offset:27648
s_add_u32 m0, s6, 8192
v_mfma_f32_16x16x32_bf16 v[136:139], v[80:83], v[36:39], v[136:139]
ds_read_b128 v[68:71], v2 offset:28672
s_mov_b32 s11, 258048
v_mfma_f32_16x16x32_bf16 v[156:159], v[84:87], v[36:39], v[156:159]
s_waitcnt vmcnt(4)
ds_read_b64_tr_b16 v[98:99], v6 offset:10240
v_mfma_f32_16x16x32_bf16 v[160:163], v[84:87], v[40:43], v[160:163]
ds_read_b64_tr_b16 v[102:103], v7 offset:10240
v_mfma_f32_16x16x32_bf16 v[164:167], v[84:87], v[44:47], v[164:167]
s_waitcnt lgkmcnt(5)
buffer_load_dwordx4 v13, s[52:55], s11 offen lds
v_mfma_f32_16x16x32_bf16 v[168:171], v[84:87], v[48:51], v[168:171]
ds_read_b64_tr_b16 v[106:107], v8 offset:10240
v_mfma_f32_16x16x32_bf16 v[172:175], v[84:87], v[52:55], v[172:175]
ds_read_b64_tr_b16 v[110:111], v9 offset:10240
v_mfma_f32_16x16x32_bf16 v[192:195], v[88:91], v[52:55], v[192:195]
ds_read_b128 v[72:75], v2 offset:29696
v_mfma_f32_16x16x32_bf16 v[188:191], v[88:91], v[48:51], v[188:191]
v_mfma_f32_16x16x32_bf16 v[184:187], v[88:91], v[44:47], v[184:187]
buffer_load_dwordx4 v14, s[52:55], s11 offen offset:1024 lds
v_mfma_f32_16x16x32_bf16 v[180:183], v[88:91], v[40:43], v[180:183]
s_add_u32 m0, s6, 10240
v_mfma_f32_16x16x32_bf16 v[176:179], v[88:91], v[36:39], v[176:179]
s_waitcnt lgkmcnt(3)
s_mov_b32 s11, 276480
v_mfma_f32_16x16x32_bf16 v[116:119], v[96:99], v[56:59], v[116:119]
s_waitcnt vmcnt(4)
ds_read_b64_tr_b16 v[76:77], v6 offset:4096
v_mfma_f32_16x16x32_bf16 v[120:123], v[96:99], v[60:63], v[120:123]
ds_read_b64_tr_b16 v[80:81], v7 offset:4096
v_mfma_f32_16x16x32_bf16 v[124:127], v[96:99], v[64:67], v[124:127]
s_waitcnt lgkmcnt(2)
buffer_load_dwordx4 v13, s[52:55], s11 offen lds
v_mfma_f32_16x16x32_bf16 v[128:131], v[96:99], v[68:71], v[128:131]
ds_read_b64_tr_b16 v[84:85], v8 offset:4096
v_mfma_f32_16x16x32_bf16 v[132:135], v[96:99], v[72:75], v[132:135]
ds_read_b64_tr_b16 v[88:89], v9 offset:4096
v_mfma_f32_16x16x32_bf16 v[152:155], v[100:103], v[72:75], v[152:155]
ds_read_b128 v[36:39], v2 offset:30720
v_mfma_f32_16x16x32_bf16 v[148:151], v[100:103], v[68:71], v[148:151]
ds_read_b128 v[40:43], v2 offset:31744
v_mfma_f32_16x16x32_bf16 v[144:147], v[100:103], v[64:67], v[144:147]
buffer_load_dwordx4 v14, s[52:55], s11 offen offset:1024 lds
v_mfma_f32_16x16x32_bf16 v[140:143], v[100:103], v[60:63], v[140:143]
ds_read_b128 v[44:47], v2 offset:32768
s_add_u32 m0, s6, 4096
v_mfma_f32_16x16x32_bf16 v[136:139], v[100:103], v[56:59], v[136:139]
ds_read_b128 v[48:51], v2 offset:33792
s_mov_b32 s11, 294912
v_mfma_f32_16x16x32_bf16 v[156:159], v[104:107], v[56:59], v[156:159]
s_waitcnt vmcnt(4)
ds_read_b64_tr_b16 v[78:79], v6 offset:6144
v_mfma_f32_16x16x32_bf16 v[160:163], v[104:107], v[60:63], v[160:163]
ds_read_b64_tr_b16 v[82:83], v7 offset:6144
v_mfma_f32_16x16x32_bf16 v[164:167], v[104:107], v[64:67], v[164:167]
s_waitcnt lgkmcnt(5)
buffer_load_dwordx4 v13, s[52:55], s11 offen lds
v_mfma_f32_16x16x32_bf16 v[168:171], v[104:107], v[68:71], v[168:171]
ds_read_b64_tr_b16 v[86:87], v8 offset:6144
v_mfma_f32_16x16x32_bf16 v[172:175], v[104:107], v[72:75], v[172:175]
ds_read_b64_tr_b16 v[90:91], v9 offset:6144
v_mfma_f32_16x16x32_bf16 v[192:195], v[108:111], v[72:75], v[192:195]
ds_read_b128 v[52:55], v2 offset:34816
v_mfma_f32_16x16x32_bf16 v[188:191], v[108:111], v[68:71], v[188:191]
v_mfma_f32_16x16x32_bf16 v[184:187], v[108:111], v[64:67], v[184:187]
buffer_load_dwordx4 v14, s[52:55], s11 offen offset:1024 lds
v_mfma_f32_16x16x32_bf16 v[180:183], v[108:111], v[60:63], v[180:183]
s_add_u32 m0, s6, 6144
v_mfma_f32_16x16x32_bf16 v[176:179], v[108:111], v[56:59], v[176:179]
s_waitcnt lgkmcnt(3)
s_mov_b32 s11, 313344
v_mfma_f32_16x16x32_bf16 v[116:119], v[76:79], v[36:39], v[116:119]
s_waitcnt vmcnt(4)
ds_read_b64_tr_b16 v[96:97], v6 offset:8192
v_mfma_f32_16x16x32_bf16 v[120:123], v[76:79], v[40:43], v[120:123]
ds_read_b64_tr_b16 v[100:101], v7 offset:8192
v_mfma_f32_16x16x32_bf16 v[124:127], v[76:79], v[44:47], v[124:127]
s_waitcnt lgkmcnt(2)
buffer_load_dwordx4 v13, s[52:55], s11 offen lds
v_mfma_f32_16x16x32_bf16 v[128:131], v[76:79], v[48:51], v[128:131]
ds_read_b64_tr_b16 v[104:105], v8 offset:8192
v_mfma_f32_16x16x32_bf16 v[132:135], v[76:79], v[52:55], v[132:135]
ds_read_b64_tr_b16 v[108:109], v9 offset:8192
v_mfma_f32_16x16x32_bf16 v[152:155], v[80:83], v[52:55], v[152:155]
ds_read_b128 v[56:59], v2 offset:35840
v_mfma_f32_16x16x32_bf16 v[148:151], v[80:83], v[48:51], v[148:151]
ds_read_b128 v[60:63], v2 offset:36864
v_mfma_f32_16x16x32_bf16 v[144:147], v[80:83], v[44:47], v[144:147]
buffer_load_dwordx4 v14, s[52:55], s11 offen offset:1024 lds
v_mfma_f32_16x16x32_bf16 v[140:143], v[80:83], v[40:43], v[140:143]
ds_read_b128 v[64:67], v2 offset:37888
s_add_u32 m0, s6, 8192
v_mfma_f32_16x16x32_bf16 v[136:139], v[80:83], v[36:39], v[136:139]
ds_read_b128 v[68:71], v2 offset:38912
s_mov_b32 s11, 368640
v_mfma_f32_16x16x32_bf16 v[156:159], v[84:87], v[36:39], v[156:159]
s_waitcnt vmcnt(4)
ds_read_b64_tr_b16 v[98:99], v6 offset:10240
v_mfma_f32_16x16x32_bf16 v[160:163], v[84:87], v[40:43], v[160:163]
ds_read_b64_tr_b16 v[102:103], v7 offset:10240
v_mfma_f32_16x16x32_bf16 v[164:167], v[84:87], v[44:47], v[164:167]
s_waitcnt lgkmcnt(5)
buffer_load_dwordx4 v13, s[52:55], s11 offen lds
v_mfma_f32_16x16x32_bf16 v[168:171], v[84:87], v[48:51], v[168:171]
ds_read_b64_tr_b16 v[106:107], v8 offset:10240
v_mfma_f32_16x16x32_bf16 v[172:175], v[84:87], v[52:55], v[172:175]
ds_read_b64_tr_b16 v[110:111], v9 offset:10240
v_mfma_f32_16x16x32_bf16 v[192:195], v[88:91], v[52:55], v[192:195]
ds_read_b128 v[72:75], v2 offset:39936
v_mfma_f32_16x16x32_bf16 v[188:191], v[88:91], v[48:51], v[188:191]
v_mfma_f32_16x16x32_bf16 v[184:187], v[88:91], v[44:47], v[184:187]
buffer_load_dwordx4 v14, s[52:55], s11 offen offset:1024 lds
v_mfma_f32_16x16x32_bf16 v[180:183], v[88:91], v[40:43], v[180:183]
s_add_u32 m0, s6, 10240
v_mfma_f32_16x16x32_bf16 v[176:179], v[88:91], v[36:39], v[176:179]
s_waitcnt lgkmcnt(3)
s_mov_b32 s11, 387072
v_mfma_f32_16x16x32_bf16 v[116:119], v[96:99], v[56:59], v[116:119]
s_waitcnt vmcnt(4)
ds_read_b64_tr_b16 v[76:77], v6 offset:4096
v_mfma_f32_16x16x32_bf16 v[120:123], v[96:99], v[60:63], v[120:123]
ds_read_b64_tr_b16 v[80:81], v7 offset:4096
v_mfma_f32_16x16x32_bf16 v[124:127], v[96:99], v[64:67], v[124:127]
s_waitcnt lgkmcnt(2)
buffer_load_dwordx4 v13, s[52:55], s11 offen lds
v_mfma_f32_16x16x32_bf16 v[128:131], v[96:99], v[68:71], v[128:131]
ds_read_b64_tr_b16 v[84:85], v8 offset:4096
v_mfma_f32_16x16x32_bf16 v[132:135], v[96:99], v[72:75], v[132:135]
ds_read_b64_tr_b16 v[88:89], v9 offset:4096
v_mfma_f32_16x16x32_bf16 v[152:155], v[100:103], v[72:75], v[152:155]
ds_read_b128 v[36:39], v2 offset:40960
v_mfma_f32_16x16x32_bf16 v[148:151], v[100:103], v[68:71], v[148:151]
ds_read_b128 v[40:43], v2 offset:41984
v_mfma_f32_16x16x32_bf16 v[144:147], v[100:103], v[64:67], v[144:147]
buffer_load_dwordx4 v14, s[52:55], s11 offen offset:1024 lds
v_mfma_f32_16x16x32_bf16 v[140:143], v[100:103], v[60:63], v[140:143]
ds_read_b128 v[44:47], v2 offset:43008
s_add_u32 m0, s6, 4096
v_mfma_f32_16x16x32_bf16 v[136:139], v[100:103], v[56:59], v[136:139]
ds_read_b128 v[48:51], v2 offset:44032
s_mov_b32 s11, 442368
v_mfma_f32_16x16x32_bf16 v[156:159], v[104:107], v[56:59], v[156:159]
s_waitcnt vmcnt(4)
ds_read_b64_tr_b16 v[78:79], v6 offset:6144
v_mfma_f32_16x16x32_bf16 v[160:163], v[104:107], v[60:63], v[160:163]
ds_read_b64_tr_b16 v[82:83], v7 offset:6144
v_mfma_f32_16x16x32_bf16 v[164:167], v[104:107], v[64:67], v[164:167]
s_waitcnt lgkmcnt(5)
buffer_load_dwordx4 v13, s[52:55], s11 offen lds
v_mfma_f32_16x16x32_bf16 v[168:171], v[104:107], v[68:71], v[168:171]
ds_read_b64_tr_b16 v[86:87], v8 offset:6144
v_mfma_f32_16x16x32_bf16 v[172:175], v[104:107], v[72:75], v[172:175]
ds_read_b64_tr_b16 v[90:91], v9 offset:6144
v_mfma_f32_16x16x32_bf16 v[192:195], v[108:111], v[72:75], v[192:195]
ds_read_b128 v[52:55], v2 offset:45056
v_mfma_f32_16x16x32_bf16 v[188:191], v[108:111], v[68:71], v[188:191]
v_mfma_f32_16x16x32_bf16 v[184:187], v[108:111], v[64:67], v[184:187]
buffer_load_dwordx4 v14, s[52:55], s11 offen offset:1024 lds
v_mfma_f32_16x16x32_bf16 v[180:183], v[108:111], v[60:63], v[180:183]
s_add_u32 m0, s6, 6144
v_mfma_f32_16x16x32_bf16 v[176:179], v[108:111], v[56:59], v[176:179]
s_waitcnt lgkmcnt(3)
s_mov_b32 s11, 460800
v_mfma_f32_16x16x32_bf16 v[116:119], v[76:79], v[36:39], v[116:119]
s_waitcnt vmcnt(4)
ds_read_b64_tr_b16 v[96:97], v6 offset:8192
v_mfma_f32_16x16x32_bf16 v[120:123], v[76:79], v[40:43], v[120:123]
ds_read_b64_tr_b16 v[100:101], v7 offset:8192
v_mfma_f32_16x16x32_bf16 v[124:127], v[76:79], v[44:47], v[124:127]
s_waitcnt lgkmcnt(2)
buffer_load_dwordx4 v13, s[52:55], s11 offen lds
v_mfma_f32_16x16x32_bf16 v[128:131], v[76:79], v[48:51], v[128:131]
ds_read_b64_tr_b16 v[104:105], v8 offset:8192
v_mfma_f32_16x16x32_bf16 v[132:135], v[76:79], v[52:55], v[132:135]
ds_read_b64_tr_b16 v[108:109], v9 offset:8192
v_mfma_f32_16x16x32_bf16 v[152:155], v[80:83], v[52:55], v[152:155]
ds_read_b128 v[56:59], v3 offset:0
v_mfma_f32_16x16x32_bf16 v[148:151], v[80:83], v[48:51], v[148:151]
ds_read_b128 v[60:63], v3 offset:1024
v_mfma_f32_16x16x32_bf16 v[144:147], v[80:83], v[44:47], v[144:147]
buffer_load_dwordx4 v14, s[52:55], s11 offen offset:1024 lds
v_mfma_f32_16x16x32_bf16 v[140:143], v[80:83], v[40:43], v[140:143]
ds_read_b128 v[64:67], v3 offset:2048
s_add_u32 m0, s6, 8192
v_mfma_f32_16x16x32_bf16 v[136:139], v[80:83], v[36:39], v[136:139]
ds_read_b128 v[68:71], v3 offset:3072
s_mov_b32 s11, 516096
v_mfma_f32_16x16x32_bf16 v[156:159], v[84:87], v[36:39], v[156:159]
s_waitcnt vmcnt(4)
ds_read_b64_tr_b16 v[98:99], v6 offset:10240
v_mfma_f32_16x16x32_bf16 v[160:163], v[84:87], v[40:43], v[160:163]
ds_read_b64_tr_b16 v[102:103], v7 offset:10240
v_mfma_f32_16x16x32_bf16 v[164:167], v[84:87], v[44:47], v[164:167]
s_waitcnt lgkmcnt(5)
buffer_load_dwordx4 v13, s[52:55], s11 offen lds
v_mfma_f32_16x16x32_bf16 v[168:171], v[84:87], v[48:51], v[168:171]
ds_read_b64_tr_b16 v[106:107], v8 offset:10240
v_mfma_f32_16x16x32_bf16 v[172:175], v[84:87], v[52:55], v[172:175]
ds_read_b64_tr_b16 v[110:111], v9 offset:10240
v_mfma_f32_16x16x32_bf16 v[192:195], v[88:91], v[52:55], v[192:195]
ds_read_b128 v[72:75], v3 offset:4096
v_mfma_f32_16x16x32_bf16 v[188:191], v[88:91], v[48:51], v[188:191]
v_mfma_f32_16x16x32_bf16 v[184:187], v[88:91], v[44:47], v[184:187]
buffer_load_dwordx4 v14, s[52:55], s11 offen offset:1024 lds
v_mfma_f32_16x16x32_bf16 v[180:183], v[88:91], v[40:43], v[180:183]
s_add_u32 m0, s6, 10240
v_mfma_f32_16x16x32_bf16 v[176:179], v[88:91], v[36:39], v[176:179]
s_waitcnt lgkmcnt(3)
s_mov_b32 s11, 534528
v_mfma_f32_16x16x32_bf16 v[116:119], v[96:99], v[56:59], v[116:119]
s_waitcnt vmcnt(4)
ds_read_b64_tr_b16 v[76:77], v6 offset:4096
v_mfma_f32_16x16x32_bf16 v[120:123], v[96:99], v[60:63], v[120:123]
ds_read_b64_tr_b16 v[80:81], v7 offset:4096
v_mfma_f32_16x16x32_bf16 v[124:127], v[96:99], v[64:67], v[124:127]
s_waitcnt lgkmcnt(2)
buffer_load_dwordx4 v13, s[52:55], s11 offen lds
v_mfma_f32_16x16x32_bf16 v[128:131], v[96:99], v[68:71], v[128:131]
ds_read_b64_tr_b16 v[84:85], v8 offset:4096
v_mfma_f32_16x16x32_bf16 v[132:135], v[96:99], v[72:75], v[132:135]
ds_read_b64_tr_b16 v[88:89], v9 offset:4096
v_mfma_f32_16x16x32_bf16 v[152:155], v[100:103], v[72:75], v[152:155]
ds_read_b128 v[36:39], v3 offset:5120
v_mfma_f32_16x16x32_bf16 v[148:151], v[100:103], v[68:71], v[148:151]
ds_read_b128 v[40:43], v3 offset:6144
v_mfma_f32_16x16x32_bf16 v[144:147], v[100:103], v[64:67], v[144:147]
buffer_load_dwordx4 v14, s[52:55], s11 offen offset:1024 lds
v_mfma_f32_16x16x32_bf16 v[140:143], v[100:103], v[60:63], v[140:143]
ds_read_b128 v[44:47], v3 offset:7168
s_add_u32 m0, s6, 4096
v_mfma_f32_16x16x32_bf16 v[136:139], v[100:103], v[56:59], v[136:139]
ds_read_b128 v[48:51], v3 offset:8192
s_mov_b32 s11, 331776
v_mfma_f32_16x16x32_bf16 v[156:159], v[104:107], v[56:59], v[156:159]
s_waitcnt vmcnt(4)
ds_read_b64_tr_b16 v[78:79], v6 offset:6144
v_mfma_f32_16x16x32_bf16 v[160:163], v[104:107], v[60:63], v[160:163]
ds_read_b64_tr_b16 v[82:83], v7 offset:6144
v_mfma_f32_16x16x32_bf16 v[164:167], v[104:107], v[64:67], v[164:167]
s_waitcnt lgkmcnt(5)
buffer_load_dwordx4 v13, s[52:55], s11 offen lds
v_mfma_f32_16x16x32_bf16 v[168:171], v[104:107], v[68:71], v[168:171]
ds_read_b64_tr_b16 v[86:87], v8 offset:6144
v_mfma_f32_16x16x32_bf16 v[172:175], v[104:107], v[72:75], v[172:175]
ds_read_b64_tr_b16 v[90:91], v9 offset:6144
v_mfma_f32_16x16x32_bf16 v[192:195], v[108:111], v[72:75], v[192:195]
ds_read_b128 v[52:55], v3 offset:9216
v_mfma_f32_16x16x32_bf16 v[188:191], v[108:111], v[68:71], v[188:191]
v_mfma_f32_16x16x32_bf16 v[184:187], v[108:111], v[64:67], v[184:187]
buffer_load_dwordx4 v14, s[52:55], s11 offen offset:1024 lds
v_mfma_f32_16x16x32_bf16 v[180:183], v[108:111], v[60:63], v[180:183]
s_add_u32 m0, s6, 6144
v_mfma_f32_16x16x32_bf16 v[176:179], v[108:111], v[56:59], v[176:179]
s_waitcnt lgkmcnt(3)
s_mov_b32 s11, 350208
v_mfma_f32_16x16x32_bf16 v[116:119], v[76:79], v[36:39], v[116:119]
s_waitcnt vmcnt(4)
ds_read_b64_tr_b16 v[96:97], v6 offset:8192
v_mfma_f32_16x16x32_bf16 v[120:123], v[76:79], v[40:43], v[120:123]
ds_read_b64_tr_b16 v[100:101], v7 offset:8192
v_mfma_f32_16x16x32_bf16 v[124:127], v[76:79], v[44:47], v[124:127]
s_waitcnt lgkmcnt(2)
buffer_load_dwordx4 v13, s[52:55], s11 offen lds
v_mfma_f32_16x16x32_bf16 v[128:131], v[76:79], v[48:51], v[128:131]
ds_read_b64_tr_b16 v[104:105], v8 offset:8192
v_mfma_f32_16x16x32_bf16 v[132:135], v[76:79], v[52:55], v[132:135]
ds_read_b64_tr_b16 v[108:109], v9 offset:8192
v_mfma_f32_16x16x32_bf16 v[152:155], v[80:83], v[52:55], v[152:155]
ds_read_b128 v[56:59], v3 offset:10240
v_mfma_f32_16x16x32_bf16 v[148:151], v[80:83], v[48:51], v[148:151]
ds_read_b128 v[60:63], v3 offset:11264
v_mfma_f32_16x16x32_bf16 v[144:147], v[80:83], v[44:47], v[144:147]
buffer_load_dwordx4 v14, s[52:55], s11 offen offset:1024 lds
v_mfma_f32_16x16x32_bf16 v[140:143], v[80:83], v[40:43], v[140:143]
ds_read_b128 v[64:67], v3 offset:12288
s_add_u32 m0, s6, 8192
v_mfma_f32_16x16x32_bf16 v[136:139], v[80:83], v[36:39], v[136:139]
ds_read_b128 v[68:71], v3 offset:13312
s_mov_b32 s11, 405504
v_mfma_f32_16x16x32_bf16 v[156:159], v[84:87], v[36:39], v[156:159]
s_waitcnt vmcnt(4)
ds_read_b64_tr_b16 v[98:99], v6 offset:10240
v_mfma_f32_16x16x32_bf16 v[160:163], v[84:87], v[40:43], v[160:163]
ds_read_b64_tr_b16 v[102:103], v7 offset:10240
v_mfma_f32_16x16x32_bf16 v[164:167], v[84:87], v[44:47], v[164:167]
s_waitcnt lgkmcnt(5)
buffer_load_dwordx4 v13, s[52:55], s11 offen lds
v_mfma_f32_16x16x32_bf16 v[168:171], v[84:87], v[48:51], v[168:171]
ds_read_b64_tr_b16 v[106:107], v8 offset:10240
v_mfma_f32_16x16x32_bf16 v[172:175], v[84:87], v[52:55], v[172:175]
ds_read_b64_tr_b16 v[110:111], v9 offset:10240
v_mfma_f32_16x16x32_bf16 v[192:195], v[88:91], v[52:55], v[192:195]
ds_read_b128 v[72:75], v3 offset:14336
v_mov_b32 v24, 34
v_mfma_f32_16x16x32_bf16 v[188:191], v[88:91], v[48:51], v[188:191]
ds_write_b32 v22, v24
v_mfma_f32_16x16x32_bf16 v[184:187], v[88:91], v[44:47], v[184:187]
buffer_load_dwordx4 v14, s[52:55], s11 offen offset:1024 lds
v_mfma_f32_16x16x32_bf16 v[180:183], v[88:91], v[40:43], v[180:183]
s_add_u32 m0, s6, 10240
v_mfma_f32_16x16x32_bf16 v[176:179], v[88:91], v[36:39], v[176:179]
s_waitcnt lgkmcnt(4)
s_mov_b32 s11, 423936
v_mfma_f32_16x16x32_bf16 v[116:119], v[96:99], v[56:59], v[116:119]
s_waitcnt vmcnt(4)
ds_read_b64_tr_b16 v[76:77], v6 offset:4096
v_mfma_f32_16x16x32_bf16 v[120:123], v[96:99], v[60:63], v[120:123]
ds_read_b64_tr_b16 v[80:81], v7 offset:4096
v_mfma_f32_16x16x32_bf16 v[124:127], v[96:99], v[64:67], v[124:127]
s_waitcnt lgkmcnt(3)
buffer_load_dwordx4 v13, s[52:55], s11 offen lds
v_mfma_f32_16x16x32_bf16 v[128:131], v[96:99], v[68:71], v[128:131]
ds_read_b64_tr_b16 v[84:85], v8 offset:4096
v_mfma_f32_16x16x32_bf16 v[132:135], v[96:99], v[72:75], v[132:135]
ds_read_b64_tr_b16 v[88:89], v9 offset:4096
v_mfma_f32_16x16x32_bf16 v[152:155], v[100:103], v[72:75], v[152:155]
ds_read_b128 v[36:39], v3 offset:15360
v_mfma_f32_16x16x32_bf16 v[148:151], v[100:103], v[68:71], v[148:151]
ds_read_b128 v[40:43], v3 offset:16384
v_mfma_f32_16x16x32_bf16 v[144:147], v[100:103], v[64:67], v[144:147]
buffer_load_dwordx4 v14, s[52:55], s11 offen offset:1024 lds
v_mfma_f32_16x16x32_bf16 v[140:143], v[100:103], v[60:63], v[140:143]
ds_read_b128 v[44:47], v3 offset:17408
s_add_u32 m0, s6, 4096
v_mfma_f32_16x16x32_bf16 v[136:139], v[100:103], v[56:59], v[136:139]
ds_read_b128 v[48:51], v3 offset:18432
s_mov_b32 s11, 479232
v_mfma_f32_16x16x32_bf16 v[156:159], v[104:107], v[56:59], v[156:159]
s_waitcnt vmcnt(4)
ds_read_b64_tr_b16 v[78:79], v6 offset:6144
v_mfma_f32_16x16x32_bf16 v[160:163], v[104:107], v[60:63], v[160:163]
ds_read_b64_tr_b16 v[82:83], v7 offset:6144
v_mfma_f32_16x16x32_bf16 v[164:167], v[104:107], v[64:67], v[164:167]
s_waitcnt lgkmcnt(5)
buffer_load_dwordx4 v13, s[52:55], s11 offen lds
v_mfma_f32_16x16x32_bf16 v[168:171], v[104:107], v[68:71], v[168:171]
ds_read_b64_tr_b16 v[86:87], v8 offset:6144
v_mfma_f32_16x16x32_bf16 v[172:175], v[104:107], v[72:75], v[172:175]
ds_read_b64_tr_b16 v[90:91], v9 offset:6144
v_mfma_f32_16x16x32_bf16 v[192:195], v[108:111], v[72:75], v[192:195]
ds_read_b128 v[52:55], v3 offset:19456
v_mfma_f32_16x16x32_bf16 v[188:191], v[108:111], v[68:71], v[188:191]
v_mfma_f32_16x16x32_bf16 v[184:187], v[108:111], v[64:67], v[184:187]
buffer_load_dwordx4 v14, s[52:55], s11 offen offset:1024 lds
v_mfma_f32_16x16x32_bf16 v[180:183], v[108:111], v[60:63], v[180:183]
s_add_u32 m0, s6, 6144
v_mfma_f32_16x16x32_bf16 v[176:179], v[108:111], v[56:59], v[176:179]
s_waitcnt lgkmcnt(3)
s_mov_b32 s11, 497664
v_mfma_f32_16x16x32_bf16 v[116:119], v[76:79], v[36:39], v[116:119]
s_waitcnt vmcnt(4)
ds_read_b64_tr_b16 v[96:97], v6 offset:8192
v_mfma_f32_16x16x32_bf16 v[120:123], v[76:79], v[40:43], v[120:123]
ds_read_b64_tr_b16 v[100:101], v7 offset:8192
v_mfma_f32_16x16x32_bf16 v[124:127], v[76:79], v[44:47], v[124:127]
s_waitcnt lgkmcnt(2)
buffer_load_dwordx4 v13, s[52:55], s11 offen lds
v_mfma_f32_16x16x32_bf16 v[128:131], v[76:79], v[48:51], v[128:131]
ds_read_b64_tr_b16 v[104:105], v8 offset:8192
v_mfma_f32_16x16x32_bf16 v[132:135], v[76:79], v[52:55], v[132:135]
ds_read_b64_tr_b16 v[108:109], v9 offset:8192
v_mfma_f32_16x16x32_bf16 v[152:155], v[80:83], v[52:55], v[152:155]
ds_read_b128 v[56:59], v3 offset:20480
v_mfma_f32_16x16x32_bf16 v[148:151], v[80:83], v[48:51], v[148:151]
ds_read_b128 v[60:63], v3 offset:21504
v_mfma_f32_16x16x32_bf16 v[144:147], v[80:83], v[44:47], v[144:147]
buffer_load_dwordx4 v14, s[52:55], s11 offen offset:1024 lds
v_mfma_f32_16x16x32_bf16 v[140:143], v[80:83], v[40:43], v[140:143]
ds_read_b128 v[64:67], v3 offset:22528
s_add_u32 m0, s6, 8192
v_mfma_f32_16x16x32_bf16 v[136:139], v[80:83], v[36:39], v[136:139]
ds_read_b128 v[68:71], v3 offset:23552
s_mov_b32 s11, 552960
v_mfma_f32_16x16x32_bf16 v[156:159], v[84:87], v[36:39], v[156:159]
s_waitcnt vmcnt(4)
ds_read_b64_tr_b16 v[98:99], v6 offset:10240
v_mfma_f32_16x16x32_bf16 v[160:163], v[84:87], v[40:43], v[160:163]
ds_read_b64_tr_b16 v[102:103], v7 offset:10240
v_mfma_f32_16x16x32_bf16 v[164:167], v[84:87], v[44:47], v[164:167]
s_waitcnt lgkmcnt(5)
buffer_load_dwordx4 v13, s[52:55], s11 offen lds
v_mfma_f32_16x16x32_bf16 v[168:171], v[84:87], v[48:51], v[168:171]
ds_read_b64_tr_b16 v[106:107], v8 offset:10240
v_mfma_f32_16x16x32_bf16 v[172:175], v[84:87], v[52:55], v[172:175]
ds_read_b64_tr_b16 v[110:111], v9 offset:10240
v_mfma_f32_16x16x32_bf16 v[192:195], v[88:91], v[52:55], v[192:195]
ds_read_b128 v[72:75], v3 offset:24576
v_mfma_f32_16x16x32_bf16 v[188:191], v[88:91], v[48:51], v[188:191]
v_mfma_f32_16x16x32_bf16 v[184:187], v[88:91], v[44:47], v[184:187]
buffer_load_dwordx4 v14, s[52:55], s11 offen offset:1024 lds
v_mfma_f32_16x16x32_bf16 v[180:183], v[88:91], v[40:43], v[180:183]
s_add_u32 m0, s6, 10240
v_mfma_f32_16x16x32_bf16 v[176:179], v[88:91], v[36:39], v[176:179]
s_waitcnt lgkmcnt(3)
s_mov_b32 s11, 571392
v_mfma_f32_16x16x32_bf16 v[116:119], v[96:99], v[56:59], v[116:119]
s_waitcnt vmcnt(4)
ds_read_b64_tr_b16 v[76:77], v6 offset:4096
v_mfma_f32_16x16x32_bf16 v[120:123], v[96:99], v[60:63], v[120:123]
ds_read_b64_tr_b16 v[80:81], v7 offset:4096
v_mfma_f32_16x16x32_bf16 v[124:127], v[96:99], v[64:67], v[124:127]
s_waitcnt lgkmcnt(2)
buffer_load_dwordx4 v13, s[52:55], s11 offen lds
v_mfma_f32_16x16x32_bf16 v[128:131], v[96:99], v[68:71], v[128:131]
ds_read_b64_tr_b16 v[84:85], v8 offset:4096
v_mfma_f32_16x16x32_bf16 v[132:135], v[96:99], v[72:75], v[132:135]
ds_read_b64_tr_b16 v[88:89], v9 offset:4096
v_mfma_f32_16x16x32_bf16 v[152:155], v[100:103], v[72:75], v[152:155]
ds_read_b128 v[36:39], v3 offset:25600
v_mfma_f32_16x16x32_bf16 v[148:151], v[100:103], v[68:71], v[148:151]
ds_read_b128 v[40:43], v3 offset:26624
v_mfma_f32_16x16x32_bf16 v[144:147], v[100:103], v[64:67], v[144:147]
buffer_load_dwordx4 v14, s[52:55], s11 offen offset:1024 lds
v_mfma_f32_16x16x32_bf16 v[140:143], v[100:103], v[60:63], v[140:143]
ds_read_b128 v[44:47], v3 offset:27648
s_add_u32 m0, s6, 4096
v_mfma_f32_16x16x32_bf16 v[136:139], v[100:103], v[56:59], v[136:139]
ds_read_b128 v[48:51], v3 offset:28672
s_mov_b32 s11, 589824
v_mfma_f32_16x16x32_bf16 v[156:159], v[104:107], v[56:59], v[156:159]
s_waitcnt vmcnt(4)
ds_read_b64_tr_b16 v[78:79], v6 offset:6144
v_mfma_f32_16x16x32_bf16 v[160:163], v[104:107], v[60:63], v[160:163]
ds_read_b64_tr_b16 v[82:83], v7 offset:6144
v_mfma_f32_16x16x32_bf16 v[164:167], v[104:107], v[64:67], v[164:167]
s_waitcnt lgkmcnt(5)
buffer_load_dwordx4 v13, s[52:55], s11 offen lds
v_mfma_f32_16x16x32_bf16 v[168:171], v[104:107], v[68:71], v[168:171]
ds_read_b64_tr_b16 v[86:87], v8 offset:6144
v_mfma_f32_16x16x32_bf16 v[172:175], v[104:107], v[72:75], v[172:175]
ds_read_b64_tr_b16 v[90:91], v9 offset:6144
v_mfma_f32_16x16x32_bf16 v[192:195], v[108:111], v[72:75], v[192:195]
ds_read_b128 v[52:55], v3 offset:29696
v_mfma_f32_16x16x32_bf16 v[188:191], v[108:111], v[68:71], v[188:191]
v_mfma_f32_16x16x32_bf16 v[184:187], v[108:111], v[64:67], v[184:187]
buffer_load_dwordx4 v14, s[52:55], s11 offen offset:1024 lds
v_mfma_f32_16x16x32_bf16 v[180:183], v[108:111], v[60:63], v[180:183]
s_add_u32 m0, s6, 6144
v_mfma_f32_16x16x32_bf16 v[176:179], v[108:111], v[56:59], v[176:179]
s_waitcnt lgkmcnt(3)
s_mov_b32 s11, 608256
v_mfma_f32_16x16x32_bf16 v[116:119], v[76:79], v[36:39], v[116:119]
s_waitcnt vmcnt(4)
ds_read_b64_tr_b16 v[96:97], v6 offset:8192
v_mfma_f32_16x16x32_bf16 v[120:123], v[76:79], v[40:43], v[120:123]
ds_read_b64_tr_b16 v[100:101], v7 offset:8192
v_mfma_f32_16x16x32_bf16 v[124:127], v[76:79], v[44:47], v[124:127]
s_waitcnt lgkmcnt(2)
buffer_load_dwordx4 v13, s[52:55], s11 offen lds
v_mfma_f32_16x16x32_bf16 v[128:131], v[76:79], v[48:51], v[128:131]
ds_read_b64_tr_b16 v[104:105], v8 offset:8192
v_mfma_f32_16x16x32_bf16 v[132:135], v[76:79], v[52:55], v[132:135]
ds_read_b64_tr_b16 v[108:109], v9 offset:8192
v_mfma_f32_16x16x32_bf16 v[152:155], v[80:83], v[52:55], v[152:155]
ds_read_b128 v[56:59], v3 offset:30720
v_mfma_f32_16x16x32_bf16 v[148:151], v[80:83], v[48:51], v[148:151]
ds_read_b128 v[60:63], v3 offset:31744
v_mfma_f32_16x16x32_bf16 v[144:147], v[80:83], v[44:47], v[144:147]
buffer_load_dwordx4 v14, s[52:55], s11 offen offset:1024 lds
v_mfma_f32_16x16x32_bf16 v[140:143], v[80:83], v[40:43], v[140:143]
ds_read_b128 v[64:67], v3 offset:32768
s_add_u32 m0, s6, 8192
v_mfma_f32_16x16x32_bf16 v[136:139], v[80:83], v[36:39], v[136:139]
ds_read_b128 v[68:71], v3 offset:33792
s_mov_b32 s11, 626688
v_mfma_f32_16x16x32_bf16 v[156:159], v[84:87], v[36:39], v[156:159]
s_waitcnt vmcnt(4)
ds_read_b64_tr_b16 v[98:99], v6 offset:10240
v_mfma_f32_16x16x32_bf16 v[160:163], v[84:87], v[40:43], v[160:163]
ds_read_b64_tr_b16 v[102:103], v7 offset:10240
v_mfma_f32_16x16x32_bf16 v[164:167], v[84:87], v[44:47], v[164:167]
s_waitcnt lgkmcnt(5)
buffer_load_dwordx4 v13, s[52:55], s11 offen lds
v_mfma_f32_16x16x32_bf16 v[168:171], v[84:87], v[48:51], v[168:171]
ds_read_b64_tr_b16 v[106:107], v8 offset:10240
v_mfma_f32_16x16x32_bf16 v[172:175], v[84:87], v[52:55], v[172:175]
ds_read_b64_tr_b16 v[110:111], v9 offset:10240
v_mfma_f32_16x16x32_bf16 v[192:195], v[88:91], v[52:55], v[192:195]
ds_read_b128 v[72:75], v3 offset:34816
v_mfma_f32_16x16x32_bf16 v[188:191], v[88:91], v[48:51], v[188:191]
v_mfma_f32_16x16x32_bf16 v[184:187], v[88:91], v[44:47], v[184:187]
buffer_load_dwordx4 v14, s[52:55], s11 offen offset:1024 lds
v_mfma_f32_16x16x32_bf16 v[180:183], v[88:91], v[40:43], v[180:183]
s_add_u32 m0, s6, 10240
v_mfma_f32_16x16x32_bf16 v[176:179], v[88:91], v[36:39], v[176:179]
s_waitcnt lgkmcnt(3)
s_mov_b32 s11, 645120
v_mfma_f32_16x16x32_bf16 v[116:119], v[96:99], v[56:59], v[116:119]
s_waitcnt vmcnt(4)
ds_read_b64_tr_b16 v[76:77], v6 offset:4096
v_mfma_f32_16x16x32_bf16 v[120:123], v[96:99], v[60:63], v[120:123]
ds_read_b64_tr_b16 v[80:81], v7 offset:4096
v_mfma_f32_16x16x32_bf16 v[124:127], v[96:99], v[64:67], v[124:127]
s_waitcnt lgkmcnt(2)
buffer_load_dwordx4 v13, s[52:55], s11 offen lds
v_mfma_f32_16x16x32_bf16 v[128:131], v[96:99], v[68:71], v[128:131]
ds_read_b64_tr_b16 v[84:85], v8 offset:4096
v_mfma_f32_16x16x32_bf16 v[132:135], v[96:99], v[72:75], v[132:135]
ds_read_b64_tr_b16 v[88:89], v9 offset:4096
v_mfma_f32_16x16x32_bf16 v[152:155], v[100:103], v[72:75], v[152:155]
ds_read_b128 v[36:39], v3 offset:35840
v_mfma_f32_16x16x32_bf16 v[148:151], v[100:103], v[68:71], v[148:151]
ds_read_b128 v[40:43], v3 offset:36864
v_mfma_f32_16x16x32_bf16 v[144:147], v[100:103], v[64:67], v[144:147]
buffer_load_dwordx4 v14, s[52:55], s11 offen offset:1024 lds
v_mfma_f32_16x16x32_bf16 v[140:143], v[100:103], v[60:63], v[140:143]
ds_read_b128 v[44:47], v3 offset:37888
v_mfma_f32_16x16x32_bf16 v[136:139], v[100:103], v[56:59], v[136:139]
ds_read_b128 v[48:51], v3 offset:38912
v_mfma_f32_16x16x32_bf16 v[156:159], v[104:107], v[56:59], v[156:159]
s_waitcnt vmcnt(4)
ds_read_b64_tr_b16 v[78:79], v6 offset:6144
v_mfma_f32_16x16x32_bf16 v[160:163], v[104:107], v[60:63], v[160:163]
ds_read_b64_tr_b16 v[82:83], v7 offset:6144
v_mfma_f32_16x16x32_bf16 v[164:167], v[104:107], v[64:67], v[164:167]
v_mfma_f32_16x16x32_bf16 v[168:171], v[104:107], v[68:71], v[168:171]
ds_read_b64_tr_b16 v[86:87], v8 offset:6144
v_mfma_f32_16x16x32_bf16 v[172:175], v[104:107], v[72:75], v[172:175]
ds_read_b64_tr_b16 v[90:91], v9 offset:6144
v_mfma_f32_16x16x32_bf16 v[192:195], v[108:111], v[72:75], v[192:195]
ds_read_b128 v[52:55], v3 offset:39936
v_mfma_f32_16x16x32_bf16 v[188:191], v[108:111], v[68:71], v[188:191]
v_mfma_f32_16x16x32_bf16 v[184:187], v[108:111], v[64:67], v[184:187]
v_mfma_f32_16x16x32_bf16 v[180:183], v[108:111], v[60:63], v[180:183]
v_mfma_f32_16x16x32_bf16 v[176:179], v[108:111], v[56:59], v[176:179]
s_waitcnt lgkmcnt(3)
v_mfma_f32_16x16x32_bf16 v[116:119], v[76:79], v[36:39], v[116:119]
s_waitcnt vmcnt(2)
ds_read_b64_tr_b16 v[96:97], v6 offset:8192
v_mfma_f32_16x16x32_bf16 v[120:123], v[76:79], v[40:43], v[120:123]
ds_read_b64_tr_b16 v[100:101], v7 offset:8192
v_mfma_f32_16x16x32_bf16 v[124:127], v[76:79], v[44:47], v[124:127]
v_mfma_f32_16x16x32_bf16 v[128:131], v[76:79], v[48:51], v[128:131]
ds_read_b64_tr_b16 v[104:105], v8 offset:8192
s_waitcnt lgkmcnt(3)
v_mfma_f32_16x16x32_bf16 v[132:135], v[76:79], v[52:55], v[132:135]
ds_read_b64_tr_b16 v[108:109], v9 offset:8192
v_mfma_f32_16x16x32_bf16 v[152:155], v[80:83], v[52:55], v[152:155]
ds_read_b128 v[56:59], v3 offset:40960
v_mfma_f32_16x16x32_bf16 v[148:151], v[80:83], v[48:51], v[148:151]
ds_read_b128 v[60:63], v3 offset:41984
v_mfma_f32_16x16x32_bf16 v[144:147], v[80:83], v[44:47], v[144:147]
v_mfma_f32_16x16x32_bf16 v[140:143], v[80:83], v[40:43], v[140:143]
ds_read_b128 v[64:67], v3 offset:43008
v_mfma_f32_16x16x32_bf16 v[136:139], v[80:83], v[36:39], v[136:139]
ds_read_b128 v[68:71], v3 offset:44032
v_mfma_f32_16x16x32_bf16 v[156:159], v[84:87], v[36:39], v[156:159]
s_waitcnt vmcnt(0)
ds_read_b64_tr_b16 v[98:99], v6 offset:10240
v_mfma_f32_16x16x32_bf16 v[160:163], v[84:87], v[40:43], v[160:163]
ds_read_b64_tr_b16 v[102:103], v7 offset:10240
v_mfma_f32_16x16x32_bf16 v[164:167], v[84:87], v[44:47], v[164:167]
v_mfma_f32_16x16x32_bf16 v[168:171], v[84:87], v[48:51], v[168:171]
ds_read_b64_tr_b16 v[106:107], v8 offset:10240
v_mfma_f32_16x16x32_bf16 v[172:175], v[84:87], v[52:55], v[172:175]
ds_read_b64_tr_b16 v[110:111], v9 offset:10240
v_mfma_f32_16x16x32_bf16 v[192:195], v[88:91], v[52:55], v[192:195]
ds_read_b128 v[72:75], v3 offset:45056
v_mfma_f32_16x16x32_bf16 v[188:191], v[88:91], v[48:51], v[188:191]
v_mfma_f32_16x16x32_bf16 v[184:187], v[88:91], v[44:47], v[184:187]
v_mfma_f32_16x16x32_bf16 v[180:183], v[88:91], v[40:43], v[180:183]
v_mfma_f32_16x16x32_bf16 v[176:179], v[88:91], v[36:39], v[176:179]
s_waitcnt lgkmcnt(3)
v_mfma_f32_16x16x32_bf16 v[116:119], v[96:99], v[56:59], v[116:119]
v_mfma_f32_16x16x32_bf16 v[120:123], v[96:99], v[60:63], v[120:123]
v_mfma_f32_16x16x32_bf16 v[124:127], v[96:99], v[64:67], v[124:127]
v_mfma_f32_16x16x32_bf16 v[128:131], v[96:99], v[68:71], v[128:131]
s_waitcnt lgkmcnt(0)
v_mfma_f32_16x16x32_bf16 v[132:135], v[96:99], v[72:75], v[132:135]
v_mfma_f32_16x16x32_bf16 v[152:155], v[100:103], v[72:75], v[152:155]
ds_read_b32 v27, v20
v_mfma_f32_16x16x32_bf16 v[148:151], v[100:103], v[68:71], v[148:151]
v_mfma_f32_16x16x32_bf16 v[144:147], v[100:103], v[64:67], v[144:147]
v_mfma_f32_16x16x32_bf16 v[140:143], v[100:103], v[60:63], v[140:143]
v_mfma_f32_16x16x32_bf16 v[136:139], v[100:103], v[56:59], v[136:139]
v_mfma_f32_16x16x32_bf16 v[156:159], v[104:107], v[56:59], v[156:159]
v_mfma_f32_16x16x32_bf16 v[160:163], v[104:107], v[60:63], v[160:163]
v_mfma_f32_16x16x32_bf16 v[164:167], v[104:107], v[64:67], v[164:167]
v_mfma_f32_16x16x32_bf16 v[168:171], v[104:107], v[68:71], v[168:171]
v_mfma_f32_16x16x32_bf16 v[172:175], v[104:107], v[72:75], v[172:175]
s_waitcnt lgkmcnt(0)
v_cmp_gt_u32 vcc, 25, v27
v_mfma_f32_16x16x32_bf16 v[192:195], v[108:111], v[72:75], v[192:195]
v_mfma_f32_16x16x32_bf16 v[188:191], v[108:111], v[68:71], v[188:191]
v_mfma_f32_16x16x32_bf16 v[184:187], v[108:111], v[64:67], v[184:187]
v_mfma_f32_16x16x32_bf16 v[180:183], v[108:111], v[60:63], v[180:183]
v_mfma_f32_16x16x32_bf16 v[176:179], v[108:111], v[56:59], v[176:179]
s_cbranch_vccnz LwQz
LrQz:
s_setprio 0
s_nop 6
s_cmp_eq_u32 s19, s23
s_cbranch_scc1 Lq_own
v_cvt_pk_bf16_f32 v116, v116, v117
v_cvt_pk_bf16_f32 v117, v118, v119
v_cvt_pk_bf16_f32 v118, v136, v137
v_cvt_pk_bf16_f32 v119, v138, v139
s_mov_b32 s7, 0
buffer_store_dwordx4 v[116:119], v18, s[60:63], s7 offen offset:0 sc1
v_cvt_pk_bf16_f32 v120, v120, v121
v_cvt_pk_bf16_f32 v121, v122, v123
v_cvt_pk_bf16_f32 v122, v140, v141
v_cvt_pk_bf16_f32 v123, v142, v143
s_mov_b32 s7, 18432
buffer_store_dwordx4 v[120:123], v18, s[60:63], s7 offen offset:0 sc1
v_cvt_pk_bf16_f32 v124, v124, v125
v_cvt_pk_bf16_f32 v125, v126, v127
v_cvt_pk_bf16_f32 v126, v144, v145
v_cvt_pk_bf16_f32 v127, v146, v147
s_mov_b32 s7, 36864
buffer_store_dwordx4 v[124:127], v18, s[60:63], s7 offen offset:0 sc1
v_cvt_pk_bf16_f32 v128, v128, v129
v_cvt_pk_bf16_f32 v129, v130, v131
v_cvt_pk_bf16_f32 v130, v148, v149
v_cvt_pk_bf16_f32 v131, v150, v151
s_mov_b32 s7, 55296
buffer_store_dwordx4 v[128:131], v18, s[60:63], s7 offen offset:0 sc1
v_cvt_pk_bf16_f32 v132, v132, v133
v_cvt_pk_bf16_f32 v133, v134, v135
v_cvt_pk_bf16_f32 v134, v152, v153
v_cvt_pk_bf16_f32 v135, v154, v155
s_mov_b32 s7, 73728
buffer_store_dwordx4 v[132:135], v18, s[60:63], s7 offen offset:0 sc1
v_cvt_pk_bf16_f32 v156, v156, v157
v_cvt_pk_bf16_f32 v157, v158, v159
v_cvt_pk_bf16_f32 v158, v176, v177
v_cvt_pk_bf16_f32 v159, v178, v179
s_mov_b32 s7, 0
buffer_store_dwordx4 v[156:159], v18, s[60:63], s7 offen offset:1024 sc1
v_cvt_pk_bf16_f32 v160, v160, v161
v_cvt_pk_bf16_f32 v161, v162, v163
v_cvt_pk_bf16_f32 v162, v180, v181
v_cvt_pk_bf16_f32 v163, v182, v183
s_mov_b32 s7, 18432
buffer_store_dwordx4 v[160:163], v18, s[60:63], s7 offen offset:1024 sc1
v_cvt_pk_bf16_f32 v164, v164, v165
v_cvt_pk_bf16_f32 v165, v166, v167
v_cvt_pk_bf16_f32 v166, v184, v185
v_cvt_pk_bf16_f32 v167, v186, v187
s_mov_b32 s7, 36864
buffer_store_dwordx4 v[164:167], v18, s[60:63], s7 offen offset:1024 sc1
v_cvt_pk_bf16_f32 v168, v168, v169
v_cvt_pk_bf16_f32 v169, v170, v171
v_cvt_pk_bf16_f32 v170, v188, v189
v_cvt_pk_bf16_f32 v171, v190, v191
s_mov_b32 s7, 55296
buffer_store_dwordx4 v[168:171], v18, s[60:63], s7 offen offset:1024 sc1
v_cvt_pk_bf16_f32 v172, v172, v173
v_cvt_pk_bf16_f32 v173, v174, v175
v_cvt_pk_bf16_f32 v174, v192, v193
v_cvt_pk_bf16_f32 v175, v194, v195
s_mov_b32 s7, 73728
buffer_store_dwordx4 v[172:175], v18, s[60:63], s7 offen offset:1024 sc1
s_branch Lq_end
Lq_own:
v_add_u32 v28, s6, v2
v_cvt_pk_bf16_f32 v116, v116, v117
v_cvt_pk_bf16_f32 v117, v118, v119
v_cvt_pk_bf16_f32 v118, v136, v137
v_cvt_pk_bf16_f32 v119, v138, v139
ds_write_b128 v28, v[116:119] offset:0
v_cvt_pk_bf16_f32 v120, v120, v121
v_cvt_pk_bf16_f32 v121, v122, v123
v_cvt_pk_bf16_f32 v122, v140, v141
v_cvt_pk_bf16_f32 v123, v142, v143
ds_write_b128 v28, v[120:123] offset:1024
v_cvt_pk_bf16_f32 v124, v124, v125
v_cvt_pk_bf16_f32 v125, v126, v127
v_cvt_pk_bf16_f32 v126, v144, v145
v_cvt_pk_bf16_f32 v127, v146, v147
ds_write_b128 v28, v[124:127] offset:2048
v_cvt_pk_bf16_f32 v128, v128, v129
v_cvt_pk_bf16_f32 v129, v130, v131
v_cvt_pk_bf16_f32 v130, v148, v149
v_cvt_pk_bf16_f32 v131, v150, v151
ds_write_b128 v28, v[128:131] offset:3072
v_cvt_pk_bf16_f32 v132, v132, v133
v_cvt_pk_bf16_f32 v133, v134, v135
v_cvt_pk_bf16_f32 v134, v152, v153
v_cvt_pk_bf16_f32 v135, v154, v155
ds_write_b128 v28, v[132:135] offset:4096
v_cvt_pk_bf16_f32 v156, v156, v157
v_cvt_pk_bf16_f32 v157, v158, v159
v_cvt_pk_bf16_f32 v158, v176, v177
v_cvt_pk_bf16_f32 v159, v178, v179
ds_write_b128 v28, v[156:159] offset:5120
v_cvt_pk_bf16_f32 v160, v160, v161
v_cvt_pk_bf16_f32 v161, v162, v163
v_cvt_pk_bf16_f32 v162, v180, v181
v_cvt_pk_bf16_f32 v163, v182, v183
ds_write_b128 v28, v[160:163] offset:6144
v_cvt_pk_bf16_f32 v164, v164, v165
v_cvt_pk_bf16_f32 v165, v166, v167
v_cvt_pk_bf16_f32 v166, v184, v185
v_cvt_pk_bf16_f32 v167, v186, v187
ds_write_b128 v28, v[164:167] offset:7168
v_cvt_pk_bf16_f32 v168, v168, v169
v_cvt_pk_bf16_f32 v169, v170, v171
v_cvt_pk_bf16_f32 v170, v188, v189
v_cvt_pk_bf16_f32 v171, v190, v191
ds_write_b128 v28, v[168:171] offset:8192
v_cvt_pk_bf16_f32 v172, v172, v173
v_cvt_pk_bf16_f32 v173, v174, v175
v_cvt_pk_bf16_f32 v174, v192, v193
v_cvt_pk_bf16_f32 v175, v194, v195
ds_write_b128 v28, v[172:175] offset:9216
s_waitcnt lgkmcnt(0)
Lq_end:
s_waitcnt vmcnt(0)
v_mov_b32 v24, 35
ds_write_b32 v22, v24
s_endpgm
LmlpP:
s_cmp_lt_u32 s3, 2
s_cselect_b32 s52, s18, s20
s_cselect_b32 s53, s19, s21
s_and_b32 s53, s53, 0xffff
s_mov_b32 s54, 2359296
s_mov_b32 s55, 0x20000
s_and_b32 s7, s3, 1
s_lshl_b32 s8, s5, 1
s_add_u32 s7, s7, s8
s_mul_i32 s7, s7, 23040
s_lshl_b32 s8, s4, 7
s_add_u32 s10, s7, s8
v_mul_u32_u24 v28, 1152, v1
s_mov_b64 exec, 0xfffff
buffer_load_dword v26, v28, s[52:55], s10 offen
s_mov_b64 exec, -1
v_lshrrev_b32 v28, 3, v1
v_mul_u32_u24 v28, 10240, v28
v_and_b32 v29, 7, v1
v_lshl_add_u32 v28, v29, 4, v28
v_lshl_add_u32 v30, v29, 2, v29
v_mov_b32 v36, 0x3f803f80
v_mov_b32 v37, 0x3f803f80
v_mov_b32 v38, 0x3f803f80
v_mov_b32 v39, 0x3f803f80
ds_write_b128 v28, v[36:39] offset:10112
ds_write_b128 v28, v[36:39] offset:20352
v_lshlrev_b32 v30, 2, v29
v_add_u32 v30, 163328, v30
v_mov_b32 v31, 0
ds_write_b32 v30, v31
s_waitcnt lgkmcnt(0)
s_barrier
s_mov_b32 s44, s16
s_and_b32 s45, s17, 0xffff
s_mov_b32 s46, 2359296
s_mov_b32 s47, 0x20000
s_mov_b32 s52, s34
s_and_b32 s53, s35, 0xffff
s_mov_b32 s54, 5308416
s_mov_b32 s55, 0x20000
s_mov_b32 s56, s32
s_and_b32 s57, s33, 0xffff
s_mov_b32 s58, 9216
s_mov_b32 s59, 0x20000
s_mov_b32 s60, s40
s_and_b32 s61, s41, 0xffff
s_mov_b32 s62, 33554432
s_mov_b32 s63, 0x20000
s_and_b32 s18, s3, 3
s_lshr_b32 s7, s3, 2
s_xor_b32 s7, s7, s4
s_and_b32 s7, s7, 1
s_xor_b32 s7, s7, 1
s_lshl_b32 s19, s7, 2
s_add_u32 s19, s19, s18
s_and_b32 s7, s4, 1
s_lshl_b32 s7, s7, 2
s_lshr_b32 s23, s4, 1
s_add_u32 s23, s23, s7
s_mul_i32 s7, s5, 2304
s_add_u32 s7, s7, 27262976
s_lshl_b32 s8, s4, 4
s_add_u32 s7, s7, s8
s_lshl_b32 s21, s19, 8
s_add_u32 s21, s21, s7
s_lshl_b32 s22, s18, 2
s_add_u32 s22, s22, s7
s_add_u32 s22, s22, 2048
v_mov_b32 v28, s21
v_writelane_b32 v28, s22, 1
s_mov_b64 exec, 3
buffer_load_dword v226, v28, s[60:63], 0 offen sc1
s_mov_b64 exec, -1
v_lshlrev_b32 v29, 2, v1
s_mul_i32 s7, s5, 2304
s_add_u32 s7, s7, 27262976
s_lshl_b32 s8, s23, 8
s_add_u32 s8, s8, s7
s_add_u32 s7, s7, 2048
buffer_load_dword v0, v29, s[60:63], s8 offen sc1
buffer_load_dword v25, v29, s[60:63], s7 offen sc1
v_lshrrev_b32 v31, 4, v1
s_mul_i32 s7, s4, 1152
v_lshl_add_u32 v29, v31, 3, s7
s_lshl_b32 s8, s3, 7
buffer_load_dwordx2 v[216:217], v29, s[56:59], s8 offen offset:0
buffer_load_dwordx2 v[218:219], v29, s[56:59], s8 offen offset:32
buffer_load_dwordx2 v[220:221], v29, s[56:59], s8 offen offset:64
buffer_load_dwordx2 v[222:223], v29, s[56:59], s8 offen offset:96
s_lshl_b32 s8, s18, 5
buffer_load_dwordx2 v[224:225], v29, s[56:59], s8 offen offset:1024
v_lshlrev_b32 v2, 4, v1
v_add_u32 v3, 46080, v2
s_lshl_b32 s6, s18, 14
s_add_u32 s6, s6, 92160
s_lshl_b32 s20, s18, 10
s_add_u32 s20, s20, 104448
v_lshrrev_b32 v28, 2, v1
v_and_b32 v30, 3, v1
v_lshlrev_b32 v29, 7, v28
v_lshl_add_u32 v29, v30, 3, v29
v_bfe_u32 v30, v1, 3, 2
v_lshl_add_u32 v29, v30, 5, v29
v_xor_b32 v6, 0, v29
v_add_u32 v6, s6, v6
v_xor_b32 v7, 32, v29
v_add_u32 v7, s6, v7
v_xor_b32 v8, 64, v29
v_add_u32 v8, s6, v8
v_xor_b32 v9, 96, v29
v_add_u32 v9, s6, v9
s_lshl_b32 s7, s18, 5
v_xor_b32 v10, s7, v29
v_add_u32 v10, 104448, v10
v_lshrrev_b32 v28, 3, v1
v_and_b32 v30, 7, v1
v_and_b32 v29, 6, v28
v_xor_b32 v30, v30, v29
v_mul_u32_u24 v31, 1152, v28
v_lshl_add_u32 v31, v30, 4, v31
s_mul_i32 s7, s4, 663552
s_lshl_b32 s8, s19, 7
s_add_u32 s8, s8, s7
v_add_u32 v13, s8, v31
v_add_u32 v14, 8192, v13
s_mul_i32 s8, s18, 9216
s_add_u32 s8, s8, s7
s_add_u32 s8, s8, 1024
v_add_u32 v15, s8, v31
v_and_b32 v29, 4, v28
v_add_u32 v29, v29, v28
v_mul_u32_u24 v31, 9216, v29
v_lshl_add_u32 v31, v30, 4, v31
s_mul_i32 s7, s4, 1152
s_lshl_b32 s8, s3, 7
s_add_u32 s8, s8, s7
v_add_u32 v11, s8, v31
v_add_u32 v12, 146432, v11
s_and_b32 s7, s3, 4
s_add_u32 s7, s7, s3
s_mul_i32 s7, s7, 5120
v_add_u32 v16, s7, v2
s_lshr_b32 s7, s18, 1
s_mul_i32 s7, s7, 5120
s_and_b32 s8, s18, 1
s_lshl_b32 s8, s8, 3
s_add_u32 s7, s7, s8
s_add_u32 s7, s7, 81920
v_add_u32 v17, s7, v2
s_mul_i32 s7, s4, 2396160
s_mul_i32 s10, s5, 92160
s_add_u32 s7, s7, s10
s_lshl_b32 s10, s19, 11
s_add_u32 s10, s10, s7
v_add_u32 v18, s10, v2
s_lshl_b32 s10, s18, 9
s_add_u32 s10, s10, s7
s_add_u32 s10, s10, 16384
v_lshl_add_u32 v19, v1, 3, s10
s_mov_b32 s9, 1060439283
s_mov_b32 s100, 0
v_and_b32 v28, 3, v1
v_lshlrev_b32 v28, 2, v28
v_add_u32 v20, 163328, v28
v_add_u32 v21, 163344, v28
s_lshl_b32 s7, s3, 2
s_add_u32 s7, s7, 163328
v_mov_b32 v22, s7
v_and_b32 v28, 15, v1
v_lshrrev_b32 v29, 4, v1
v_lshrrev_b32 v30, 1, v28
v_xor_b32 v29, v29, v30
v_lshlrev_b32 v4, 7, v28
v_lshl_add_u32 v4, v29, 4, v4
v_xor_b32 v5, 64, v4
v_add_u32 v254, 51200, v4
v_add_u32 v255, 51200, v5
s_waitcnt vmcnt(9)
s_add_u32 m0, s6, 4096
s_mov_b32 s11, 0
buffer_load_dwordx4 v11, s[48:51], s11 offen lds
buffer_load_dwordx4 v12, s[48:51], s11 offen offset:1024 lds
s_add_u32 m0, s6, 6144
s_mov_b32 s11, 36864
buffer_load_dwordx4 v11, s[48:51], s11 offen lds
buffer_load_dwordx4 v12, s[48:51], s11 offen offset:1024 lds
s_add_u32 m0, s6, 0
s_mov_b32 s11, 294912
buffer_load_dwordx4 v11, s[48:51], s11 offen lds
buffer_load_dwordx4 v12, s[48:51], s11 offen offset:1024 lds
s_add_u32 m0, s6, 2048
s_mov_b32 s11, 331776
buffer_load_dwordx4 v11, s[48:51], s11 offen lds
buffer_load_dwordx4 v12, s[48:51], s11 offen offset:1024 lds
s_add_u32 m0, s6, 8192
s_mov_b32 s11, 589824
buffer_load_dwordx4 v11, s[48:51], s11 offen lds
buffer_load_dwordx4 v12, s[48:51], s11 offen offset:1024 lds
s_add_u32 m0, s6, 10240
s_mov_b32 s11, 626688
buffer_load_dwordx4 v11, s[48:51], s11 offen lds
buffer_load_dwordx4 v12, s[48:51], s11 offen offset:1024 lds
s_add_u32 m0, s6, 12288
s_mov_b32 s11, 884736
buffer_load_dwordx4 v11, s[48:51], s11 offen lds
buffer_load_dwordx4 v12, s[48:51], s11 offen offset:1024 lds
s_add_u32 m0, s6, 14336
s_mov_b32 s11, 921600
buffer_load_dwordx4 v11, s[48:51], s11 offen lds
buffer_load_dwordx4 v12, s[48:51], s11 offen offset:1024 lds
s_waitcnt vmcnt(14)
ds_read_b64_tr_b16 v[76:77], v6 offset:4096
ds_read_b64_tr_b16 v[80:81], v7 offset:4096
ds_read_b64_tr_b16 v[84:85], v8 offset:4096
ds_read_b64_tr_b16 v[88:89], v9 offset:4096
s_waitcnt vmcnt(12)
ds_read_b64_tr_b16 v[78:79], v6 offset:6144
ds_read_b64_tr_b16 v[82:83], v7 offset:6144
ds_read_b64_tr_b16 v[86:87], v8 offset:6144
ds_read_b64_tr_b16 v[90:91], v9 offset:6144
s_add_u32 m0, s6, 4096
s_mov_b32 s11, 1179648
s_waitcnt lgkmcnt(4)
buffer_load_dwordx4 v11, s[48:51], s11 offen lds
buffer_load_dwordx4 v12, s[48:51], s11 offen offset:1024 lds
s_add_u32 m0, s6, 6144
s_mov_b32 s11, 1216512
s_waitcnt lgkmcnt(0)
buffer_load_dwordx4 v11, s[48:51], s11 offen lds
buffer_load_dwordx4 v12, s[48:51], s11 offen offset:1024 lds
v_readlane_b32 s24, v226, 0
v_readlane_b32 s25, v226, 1
ds_read_b32 v27, v21
s_waitcnt lgkmcnt(0)
v_cmp_gt_u32 vcc, 1, v27
s_cbranch_vccnz LwP0
LrP0:
s_setprio 3
ds_read_b128 v[36:39], v4 offset:0
ds_read_b128 v[40:43], v4 offset:2048
ds_read_b128 v[44:47], v4 offset:4096
ds_read_b128 v[48:51], v4 offset:6144
ds_read_b128 v[52:55], v4 offset:8192
s_waitcnt lgkmcnt(4)
v_mfma_f32_16x16x32_bf16 v[116:119], v[76:79], v[36:39], 0
s_waitcnt vmcnt(14)
ds_read_b64_tr_b16 v[96:97], v6 offset:0
s_waitcnt lgkmcnt(4)
v_mfma_f32_16x16x32_bf16 v[120:123], v[76:79], v[40:43], 0
ds_read_b64_tr_b16 v[100:101], v7 offset:0
s_waitcnt lgkmcnt(4)
v_mfma_f32_16x16x32_bf16 v[124:127], v[76:79], v[44:47], 0
s_waitcnt lgkmcnt(3)
v_mfma_f32_16x16x32_bf16 v[128:131], v[76:79], v[48:51], 0
ds_read_b64_tr_b16 v[104:105], v8 offset:0
s_waitcnt lgkmcnt(3)
v_mfma_f32_16x16x32_bf16 v[132:135], v[76:79], v[52:55], 0
ds_read_b64_tr_b16 v[108:109], v9 offset:0
v_mfma_f32_16x16x32_bf16 v[152:155], v[80:83], v[52:55], 0
ds_read_b128 v[56:59], v5 offset:0
v_mfma_f32_16x16x32_bf16 v[148:151], v[80:83], v[48:51], 0
ds_read_b128 v[60:63], v5 offset:2048
v_mfma_f32_16x16x32_bf16 v[144:147], v[80:83], v[44:47], 0
v_mfma_f32_16x16x32_bf16 v[140:143], v[80:83], v[40:43], 0
ds_read_b128 v[64:67], v5 offset:4096
s_add_u32 m0, s6, 0
v_mfma_f32_16x16x32_bf16 v[136:139], v[80:83], v[36:39], 0
ds_read_b128 v[68:71], v5 offset:6144
s_mov_b32 s11, 1474560
v_mfma_f32_16x16x32_bf16 v[156:159], v[84:87], v[36:39], 0
s_waitcnt vmcnt(12)
ds_read_b64_tr_b16 v[98:99], v6 offset:2048
v_mfma_f32_16x16x32_bf16 v[160:163], v[84:87], v[40:43], 0
ds_read_b64_tr_b16 v[102:103], v7 offset:2048
v_mfma_f32_16x16x32_bf16 v[164:167], v[84:87], v[44:47], 0
s_waitcnt lgkmcnt(5)
buffer_load_dwordx4 v11, s[48:51], s11 offen lds
v_mfma_f32_16x16x32_bf16 v[168:171], v[84:87], v[48:51], 0
ds_read_b64_tr_b16 v[106:107], v8 offset:2048
v_mfma_f32_16x16x32_bf16 v[172:175], v[84:87], v[52:55], 0
ds_read_b64_tr_b16 v[110:111], v9 offset:2048
v_mfma_f32_16x16x32_bf16 v[192:195], v[88:91], v[52:55], 0
ds_read_b128 v[72:75], v5 offset:8192
v_mfma_f32_16x16x32_bf16 v[188:191], v[88:91], v[48:51], 0
ds_read_b32 v27, v21
v_mfma_f32_16x16x32_bf16 v[184:187], v[88:91], v[44:47], 0
buffer_load_dwordx4 v12, s[48:51], s11 offen offset:1024 lds
v_mfma_f32_16x16x32_bf16 v[180:183], v[88:91], v[40:43], 0
s_add_u32 m0, s6, 2048
v_mfma_f32_16x16x32_bf16 v[176:179], v[88:91], v[36:39], 0
s_waitcnt lgkmcnt(4)
s_mov_b32 s11, 1511424
v_mfma_f32_16x16x32_bf16 v[116:119], v[96:99], v[56:59], v[116:119]
s_waitcnt vmcnt(12)
ds_read_b64_tr_b16 v[76:77], v6 offset:8192
v_mfma_f32_16x16x32_bf16 v[120:123], v[96:99], v[60:63], v[120:123]
ds_read_b64_tr_b16 v[80:81], v7 offset:8192
s_waitcnt lgkmcnt(2)
v_cmp_gt_u32 vcc, 2, v27
v_mfma_f32_16x16x32_bf16 v[124:127], v[96:99], v[64:67], v[124:127]
buffer_load_dwordx4 v11, s[48:51], s11 offen lds
v_mfma_f32_16x16x32_bf16 v[128:131], v[96:99], v[68:71], v[128:131]
ds_read_b64_tr_b16 v[84:85], v8 offset:8192
s_cbranch_vccnz LwPg1
LrPg1:
v_mfma_f32_16x16x32_bf16 v[132:135], v[96:99], v[72:75], v[132:135]
ds_read_b64_tr_b16 v[88:89], v9 offset:8192
v_mfma_f32_16x16x32_bf16 v[152:155], v[100:103], v[72:75], v[152:155]
ds_read_b128 v[36:39], v4 offset:10240
v_mfma_f32_16x16x32_bf16 v[148:151], v[100:103], v[68:71], v[148:151]
ds_read_b128 v[40:43], v4 offset:12288
v_mfma_f32_16x16x32_bf16 v[144:147], v[100:103], v[64:67], v[144:147]
buffer_load_dwordx4 v12, s[48:51], s11 offen offset:1024 lds
v_mfma_f32_16x16x32_bf16 v[140:143], v[100:103], v[60:63], v[140:143]
ds_read_b128 v[44:47], v4 offset:14336
s_add_u32 m0, s6, 8192
v_mfma_f32_16x16x32_bf16 v[136:139], v[100:103], v[56:59], v[136:139]
ds_read_b128 v[48:51], v4 offset:16384
s_mov_b32 s11, 1769472
v_mfma_f32_16x16x32_bf16 v[156:159], v[104:107], v[56:59], v[156:159]
s_waitcnt vmcnt(12)
ds_read_b64_tr_b16 v[78:79], v6 offset:10240
v_mfma_f32_16x16x32_bf16 v[160:163], v[104:107], v[60:63], v[160:163]
ds_read_b64_tr_b16 v[82:83], v7 offset:10240
v_mfma_f32_16x16x32_bf16 v[164:167], v[104:107], v[64:67], v[164:167]
s_waitcnt lgkmcnt(5)
buffer_load_dwordx4 v11, s[48:51], s11 offen lds
v_mfma_f32_16x16x32_bf16 v[168:171], v[104:107], v[68:71], v[168:171]
ds_read_b64_tr_b16 v[86:87], v8 offset:10240
v_mfma_f32_16x16x32_bf16 v[172:175], v[104:107], v[72:75], v[172:175]
ds_read_b64_tr_b16 v[90:91], v9 offset:10240
v_mfma_f32_16x16x32_bf16 v[192:195], v[108:111], v[72:75], v[192:195]
ds_read_b128 v[52:55], v4 offset:18432
v_mfma_f32_16x16x32_bf16 v[188:191], v[108:111], v[68:71], v[188:191]
v_mfma_f32_16x16x32_bf16 v[184:187], v[108:111], v[64:67], v[184:187]
buffer_load_dwordx4 v12, s[48:51], s11 offen offset:1024 lds
v_mfma_f32_16x16x32_bf16 v[180:183], v[108:111], v[60:63], v[180:183]
s_add_u32 m0, s6, 10240
v_mfma_f32_16x16x32_bf16 v[176:179], v[108:111], v[56:59], v[176:179]
s_waitcnt lgkmcnt(3)
s_mov_b32 s11, 1806336
v_mfma_f32_16x16x32_bf16 v[116:119], v[76:79], v[36:39], v[116:119]
s_waitcnt vmcnt(12)
ds_read_b64_tr_b16 v[96:97], v6 offset:12288
v_mfma_f32_16x16x32_bf16 v[120:123], v[76:79], v[40:43], v[120:123]
ds_read_b64_tr_b16 v[100:101], v7 offset:12288
v_mfma_f32_16x16x32_bf16 v[124:127], v[76:79], v[44:47], v[124:127]
s_waitcnt lgkmcnt(2)
buffer_load_dwordx4 v11, s[48:51], s11 offen lds
v_mfma_f32_16x16x32_bf16 v[128:131], v[76:79], v[48:51], v[128:131]
ds_read_b64_tr_b16 v[104:105], v8 offset:12288
v_mfma_f32_16x16x32_bf16 v[132:135], v[76:79], v[52:55], v[132:135]
ds_read_b64_tr_b16 v[108:109], v9 offset:12288
v_mfma_f32_16x16x32_bf16 v[152:155], v[80:83], v[52:55], v[152:155]
ds_read_b128 v[56:59], v5 offset:10240
v_mfma_f32_16x16x32_bf16 v[148:151], v[80:83], v[48:51], v[148:151]
ds_read_b128 v[60:63], v5 offset:12288
v_mfma_f32_16x16x32_bf16 v[144:147], v[80:83], v[44:47], v[144:147]
buffer_load_dwordx4 v12, s[48:51], s11 offen offset:1024 lds
v_mfma_f32_16x16x32_bf16 v[140:143], v[80:83], v[40:43], v[140:143]
ds_read_b128 v[64:67], v5 offset:14336
s_add_u32 m0, s6, 12288
v_mfma_f32_16x16x32_bf16 v[136:139], v[80:83], v[36:39], v[136:139]
ds_read_b128 v[68:71], v5 offset:16384
s_mov_b32 s11, 2064384
v_mfma_f32_16x16x32_bf16 v[156:159], v[84:87], v[36:39], v[156:159]
s_waitcnt vmcnt(12)
ds_read_b64_tr_b16 v[98:99], v6 offset:14336
v_mfma_f32_16x16x32_bf16 v[160:163], v[84:87], v[40:43], v[160:163]
ds_read_b64_tr_b16 v[102:103], v7 offset:14336
v_mfma_f32_16x16x32_bf16 v[164:167], v[84:87], v[44:47], v[164:167]
s_waitcnt lgkmcnt(5)
buffer_load_dwordx4 v11, s[48:51], s11 offen lds
v_mfma_f32_16x16x32_bf16 v[168:171], v[84:87], v[48:51], v[168:171]
ds_read_b64_tr_b16 v[106:107], v8 offset:14336
v_mfma_f32_16x16x32_bf16 v[172:175], v[84:87], v[52:55], v[172:175]
ds_read_b64_tr_b16 v[110:111], v9 offset:14336
v_mfma_f32_16x16x32_bf16 v[192:195], v[88:91], v[52:55], v[192:195]
ds_read_b128 v[72:75], v5 offset:18432
v_mfma_f32_16x16x32_bf16 v[188:191], v[88:91], v[48:51], v[188:191]
ds_read_b32 v27, v21
v_mfma_f32_16x16x32_bf16 v[184:187], v[88:91], v[44:47], v[184:187]
buffer_load_dwordx4 v12, s[48:51], s11 offen offset:1024 lds
v_mfma_f32_16x16x32_bf16 v[180:183], v[88:91], v[40:43], v[180:183]
s_add_u32 m0, s6, 14336
v_mfma_f32_16x16x32_bf16 v[176:179], v[88:91], v[36:39], v[176:179]
s_waitcnt lgkmcnt(4)
s_mov_b32 s11, 2101248
v_mfma_f32_16x16x32_bf16 v[116:119], v[96:99], v[56:59], v[116:119]
s_waitcnt vmcnt(12)
ds_read_b64_tr_b16 v[76:77], v6 offset:4096
v_mfma_f32_16x16x32_bf16 v[120:123], v[96:99], v[60:63], v[120:123]
ds_read_b64_tr_b16 v[80:81], v7 offset:4096
s_waitcnt lgkmcnt(2)
v_cmp_gt_u32 vcc, 3, v27
v_mfma_f32_16x16x32_bf16 v[124:127], v[96:99], v[64:67], v[124:127]
buffer_load_dwordx4 v11, s[48:51], s11 offen lds
v_mfma_f32_16x16x32_bf16 v[128:131], v[96:99], v[68:71], v[128:131]
ds_read_b64_tr_b16 v[84:85], v8 offset:4096
s_cbranch_vccnz LwPg3
LrPg3:
v_mfma_f32_16x16x32_bf16 v[132:135], v[96:99], v[72:75], v[132:135]
ds_read_b64_tr_b16 v[88:89], v9 offset:4096
v_mfma_f32_16x16x32_bf16 v[152:155], v[100:103], v[72:75], v[152:155]
ds_read_b128 v[36:39], v4 offset:20480
v_mfma_f32_16x16x32_bf16 v[148:151], v[100:103], v[68:71], v[148:151]
ds_read_b128 v[40:43], v4 offset:22528
v_mfma_f32_16x16x32_bf16 v[144:147], v[100:103], v[64:67], v[144:147]
buffer_load_dwordx4 v12, s[48:51], s11 offen offset:1024 lds
v_mfma_f32_16x16x32_bf16 v[140:143], v[100:103], v[60:63], v[140:143]
ds_read_b128 v[44:47], v4 offset:24576
s_add_u32 m0, s6, 4096
v_mfma_f32_16x16x32_bf16 v[136:139], v[100:103], v[56:59], v[136:139]
ds_read_b128 v[48:51], v4 offset:26624
s_mov_b32 s11, 2359296
v_mfma_f32_16x16x32_bf16 v[156:159], v[104:107], v[56:59], v[156:159]
s_waitcnt vmcnt(12)
ds_read_b64_tr_b16 v[78:79], v6 offset:6144
v_mfma_f32_16x16x32_bf16 v[160:163], v[104:107], v[60:63], v[160:163]
ds_read_b64_tr_b16 v[82:83], v7 offset:6144
v_mfma_f32_16x16x32_bf16 v[164:167], v[104:107], v[64:67], v[164:167]
s_waitcnt lgkmcnt(5)
buffer_load_dwordx4 v11, s[48:51], s11 offen lds
v_mfma_f32_16x16x32_bf16 v[168:171], v[104:107], v[68:71], v[168:171]
ds_read_b64_tr_b16 v[86:87], v8 offset:6144
v_mfma_f32_16x16x32_bf16 v[172:175], v[104:107], v[72:75], v[172:175]
ds_read_b64_tr_b16 v[90:91], v9 offset:6144
v_mfma_f32_16x16x32_bf16 v[192:195], v[108:111], v[72:75], v[192:195]
ds_read_b128 v[52:55], v4 offset:28672
v_mfma_f32_16x16x32_bf16 v[188:191], v[108:111], v[68:71], v[188:191]
v_mfma_f32_16x16x32_bf16 v[184:187], v[108:111], v[64:67], v[184:187]
buffer_load_dwordx4 v12, s[48:51], s11 offen offset:1024 lds
v_mfma_f32_16x16x32_bf16 v[180:183], v[108:111], v[60:63], v[180:183]
s_add_u32 m0, s6, 6144
v_mfma_f32_16x16x32_bf16 v[176:179], v[108:111], v[56:59], v[176:179]
s_waitcnt lgkmcnt(3)
s_mov_b32 s11, 2396160
v_mfma_f32_16x16x32_bf16 v[116:119], v[76:79], v[36:39], v[116:119]
s_waitcnt vmcnt(12)
ds_read_b64_tr_b16 v[96:97], v6 offset:0
v_mfma_f32_16x16x32_bf16 v[120:123], v[76:79], v[40:43], v[120:123]
ds_read_b64_tr_b16 v[100:101], v7 offset:0
v_mfma_f32_16x16x32_bf16 v[124:127], v[76:79], v[44:47], v[124:127]
s_waitcnt lgkmcnt(2)
buffer_load_dwordx4 v11, s[48:51], s11 offen lds
v_mfma_f32_16x16x32_bf16 v[128:131], v[76:79], v[48:51], v[128:131]
ds_read_b64_tr_b16 v[104:105], v8 offset:0
v_mfma_f32_16x16x32_bf16 v[132:135], v[76:79], v[52:55], v[132:135]
ds_read_b64_tr_b16 v[108:109], v9 offset:0
v_mfma_f32_16x16x32_bf16 v[152:155], v[80:83], v[52:55], v[152:155]
ds_read_b128 v[56:59], v5 offset:20480
v_mfma_f32_16x16x32_bf16 v[148:151], v[80:83], v[48:51], v[148:151]
ds_read_b128 v[60:63], v5 offset:22528
v_mfma_f32_16x16x32_bf16 v[144:147], v[80:83], v[44:47], v[144:147]
buffer_load_dwordx4 v12, s[48:51], s11 offen offset:1024 lds
v_mfma_f32_16x16x32_bf16 v[140:143], v[80:83], v[40:43], v[140:143]
ds_read_b128 v[64:67], v5 offset:24576
s_add_u32 m0, s6, 0
v_mfma_f32_16x16x32_bf16 v[136:139], v[80:83], v[36:39], v[136:139]
ds_read_b128 v[68:71], v5 offset:26624
s_mov_b32 s11, 2654208
v_mfma_f32_16x16x32_bf16 v[156:159], v[84:87], v[36:39], v[156:159]
s_waitcnt vmcnt(12)
ds_read_b64_tr_b16 v[98:99], v6 offset:2048
v_mfma_f32_16x16x32_bf16 v[160:163], v[84:87], v[40:43], v[160:163]
ds_read_b64_tr_b16 v[102:103], v7 offset:2048
v_mfma_f32_16x16x32_bf16 v[164:167], v[84:87], v[44:47], v[164:167]
s_waitcnt lgkmcnt(5)
buffer_load_dwordx4 v11, s[48:51], s11 offen lds
v_mfma_f32_16x16x32_bf16 v[168:171], v[84:87], v[48:51], v[168:171]
ds_read_b64_tr_b16 v[106:107], v8 offset:2048
v_mfma_f32_16x16x32_bf16 v[172:175], v[84:87], v[52:55], v[172:175]
ds_read_b64_tr_b16 v[110:111], v9 offset:2048
v_mfma_f32_16x16x32_bf16 v[192:195], v[88:91], v[52:55], v[192:195]
ds_read_b128 v[72:75], v5 offset:28672
v_mfma_f32_16x16x32_bf16 v[188:191], v[88:91], v[48:51], v[188:191]
ds_read_b32 v27, v21
v_mfma_f32_16x16x32_bf16 v[184:187], v[88:91], v[44:47], v[184:187]
buffer_load_dwordx4 v12, s[48:51], s11 offen offset:1024 lds
v_mfma_f32_16x16x32_bf16 v[180:183], v[88:91], v[40:43], v[180:183]
s_add_u32 m0, s6, 2048
v_mfma_f32_16x16x32_bf16 v[176:179], v[88:91], v[36:39], v[176:179]
s_waitcnt lgkmcnt(4)
s_mov_b32 s11, 2691072
v_mfma_f32_16x16x32_bf16 v[116:119], v[96:99], v[56:59], v[116:119]
s_waitcnt vmcnt(12)
ds_read_b64_tr_b16 v[76:77], v6 offset:8192
v_mfma_f32_16x16x32_bf16 v[120:123], v[96:99], v[60:63], v[120:123]
ds_read_b64_tr_b16 v[80:81], v7 offset:8192
s_waitcnt lgkmcnt(2)
v_cmp_gt_u32 vcc, 4, v27
v_mfma_f32_16x16x32_bf16 v[124:127], v[96:99], v[64:67], v[124:127]
buffer_load_dwordx4 v11, s[48:51], s11 offen lds
v_mfma_f32_16x16x32_bf16 v[128:131], v[96:99], v[68:71], v[128:131]
ds_read_b64_tr_b16 v[84:85], v8 offset:8192
s_cbranch_vccnz LwPg5
LrPg5:
v_mfma_f32_16x16x32_bf16 v[132:135], v[96:99], v[72:75], v[132:135]
ds_read_b64_tr_b16 v[88:89], v9 offset:8192
v_mfma_f32_16x16x32_bf16 v[152:155], v[100:103], v[72:75], v[152:155]
ds_read_b128 v[36:39], v4 offset:30720
v_mfma_f32_16x16x32_bf16 v[148:151], v[100:103], v[68:71], v[148:151]
ds_read_b128 v[40:43], v4 offset:32768
v_mfma_f32_16x16x32_bf16 v[144:147], v[100:103], v[64:67], v[144:147]
buffer_load_dwordx4 v12, s[48:51], s11 offen offset:1024 lds
v_mfma_f32_16x16x32_bf16 v[140:143], v[100:103], v[60:63], v[140:143]
ds_read_b128 v[44:47], v4 offset:34816
s_add_u32 m0, s6, 8192
v_mfma_f32_16x16x32_bf16 v[136:139], v[100:103], v[56:59], v[136:139]
ds_read_b128 v[48:51], v4 offset:36864
s_mov_b32 s11, 2949120
v_mfma_f32_16x16x32_bf16 v[156:159], v[104:107], v[56:59], v[156:159]
s_waitcnt vmcnt(12)
ds_read_b64_tr_b16 v[78:79], v6 offset:10240
v_mfma_f32_16x16x32_bf16 v[160:163], v[104:107], v[60:63], v[160:163]
ds_read_b64_tr_b16 v[82:83], v7 offset:10240
v_mfma_f32_16x16x32_bf16 v[164:167], v[104:107], v[64:67], v[164:167]
s_waitcnt lgkmcnt(5)
buffer_load_dwordx4 v11, s[48:51], s11 offen lds
v_mfma_f32_16x16x32_bf16 v[168:171], v[104:107], v[68:71], v[168:171]
ds_read_b64_tr_b16 v[86:87], v8 offset:10240
v_mfma_f32_16x16x32_bf16 v[172:175], v[104:107], v[72:75], v[172:175]
ds_read_b64_tr_b16 v[90:91], v9 offset:10240
v_mfma_f32_16x16x32_bf16 v[192:195], v[108:111], v[72:75], v[192:195]
ds_read_b128 v[52:55], v4 offset:38912
v_mfma_f32_16x16x32_bf16 v[188:191], v[108:111], v[68:71], v[188:191]
v_mfma_f32_16x16x32_bf16 v[184:187], v[108:111], v[64:67], v[184:187]
buffer_load_dwordx4 v12, s[48:51], s11 offen offset:1024 lds
v_mfma_f32_16x16x32_bf16 v[180:183], v[108:111], v[60:63], v[180:183]
s_add_u32 m0, s6, 10240
v_mfma_f32_16x16x32_bf16 v[176:179], v[108:111], v[56:59], v[176:179]
s_waitcnt lgkmcnt(3)
s_mov_b32 s11, 2985984
v_mfma_f32_16x16x32_bf16 v[116:119], v[76:79], v[36:39], v[116:119]
s_waitcnt vmcnt(12)
ds_read_b64_tr_b16 v[96:97], v6 offset:12288
v_mfma_f32_16x16x32_bf16 v[120:123], v[76:79], v[40:43], v[120:123]
ds_read_b64_tr_b16 v[100:101], v7 offset:12288
v_mfma_f32_16x16x32_bf16 v[124:127], v[76:79], v[44:47], v[124:127]
s_waitcnt lgkmcnt(2)
buffer_load_dwordx4 v11, s[48:51], s11 offen lds
v_mfma_f32_16x16x32_bf16 v[128:131], v[76:79], v[48:51], v[128:131]
ds_read_b64_tr_b16 v[104:105], v8 offset:12288
v_mfma_f32_16x16x32_bf16 v[132:135], v[76:79], v[52:55], v[132:135]
ds_read_b64_tr_b16 v[108:109], v9 offset:12288
v_mfma_f32_16x16x32_bf16 v[152:155], v[80:83], v[52:55], v[152:155]
ds_read_b128 v[56:59], v5 offset:30720
v_mfma_f32_16x16x32_bf16 v[148:151], v[80:83], v[48:51], v[148:151]
ds_read_b128 v[60:63], v5 offset:32768
v_mfma_f32_16x16x32_bf16 v[144:147], v[80:83], v[44:47], v[144:147]
buffer_load_dwordx4 v12, s[48:51], s11 offen offset:1024 lds
v_mfma_f32_16x16x32_bf16 v[140:143], v[80:83], v[40:43], v[140:143]
ds_read_b128 v[64:67], v5 offset:34816
s_add_u32 m0, s6, 12288
v_mfma_f32_16x16x32_bf16 v[136:139], v[80:83], v[36:39], v[136:139]
ds_read_b128 v[68:71], v5 offset:36864
s_mov_b32 s11, 3244032
v_mfma_f32_16x16x32_bf16 v[156:159], v[84:87], v[36:39], v[156:159]
s_waitcnt vmcnt(12)
ds_read_b64_tr_b16 v[98:99], v6 offset:14336
v_mfma_f32_16x16x32_bf16 v[160:163], v[84:87], v[40:43], v[160:163]
ds_read_b64_tr_b16 v[102:103], v7 offset:14336
v_mfma_f32_16x16x32_bf16 v[164:167], v[84:87], v[44:47], v[164:167]
s_waitcnt lgkmcnt(5)
buffer_load_dwordx4 v11, s[48:51], s11 offen lds
v_mfma_f32_16x16x32_bf16 v[168:171], v[84:87], v[48:51], v[168:171]
ds_read_b64_tr_b16 v[106:107], v8 offset:14336
v_mfma_f32_16x16x32_bf16 v[172:175], v[84:87], v[52:55], v[172:175]
ds_read_b64_tr_b16 v[110:111], v9 offset:14336
v_mfma_f32_16x16x32_bf16 v[192:195], v[88:91], v[52:55], v[192:195]
ds_read_b128 v[72:75], v5 offset:38912
v_mfma_f32_16x16x32_bf16 v[188:191], v[88:91], v[48:51], v[188:191]
ds_read_b32 v27, v21
v_mfma_f32_16x16x32_bf16 v[184:187], v[88:91], v[44:47], v[184:187]
buffer_load_dwordx4 v12, s[48:51], s11 offen offset:1024 lds
v_mfma_f32_16x16x32_bf16 v[180:183], v[88:91], v[40:43], v[180:183]
s_add_u32 m0, s6, 14336
v_mfma_f32_16x16x32_bf16 v[176:179], v[88:91], v[36:39], v[176:179]
s_waitcnt lgkmcnt(4)
s_mov_b32 s11, 3280896
v_mfma_f32_16x16x32_bf16 v[116:119], v[96:99], v[56:59], v[116:119]
s_waitcnt vmcnt(12)
ds_read_b64_tr_b16 v[76:77], v6 offset:4096
v_mfma_f32_16x16x32_bf16 v[120:123], v[96:99], v[60:63], v[120:123]
ds_read_b64_tr_b16 v[80:81], v7 offset:4096
s_waitcnt lgkmcnt(2)
v_cmp_gt_u32 vcc, 5, v27
v_mfma_f32_16x16x32_bf16 v[124:127], v[96:99], v[64:67], v[124:127]
buffer_load_dwordx4 v11, s[48:51], s11 offen lds
v_mfma_f32_16x16x32_bf16 v[128:131], v[96:99], v[68:71], v[128:131]
ds_read_b64_tr_b16 v[84:85], v8 offset:4096
s_cbranch_vccnz LwPg7
LrPg7:
v_mfma_f32_16x16x32_bf16 v[132:135], v[96:99], v[72:75], v[132:135]
ds_read_b64_tr_b16 v[88:89], v9 offset:4096
v_mfma_f32_16x16x32_bf16 v[152:155], v[100:103], v[72:75], v[152:155]
ds_read_b128 v[36:39], v4 offset:40960
v_mfma_f32_16x16x32_bf16 v[148:151], v[100:103], v[68:71], v[148:151]
ds_read_b128 v[40:43], v4 offset:43008
v_mfma_f32_16x16x32_bf16 v[144:147], v[100:103], v[64:67], v[144:147]
buffer_load_dwordx4 v12, s[48:51], s11 offen offset:1024 lds
v_mfma_f32_16x16x32_bf16 v[140:143], v[100:103], v[60:63], v[140:143]
ds_read_b128 v[44:47], v4 offset:45056
s_add_u32 m0, s6, 4096
v_mfma_f32_16x16x32_bf16 v[136:139], v[100:103], v[56:59], v[136:139]
ds_read_b128 v[48:51], v4 offset:47104
s_mov_b32 s11, 3538944
v_mfma_f32_16x16x32_bf16 v[156:159], v[104:107], v[56:59], v[156:159]
s_waitcnt vmcnt(12)
ds_read_b64_tr_b16 v[78:79], v6 offset:6144
v_mfma_f32_16x16x32_bf16 v[160:163], v[104:107], v[60:63], v[160:163]
ds_read_b64_tr_b16 v[82:83], v7 offset:6144
v_mfma_f32_16x16x32_bf16 v[164:167], v[104:107], v[64:67], v[164:167]
s_waitcnt lgkmcnt(5)
buffer_load_dwordx4 v11, s[48:51], s11 offen lds
v_mfma_f32_16x16x32_bf16 v[168:171], v[104:107], v[68:71], v[168:171]
ds_read_b64_tr_b16 v[86:87], v8 offset:6144
v_mfma_f32_16x16x32_bf16 v[172:175], v[104:107], v[72:75], v[172:175]
ds_read_b64_tr_b16 v[90:91], v9 offset:6144
v_mfma_f32_16x16x32_bf16 v[192:195], v[108:111], v[72:75], v[192:195]
ds_read_b128 v[52:55], v4 offset:49152
v_mfma_f32_16x16x32_bf16 v[188:191], v[108:111], v[68:71], v[188:191]
v_mfma_f32_16x16x32_bf16 v[184:187], v[108:111], v[64:67], v[184:187]
buffer_load_dwordx4 v12, s[48:51], s11 offen offset:1024 lds
v_mfma_f32_16x16x32_bf16 v[180:183], v[108:111], v[60:63], v[180:183]
s_add_u32 m0, s6, 6144
v_mfma_f32_16x16x32_bf16 v[176:179], v[108:111], v[56:59], v[176:179]
s_waitcnt lgkmcnt(3)
s_mov_b32 s11, 3575808
v_mfma_f32_16x16x32_bf16 v[116:119], v[76:79], v[36:39], v[116:119]
s_waitcnt vmcnt(12)
ds_read_b64_tr_b16 v[96:97], v6 offset:0
v_mfma_f32_16x16x32_bf16 v[120:123], v[76:79], v[40:43], v[120:123]
ds_read_b64_tr_b16 v[100:101], v7 offset:0
v_mfma_f32_16x16x32_bf16 v[124:127], v[76:79], v[44:47], v[124:127]
s_waitcnt lgkmcnt(2)
buffer_load_dwordx4 v11, s[48:51], s11 offen lds
v_mfma_f32_16x16x32_bf16 v[128:131], v[76:79], v[48:51], v[128:131]
ds_read_b64_tr_b16 v[104:105], v8 offset:0
v_mfma_f32_16x16x32_bf16 v[132:135], v[76:79], v[52:55], v[132:135]
ds_read_b64_tr_b16 v[108:109], v9 offset:0
v_mfma_f32_16x16x32_bf16 v[152:155], v[80:83], v[52:55], v[152:155]
ds_read_b128 v[56:59], v5 offset:40960
v_mfma_f32_16x16x32_bf16 v[148:151], v[80:83], v[48:51], v[148:151]
ds_read_b128 v[60:63], v5 offset:43008
v_mfma_f32_16x16x32_bf16 v[144:147], v[80:83], v[44:47], v[144:147]
buffer_load_dwordx4 v12, s[48:51], s11 offen offset:1024 lds
v_mfma_f32_16x16x32_bf16 v[140:143], v[80:83], v[40:43], v[140:143]
ds_read_b128 v[64:67], v5 offset:45056
s_add_u32 m0, s6, 0
v_mfma_f32_16x16x32_bf16 v[136:139], v[80:83], v[36:39], v[136:139]
ds_read_b128 v[68:71], v5 offset:47104
s_mov_b32 s11, 3833856
v_mfma_f32_16x16x32_bf16 v[156:159], v[84:87], v[36:39], v[156:159]
s_waitcnt vmcnt(12)
ds_read_b64_tr_b16 v[98:99], v6 offset:2048
v_mfma_f32_16x16x32_bf16 v[160:163], v[84:87], v[40:43], v[160:163]
ds_read_b64_tr_b16 v[102:103], v7 offset:2048
v_mfma_f32_16x16x32_bf16 v[164:167], v[84:87], v[44:47], v[164:167]
s_waitcnt lgkmcnt(5)
buffer_load_dwordx4 v11, s[48:51], s11 offen lds
v_mfma_f32_16x16x32_bf16 v[168:171], v[84:87], v[48:51], v[168:171]
ds_read_b64_tr_b16 v[106:107], v8 offset:2048
v_mfma_f32_16x16x32_bf16 v[172:175], v[84:87], v[52:55], v[172:175]
ds_read_b64_tr_b16 v[110:111], v9 offset:2048
v_mfma_f32_16x16x32_bf16 v[192:195], v[88:91], v[52:55], v[192:195]
ds_read_b128 v[72:75], v5 offset:49152
v_mfma_f32_16x16x32_bf16 v[188:191], v[88:91], v[48:51], v[188:191]
ds_read_b32 v27, v21
v_mfma_f32_16x16x32_bf16 v[184:187], v[88:91], v[44:47], v[184:187]
buffer_load_dwordx4 v12, s[48:51], s11 offen offset:1024 lds
v_mfma_f32_16x16x32_bf16 v[180:183], v[88:91], v[40:43], v[180:183]
s_add_u32 m0, s6, 2048
v_mfma_f32_16x16x32_bf16 v[176:179], v[88:91], v[36:39], v[176:179]
s_waitcnt lgkmcnt(4)
s_mov_b32 s11, 3870720
v_mfma_f32_16x16x32_bf16 v[116:119], v[96:99], v[56:59], v[116:119]
s_waitcnt vmcnt(12)
ds_read_b64_tr_b16 v[76:77], v6 offset:8192
v_mfma_f32_16x16x32_bf16 v[120:123], v[96:99], v[60:63], v[120:123]
ds_read_b64_tr_b16 v[80:81], v7 offset:8192
s_waitcnt lgkmcnt(2)
v_cmp_gt_u32 vcc, 6, v27
v_mfma_f32_16x16x32_bf16 v[124:127], v[96:99], v[64:67], v[124:127]
buffer_load_dwordx4 v11, s[48:51], s11 offen lds
v_mfma_f32_16x16x32_bf16 v[128:131], v[96:99], v[68:71], v[128:131]
ds_read_b64_tr_b16 v[84:85], v8 offset:8192
s_cbranch_vccnz LwPg9
LrPg9:
v_mfma_f32_16x16x32_bf16 v[132:135], v[96:99], v[72:75], v[132:135]
ds_read_b64_tr_b16 v[88:89], v9 offset:8192
v_mfma_f32_16x16x32_bf16 v[152:155], v[100:103], v[72:75], v[152:155]
ds_read_b128 v[36:39], v254 offset:0
v_mfma_f32_16x16x32_bf16 v[148:151], v[100:103], v[68:71], v[148:151]
ds_read_b128 v[40:43], v254 offset:2048
v_mfma_f32_16x16x32_bf16 v[144:147], v[100:103], v[64:67], v[144:147]
buffer_load_dwordx4 v12, s[48:51], s11 offen offset:1024 lds
v_mfma_f32_16x16x32_bf16 v[140:143], v[100:103], v[60:63], v[140:143]
ds_read_b128 v[44:47], v254 offset:4096
v_mfma_f32_16x16x32_bf16 v[136:139], v[100:103], v[56:59], v[136:139]
ds_read_b128 v[48:51], v254 offset:6144
v_mfma_f32_16x16x32_bf16 v[156:159], v[104:107], v[56:59], v[156:159]
s_waitcnt vmcnt(12)
ds_read_b64_tr_b16 v[78:79], v6 offset:10240
v_mfma_f32_16x16x32_bf16 v[160:163], v[104:107], v[60:63], v[160:163]
ds_read_b64_tr_b16 v[82:83], v7 offset:10240
v_mfma_f32_16x16x32_bf16 v[164:167], v[104:107], v[64:67], v[164:167]
v_mfma_f32_16x16x32_bf16 v[168:171], v[104:107], v[68:71], v[168:171]
ds_read_b64_tr_b16 v[86:87], v8 offset:10240
v_mfma_f32_16x16x32_bf16 v[172:175], v[104:107], v[72:75], v[172:175]
ds_read_b64_tr_b16 v[90:91], v9 offset:10240
v_mfma_f32_16x16x32_bf16 v[192:195], v[108:111], v[72:75], v[192:195]
ds_read_b128 v[52:55], v254 offset:8192
v_mfma_f32_16x16x32_bf16 v[188:191], v[108:111], v[68:71], v[188:191]
v_mfma_f32_16x16x32_bf16 v[184:187], v[108:111], v[64:67], v[184:187]
v_mfma_f32_16x16x32_bf16 v[180:183], v[108:111], v[60:63], v[180:183]
v_mfma_f32_16x16x32_bf16 v[176:179], v[108:111], v[56:59], v[176:179]
s_waitcnt lgkmcnt(3)
v_mfma_f32_16x16x32_bf16 v[116:119], v[76:79], v[36:39], v[116:119]
s_waitcnt vmcnt(10)
ds_read_b64_tr_b16 v[96:97], v6 offset:12288
v_mfma_f32_16x16x32_bf16 v[120:123], v[76:79], v[40:43], v[120:123]
ds_read_b64_tr_b16 v[100:101], v7 offset:12288
v_mfma_f32_16x16x32_bf16 v[124:127], v[76:79], v[44:47], v[124:127]
v_mfma_f32_16x16x32_bf16 v[128:131], v[76:79], v[48:51], v[128:131]
ds_read_b64_tr_b16 v[104:105], v8 offset:12288
s_waitcnt lgkmcnt(3)
v_mfma_f32_16x16x32_bf16 v[132:135], v[76:79], v[52:55], v[132:135]
ds_read_b64_tr_b16 v[108:109], v9 offset:12288
v_mfma_f32_16x16x32_bf16 v[152:155], v[80:83], v[52:55], v[152:155]
ds_read_b128 v[56:59], v255 offset:0
v_mfma_f32_16x16x32_bf16 v[148:151], v[80:83], v[48:51], v[148:151]
ds_read_b128 v[60:63], v255 offset:2048
v_mfma_f32_16x16x32_bf16 v[144:147], v[80:83], v[44:47], v[144:147]
v_mfma_f32_16x16x32_bf16 v[140:143], v[80:83], v[40:43], v[140:143]
ds_read_b128 v[64:67], v255 offset:4096
v_mfma_f32_16x16x32_bf16 v[136:139], v[80:83], v[36:39], v[136:139]
ds_read_b128 v[68:71], v255 offset:6144
v_mfma_f32_16x16x32_bf16 v[156:159], v[84:87], v[36:39], v[156:159]
s_waitcnt vmcnt(8)
ds_read_b64_tr_b16 v[98:99], v6 offset:14336
v_mfma_f32_16x16x32_bf16 v[160:163], v[84:87], v[40:43], v[160:163]
ds_read_b64_tr_b16 v[102:103], v7 offset:14336
v_mfma_f32_16x16x32_bf16 v[164:167], v[84:87], v[44:47], v[164:167]
v_mfma_f32_16x16x32_bf16 v[168:171], v[84:87], v[48:51], v[168:171]
ds_read_b64_tr_b16 v[106:107], v8 offset:14336
v_mfma_f32_16x16x32_bf16 v[172:175], v[84:87], v[52:55], v[172:175]
ds_read_b64_tr_b16 v[110:111], v9 offset:14336
v_mfma_f32_16x16x32_bf16 v[192:195], v[88:91], v[52:55], v[192:195]
ds_read_b128 v[72:75], v255 offset:8192
v_mfma_f32_16x16x32_bf16 v[188:191], v[88:91], v[48:51], v[188:191]
ds_read_b32 v27, v21
v_mfma_f32_16x16x32_bf16 v[184:187], v[88:91], v[44:47], v[184:187]
v_mfma_f32_16x16x32_bf16 v[180:183], v[88:91], v[40:43], v[180:183]
v_mfma_f32_16x16x32_bf16 v[176:179], v[88:91], v[36:39], v[176:179]
s_waitcnt lgkmcnt(4)
v_mfma_f32_16x16x32_bf16 v[116:119], v[96:99], v[56:59], v[116:119]
s_waitcnt vmcnt(6)
ds_read_b64_tr_b16 v[76:77], v6 offset:4096
v_mfma_f32_16x16x32_bf16 v[120:123], v[96:99], v[60:63], v[120:123]
ds_read_b64_tr_b16 v[80:81], v7 offset:4096
s_waitcnt lgkmcnt(2)
v_cmp_gt_u32 vcc, 7, v27
v_mfma_f32_16x16x32_bf16 v[124:127], v[96:99], v[64:67], v[124:127]
v_mfma_f32_16x16x32_bf16 v[128:131], v[96:99], v[68:71], v[128:131]
ds_read_b64_tr_b16 v[84:85], v8 offset:4096
s_cbranch_vccnz LwPg11
LrPg11:
v_mfma_f32_16x16x32_bf16 v[132:135], v[96:99], v[72:75], v[132:135]
ds_read_b64_tr_b16 v[88:89], v9 offset:4096
v_mfma_f32_16x16x32_bf16 v[152:155], v[100:103], v[72:75], v[152:155]
ds_read_b128 v[36:39], v254 offset:10240
v_mfma_f32_16x16x32_bf16 v[148:151], v[100:103], v[68:71], v[148:151]
ds_read_b128 v[40:43], v254 offset:12288
v_mfma_f32_16x16x32_bf16 v[144:147], v[100:103], v[64:67], v[144:147]
v_mfma_f32_16x16x32_bf16 v[140:143], v[100:103], v[60:63], v[140:143]
ds_read_b128 v[44:47], v254 offset:14336
s_add_u32 m0, s6, 4096
v_mfma_f32_16x16x32_bf16 v[136:139], v[100:103], v[56:59], v[136:139]
ds_read_b128 v[48:51], v254 offset:16384
s_mov_b32 s11, 4128768
v_mfma_f32_16x16x32_bf16 v[156:159], v[104:107], v[56:59], v[156:159]
s_waitcnt vmcnt(4)
ds_read_b64_tr_b16 v[78:79], v6 offset:6144
v_mfma_f32_16x16x32_bf16 v[160:163], v[104:107], v[60:63], v[160:163]
ds_read_b64_tr_b16 v[82:83], v7 offset:6144
v_mfma_f32_16x16x32_bf16 v[164:167], v[104:107], v[64:67], v[164:167]
s_waitcnt lgkmcnt(5)
buffer_load_dwordx4 v11, s[48:51], s11 offen lds
v_mfma_f32_16x16x32_bf16 v[168:171], v[104:107], v[68:71], v[168:171]
ds_read_b64_tr_b16 v[86:87], v8 offset:6144
v_mfma_f32_16x16x32_bf16 v[172:175], v[104:107], v[72:75], v[172:175]
ds_read_b64_tr_b16 v[90:91], v9 offset:6144
v_mfma_f32_16x16x32_bf16 v[192:195], v[108:111], v[72:75], v[192:195]
ds_read_b128 v[52:55], v254 offset:18432
v_mfma_f32_16x16x32_bf16 v[188:191], v[108:111], v[68:71], v[188:191]
v_mfma_f32_16x16x32_bf16 v[184:187], v[108:111], v[64:67], v[184:187]
buffer_load_dwordx4 v12, s[48:51], s11 offen offset:1024 lds
v_mov_b32 v24, 1
v_mfma_f32_16x16x32_bf16 v[180:183], v[108:111], v[60:63], v[180:183]
s_add_u32 m0, s6, 6144
ds_write_b32 v22, v24
v_mfma_f32_16x16x32_bf16 v[176:179], v[108:111], v[56:59], v[176:179]
s_waitcnt lgkmcnt(4)
s_mov_b32 s11, 4165632
v_mfma_f32_16x16x32_bf16 v[116:119], v[76:79], v[36:39], v[116:119]
s_waitcnt vmcnt(4)
ds_read_b64_tr_b16 v[96:97], v6 offset:0
v_mfma_f32_16x16x32_bf16 v[120:123], v[76:79], v[40:43], v[120:123]
ds_read_b64_tr_b16 v[100:101], v7 offset:0
v_mfma_f32_16x16x32_bf16 v[124:127], v[76:79], v[44:47], v[124:127]
s_waitcnt lgkmcnt(3)
buffer_load_dwordx4 v11, s[48:51], s11 offen lds
v_mfma_f32_16x16x32_bf16 v[128:131], v[76:79], v[48:51], v[128:131]
ds_read_b64_tr_b16 v[104:105], v8 offset:0
v_mfma_f32_16x16x32_bf16 v[132:135], v[76:79], v[52:55], v[132:135]
ds_read_b64_tr_b16 v[108:109], v9 offset:0
v_mfma_f32_16x16x32_bf16 v[152:155], v[80:83], v[52:55], v[152:155]
ds_read_b128 v[56:59], v255 offset:10240
v_mfma_f32_16x16x32_bf16 v[148:151], v[80:83], v[48:51], v[148:151]
ds_read_b128 v[60:63], v255 offset:12288
v_mfma_f32_16x16x32_bf16 v[144:147], v[80:83], v[44:47], v[144:147]
buffer_load_dwordx4 v12, s[48:51], s11 offen offset:1024 lds
v_mfma_f32_16x16x32_bf16 v[140:143], v[80:83], v[40:43], v[140:143]
ds_read_b128 v[64:67], v255 offset:14336
s_add_u32 m0, s6, 0
v_mfma_f32_16x16x32_bf16 v[136:139], v[80:83], v[36:39], v[136:139]
ds_read_b128 v[68:71], v255 offset:16384
s_mov_b32 s11, 4423680
v_mfma_f32_16x16x32_bf16 v[156:159], v[84:87], v[36:39], v[156:159]
s_waitcnt vmcnt(4)
ds_read_b64_tr_b16 v[98:99], v6 offset:2048
v_mfma_f32_16x16x32_bf16 v[160:163], v[84:87], v[40:43], v[160:163]
ds_read_b64_tr_b16 v[102:103], v7 offset:2048
v_mfma_f32_16x16x32_bf16 v[164:167], v[84:87], v[44:47], v[164:167]
s_waitcnt lgkmcnt(5)
buffer_load_dwordx4 v11, s[48:51], s11 offen lds
v_mfma_f32_16x16x32_bf16 v[168:171], v[84:87], v[48:51], v[168:171]
ds_read_b64_tr_b16 v[106:107], v8 offset:2048
v_mfma_f32_16x16x32_bf16 v[172:175], v[84:87], v[52:55], v[172:175]
ds_read_b64_tr_b16 v[110:111], v9 offset:2048
v_mfma_f32_16x16x32_bf16 v[192:195], v[88:91], v[52:55], v[192:195]
ds_read_b128 v[72:75], v255 offset:18432
v_mfma_f32_16x16x32_bf16 v[188:191], v[88:91], v[48:51], v[188:191]
ds_read_b32 v27, v21
v_mfma_f32_16x16x32_bf16 v[184:187], v[88:91], v[44:47], v[184:187]
buffer_load_dwordx4 v12, s[48:51], s11 offen offset:1024 lds
v_mfma_f32_16x16x32_bf16 v[180:183], v[88:91], v[40:43], v[180:183]
s_add_u32 m0, s6, 2048
v_mfma_f32_16x16x32_bf16 v[176:179], v[88:91], v[36:39], v[176:179]
s_waitcnt lgkmcnt(4)
s_mov_b32 s11, 4460544
v_mfma_f32_16x16x32_bf16 v[116:119], v[96:99], v[56:59], v[116:119]
s_waitcnt vmcnt(4)
ds_read_b64_tr_b16 v[76:77], v6 offset:4096
v_mfma_f32_16x16x32_bf16 v[120:123], v[96:99], v[60:63], v[120:123]
ds_read_b64_tr_b16 v[80:81], v7 offset:4096
s_waitcnt lgkmcnt(2)
v_cmp_gt_u32 vcc, 8, v27
v_mfma_f32_16x16x32_bf16 v[124:127], v[96:99], v[64:67], v[124:127]
buffer_load_dwordx4 v11, s[48:51], s11 offen lds
v_mfma_f32_16x16x32_bf16 v[128:131], v[96:99], v[68:71], v[128:131]
ds_read_b64_tr_b16 v[84:85], v8 offset:4096
s_cbranch_vccnz LwPg13
LrPg13:
v_mfma_f32_16x16x32_bf16 v[132:135], v[96:99], v[72:75], v[132:135]
ds_read_b64_tr_b16 v[88:89], v9 offset:4096
v_mfma_f32_16x16x32_bf16 v[152:155], v[100:103], v[72:75], v[152:155]
ds_read_b128 v[36:39], v254 offset:20480
v_mfma_f32_16x16x32_bf16 v[148:151], v[100:103], v[68:71], v[148:151]
ds_read_b128 v[40:43], v254 offset:22528
v_mfma_f32_16x16x32_bf16 v[144:147], v[100:103], v[64:67], v[144:147]
buffer_load_dwordx4 v12, s[48:51], s11 offen offset:1024 lds
v_mfma_f32_16x16x32_bf16 v[140:143], v[100:103], v[60:63], v[140:143]
ds_read_b128 v[44:47], v254 offset:24576
s_add_u32 m0, s6, 4096
v_mfma_f32_16x16x32_bf16 v[136:139], v[100:103], v[56:59], v[136:139]
ds_read_b128 v[48:51], v254 offset:26624
s_mov_b32 s11, 4718592
v_mfma_f32_16x16x32_bf16 v[156:159], v[104:107], v[56:59], v[156:159]
s_waitcnt vmcnt(4)
ds_read_b64_tr_b16 v[78:79], v6 offset:6144
v_mfma_f32_16x16x32_bf16 v[160:163], v[104:107], v[60:63], v[160:163]
ds_read_b64_tr_b16 v[82:83], v7 offset:6144
v_mfma_f32_16x16x32_bf16 v[164:167], v[104:107], v[64:67], v[164:167]
s_waitcnt lgkmcnt(5)
buffer_load_dwordx4 v11, s[48:51], s11 offen lds
v_mfma_f32_16x16x32_bf16 v[168:171], v[104:107], v[68:71], v[168:171]
ds_read_b64_tr_b16 v[86:87], v8 offset:6144
v_mfma_f32_16x16x32_bf16 v[172:175], v[104:107], v[72:75], v[172:175]
ds_read_b64_tr_b16 v[90:91], v9 offset:6144
v_mfma_f32_16x16x32_bf16 v[192:195], v[108:111], v[72:75], v[192:195]
ds_read_b128 v[52:55], v254 offset:28672
v_mfma_f32_16x16x32_bf16 v[188:191], v[108:111], v[68:71], v[188:191]
v_mfma_f32_16x16x32_bf16 v[184:187], v[108:111], v[64:67], v[184:187]
buffer_load_dwordx4 v12, s[48:51], s11 offen offset:1024 lds
v_mfma_f32_16x16x32_bf16 v[180:183], v[108:111], v[60:63], v[180:183]
s_add_u32 m0, s6, 6144
v_mfma_f32_16x16x32_bf16 v[176:179], v[108:111], v[56:59], v[176:179]
s_waitcnt lgkmcnt(3)
s_mov_b32 s11, 4755456
v_mfma_f32_16x16x32_bf16 v[116:119], v[76:79], v[36:39], v[116:119]
s_waitcnt vmcnt(4)
ds_read_b64_tr_b16 v[96:97], v6 offset:0
v_mfma_f32_16x16x32_bf16 v[120:123], v[76:79], v[40:43], v[120:123]
ds_read_b64_tr_b16 v[100:101], v7 offset:0
v_mfma_f32_16x16x32_bf16 v[124:127], v[76:79], v[44:47], v[124:127]
s_waitcnt lgkmcnt(2)
buffer_load_dwordx4 v11, s[48:51], s11 offen lds
v_mfma_f32_16x16x32_bf16 v[128:131], v[76:79], v[48:51], v[128:131]
ds_read_b64_tr_b16 v[104:105], v8 offset:0
v_mfma_f32_16x16x32_bf16 v[132:135], v[76:79], v[52:55], v[132:135]
ds_read_b64_tr_b16 v[108:109], v9 offset:0
v_mfma_f32_16x16x32_bf16 v[152:155], v[80:83], v[52:55], v[152:155]
ds_read_b128 v[56:59], v255 offset:20480
v_mfma_f32_16x16x32_bf16 v[148:151], v[80:83], v[48:51], v[148:151]
ds_read_b128 v[60:63], v255 offset:22528
v_mfma_f32_16x16x32_bf16 v[144:147], v[80:83], v[44:47], v[144:147]
buffer_load_dwordx4 v12, s[48:51], s11 offen offset:1024 lds
v_mfma_f32_16x16x32_bf16 v[140:143], v[80:83], v[40:43], v[140:143]
ds_read_b128 v[64:67], v255 offset:24576
s_add_u32 m0, s6, 0
v_mfma_f32_16x16x32_bf16 v[136:139], v[80:83], v[36:39], v[136:139]
ds_read_b128 v[68:71], v255 offset:26624
s_mov_b32 s11, 5013504
v_mfma_f32_16x16x32_bf16 v[156:159], v[84:87], v[36:39], v[156:159]
s_waitcnt vmcnt(4)
ds_read_b64_tr_b16 v[98:99], v6 offset:2048
v_mfma_f32_16x16x32_bf16 v[160:163], v[84:87], v[40:43], v[160:163]
ds_read_b64_tr_b16 v[102:103], v7 offset:2048
v_mfma_f32_16x16x32_bf16 v[164:167], v[84:87], v[44:47], v[164:167]
s_waitcnt lgkmcnt(5)
buffer_load_dwordx4 v11, s[48:51], s11 offen lds
v_mfma_f32_16x16x32_bf16 v[168:171], v[84:87], v[48:51], v[168:171]
ds_read_b64_tr_b16 v[106:107], v8 offset:2048
v_mfma_f32_16x16x32_bf16 v[172:175], v[84:87], v[52:55], v[172:175]
ds_read_b64_tr_b16 v[110:111], v9 offset:2048
v_mfma_f32_16x16x32_bf16 v[192:195], v[88:91], v[52:55], v[192:195]
ds_read_b128 v[72:75], v255 offset:28672
v_mfma_f32_16x16x32_bf16 v[188:191], v[88:91], v[48:51], v[188:191]
ds_read_b32 v27, v21
v_mfma_f32_16x16x32_bf16 v[184:187], v[88:91], v[44:47], v[184:187]
buffer_load_dwordx4 v12, s[48:51], s11 offen offset:1024 lds
v_mfma_f32_16x16x32_bf16 v[180:183], v[88:91], v[40:43], v[180:183]
s_add_u32 m0, s6, 2048
v_mfma_f32_16x16x32_bf16 v[176:179], v[88:91], v[36:39], v[176:179]
s_waitcnt lgkmcnt(4)
s_mov_b32 s11, 5050368
v_mfma_f32_16x16x32_bf16 v[116:119], v[96:99], v[56:59], v[116:119]
s_waitcnt vmcnt(4)
ds_read_b64_tr_b16 v[76:77], v6 offset:4096
v_mfma_f32_16x16x32_bf16 v[120:123], v[96:99], v[60:63], v[120:123]
ds_read_b64_tr_b16 v[80:81], v7 offset:4096
s_waitcnt lgkmcnt(2)
v_cmp_gt_u32 vcc, 9, v27
v_mfma_f32_16x16x32_bf16 v[124:127], v[96:99], v[64:67], v[124:127]
buffer_load_dwordx4 v11, s[48:51], s11 offen lds
v_mfma_f32_16x16x32_bf16 v[128:131], v[96:99], v[68:71], v[128:131]
ds_read_b64_tr_b16 v[84:85], v8 offset:4096
s_cbranch_vccnz LwPg15
LrPg15:
v_mfma_f32_16x16x32_bf16 v[132:135], v[96:99], v[72:75], v[132:135]
ds_read_b64_tr_b16 v[88:89], v9 offset:4096
v_mfma_f32_16x16x32_bf16 v[152:155], v[100:103], v[72:75], v[152:155]
ds_read_b128 v[36:39], v254 offset:30720
v_mfma_f32_16x16x32_bf16 v[148:151], v[100:103], v[68:71], v[148:151]
ds_read_b128 v[40:43], v254 offset:32768
v_mfma_f32_16x16x32_bf16 v[144:147], v[100:103], v[64:67], v[144:147]
buffer_load_dwordx4 v12, s[48:51], s11 offen offset:1024 lds
v_mfma_f32_16x16x32_bf16 v[140:143], v[100:103], v[60:63], v[140:143]
ds_read_b128 v[44:47], v254 offset:34816
v_mfma_f32_16x16x32_bf16 v[136:139], v[100:103], v[56:59], v[136:139]
ds_read_b128 v[48:51], v254 offset:36864
v_mfma_f32_16x16x32_bf16 v[156:159], v[104:107], v[56:59], v[156:159]
s_waitcnt vmcnt(4)
ds_read_b64_tr_b16 v[78:79], v6 offset:6144
v_mfma_f32_16x16x32_bf16 v[160:163], v[104:107], v[60:63], v[160:163]
ds_read_b64_tr_b16 v[82:83], v7 offset:6144
v_mfma_f32_16x16x32_bf16 v[164:167], v[104:107], v[64:67], v[164:167]
v_mfma_f32_16x16x32_bf16 v[168:171], v[104:107], v[68:71], v[168:171]
ds_read_b64_tr_b16 v[86:87], v8 offset:6144
v_mfma_f32_16x16x32_bf16 v[172:175], v[104:107], v[72:75], v[172:175]
ds_read_b64_tr_b16 v[90:91], v9 offset:6144
v_mfma_f32_16x16x32_bf16 v[192:195], v[108:111], v[72:75], v[192:195]
ds_read_b128 v[52:55], v254 offset:38912
v_mfma_f32_16x16x32_bf16 v[188:191], v[108:111], v[68:71], v[188:191]
v_mfma_f32_16x16x32_bf16 v[184:187], v[108:111], v[64:67], v[184:187]
v_mfma_f32_16x16x32_bf16 v[180:183], v[108:111], v[60:63], v[180:183]
v_mfma_f32_16x16x32_bf16 v[176:179], v[108:111], v[56:59], v[176:179]
s_waitcnt lgkmcnt(3)
v_mfma_f32_16x16x32_bf16 v[116:119], v[76:79], v[36:39], v[116:119]
s_waitcnt vmcnt(2)
ds_read_b64_tr_b16 v[96:97], v6 offset:0
v_mov_b32 v24, 2
v_mfma_f32_16x16x32_bf16 v[120:123], v[76:79], v[40:43], v[120:123]
ds_read_b64_tr_b16 v[100:101], v7 offset:0
v_mfma_f32_16x16x32_bf16 v[124:127], v[76:79], v[44:47], v[124:127]
s_waitcnt lgkmcnt(2)
ds_write_b32 v22, v24
v_mfma_f32_16x16x32_bf16 v[128:131], v[76:79], v[48:51], v[128:131]
ds_read_b64_tr_b16 v[104:105], v8 offset:0
v_mfma_f32_16x16x32_bf16 v[132:135], v[76:79], v[52:55], v[132:135]
ds_read_b64_tr_b16 v[108:109], v9 offset:0
v_mfma_f32_16x16x32_bf16 v[152:155], v[80:83], v[52:55], v[152:155]
ds_read_b128 v[56:59], v255 offset:30720
v_mfma_f32_16x16x32_bf16 v[148:151], v[80:83], v[48:51], v[148:151]
ds_read_b128 v[60:63], v255 offset:32768
v_mfma_f32_16x16x32_bf16 v[144:147], v[80:83], v[44:47], v[144:147]
v_mfma_f32_16x16x32_bf16 v[140:143], v[80:83], v[40:43], v[140:143]
ds_read_b128 v[64:67], v255 offset:34816
s_add_u32 m0, s6, 0
v_mfma_f32_16x16x32_bf16 v[136:139], v[80:83], v[36:39], v[136:139]
ds_read_b128 v[68:71], v255 offset:36864
s_mov_b32 s11, 0
v_mfma_f32_16x16x32_bf16 v[156:159], v[84:87], v[36:39], v[156:159]
s_waitcnt vmcnt(0)
ds_read_b64_tr_b16 v[98:99], v6 offset:2048
v_mfma_f32_16x16x32_bf16 v[160:163], v[84:87], v[40:43], v[160:163]
ds_read_b64_tr_b16 v[102:103], v7 offset:2048
v_mfma_f32_16x16x32_bf16 v[164:167], v[84:87], v[44:47], v[164:167]
s_waitcnt lgkmcnt(5)
buffer_load_dwordx4 v13, s[52:55], s11 offen lds
v_mfma_f32_16x16x32_bf16 v[168:171], v[84:87], v[48:51], v[168:171]
ds_read_b64_tr_b16 v[106:107], v8 offset:2048
v_mfma_f32_16x16x32_bf16 v[172:175], v[84:87], v[52:55], v[172:175]
ds_read_b64_tr_b16 v[110:111], v9 offset:2048
v_mfma_f32_16x16x32_bf16 v[192:195], v[88:91], v[52:55], v[192:195]
ds_read_b128 v[72:75], v255 offset:38912
v_mfma_f32_16x16x32_bf16 v[188:191], v[88:91], v[48:51], v[188:191]
v_mfma_f32_16x16x32_bf16 v[184:187], v[88:91], v[44:47], v[184:187]
buffer_load_dwordx4 v14, s[52:55], s11 offen offset:1024 lds
v_mfma_f32_16x16x32_bf16 v[180:183], v[88:91], v[40:43], v[180:183]
s_add_u32 m0, s6, 2048
v_mfma_f32_16x16x32_bf16 v[176:179], v[88:91], v[36:39], v[176:179]
s_waitcnt lgkmcnt(3)
s_mov_b32 s11, 18432
v_mfma_f32_16x16x32_bf16 v[116:119], v[96:99], v[56:59], v[116:119]
v_mfma_f32_16x16x32_bf16 v[120:123], v[96:99], v[60:63], v[120:123]
v_mfma_f32_16x16x32_bf16 v[124:127], v[96:99], v[64:67], v[124:127]
s_waitcnt lgkmcnt(0)
buffer_load_dwordx4 v13, s[52:55], s11 offen lds
v_mfma_f32_16x16x32_bf16 v[128:131], v[96:99], v[68:71], v[128:131]
v_mfma_f32_16x16x32_bf16 v[132:135], v[96:99], v[72:75], v[132:135]
v_mfma_f32_16x16x32_bf16 v[152:155], v[100:103], v[72:75], v[152:155]
v_mfma_f32_16x16x32_bf16 v[148:151], v[100:103], v[68:71], v[148:151]
v_mfma_f32_16x16x32_bf16 v[144:147], v[100:103], v[64:67], v[144:147]
buffer_load_dwordx4 v14, s[52:55], s11 offen offset:1024 lds
v_mfma_f32_16x16x32_bf16 v[140:143], v[100:103], v[60:63], v[140:143]
v_mfma_f32_16x16x32_bf16 v[136:139], v[100:103], v[56:59], v[136:139]
v_mfma_f32_16x16x32_bf16 v[156:159], v[104:107], v[56:59], v[156:159]
v_mfma_f32_16x16x32_bf16 v[160:163], v[104:107], v[60:63], v[160:163]
v_mfma_f32_16x16x32_bf16 v[164:167], v[104:107], v[64:67], v[164:167]
v_mfma_f32_16x16x32_bf16 v[168:171], v[104:107], v[68:71], v[168:171]
v_mfma_f32_16x16x32_bf16 v[172:175], v[104:107], v[72:75], v[172:175]
v_mfma_f32_16x16x32_bf16 v[192:195], v[108:111], v[72:75], v[192:195]
v_mfma_f32_16x16x32_bf16 v[188:191], v[108:111], v[68:71], v[188:191]
v_mfma_f32_16x16x32_bf16 v[184:187], v[108:111], v[64:67], v[184:187]
v_mfma_f32_16x16x32_bf16 v[180:183], v[108:111], v[60:63], v[180:183]
v_mfma_f32_16x16x32_bf16 v[176:179], v[108:111], v[56:59], v[176:179]
s_setprio 0
v_and_b32 v28, 15, v1
v_lshrrev_b32 v29, 5, v1
v_bfe_u32 v30, v1, 4, 1
v_lshl_add_u32 v29, v30, 1, v29
v_lshrrev_b32 v30, 1, v28
v_xor_b32 v29, v29, v30
v_lshlrev_b32 v28, 7, v28
v_lshl_add_u32 v28, v29, 4, v28
s_add_u32 s13, s18, 0
s_lshl_b32 s14, s23, 1
s_cmp_ge_u32 s13, 5
s_cselect_b32 s7, 5, 0
s_addc_u32 s14, s14, 0
s_sub_u32 s15, s13, s7
s_lshr_b32 s7, s14, 1
s_mul_i32 s7, s7, 10240
s_lshl_b32 s15, s15, 11
s_add_u32 s7, s7, s15
s_and_b32 s14, s14, 1
s_lshl_b32 s14, s14, 6
v_xor_b32 v29, s14, v28
v_add_u32 v29, s7, v29
ds_read_b128 v[196:199], v29
s_add_u32 s13, s18, 4
s_lshl_b32 s14, s23, 1
s_cmp_ge_u32 s13, 5
s_cselect_b32 s7, 5, 0
s_addc_u32 s14, s14, 0
s_sub_u32 s15, s13, s7
s_lshr_b32 s7, s14, 1
s_mul_i32 s7, s7, 10240
s_lshl_b32 s15, s15, 11
s_add_u32 s7, s7, s15
s_and_b32 s14, s14, 1
s_lshl_b32 s14, s14, 6
v_xor_b32 v29, s14, v28
v_add_u32 v29, s7, v29
ds_read_b128 v[200:203], v29
s_add_u32 s13, s18, 8
s_lshl_b32 s14, s23, 1
s_cmp_ge_u32 s13, 5
s_cselect_b32 s7, 5, 0
s_addc_u32 s14, s14, 0
s_sub_u32 s15, s13, s7
s_cmp_lt_u32 s18, 2
s_cbranch_scc1 Lxk3
s_sub_u32 s7, s18, 2
s_lshl_b32 s7, s7, 3
s_add_u32 s7, s7, s4
s_cmp_ge_u32 s7, 5
s_cselect_b32 s8, 5, 0
s_cselect_b32 s14, 17, 16
s_sub_u32 s15, s7, s8
s_min_u32 s15, s15, 4
Lxk3:
s_lshr_b32 s7, s14, 1
s_mul_i32 s7, s7, 10240
s_lshl_b32 s15, s15, 11
s_add_u32 s7, s7, s15
s_and_b32 s14, s14, 1
s_lshl_b32 s14, s14, 6
v_xor_b32 v29, s14, v28
v_add_u32 v29, s7, v29
ds_read_b128 v[204:207], v29
s_waitcnt lgkmcnt(0)
v_mov_b32 v24, 3
ds_write_b32 v22, v24
ds_read_b32 v27, v21
s_waitcnt lgkmcnt(0)
v_cmp_gt_u32 vcc, 10, v27
s_cbranch_vccnz LwPst
LrPst:
v_and_b32 v28, 15, v1
v_lshlrev_b32 v28, 4, v28
v_add_u32 v28, 161792, v28
ds_read_b128 v[56:59], v28 offset:0
ds_read_b128 v[60:63], v28 offset:256
ds_read_b128 v[64:67], v28 offset:512
ds_read_b128 v[68:71], v28 offset:768
ds_read_b128 v[72:75], v28 offset:1024
s_waitcnt lgkmcnt(4)
v_add_f32 v56, v56, v58
v_add_f32 v57, v57, v59
v_mul_f32 v56, 0x3ae38e39, v56
v_mul_f32 v57, 0x3ae38e39, v57
v_fma_f32 v57, -v56, v56, v57
v_max_f32 v57, 0, v57
v_cvt_pk_bf16_f32 v58, v56, v57
v_and_b32 v57, 0xffff0000, v58
v_add_f32 v57, 0x3727c5ac, v57
v_cvt_pk_bf16_f32 v57, v57, v57
v_and_b32 v57, 0xffff0000, v57
v_sqrt_f32 v57, v57
v_lshlrev_b32 v233, 16, v58
v_cvt_pk_bf16_f32 v57, v57, v57
v_and_b32 v57, 0xffff0000, v57
v_rcp_f32 v228, v57
s_waitcnt lgkmcnt(3)
v_add_f32 v60, v60, v62
v_add_f32 v61, v61, v63
v_mul_f32 v60, 0x3ae38e39, v60
v_mul_f32 v61, 0x3ae38e39, v61
v_fma_f32 v61, -v60, v60, v61
v_max_f32 v61, 0, v61
v_cvt_pk_bf16_f32 v62, v60, v61
v_and_b32 v61, 0xffff0000, v62
v_add_f32 v61, 0x3727c5ac, v61
v_cvt_pk_bf16_f32 v61, v61, v61
v_and_b32 v61, 0xffff0000, v61
v_sqrt_f32 v61, v61
v_lshlrev_b32 v234, 16, v62
v_cvt_pk_bf16_f32 v61, v61, v61
v_and_b32 v61, 0xffff0000, v61
v_rcp_f32 v229, v61
s_waitcnt lgkmcnt(2)
v_add_f32 v64, v64, v66
v_add_f32 v65, v65, v67
v_mul_f32 v64, 0x3ae38e39, v64
v_mul_f32 v65, 0x3ae38e39, v65
v_fma_f32 v65, -v64, v64, v65
v_max_f32 v65, 0, v65
v_cvt_pk_bf16_f32 v66, v64, v65
v_and_b32 v65, 0xffff0000, v66
v_add_f32 v65, 0x3727c5ac, v65
v_cvt_pk_bf16_f32 v65, v65, v65
v_and_b32 v65, 0xffff0000, v65
v_sqrt_f32 v65, v65
v_lshlrev_b32 v235, 16, v66
v_cvt_pk_bf16_f32 v65, v65, v65
v_and_b32 v65, 0xffff0000, v65
v_rcp_f32 v230, v65
s_waitcnt lgkmcnt(1)
v_add_f32 v68, v68, v70
v_add_f32 v69, v69, v71
v_mul_f32 v68, 0x3ae38e39, v68
v_mul_f32 v69, 0x3ae38e39, v69
v_fma_f32 v69, -v68, v68, v69
v_max_f32 v69, 0, v69
v_cvt_pk_bf16_f32 v70, v68, v69
v_and_b32 v69, 0xffff0000, v70
v_add_f32 v69, 0x3727c5ac, v69
v_cvt_pk_bf16_f32 v69, v69, v69
v_and_b32 v69, 0xffff0000, v69
v_sqrt_f32 v69, v69
v_lshlrev_b32 v236, 16, v70
v_cvt_pk_bf16_f32 v69, v69, v69
v_and_b32 v69, 0xffff0000, v69
v_rcp_f32 v231, v69
s_waitcnt lgkmcnt(0)
v_add_f32 v72, v72, v74
v_add_f32 v73, v73, v75
v_mul_f32 v72, 0x3ae38e39, v72
v_mul_f32 v73, 0x3ae38e39, v73
v_fma_f32 v73, -v72, v72, v73
v_max_f32 v73, 0, v73
v_cvt_pk_bf16_f32 v74, v72, v73
v_and_b32 v73, 0xffff0000, v74
v_add_f32 v73, 0x3727c5ac, v73
v_cvt_pk_bf16_f32 v73, v73, v73
v_and_b32 v73, 0xffff0000, v73
v_sqrt_f32 v73, v73
v_lshlrev_b32 v237, 16, v74
v_cvt_pk_bf16_f32 v73, v73, v73
v_and_b32 v73, 0xffff0000, v73
v_rcp_f32 v232, v73
v_mul_f32 v228, 0x3fb8aa3b, v228
v_mul_f32 v233, v233, v228
v_mul_f32 v229, 0x3fb8aa3b, v229
v_mul_f32 v234, v234, v229
v_mul_f32 v230, 0x3fb8aa3b, v230
v_mul_f32 v235, v235, v230
v_mul_f32 v231, 0x3fb8aa3b, v231
v_mul_f32 v236, v236, v231
v_mul_f32 v232, 0x3fb8aa3b, v232
v_mul_f32 v237, v237, v232
v_mov_b32_dpp v238, v132 row_newbcast:15 row_mask:0xf bank_mask:0xf
v_mov_b32_dpp v239, v133 row_newbcast:15 row_mask:0xf bank_mask:0xf
v_mov_b32_dpp v240, v134 row_newbcast:15 row_mask:0xf bank_mask:0xf
v_mov_b32_dpp v241, v135 row_newbcast:15 row_mask:0xf bank_mask:0xf
v_lshlrev_b32 v242, 16, v216
v_and_b32 v243, 0xffff0000, v216
v_lshlrev_b32 v244, 16, v217
v_and_b32 v245, 0xffff0000, v217
v_mul_f32 v242, 0x3fb8aa3b, v242
v_mul_f32 v243, 0x3fb8aa3b, v243
v_mul_f32 v244, 0x3fb8aa3b, v244
v_mul_f32 v245, 0x3fb8aa3b, v245
v_mov_b32_dpp v246, v152 row_newbcast:15 row_mask:0xf bank_mask:0xf
v_mov_b32_dpp v247, v153 row_newbcast:15 row_mask:0xf bank_mask:0xf
v_mov_b32_dpp v248, v154 row_newbcast:15 row_mask:0xf bank_mask:0xf
v_mov_b32_dpp v249, v155 row_newbcast:15 row_mask:0xf bank_mask:0xf
v_lshlrev_b32 v250, 16, v218
v_and_b32 v251, 0xffff0000, v218
v_lshlrev_b32 v252, 16, v219
v_and_b32 v253, 0xffff0000, v219
v_mul_f32 v250, 0x3fb8aa3b, v250
v_mul_f32 v251, 0x3fb8aa3b, v251
v_mul_f32 v252, 0x3fb8aa3b, v252
v_mul_f32 v253, 0x3fb8aa3b, v253
v_fma_f32 v28, -v238, v233, v242
v_fma_f32 v29, -v239, v233, v243
v_fma_f32 v30, -v240, v233, v244
v_fma_f32 v31, -v241, v233, v245
v_fma_f32 v116, v116, v228, v28
v_fma_f32 v117, v117, v228, v29
v_fma_f32 v118, v118, v228, v30
v_fma_f32 v119, v119, v228, v31
v_exp_f32 v28, v116
v_exp_f32 v29, v117
v_exp_f32 v30, v118
v_exp_f32 v31, v119
v_fma_f32 v28, v28, s9, s9
v_fma_f32 v29, v29, s9, s9
v_fma_f32 v30, v30, s9, s9
v_fma_f32 v31, v31, s9, s9
v_fma_f32 v28, v28, v28, 0.5
v_fma_f32 v29, v29, v29, 0.5
v_fma_f32 v30, v30, v30, 0.5
v_fma_f32 v31, v31, v31, 0.5
v_rcp_f32 v28, v28
v_rcp_f32 v29, v29
v_rcp_f32 v30, v30
v_rcp_f32 v31, v31
v_fma_f32 v28, -v116, v28, v116
v_fma_f32 v29, -v117, v29, v117
v_fma_f32 v30, -v118, v30, v118
v_fma_f32 v31, -v119, v31, v119
v_cvt_pk_bf16_f32 v116, v28, v29
v_cvt_pk_bf16_f32 v117, v30, v31
v_fma_f32 v32, -v246, v233, v250
v_fma_f32 v33, -v247, v233, v251
v_fma_f32 v34, -v248, v233, v252
v_fma_f32 v35, -v249, v233, v253
v_fma_f32 v136, v136, v228, v32
v_fma_f32 v137, v137, v228, v33
v_fma_f32 v138, v138, v228, v34
v_fma_f32 v139, v139, v228, v35
v_exp_f32 v32, v136
v_exp_f32 v33, v137
v_exp_f32 v34, v138
v_exp_f32 v35, v139
v_fma_f32 v32, v32, s9, s9
v_fma_f32 v33, v33, s9, s9
v_fma_f32 v34, v34, s9, s9
v_fma_f32 v35, v35, s9, s9
v_fma_f32 v32, v32, v32, 0.5
v_fma_f32 v33, v33, v33, 0.5
v_fma_f32 v34, v34, v34, 0.5
v_fma_f32 v35, v35, v35, 0.5
v_rcp_f32 v32, v32
v_rcp_f32 v33, v33
v_rcp_f32 v34, v34
v_rcp_f32 v35, v35
v_fma_f32 v32, -v136, v32, v136
v_fma_f32 v33, -v137, v33, v137
v_fma_f32 v34, -v138, v34, v138
v_fma_f32 v35, -v139, v35, v139
v_cvt_pk_bf16_f32 v118, v32, v33
v_cvt_pk_bf16_f32 v119, v34, v35
v_fma_f32 v28, -v238, v234, v242
v_fma_f32 v29, -v239, v234, v243
v_fma_f32 v30, -v240, v234, v244
v_fma_f32 v31, -v241, v234, v245
v_fma_f32 v120, v120, v229, v28
v_fma_f32 v121, v121, v229, v29
v_fma_f32 v122, v122, v229, v30
v_fma_f32 v123, v123, v229, v31
v_exp_f32 v28, v120
v_exp_f32 v29, v121
v_exp_f32 v30, v122
v_exp_f32 v31, v123
v_fma_f32 v28, v28, s9, s9
v_fma_f32 v29, v29, s9, s9
v_fma_f32 v30, v30, s9, s9
v_fma_f32 v31, v31, s9, s9
v_fma_f32 v28, v28, v28, 0.5
v_fma_f32 v29, v29, v29, 0.5
v_fma_f32 v30, v30, v30, 0.5
v_fma_f32 v31, v31, v31, 0.5
v_rcp_f32 v28, v28
v_rcp_f32 v29, v29
v_rcp_f32 v30, v30
v_rcp_f32 v31, v31
v_fma_f32 v28, -v120, v28, v120
v_fma_f32 v29, -v121, v29, v121
v_fma_f32 v30, -v122, v30, v122
v_fma_f32 v31, -v123, v31, v123
v_cvt_pk_bf16_f32 v120, v28, v29
v_cvt_pk_bf16_f32 v121, v30, v31
v_fma_f32 v32, -v246, v234, v250
v_fma_f32 v33, -v247, v234, v251
v_fma_f32 v34, -v248, v234, v252
v_fma_f32 v35, -v249, v234, v253
v_fma_f32 v140, v140, v229, v32
v_fma_f32 v141, v141, v229, v33
v_fma_f32 v142, v142, v229, v34
v_fma_f32 v143, v143, v229, v35
v_exp_f32 v32, v140
v_exp_f32 v33, v141
v_exp_f32 v34, v142
v_exp_f32 v35, v143
v_fma_f32 v32, v32, s9, s9
v_fma_f32 v33, v33, s9, s9
v_fma_f32 v34, v34, s9, s9
v_fma_f32 v35, v35, s9, s9
v_fma_f32 v32, v32, v32, 0.5
v_fma_f32 v33, v33, v33, 0.5
v_fma_f32 v34, v34, v34, 0.5
v_fma_f32 v35, v35, v35, 0.5
v_rcp_f32 v32, v32
v_rcp_f32 v33, v33
v_rcp_f32 v34, v34
v_rcp_f32 v35, v35
v_fma_f32 v32, -v140, v32, v140
v_fma_f32 v33, -v141, v33, v141
v_fma_f32 v34, -v142, v34, v142
v_fma_f32 v35, -v143, v35, v143
v_cvt_pk_bf16_f32 v122, v32, v33
v_cvt_pk_bf16_f32 v123, v34, v35
v_fma_f32 v28, -v238, v235, v242
v_fma_f32 v29, -v239, v235, v243
v_fma_f32 v30, -v240, v235, v244
v_fma_f32 v31, -v241, v235, v245
v_fma_f32 v124, v124, v230, v28
v_fma_f32 v125, v125, v230, v29
v_fma_f32 v126, v126, v230, v30
v_fma_f32 v127, v127, v230, v31
v_exp_f32 v28, v124
v_exp_f32 v29, v125
v_exp_f32 v30, v126
v_exp_f32 v31, v127
v_fma_f32 v28, v28, s9, s9
v_fma_f32 v29, v29, s9, s9
v_fma_f32 v30, v30, s9, s9
v_fma_f32 v31, v31, s9, s9
v_fma_f32 v28, v28, v28, 0.5
v_fma_f32 v29, v29, v29, 0.5
v_fma_f32 v30, v30, v30, 0.5
v_fma_f32 v31, v31, v31, 0.5
v_rcp_f32 v28, v28
v_rcp_f32 v29, v29
v_rcp_f32 v30, v30
v_rcp_f32 v31, v31
v_fma_f32 v28, -v124, v28, v124
v_fma_f32 v29, -v125, v29, v125
v_fma_f32 v30, -v126, v30, v126
v_fma_f32 v31, -v127, v31, v127
v_cvt_pk_bf16_f32 v124, v28, v29
v_cvt_pk_bf16_f32 v125, v30, v31
v_fma_f32 v32, -v246, v235, v250
v_fma_f32 v33, -v247, v235, v251
v_fma_f32 v34, -v248, v235, v252
v_fma_f32 v35, -v249, v235, v253
v_fma_f32 v144, v144, v230, v32
v_fma_f32 v145, v145, v230, v33
v_fma_f32 v146, v146, v230, v34
v_fma_f32 v147, v147, v230, v35
v_exp_f32 v32, v144
v_exp_f32 v33, v145
v_exp_f32 v34, v146
v_exp_f32 v35, v147
v_fma_f32 v32, v32, s9, s9
v_fma_f32 v33, v33, s9, s9
v_fma_f32 v34, v34, s9, s9
v_fma_f32 v35, v35, s9, s9
v_fma_f32 v32, v32, v32, 0.5
v_fma_f32 v33, v33, v33, 0.5
v_fma_f32 v34, v34, v34, 0.5
v_fma_f32 v35, v35, v35, 0.5
v_rcp_f32 v32, v32
v_rcp_f32 v33, v33
v_rcp_f32 v34, v34
v_rcp_f32 v35, v35
v_fma_f32 v32, -v144, v32, v144
v_fma_f32 v33, -v145, v33, v145
v_fma_f32 v34, -v146, v34, v146
v_fma_f32 v35, -v147, v35, v147
v_cvt_pk_bf16_f32 v126, v32, v33
v_cvt_pk_bf16_f32 v127, v34, v35
ds_read_b32 v27, v20
s_waitcnt lgkmcnt(0)
v_cmp_gt_u32 vcc, 3, v27
s_cbranch_vccnz LwPa
LrPa:
ds_read_b32 v27, v21
s_waitcnt lgkmcnt(0)
v_cmp_gt_u32 vcc, 16, v27
s_cbranch_vccnz LwPb
LrPb:
v_fma_f32 v28, -v238, v236, v242
v_fma_f32 v29, -v239, v236, v243
v_fma_f32 v30, -v240, v236, v244
v_fma_f32 v31, -v241, v236, v245
v_fma_f32 v128, v128, v231, v28
v_fma_f32 v129, v129, v231, v29
v_fma_f32 v130, v130, v231, v30
v_fma_f32 v131, v131, v231, v31
v_exp_f32 v28, v128
v_exp_f32 v29, v129
v_exp_f32 v30, v130
v_exp_f32 v31, v131
v_fma_f32 v28, v28, s9, s9
v_fma_f32 v29, v29, s9, s9
v_fma_f32 v30, v30, s9, s9
v_fma_f32 v31, v31, s9, s9
ds_write_b128 v16, v[116:119] offset:0
v_fma_f32 v28, v28, v28, 0.5
v_fma_f32 v29, v29, v29, 0.5
v_fma_f32 v30, v30, v30, 0.5
v_fma_f32 v31, v31, v31, 0.5
v_rcp_f32 v28, v28
v_rcp_f32 v29, v29
v_rcp_f32 v30, v30
v_rcp_f32 v31, v31
v_fma_f32 v28, -v128, v28, v128
v_fma_f32 v29, -v129, v29, v129
v_fma_f32 v30, -v130, v30, v130
v_fma_f32 v31, -v131, v31, v131
v_cvt_pk_bf16_f32 v128, v28, v29
v_cvt_pk_bf16_f32 v129, v30, v31
v_fma_f32 v32, -v246, v236, v250
v_fma_f32 v33, -v247, v236, v251
v_fma_f32 v34, -v248, v236, v252
v_fma_f32 v35, -v249, v236, v253
v_fma_f32 v148, v148, v231, v32
v_fma_f32 v149, v149, v231, v33
v_fma_f32 v150, v150, v231, v34
v_fma_f32 v151, v151, v231, v35
v_exp_f32 v32, v148
v_exp_f32 v33, v149
v_exp_f32 v34, v150
v_exp_f32 v35, v151
v_fma_f32 v32, v32, s9, s9
v_fma_f32 v33, v33, s9, s9
v_fma_f32 v34, v34, s9, s9
v_fma_f32 v35, v35, s9, s9
ds_write_b128 v16, v[120:123] offset:1024
v_fma_f32 v32, v32, v32, 0.5
v_fma_f32 v33, v33, v33, 0.5
v_fma_f32 v34, v34, v34, 0.5
v_fma_f32 v35, v35, v35, 0.5
v_rcp_f32 v32, v32
v_rcp_f32 v33, v33
v_rcp_f32 v34, v34
v_rcp_f32 v35, v35
v_fma_f32 v32, -v148, v32, v148
v_fma_f32 v33, -v149, v33, v149
v_fma_f32 v34, -v150, v34, v150
v_fma_f32 v35, -v151, v35, v151
v_cvt_pk_bf16_f32 v130, v32, v33
v_cvt_pk_bf16_f32 v131, v34, v35
v_fma_f32 v28, -v238, v237, v242
v_fma_f32 v29, -v239, v237, v243
v_fma_f32 v30, -v240, v237, v244
v_fma_f32 v31, -v241, v237, v245
v_fma_f32 v132, v132, v232, v28
v_fma_f32 v133, v133, v232, v29
v_fma_f32 v134, v134, v232, v30
v_fma_f32 v135, v135, v232, v31
v_exp_f32 v28, v132
v_exp_f32 v29, v133
v_exp_f32 v30, v134
v_exp_f32 v31, v135
v_fma_f32 v28, v28, s9, s9
v_fma_f32 v29, v29, s9, s9
v_fma_f32 v30, v30, s9, s9
v_fma_f32 v31, v31, s9, s9
ds_write_b128 v16, v[124:127] offset:2048
v_fma_f32 v28, v28, v28, 0.5
v_fma_f32 v29, v29, v29, 0.5
v_fma_f32 v30, v30, v30, 0.5
v_fma_f32 v31, v31, v31, 0.5
v_rcp_f32 v28, v28
v_rcp_f32 v29, v29
v_rcp_f32 v30, v30
v_rcp_f32 v31, v31
v_fma_f32 v28, -v132, v28, v132
v_fma_f32 v29, -v133, v29, v133
v_fma_f32 v30, -v134, v30, v134
v_fma_f32 v31, -v135, v31, v135
v_cvt_pk_bf16_f32 v132, v28, v29
v_cvt_pk_bf16_f32 v133, v30, v31
v_fma_f32 v32, -v246, v237, v250
v_fma_f32 v33, -v247, v237, v251
v_fma_f32 v34, -v248, v237, v252
v_fma_f32 v35, -v249, v237, v253
v_fma_f32 v152, v152, v232, v32
v_fma_f32 v153, v153, v232, v33
v_fma_f32 v154, v154, v232, v34
v_fma_f32 v155, v155, v232, v35
v_exp_f32 v32, v152
v_exp_f32 v33, v153
v_exp_f32 v34, v154
v_exp_f32 v35, v155
v_fma_f32 v32, v32, s9, s9
v_fma_f32 v33, v33, s9, s9
v_fma_f32 v34, v34, s9, s9
v_fma_f32 v35, v35, s9, s9
ds_write_b128 v16, v[128:131] offset:3072
v_fma_f32 v32, v32, v32, 0.5
v_fma_f32 v33, v33, v33, 0.5
v_fma_f32 v34, v34, v34, 0.5
v_fma_f32 v35, v35, v35, 0.5
v_rcp_f32 v32, v32
v_rcp_f32 v33, v33
v_rcp_f32 v34, v34
v_rcp_f32 v35, v35
v_fma_f32 v32, -v152, v32, v152
v_fma_f32 v33, -v153, v33, v153
v_fma_f32 v34, -v154, v34, v154
v_fma_f32 v35, -v155, v35, v155
v_cvt_pk_bf16_f32 v134, v32, v33
v_cvt_pk_bf16_f32 v135, v34, v35
v_mov_b32_dpp v238, v172 row_newbcast:15 row_mask:0xf bank_mask:0xf
v_mov_b32_dpp v239, v173 row_newbcast:15 row_mask:0xf bank_mask:0xf
v_mov_b32_dpp v240, v174 row_newbcast:15 row_mask:0xf bank_mask:0xf
v_mov_b32_dpp v241, v175 row_newbcast:15 row_mask:0xf bank_mask:0xf
v_lshlrev_b32 v242, 16, v220
v_and_b32 v243, 0xffff0000, v220
v_lshlrev_b32 v244, 16, v221
v_and_b32 v245, 0xffff0000, v221
v_mul_f32 v242, 0x3fb8aa3b, v242
v_mul_f32 v243, 0x3fb8aa3b, v243
v_mul_f32 v244, 0x3fb8aa3b, v244
v_mul_f32 v245, 0x3fb8aa3b, v245
v_mov_b32_dpp v246, v192 row_newbcast:15 row_mask:0xf bank_mask:0xf
v_mov_b32_dpp v247, v193 row_newbcast:15 row_mask:0xf bank_mask:0xf
v_mov_b32_dpp v248, v194 row_newbcast:15 row_mask:0xf bank_mask:0xf
v_mov_b32_dpp v249, v195 row_newbcast:15 row_mask:0xf bank_mask:0xf
v_lshlrev_b32 v250, 16, v222
v_and_b32 v251, 0xffff0000, v222
v_lshlrev_b32 v252, 16, v223
v_and_b32 v253, 0xffff0000, v223
v_mul_f32 v250, 0x3fb8aa3b, v250
v_mul_f32 v251, 0x3fb8aa3b, v251
v_mul_f32 v252, 0x3fb8aa3b, v252
v_mul_f32 v253, 0x3fb8aa3b, v253
v_fma_f32 v28, -v238, v233, v242
v_fma_f32 v29, -v239, v233, v243
v_fma_f32 v30, -v240, v233, v244
v_fma_f32 v31, -v241, v233, v245
s_waitcnt vmcnt(2)
ds_read_b64_tr_b16 v[76:77], v6 offset:0
v_fma_f32 v156, v156, v228, v28
v_fma_f32 v157, v157, v228, v29
v_fma_f32 v158, v158, v228, v30
v_fma_f32 v159, v159, v228, v31
v_exp_f32 v28, v156
v_exp_f32 v29, v157
v_exp_f32 v30, v158
v_exp_f32 v31, v159
v_fma_f32 v28, v28, s9, s9
v_fma_f32 v29, v29, s9, s9
v_fma_f32 v30, v30, s9, s9
v_fma_f32 v31, v31, s9, s9
ds_write_b128 v16, v[132:135] offset:4096
v_fma_f32 v28, v28, v28, 0.5
v_fma_f32 v29, v29, v29, 0.5
v_fma_f32 v30, v30, v30, 0.5
v_fma_f32 v31, v31, v31, 0.5
v_rcp_f32 v28, v28
v_rcp_f32 v29, v29
v_rcp_f32 v30, v30
v_rcp_f32 v31, v31
v_fma_f32 v28, -v156, v28, v156
v_fma_f32 v29, -v157, v29, v157
v_fma_f32 v30, -v158, v30, v158
ds_read_b64_tr_b16 v[80:81], v7 offset:0
v_fma_f32 v31, -v159, v31, v159
v_cvt_pk_bf16_f32 v156, v28, v29
v_cvt_pk_bf16_f32 v157, v30, v31
v_fma_f32 v32, -v246, v233, v250
v_fma_f32 v33, -v247, v233, v251
v_fma_f32 v34, -v248, v233, v252
v_fma_f32 v35, -v249, v233, v253
ds_read_b64_tr_b16 v[84:85], v8 offset:0
v_fma_f32 v176, v176, v228, v32
v_fma_f32 v177, v177, v228, v33
v_fma_f32 v178, v178, v228, v34
v_fma_f32 v179, v179, v228, v35
v_exp_f32 v32, v176
v_exp_f32 v33, v177
v_exp_f32 v34, v178
v_exp_f32 v35, v179
v_fma_f32 v32, v32, s9, s9
v_fma_f32 v33, v33, s9, s9
v_fma_f32 v34, v34, s9, s9
v_fma_f32 v35, v35, s9, s9
v_fma_f32 v32, v32, v32, 0.5
v_fma_f32 v33, v33, v33, 0.5
v_fma_f32 v34, v34, v34, 0.5
v_fma_f32 v35, v35, v35, 0.5
v_rcp_f32 v32, v32
v_rcp_f32 v33, v33
v_rcp_f32 v34, v34
v_rcp_f32 v35, v35
v_fma_f32 v32, -v176, v32, v176
v_fma_f32 v33, -v177, v33, v177
v_fma_f32 v34, -v178, v34, v178
ds_read_b64_tr_b16 v[88:89], v9 offset:0
v_fma_f32 v35, -v179, v35, v179
v_cvt_pk_bf16_f32 v158, v32, v33
v_cvt_pk_bf16_f32 v159, v34, v35
v_fma_f32 v28, -v238, v234, v242
v_fma_f32 v29, -v239, v234, v243
v_fma_f32 v30, -v240, v234, v244
v_fma_f32 v31, -v241, v234, v245
s_waitcnt vmcnt(0)
ds_read_b64_tr_b16 v[78:79], v6 offset:2048
v_fma_f32 v160, v160, v229, v28
v_fma_f32 v161, v161, v229, v29
v_fma_f32 v162, v162, v229, v30
v_fma_f32 v163, v163, v229, v31
v_exp_f32 v28, v160
v_exp_f32 v29, v161
v_exp_f32 v30, v162
v_exp_f32 v31, v163
v_fma_f32 v28, v28, s9, s9
v_fma_f32 v29, v29, s9, s9
v_fma_f32 v30, v30, s9, s9
v_fma_f32 v31, v31, s9, s9
v_fma_f32 v28, v28, v28, 0.5
v_fma_f32 v29, v29, v29, 0.5
v_fma_f32 v30, v30, v30, 0.5
v_fma_f32 v31, v31, v31, 0.5
v_rcp_f32 v28, v28
v_rcp_f32 v29, v29
v_rcp_f32 v30, v30
v_rcp_f32 v31, v31
v_fma_f32 v28, -v160, v28, v160
v_fma_f32 v29, -v161, v29, v161
v_fma_f32 v30, -v162, v30, v162
ds_read_b64_tr_b16 v[82:83], v7 offset:2048
v_fma_f32 v31, -v163, v31, v163
v_cvt_pk_bf16_f32 v160, v28, v29
v_cvt_pk_bf16_f32 v161, v30, v31
v_fma_f32 v32, -v246, v234, v250
v_fma_f32 v33, -v247, v234, v251
v_fma_f32 v34, -v248, v234, v252
v_fma_f32 v35, -v249, v234, v253
ds_read_b64_tr_b16 v[86:87], v8 offset:2048
v_fma_f32 v180, v180, v229, v32
v_fma_f32 v181, v181, v229, v33
v_fma_f32 v182, v182, v229, v34
v_fma_f32 v183, v183, v229, v35
v_exp_f32 v32, v180
v_exp_f32 v33, v181
v_exp_f32 v34, v182
v_exp_f32 v35, v183
v_fma_f32 v32, v32, s9, s9
v_fma_f32 v33, v33, s9, s9
v_fma_f32 v34, v34, s9, s9
v_fma_f32 v35, v35, s9, s9
v_fma_f32 v32, v32, v32, 0.5
v_fma_f32 v33, v33, v33, 0.5
v_fma_f32 v34, v34, v34, 0.5
v_fma_f32 v35, v35, v35, 0.5
v_rcp_f32 v32, v32
v_rcp_f32 v33, v33
v_rcp_f32 v34, v34
v_rcp_f32 v35, v35
v_fma_f32 v32, -v180, v32, v180
v_fma_f32 v33, -v181, v33, v181
v_fma_f32 v34, -v182, v34, v182
ds_read_b64_tr_b16 v[90:91], v9 offset:2048
v_fma_f32 v35, -v183, v35, v183
v_cvt_pk_bf16_f32 v162, v32, v33
v_cvt_pk_bf16_f32 v163, v34, v35
ds_read_b32 v27, v21
s_waitcnt lgkmcnt(0)
v_cmp_gt_u32 vcc, 20, v27
s_cbranch_vccnz LwPb2
LrPb2:
v_fma_f32 v28, -v238, v235, v242
v_fma_f32 v29, -v239, v235, v243
v_fma_f32 v30, -v240, v235, v244
v_fma_f32 v31, -v241, v235, v245
s_add_u32 m0, s6, 0
s_mov_b32 s11, 73728
buffer_load_dwordx4 v13, s[52:55], s11 offen lds
v_fma_f32 v164, v164, v230, v28
v_fma_f32 v165, v165, v230, v29
v_fma_f32 v166, v166, v230, v30
v_fma_f32 v167, v167, v230, v31
v_exp_f32 v28, v164
v_exp_f32 v29, v165
v_exp_f32 v30, v166
v_exp_f32 v31, v167
v_fma_f32 v28, v28, s9, s9
v_fma_f32 v29, v29, s9, s9
v_fma_f32 v30, v30, s9, s9
v_fma_f32 v31, v31, s9, s9
ds_write_b128 v16, v[156:159] offset:20480
v_fma_f32 v28, v28, v28, 0.5
v_fma_f32 v29, v29, v29, 0.5
v_fma_f32 v30, v30, v30, 0.5
v_fma_f32 v31, v31, v31, 0.5
v_rcp_f32 v28, v28
v_rcp_f32 v29, v29
v_rcp_f32 v30, v30
v_rcp_f32 v31, v31
v_fma_f32 v28, -v164, v28, v164
v_fma_f32 v29, -v165, v29, v165
v_fma_f32 v30, -v166, v30, v166
buffer_load_dwordx4 v14, s[52:55], s11 offen offset:1024 lds
v_fma_f32 v31, -v167, v31, v167
v_cvt_pk_bf16_f32 v164, v28, v29
v_cvt_pk_bf16_f32 v165, v30, v31
v_fma_f32 v32, -v246, v235, v250
v_fma_f32 v33, -v247, v235, v251
v_fma_f32 v34, -v248, v235, v252
v_fma_f32 v35, -v249, v235, v253
s_add_u32 m0, s6, 2048
s_mov_b32 s11, 92160
buffer_load_dwordx4 v13, s[52:55], s11 offen lds
v_fma_f32 v184, v184, v230, v32
v_fma_f32 v185, v185, v230, v33
v_fma_f32 v186, v186, v230, v34
v_fma_f32 v187, v187, v230, v35
v_exp_f32 v32, v184
v_exp_f32 v33, v185
v_exp_f32 v34, v186
v_exp_f32 v35, v187
v_fma_f32 v32, v32, s9, s9
v_fma_f32 v33, v33, s9, s9
v_fma_f32 v34, v34, s9, s9
v_fma_f32 v35, v35, s9, s9
ds_write_b128 v16, v[160:163] offset:21504
v_fma_f32 v32, v32, v32, 0.5
v_fma_f32 v33, v33, v33, 0.5
v_fma_f32 v34, v34, v34, 0.5
v_fma_f32 v35, v35, v35, 0.5
v_rcp_f32 v32, v32
v_rcp_f32 v33, v33
v_rcp_f32 v34, v34
v_rcp_f32 v35, v35
v_fma_f32 v32, -v184, v32, v184
v_fma_f32 v33, -v185, v33, v185
v_fma_f32 v34, -v186, v34, v186
buffer_load_dwordx4 v14, s[52:55], s11 offen offset:1024 lds
v_fma_f32 v35, -v187, v35, v187
v_cvt_pk_bf16_f32 v166, v32, v33
v_cvt_pk_bf16_f32 v167, v34, v35
v_fma_f32 v28, -v238, v236, v242
v_fma_f32 v29, -v239, v236, v243
v_fma_f32 v30, -v240, v236, v244
v_fma_f32 v31, -v241, v236, v245
v_fma_f32 v168, v168, v231, v28
v_fma_f32 v169, v169, v231, v29
v_fma_f32 v170, v170, v231, v30
v_fma_f32 v171, v171, v231, v31
v_exp_f32 v28, v168
v_exp_f32 v29, v169
v_exp_f32 v30, v170
v_exp_f32 v31, v171
v_fma_f32 v28, v28, s9, s9
v_fma_f32 v29, v29, s9, s9
v_fma_f32 v30, v30, s9, s9
v_fma_f32 v31, v31, s9, s9
ds_write_b128 v16, v[164:167] offset:22528
v_fma_f32 v28, v28, v28, 0.5
v_fma_f32 v29, v29, v29, 0.5
v_fma_f32 v30, v30, v30, 0.5
v_fma_f32 v31, v31, v31, 0.5
v_rcp_f32 v28, v28
v_rcp_f32 v29, v29
v_rcp_f32 v30, v30
v_rcp_f32 v31, v31
v_fma_f32 v28, -v168, v28, v168
v_fma_f32 v29, -v169, v29, v169
v_fma_f32 v30, -v170, v30, v170
v_fma_f32 v31, -v171, v31, v171
v_cvt_pk_bf16_f32 v168, v28, v29
v_cvt_pk_bf16_f32 v169, v30, v31
v_fma_f32 v32, -v246, v236, v250
v_fma_f32 v33, -v247, v236, v251
v_fma_f32 v34, -v248, v236, v252
v_fma_f32 v35, -v249, v236, v253
v_fma_f32 v188, v188, v231, v32
v_fma_f32 v189, v189, v231, v33
v_fma_f32 v190, v190, v231, v34
v_fma_f32 v191, v191, v231, v35
v_exp_f32 v32, v188
v_exp_f32 v33, v189
v_exp_f32 v34, v190
v_exp_f32 v35, v191
v_fma_f32 v32, v32, s9, s9
v_fma_f32 v33, v33, s9, s9
v_fma_f32 v34, v34, s9, s9
v_fma_f32 v35, v35, s9, s9
v_fma_f32 v32, v32, v32, 0.5
v_fma_f32 v33, v33, v33, 0.5
v_fma_f32 v34, v34, v34, 0.5
v_fma_f32 v35, v35, v35, 0.5
v_rcp_f32 v32, v32
v_rcp_f32 v33, v33
v_rcp_f32 v34, v34
v_rcp_f32 v35, v35
v_fma_f32 v32, -v188, v32, v188
v_fma_f32 v33, -v189, v33, v189
v_fma_f32 v34, -v190, v34, v190
v_fma_f32 v35, -v191, v35, v191
v_cvt_pk_bf16_f32 v170, v32, v33
v_cvt_pk_bf16_f32 v171, v34, v35
v_fma_f32 v28, -v238, v237, v242
v_fma_f32 v29, -v239, v237, v243
v_fma_f32 v30, -v240, v237, v244
v_fma_f32 v31, -v241, v237, v245
v_fma_f32 v172, v172, v232, v28
v_fma_f32 v173, v173, v232, v29
v_fma_f32 v174, v174, v232, v30
v_fma_f32 v175, v175, v232, v31
v_exp_f32 v28, v172
v_exp_f32 v29, v173
v_exp_f32 v30, v174
v_exp_f32 v31, v175
v_fma_f32 v28, v28, s9, s9
v_fma_f32 v29, v29, s9, s9
v_fma_f32 v30, v30, s9, s9
v_fma_f32 v31, v31, s9, s9
ds_write_b128 v16, v[168:171] offset:23552
v_fma_f32 v28, v28, v28, 0.5
v_fma_f32 v29, v29, v29, 0.5
v_fma_f32 v30, v30, v30, 0.5
v_fma_f32 v31, v31, v31, 0.5
v_rcp_f32 v28, v28
v_rcp_f32 v29, v29
v_rcp_f32 v30, v30
v_rcp_f32 v31, v31
v_fma_f32 v28, -v172, v28, v172
v_fma_f32 v29, -v173, v29, v173
v_fma_f32 v30, -v174, v30, v174
v_fma_f32 v31, -v175, v31, v175
v_cvt_pk_bf16_f32 v172, v28, v29
v_cvt_pk_bf16_f32 v173, v30, v31
v_fma_f32 v32, -v246, v237, v250
v_fma_f32 v33, -v247, v237, v251
v_fma_f32 v34, -v248, v237, v252
v_fma_f32 v35, -v249, v237, v253
v_fma_f32 v192, v192, v232, v32
v_fma_f32 v193, v193, v232, v33
v_fma_f32 v194, v194, v232, v34
v_fma_f32 v195, v195, v232, v35
v_exp_f32 v32, v192
v_exp_f32 v33, v193
v_exp_f32 v34, v194
v_exp_f32 v35, v195
v_fma_f32 v32, v32, s9, s9
v_fma_f32 v33, v33, s9, s9
v_fma_f32 v34, v34, s9, s9
v_fma_f32 v35, v35, s9, s9
v_fma_f32 v32, v32, v32, 0.5
v_fma_f32 v33, v33, v33, 0.5
v_fma_f32 v34, v34, v34, 0.5
v_fma_f32 v35, v35, v35, 0.5
v_rcp_f32 v32, v32
v_rcp_f32 v33, v33
v_rcp_f32 v34, v34
v_rcp_f32 v35, v35
v_fma_f32 v32, -v192, v32, v192
v_fma_f32 v33, -v193, v33, v193
v_fma_f32 v34, -v194, v34, v194
v_fma_f32 v35, -v195, v35, v195
v_cvt_pk_bf16_f32 v174, v32, v33
v_cvt_pk_bf16_f32 v175, v34, v35
ds_write_b128 v16, v[172:175] offset:24576
v_mov_b32 v240, v196
v_mov_b32 v241, v197
v_mov_b32 v242, v198
v_mov_b32 v243, v199
v_mov_b32 v244, v200
v_mov_b32 v245, v201
v_mov_b32 v246, v202
v_mov_b32 v247, v203
v_mov_b32 v248, v204
v_mov_b32 v249, v205
v_mov_b32 v250, v206
v_mov_b32 v251, v207
s_waitcnt lgkmcnt(0)
v_mov_b32 v24, 4
ds_write_b32 v22, v24
ds_read_b32 v27, v21
s_waitcnt lgkmcnt(0)
v_cmp_gt_u32 vcc, 27, v27
s_cbranch_vccnz LwPc0
LrPc0:
s_add_u32 m0, s20, 49152
s_mov_b32 s11, 0
buffer_load_dwordx4 v15, s[52:55], s11 offen lds
s_add_u32 m0, s20, 53248
s_mov_b32 s11, 73728
buffer_load_dwordx4 v15, s[52:55], s11 offen lds
s_add_u32 m0, s20, 0
s_mov_b32 s11, 147456
buffer_load_dwordx4 v15, s[52:55], s11 offen lds
s_waitcnt vmcnt(0)
v_mov_b32 v24, 5
ds_write_b32 v22, v24
ds_read_b32 v27, v20
s_waitcnt lgkmcnt(0)
v_cmp_gt_u32 vcc, 5, v27
s_cbranch_vccnz LwPd
LrPd:
ds_read_b64_tr_b16 v[92:93], v10 offset:49152
ds_read_b64_tr_b16 v[94:95], v10 offset:51200
ds_read_b128 v[36:39], v2 offset:0
ds_read_b128 v[40:43], v2 offset:1024
ds_read_b128 v[44:47], v2 offset:2048
ds_read_b128 v[48:51], v2 offset:3072
ds_read_b128 v[52:55], v2 offset:4096
s_waitcnt lgkmcnt(5)
v_mov_b32 v24, 6
ds_write_b32 v22, v24
ds_read_b32 v27, v21
s_waitcnt lgkmcnt(0)
v_cmp_gt_u32 vcc, 29, v27
s_cbranch_vccnz LwPc3
LrPc3:
s_add_u32 m0, s6, 4096
s_mov_b32 s11, 147456
buffer_load_dwordx4 v13, s[52:55], s11 offen lds
buffer_load_dwordx4 v14, s[52:55], s11 offen offset:1024 lds
s_add_u32 m0, s6, 6144
s_mov_b32 s11, 165888
buffer_load_dwordx4 v13, s[52:55], s11 offen lds
buffer_load_dwordx4 v14, s[52:55], s11 offen offset:1024 lds
s_add_u32 m0, s20, 16384
s_mov_b32 s11, 221184
buffer_load_dwordx4 v15, s[52:55], s11 offen lds
s_add_u32 m0, s20, 32768
s_mov_b32 s11, 36864
buffer_load_dwordx4 v15, s[52:55], s11 offen lds
s_setprio 1
v_mfma_f32_16x16x32_bf16 v[116:119], v[76:79], v[36:39], 0
ds_read_b64_tr_b16 v[96:97], v6 offset:0
v_mfma_f32_16x16x32_bf16 v[120:123], v[76:79], v[40:43], 0
ds_read_b64_tr_b16 v[100:101], v7 offset:0
v_mfma_f32_16x16x32_bf16 v[124:127], v[76:79], v[44:47], 0
v_mfma_f32_16x16x32_bf16 v[128:131], v[76:79], v[48:51], 0
ds_read_b64_tr_b16 v[104:105], v8 offset:0
v_mfma_f32_16x16x32_bf16 v[132:135], v[76:79], v[52:55], 0
ds_read_b64_tr_b16 v[108:109], v9 offset:0
v_mfma_f32_16x16x32_bf16 v[152:155], v[80:83], v[52:55], 0
ds_read_b64_tr_b16 v[112:113], v10 offset:53248
v_mfma_f32_16x16x32_bf16 v[148:151], v[80:83], v[48:51], 0
ds_read_b64_tr_b16 v[114:115], v10 offset:55296
v_mfma_f32_16x16x32_bf16 v[144:147], v[80:83], v[44:47], 0
v_mfma_f32_16x16x32_bf16 v[140:143], v[80:83], v[40:43], 0
ds_read_b128 v[56:59], v2 offset:5120
s_add_u32 m0, s6, 0
v_mfma_f32_16x16x32_bf16 v[136:139], v[80:83], v[36:39], 0
ds_read_b128 v[60:63], v2 offset:6144
s_mov_b32 s11, 221184
v_mfma_f32_16x16x32_bf16 v[156:159], v[84:87], v[36:39], 0
ds_read_b32 v23, v20
v_mfma_f32_16x16x32_bf16 v[160:163], v[84:87], v[40:43], 0
ds_read_b128 v[64:67], v2 offset:7168
v_mov_b32 v24, 7
v_mfma_f32_16x16x32_bf16 v[164:167], v[84:87], v[44:47], 0
s_waitcnt lgkmcnt(5)
buffer_load_dwordx4 v13, s[52:55], s11 offen lds
v_mfma_f32_16x16x32_bf16 v[168:171], v[84:87], v[48:51], 0
s_waitcnt vmcnt(2) lgkmcnt(4)
ds_write_b32 v22, v24
v_mfma_f32_16x16x32_bf16 v[172:175], v[84:87], v[52:55], 0
ds_read_b64_tr_b16 v[98:99], v6 offset:2048
v_mfma_f32_16x16x32_bf16 v[192:195], v[88:91], v[52:55], 0
ds_read_b64_tr_b16 v[102:103], v7 offset:2048
v_mfma_f32_16x16x32_bf16 v[188:191], v[88:91], v[48:51], 0
ds_read_b64_tr_b16 v[106:107], v8 offset:2048
v_mfma_f32_16x16x32_bf16 v[184:187], v[88:91], v[44:47], 0
buffer_load_dwordx4 v14, s[52:55], s11 offen offset:1024 lds
v_mfma_f32_16x16x32_bf16 v[180:183], v[88:91], v[40:43], 0
ds_read_b64_tr_b16 v[110:111], v9 offset:2048
s_add_u32 m0, s20, 49152
v_mfma_f32_16x16x32_bf16 v[176:179], v[88:91], v[36:39], 0
ds_read_b128 v[68:71], v2 offset:8192
s_waitcnt lgkmcnt(6)
v_cmp_gt_u32 vcc, 6, v23
v_mfma_f32_16x16x32_bf16 v[196:199], v[92:95], v[36:39], 0
ds_read_b128 v[72:75], v2 offset:9216
s_mov_b32 s11, 110592
v_mfma_f32_16x16x32_bf16 v[200:203], v[92:95], v[40:43], 0
s_cbranch_vccnz LwPo0
LrPo0:
v_mfma_f32_16x16x32_bf16 v[204:207], v[92:95], v[44:47], 0
buffer_load_dwordx4 v15, s[52:55], s11 offen lds
v_mfma_f32_16x16x32_bf16 v[208:211], v[92:95], v[48:51], 0
s_add_u32 m0, s6, 2048
s_mov_b32 s11, 239616
v_mfma_f32_16x16x32_bf16 v[212:215], v[92:95], v[52:55], 0
s_waitcnt lgkmcnt(3)
v_mfma_f32_16x16x32_bf16 v[116:119], v[96:99], v[56:59], v[116:119]
ds_read_b64_tr_b16 v[76:77], v6 offset:4096
v_mfma_f32_16x16x32_bf16 v[120:123], v[96:99], v[60:63], v[120:123]
ds_read_b64_tr_b16 v[80:81], v7 offset:4096
v_mfma_f32_16x16x32_bf16 v[124:127], v[96:99], v[64:67], v[124:127]
s_waitcnt lgkmcnt(2)
buffer_load_dwordx4 v13, s[52:55], s11 offen lds
v_mfma_f32_16x16x32_bf16 v[128:131], v[96:99], v[68:71], v[128:131]
ds_read_b64_tr_b16 v[84:85], v8 offset:4096
v_mfma_f32_16x16x32_bf16 v[132:135], v[96:99], v[72:75], v[132:135]
ds_read_b64_tr_b16 v[88:89], v9 offset:4096
v_mfma_f32_16x16x32_bf16 v[152:155], v[100:103], v[72:75], v[152:155]
ds_read_b64_tr_b16 v[92:93], v10 offset:0
v_mfma_f32_16x16x32_bf16 v[148:151], v[100:103], v[68:71], v[148:151]
ds_read_b64_tr_b16 v[94:95], v10 offset:2048
v_mfma_f32_16x16x32_bf16 v[144:147], v[100:103], v[64:67], v[144:147]
buffer_load_dwordx4 v14, s[52:55], s11 offen offset:1024 lds
v_mfma_f32_16x16x32_bf16 v[140:143], v[100:103], v[60:63], v[140:143]
ds_read_b128 v[36:39], v2 offset:10240
s_add_u32 m0, s6, 4096
v_mfma_f32_16x16x32_bf16 v[136:139], v[100:103], v[56:59], v[136:139]
ds_read_b128 v[40:43], v2 offset:11264
s_mov_b32 s11, 36864
v_mfma_f32_16x16x32_bf16 v[156:159], v[104:107], v[56:59], v[156:159]
ds_read_b32 v23, v20
v_mfma_f32_16x16x32_bf16 v[160:163], v[104:107], v[60:63], v[160:163]
ds_read_b128 v[44:47], v2 offset:12288
v_mov_b32 v24, 8
v_mfma_f32_16x16x32_bf16 v[164:167], v[104:107], v[64:67], v[164:167]
s_waitcnt lgkmcnt(5)
buffer_load_dwordx4 v13, s[52:55], s11 offen lds
v_mfma_f32_16x16x32_bf16 v[168:171], v[104:107], v[68:71], v[168:171]
s_waitcnt vmcnt(6) lgkmcnt(4)
ds_write_b32 v22, v24
v_mfma_f32_16x16x32_bf16 v[172:175], v[104:107], v[72:75], v[172:175]
ds_read_b64_tr_b16 v[78:79], v6 offset:6144
v_mfma_f32_16x16x32_bf16 v[192:195], v[108:111], v[72:75], v[192:195]
ds_read_b64_tr_b16 v[82:83], v7 offset:6144
v_mfma_f32_16x16x32_bf16 v[188:191], v[108:111], v[68:71], v[188:191]
ds_read_b64_tr_b16 v[86:87], v8 offset:6144
v_mfma_f32_16x16x32_bf16 v[184:187], v[108:111], v[64:67], v[184:187]
buffer_load_dwordx4 v14, s[52:55], s11 offen offset:1024 lds
v_mfma_f32_16x16x32_bf16 v[180:183], v[108:111], v[60:63], v[180:183]
ds_read_b64_tr_b16 v[90:91], v9 offset:6144
s_add_u32 m0, s20, 53248
v_mfma_f32_16x16x32_bf16 v[176:179], v[108:111], v[56:59], v[176:179]
ds_read_b128 v[48:51], v2 offset:13312
s_waitcnt lgkmcnt(6)
v_cmp_gt_u32 vcc, 7, v23
v_mfma_f32_16x16x32_bf16 v[196:199], v[112:115], v[56:59], v[196:199]
ds_read_b128 v[52:55], v2 offset:14336
s_mov_b32 s11, 184320
v_mfma_f32_16x16x32_bf16 v[200:203], v[112:115], v[60:63], v[200:203]
s_cbranch_vccnz LwPo1
LrPo1:
v_mfma_f32_16x16x32_bf16 v[204:207], v[112:115], v[64:67], v[204:207]
buffer_load_dwordx4 v15, s[52:55], s11 offen lds
v_mfma_f32_16x16x32_bf16 v[208:211], v[112:115], v[68:71], v[208:211]
s_add_u32 m0, s6, 6144
s_mov_b32 s11, 55296
v_mfma_f32_16x16x32_bf16 v[212:215], v[112:115], v[72:75], v[212:215]
s_waitcnt lgkmcnt(3)
v_mfma_f32_16x16x32_bf16 v[116:119], v[76:79], v[36:39], v[116:119]
s_waitcnt vmcnt(6)
ds_read_b64_tr_b16 v[96:97], v6 offset:0
v_mfma_f32_16x16x32_bf16 v[120:123], v[76:79], v[40:43], v[120:123]
ds_read_b64_tr_b16 v[100:101], v7 offset:0
v_mfma_f32_16x16x32_bf16 v[124:127], v[76:79], v[44:47], v[124:127]
s_waitcnt lgkmcnt(2)
buffer_load_dwordx4 v13, s[52:55], s11 offen lds
v_mfma_f32_16x16x32_bf16 v[128:131], v[76:79], v[48:51], v[128:131]
ds_read_b64_tr_b16 v[104:105], v8 offset:0
v_mfma_f32_16x16x32_bf16 v[132:135], v[76:79], v[52:55], v[132:135]
ds_read_b64_tr_b16 v[108:109], v9 offset:0
v_mfma_f32_16x16x32_bf16 v[152:155], v[80:83], v[52:55], v[152:155]
ds_read_b64_tr_b16 v[112:113], v10 offset:16384
v_mfma_f32_16x16x32_bf16 v[148:151], v[80:83], v[48:51], v[148:151]
ds_read_b64_tr_b16 v[114:115], v10 offset:18432
v_mfma_f32_16x16x32_bf16 v[144:147], v[80:83], v[44:47], v[144:147]
buffer_load_dwordx4 v14, s[52:55], s11 offen offset:1024 lds
v_mfma_f32_16x16x32_bf16 v[140:143], v[80:83], v[40:43], v[140:143]
ds_read_b128 v[56:59], v2 offset:15360
s_add_u32 m0, s6, 0
v_mfma_f32_16x16x32_bf16 v[136:139], v[80:83], v[36:39], v[136:139]
ds_read_b128 v[60:63], v2 offset:16384
s_mov_b32 s11, 110592
v_mfma_f32_16x16x32_bf16 v[156:159], v[84:87], v[36:39], v[156:159]
ds_read_b32 v23, v20
v_mfma_f32_16x16x32_bf16 v[160:163], v[84:87], v[40:43], v[160:163]
ds_read_b128 v[64:67], v2 offset:17408
v_mov_b32 v24, 9
v_mfma_f32_16x16x32_bf16 v[164:167], v[84:87], v[44:47], v[164:167]
s_waitcnt lgkmcnt(5)
buffer_load_dwordx4 v13, s[52:55], s11 offen lds
v_mfma_f32_16x16x32_bf16 v[168:171], v[84:87], v[48:51], v[168:171]
s_waitcnt vmcnt(8) lgkmcnt(4)
ds_write_b32 v22, v24
v_mfma_f32_16x16x32_bf16 v[172:175], v[84:87], v[52:55], v[172:175]
s_waitcnt vmcnt(6)
ds_read_b64_tr_b16 v[98:99], v6 offset:2048
v_mfma_f32_16x16x32_bf16 v[192:195], v[88:91], v[52:55], v[192:195]
ds_read_b64_tr_b16 v[102:103], v7 offset:2048
v_mfma_f32_16x16x32_bf16 v[188:191], v[88:91], v[48:51], v[188:191]
ds_read_b64_tr_b16 v[106:107], v8 offset:2048
v_mfma_f32_16x16x32_bf16 v[184:187], v[88:91], v[44:47], v[184:187]
buffer_load_dwordx4 v14, s[52:55], s11 offen offset:1024 lds
v_mfma_f32_16x16x32_bf16 v[180:183], v[88:91], v[40:43], v[180:183]
ds_read_b64_tr_b16 v[110:111], v9 offset:2048
s_add_u32 m0, s20, 0
v_mfma_f32_16x16x32_bf16 v[176:179], v[88:91], v[36:39], v[176:179]
ds_read_b128 v[68:71], v2 offset:18432
s_waitcnt lgkmcnt(6)
v_cmp_gt_u32 vcc, 8, v23
v_mfma_f32_16x16x32_bf16 v[196:199], v[92:95], v[36:39], v[196:199]
ds_read_b128 v[72:75], v2 offset:19456
s_mov_b32 s11, 258048
v_mfma_f32_16x16x32_bf16 v[200:203], v[92:95], v[40:43], v[200:203]
s_cbranch_vccnz LwPo2
LrPo2:
v_mfma_f32_16x16x32_bf16 v[204:207], v[92:95], v[44:47], v[204:207]
buffer_load_dwordx4 v15, s[52:55], s11 offen lds
v_mfma_f32_16x16x32_bf16 v[208:211], v[92:95], v[48:51], v[208:211]
s_add_u32 m0, s6, 2048
s_mov_b32 s11, 129024
v_mfma_f32_16x16x32_bf16 v[212:215], v[92:95], v[52:55], v[212:215]
s_waitcnt lgkmcnt(3)
v_mfma_f32_16x16x32_bf16 v[116:119], v[96:99], v[56:59], v[116:119]
s_waitcnt vmcnt(6)
ds_read_b64_tr_b16 v[76:77], v6 offset:4096
v_mfma_f32_16x16x32_bf16 v[120:123], v[96:99], v[60:63], v[120:123]
ds_read_b64_tr_b16 v[80:81], v7 offset:4096
v_mfma_f32_16x16x32_bf16 v[124:127], v[96:99], v[64:67], v[124:127]
s_waitcnt lgkmcnt(2)
buffer_load_dwordx4 v13, s[52:55], s11 offen lds
v_mfma_f32_16x16x32_bf16 v[128:131], v[96:99], v[68:71], v[128:131]
ds_read_b64_tr_b16 v[84:85], v8 offset:4096
v_mfma_f32_16x16x32_bf16 v[132:135], v[96:99], v[72:75], v[132:135]
ds_read_b64_tr_b16 v[88:89], v9 offset:4096
v_mfma_f32_16x16x32_bf16 v[152:155], v[100:103], v[72:75], v[152:155]
ds_read_b64_tr_b16 v[92:93], v10 offset:32768
v_mfma_f32_16x16x32_bf16 v[148:151], v[100:103], v[68:71], v[148:151]
ds_read_b64_tr_b16 v[94:95], v10 offset:34816
v_mfma_f32_16x16x32_bf16 v[144:147], v[100:103], v[64:67], v[144:147]
buffer_load_dwordx4 v14, s[52:55], s11 offen offset:1024 lds
v_mfma_f32_16x16x32_bf16 v[140:143], v[100:103], v[60:63], v[140:143]
ds_read_b128 v[36:39], v2 offset:20480
s_add_u32 m0, s6, 4096
v_mfma_f32_16x16x32_bf16 v[136:139], v[100:103], v[56:59], v[136:139]
ds_read_b128 v[40:43], v2 offset:21504
s_mov_b32 s11, 184320
v_mfma_f32_16x16x32_bf16 v[156:159], v[104:107], v[56:59], v[156:159]
ds_read_b32 v23, v20
v_mfma_f32_16x16x32_bf16 v[160:163], v[104:107], v[60:63], v[160:163]
ds_read_b128 v[44:47], v2 offset:22528
v_mov_b32 v24, 10
v_mfma_f32_16x16x32_bf16 v[164:167], v[104:107], v[64:67], v[164:167]
s_waitcnt lgkmcnt(5)
buffer_load_dwordx4 v13, s[52:55], s11 offen lds
v_mfma_f32_16x16x32_bf16 v[168:171], v[104:107], v[68:71], v[168:171]
s_waitcnt vmcnt(8) lgkmcnt(4)
ds_write_b32 v22, v24
v_mfma_f32_16x16x32_bf16 v[172:175], v[104:107], v[72:75], v[172:175]
s_waitcnt vmcnt(6)
ds_read_b64_tr_b16 v[78:79], v6 offset:6144
v_mfma_f32_16x16x32_bf16 v[192:195], v[108:111], v[72:75], v[192:195]
ds_read_b64_tr_b16 v[82:83], v7 offset:6144
v_mfma_f32_16x16x32_bf16 v[188:191], v[108:111], v[68:71], v[188:191]
ds_read_b64_tr_b16 v[86:87], v8 offset:6144
v_mfma_f32_16x16x32_bf16 v[184:187], v[108:111], v[64:67], v[184:187]
buffer_load_dwordx4 v14, s[52:55], s11 offen offset:1024 lds
v_mfma_f32_16x16x32_bf16 v[180:183], v[108:111], v[60:63], v[180:183]
ds_read_b64_tr_b16 v[90:91], v9 offset:6144
s_add_u32 m0, s20, 16384
v_mfma_f32_16x16x32_bf16 v[176:179], v[108:111], v[56:59], v[176:179]
ds_read_b128 v[48:51], v2 offset:23552
s_waitcnt lgkmcnt(6)
v_cmp_gt_u32 vcc, 9, v23
v_mfma_f32_16x16x32_bf16 v[196:199], v[112:115], v[56:59], v[196:199]
ds_read_b128 v[52:55], v2 offset:24576
s_mov_b32 s11, 294912
v_mfma_f32_16x16x32_bf16 v[200:203], v[112:115], v[60:63], v[200:203]
s_cbranch_vccnz LwPo3
LrPo3:
v_mfma_f32_16x16x32_bf16 v[204:207], v[112:115], v[64:67], v[204:207]
buffer_load_dwordx4 v15, s[52:55], s11 offen lds
v_mfma_f32_16x16x32_bf16 v[208:211], v[112:115], v[68:71], v[208:211]
s_add_u32 m0, s6, 6144
s_mov_b32 s11, 202752
v_mfma_f32_16x16x32_bf16 v[212:215], v[112:115], v[72:75], v[212:215]
s_waitcnt lgkmcnt(3)
v_mfma_f32_16x16x32_bf16 v[116:119], v[76:79], v[36:39], v[116:119]
s_waitcnt vmcnt(6)
ds_read_b64_tr_b16 v[96:97], v6 offset:0
v_mfma_f32_16x16x32_bf16 v[120:123], v[76:79], v[40:43], v[120:123]
ds_read_b64_tr_b16 v[100:101], v7 offset:0
v_mfma_f32_16x16x32_bf16 v[124:127], v[76:79], v[44:47], v[124:127]
s_waitcnt lgkmcnt(2)
buffer_load_dwordx4 v13, s[52:55], s11 offen lds
v_mfma_f32_16x16x32_bf16 v[128:131], v[76:79], v[48:51], v[128:131]
ds_read_b64_tr_b16 v[104:105], v8 offset:0
v_mfma_f32_16x16x32_bf16 v[132:135], v[76:79], v[52:55], v[132:135]
ds_read_b64_tr_b16 v[108:109], v9 offset:0
v_mfma_f32_16x16x32_bf16 v[152:155], v[80:83], v[52:55], v[152:155]
ds_read_b64_tr_b16 v[112:113], v10 offset:49152
v_mfma_f32_16x16x32_bf16 v[148:151], v[80:83], v[48:51], v[148:151]
ds_read_b64_tr_b16 v[114:115], v10 offset:51200
v_mfma_f32_16x16x32_bf16 v[144:147], v[80:83], v[44:47], v[144:147]
buffer_load_dwordx4 v14, s[52:55], s11 offen offset:1024 lds
v_mfma_f32_16x16x32_bf16 v[140:143], v[80:83], v[40:43], v[140:143]
ds_read_b128 v[56:59], v2 offset:25600
s_add_u32 m0, s6, 0
v_mfma_f32_16x16x32_bf16 v[136:139], v[80:83], v[36:39], v[136:139]
ds_read_b128 v[60:63], v2 offset:26624
s_mov_b32 s11, 258048
v_mfma_f32_16x16x32_bf16 v[156:159], v[84:87], v[36:39], v[156:159]
ds_read_b32 v23, v20
v_mfma_f32_16x16x32_bf16 v[160:163], v[84:87], v[40:43], v[160:163]
ds_read_b128 v[64:67], v2 offset:27648
v_mov_b32 v24, 11
v_mfma_f32_16x16x32_bf16 v[164:167], v[84:87], v[44:47], v[164:167]
s_waitcnt lgkmcnt(5)
buffer_load_dwordx4 v13, s[52:55], s11 offen lds
v_mfma_f32_16x16x32_bf16 v[168:171], v[84:87], v[48:51], v[168:171]
s_waitcnt vmcnt(8) lgkmcnt(4)
ds_write_b32 v22, v24
v_mfma_f32_16x16x32_bf16 v[172:175], v[84:87], v[52:55], v[172:175]
s_waitcnt vmcnt(6)
ds_read_b64_tr_b16 v[98:99], v6 offset:2048
v_mfma_f32_16x16x32_bf16 v[192:195], v[88:91], v[52:55], v[192:195]
ds_read_b64_tr_b16 v[102:103], v7 offset:2048
v_mfma_f32_16x16x32_bf16 v[188:191], v[88:91], v[48:51], v[188:191]
ds_read_b64_tr_b16 v[106:107], v8 offset:2048
v_mfma_f32_16x16x32_bf16 v[184:187], v[88:91], v[44:47], v[184:187]
buffer_load_dwordx4 v14, s[52:55], s11 offen offset:1024 lds
v_mfma_f32_16x16x32_bf16 v[180:183], v[88:91], v[40:43], v[180:183]
ds_read_b64_tr_b16 v[110:111], v9 offset:2048
s_add_u32 m0, s20, 32768
v_mfma_f32_16x16x32_bf16 v[176:179], v[88:91], v[36:39], v[176:179]
ds_read_b128 v[68:71], v2 offset:28672
s_waitcnt lgkmcnt(6)
v_cmp_gt_u32 vcc, 10, v23
v_mfma_f32_16x16x32_bf16 v[196:199], v[92:95], v[36:39], v[196:199]
ds_read_b128 v[72:75], v2 offset:29696
s_mov_b32 s11, 368640
v_mfma_f32_16x16x32_bf16 v[200:203], v[92:95], v[40:43], v[200:203]
s_cbranch_vccnz LwPo4
LrPo4:
v_mfma_f32_16x16x32_bf16 v[204:207], v[92:95], v[44:47], v[204:207]
buffer_load_dwordx4 v15, s[52:55], s11 offen lds
v_mfma_f32_16x16x32_bf16 v[208:211], v[92:95], v[48:51], v[208:211]
s_add_u32 m0, s6, 2048
s_mov_b32 s11, 276480
v_mfma_f32_16x16x32_bf16 v[212:215], v[92:95], v[52:55], v[212:215]
s_waitcnt lgkmcnt(3)
v_mfma_f32_16x16x32_bf16 v[116:119], v[96:99], v[56:59], v[116:119]
s_waitcnt vmcnt(6)
ds_read_b64_tr_b16 v[76:77], v6 offset:4096
v_mfma_f32_16x16x32_bf16 v[120:123], v[96:99], v[60:63], v[120:123]
ds_read_b64_tr_b16 v[80:81], v7 offset:4096
v_mfma_f32_16x16x32_bf16 v[124:127], v[96:99], v[64:67], v[124:127]
s_waitcnt lgkmcnt(2)
buffer_load_dwordx4 v13, s[52:55], s11 offen lds
v_mfma_f32_16x16x32_bf16 v[128:131], v[96:99], v[68:71], v[128:131]
ds_read_b64_tr_b16 v[84:85], v8 offset:4096
v_mfma_f32_16x16x32_bf16 v[132:135], v[96:99], v[72:75], v[132:135]
ds_read_b64_tr_b16 v[88:89], v9 offset:4096
v_mfma_f32_16x16x32_bf16 v[152:155], v[100:103], v[72:75], v[152:155]
ds_read_b64_tr_b16 v[92:93], v10 offset:53248
v_mfma_f32_16x16x32_bf16 v[148:151], v[100:103], v[68:71], v[148:151]
ds_read_b64_tr_b16 v[94:95], v10 offset:55296
v_mfma_f32_16x16x32_bf16 v[144:147], v[100:103], v[64:67], v[144:147]
buffer_load_dwordx4 v14, s[52:55], s11 offen offset:1024 lds
v_mfma_f32_16x16x32_bf16 v[140:143], v[100:103], v[60:63], v[140:143]
ds_read_b128 v[36:39], v2 offset:30720
s_add_u32 m0, s6, 4096
v_mfma_f32_16x16x32_bf16 v[136:139], v[100:103], v[56:59], v[136:139]
ds_read_b128 v[40:43], v2 offset:31744
s_mov_b32 s11, 294912
v_mfma_f32_16x16x32_bf16 v[156:159], v[104:107], v[56:59], v[156:159]
ds_read_b32 v23, v20
v_mfma_f32_16x16x32_bf16 v[160:163], v[104:107], v[60:63], v[160:163]
ds_read_b128 v[44:47], v2 offset:32768
v_mov_b32 v24, 12
v_mfma_f32_16x16x32_bf16 v[164:167], v[104:107], v[64:67], v[164:167]
s_waitcnt lgkmcnt(5)
buffer_load_dwordx4 v13, s[52:55], s11 offen lds
v_mfma_f32_16x16x32_bf16 v[168:171], v[104:107], v[68:71], v[168:171]
s_waitcnt vmcnt(8) lgkmcnt(4)
ds_write_b32 v22, v24
v_mfma_f32_16x16x32_bf16 v[172:175], v[104:107], v[72:75], v[172:175]
s_waitcnt vmcnt(6)
ds_read_b64_tr_b16 v[78:79], v6 offset:6144
v_mfma_f32_16x16x32_bf16 v[192:195], v[108:111], v[72:75], v[192:195]
ds_read_b64_tr_b16 v[82:83], v7 offset:6144
v_mfma_f32_16x16x32_bf16 v[188:191], v[108:111], v[68:71], v[188:191]
ds_read_b64_tr_b16 v[86:87], v8 offset:6144
v_mfma_f32_16x16x32_bf16 v[184:187], v[108:111], v[64:67], v[184:187]
buffer_load_dwordx4 v14, s[52:55], s11 offen offset:1024 lds
v_mfma_f32_16x16x32_bf16 v[180:183], v[108:111], v[60:63], v[180:183]
ds_read_b64_tr_b16 v[90:91], v9 offset:6144
s_add_u32 m0, s20, 49152
v_mfma_f32_16x16x32_bf16 v[176:179], v[108:111], v[56:59], v[176:179]
ds_read_b128 v[48:51], v2 offset:33792
s_waitcnt lgkmcnt(6)
v_cmp_gt_u32 vcc, 11, v23
v_mfma_f32_16x16x32_bf16 v[196:199], v[112:115], v[56:59], v[196:199]
ds_read_b128 v[52:55], v2 offset:34816
s_mov_b32 s11, 442368
v_mfma_f32_16x16x32_bf16 v[200:203], v[112:115], v[60:63], v[200:203]
s_cbranch_vccnz LwPo5
LrPo5:
v_mfma_f32_16x16x32_bf16 v[204:207], v[112:115], v[64:67], v[204:207]
buffer_load_dwordx4 v15, s[52:55], s11 offen lds
v_mfma_f32_16x16x32_bf16 v[208:211], v[112:115], v[68:71], v[208:211]
s_add_u32 m0, s6, 6144
s_mov_b32 s11, 313344
v_mfma_f32_16x16x32_bf16 v[212:215], v[112:115], v[72:75], v[212:215]
s_waitcnt lgkmcnt(3)
v_mfma_f32_16x16x32_bf16 v[116:119], v[76:79], v[36:39], v[116:119]
s_waitcnt vmcnt(6)
ds_read_b64_tr_b16 v[96:97], v6 offset:0
v_mfma_f32_16x16x32_bf16 v[120:123], v[76:79], v[40:43], v[120:123]
ds_read_b64_tr_b16 v[100:101], v7 offset:0
v_mfma_f32_16x16x32_bf16 v[124:127], v[76:79], v[44:47], v[124:127]
s_waitcnt lgkmcnt(2)
buffer_load_dwordx4 v13, s[52:55], s11 offen lds
v_mfma_f32_16x16x32_bf16 v[128:131], v[76:79], v[48:51], v[128:131]
ds_read_b64_tr_b16 v[104:105], v8 offset:0
v_mfma_f32_16x16x32_bf16 v[132:135], v[76:79], v[52:55], v[132:135]
ds_read_b64_tr_b16 v[108:109], v9 offset:0
v_mfma_f32_16x16x32_bf16 v[152:155], v[80:83], v[52:55], v[152:155]
ds_read_b64_tr_b16 v[112:113], v10 offset:0
v_mfma_f32_16x16x32_bf16 v[148:151], v[80:83], v[48:51], v[148:151]
ds_read_b64_tr_b16 v[114:115], v10 offset:2048
v_mfma_f32_16x16x32_bf16 v[144:147], v[80:83], v[44:47], v[144:147]
buffer_load_dwordx4 v14, s[52:55], s11 offen offset:1024 lds
v_mfma_f32_16x16x32_bf16 v[140:143], v[80:83], v[40:43], v[140:143]
ds_read_b128 v[56:59], v2 offset:35840
s_add_u32 m0, s6, 0
v_mfma_f32_16x16x32_bf16 v[136:139], v[80:83], v[36:39], v[136:139]
ds_read_b128 v[60:63], v2 offset:36864
s_mov_b32 s11, 368640
v_mfma_f32_16x16x32_bf16 v[156:159], v[84:87], v[36:39], v[156:159]
ds_read_b32 v23, v20
v_mfma_f32_16x16x32_bf16 v[160:163], v[84:87], v[40:43], v[160:163]
ds_read_b128 v[64:67], v2 offset:37888
v_mov_b32 v24, 13
v_mfma_f32_16x16x32_bf16 v[164:167], v[84:87], v[44:47], v[164:167]
s_waitcnt lgkmcnt(5)
buffer_load_dwordx4 v13, s[52:55], s11 offen lds
v_mfma_f32_16x16x32_bf16 v[168:171], v[84:87], v[48:51], v[168:171]
s_waitcnt vmcnt(8) lgkmcnt(4)
ds_write_b32 v22, v24
v_mfma_f32_16x16x32_bf16 v[172:175], v[84:87], v[52:55], v[172:175]
s_waitcnt vmcnt(6)
ds_read_b64_tr_b16 v[98:99], v6 offset:2048
v_mfma_f32_16x16x32_bf16 v[192:195], v[88:91], v[52:55], v[192:195]
ds_read_b64_tr_b16 v[102:103], v7 offset:2048
v_mfma_f32_16x16x32_bf16 v[188:191], v[88:91], v[48:51], v[188:191]
ds_read_b64_tr_b16 v[106:107], v8 offset:2048
v_mfma_f32_16x16x32_bf16 v[184:187], v[88:91], v[44:47], v[184:187]
buffer_load_dwordx4 v14, s[52:55], s11 offen offset:1024 lds
v_mfma_f32_16x16x32_bf16 v[180:183], v[88:91], v[40:43], v[180:183]
ds_read_b64_tr_b16 v[110:111], v9 offset:2048
s_add_u32 m0, s20, 53248
v_mfma_f32_16x16x32_bf16 v[176:179], v[88:91], v[36:39], v[176:179]
ds_read_b128 v[68:71], v2 offset:38912
s_waitcnt lgkmcnt(6)
v_cmp_gt_u32 vcc, 12, v23
v_mfma_f32_16x16x32_bf16 v[196:199], v[92:95], v[36:39], v[196:199]
ds_read_b128 v[72:75], v2 offset:39936
s_mov_b32 s11, 516096
v_mfma_f32_16x16x32_bf16 v[200:203], v[92:95], v[40:43], v[200:203]
s_cbranch_vccnz LwPo6
LrPo6:
ds_read_b32 v27, v21
v_mfma_f32_16x16x32_bf16 v[204:207], v[92:95], v[44:47], v[204:207]
buffer_load_dwordx4 v15, s[52:55], s11 offen lds
v_mfma_f32_16x16x32_bf16 v[208:211], v[92:95], v[48:51], v[208:211]
s_add_u32 m0, s6, 2048
s_mov_b32 s11, 387072
v_mfma_f32_16x16x32_bf16 v[212:215], v[92:95], v[52:55], v[212:215]
s_waitcnt lgkmcnt(4)
v_mfma_f32_16x16x32_bf16 v[116:119], v[96:99], v[56:59], v[116:119]
s_waitcnt vmcnt(6)
ds_read_b64_tr_b16 v[76:77], v6 offset:4096
v_mfma_f32_16x16x32_bf16 v[120:123], v[96:99], v[60:63], v[120:123]
ds_read_b64_tr_b16 v[80:81], v7 offset:4096
v_mfma_f32_16x16x32_bf16 v[124:127], v[96:99], v[64:67], v[124:127]
s_waitcnt lgkmcnt(3)
buffer_load_dwordx4 v13, s[52:55], s11 offen lds
v_mfma_f32_16x16x32_bf16 v[128:131], v[96:99], v[68:71], v[128:131]
ds_read_b64_tr_b16 v[84:85], v8 offset:4096
s_waitcnt lgkmcnt(3)
v_cmp_gt_u32 vcc, 31, v27
v_mfma_f32_16x16x32_bf16 v[132:135], v[96:99], v[72:75], v[132:135]
ds_read_b64_tr_b16 v[88:89], v9 offset:4096
v_mfma_f32_16x16x32_bf16 v[152:155], v[100:103], v[72:75], v[152:155]
s_cbranch_vccnz LwPg25
LrPg25:
ds_read_b64_tr_b16 v[92:93], v10 offset:16384
v_mfma_f32_16x16x32_bf16 v[148:151], v[100:103], v[68:71], v[148:151]
ds_read_b64_tr_b16 v[94:95], v10 offset:18432
v_mfma_f32_16x16x32_bf16 v[144:147], v[100:103], v[64:67], v[144:147]
buffer_load_dwordx4 v14, s[52:55], s11 offen offset:1024 lds
v_mfma_f32_16x16x32_bf16 v[140:143], v[100:103], v[60:63], v[140:143]
ds_read_b128 v[36:39], v2 offset:40960
s_add_u32 m0, s6, 4096
v_mfma_f32_16x16x32_bf16 v[136:139], v[100:103], v[56:59], v[136:139]
ds_read_b128 v[40:43], v2 offset:41984
s_mov_b32 s11, 442368
v_mfma_f32_16x16x32_bf16 v[156:159], v[104:107], v[56:59], v[156:159]
ds_read_b32 v23, v20
v_mfma_f32_16x16x32_bf16 v[160:163], v[104:107], v[60:63], v[160:163]
ds_read_b128 v[44:47], v2 offset:43008
v_mov_b32 v24, 14
v_mfma_f32_16x16x32_bf16 v[164:167], v[104:107], v[64:67], v[164:167]
s_waitcnt lgkmcnt(5)
buffer_load_dwordx4 v13, s[52:55], s11 offen lds
v_mfma_f32_16x16x32_bf16 v[168:171], v[104:107], v[68:71], v[168:171]
s_waitcnt vmcnt(8) lgkmcnt(4)
ds_write_b32 v22, v24
v_mfma_f32_16x16x32_bf16 v[172:175], v[104:107], v[72:75], v[172:175]
s_waitcnt vmcnt(6)
ds_read_b64_tr_b16 v[78:79], v6 offset:6144
v_mfma_f32_16x16x32_bf16 v[192:195], v[108:111], v[72:75], v[192:195]
ds_read_b64_tr_b16 v[82:83], v7 offset:6144
v_mfma_f32_16x16x32_bf16 v[188:191], v[108:111], v[68:71], v[188:191]
ds_read_b64_tr_b16 v[86:87], v8 offset:6144
v_mfma_f32_16x16x32_bf16 v[184:187], v[108:111], v[64:67], v[184:187]
buffer_load_dwordx4 v14, s[52:55], s11 offen offset:1024 lds
v_mfma_f32_16x16x32_bf16 v[180:183], v[108:111], v[60:63], v[180:183]
ds_read_b64_tr_b16 v[90:91], v9 offset:6144
s_add_u32 m0, s20, 0
v_mfma_f32_16x16x32_bf16 v[176:179], v[108:111], v[56:59], v[176:179]
ds_read_b128 v[48:51], v2 offset:44032
s_waitcnt lgkmcnt(6)
v_cmp_gt_u32 vcc, 13, v23
v_mfma_f32_16x16x32_bf16 v[196:199], v[112:115], v[56:59], v[196:199]
ds_read_b128 v[52:55], v2 offset:45056
s_mov_b32 s11, 331776
v_mfma_f32_16x16x32_bf16 v[200:203], v[112:115], v[60:63], v[200:203]
s_cbranch_vccnz LwPo7
LrPo7:
v_mfma_f32_16x16x32_bf16 v[204:207], v[112:115], v[64:67], v[204:207]
buffer_load_dwordx4 v15, s[52:55], s11 offen lds
v_mfma_f32_16x16x32_bf16 v[208:211], v[112:115], v[68:71], v[208:211]
s_add_u32 m0, s6, 6144
s_mov_b32 s11, 460800
v_mfma_f32_16x16x32_bf16 v[212:215], v[112:115], v[72:75], v[212:215]
s_waitcnt lgkmcnt(3)
v_mfma_f32_16x16x32_bf16 v[116:119], v[76:79], v[36:39], v[116:119]
s_waitcnt vmcnt(6)
ds_read_b64_tr_b16 v[96:97], v6 offset:0
v_mfma_f32_16x16x32_bf16 v[120:123], v[76:79], v[40:43], v[120:123]
ds_read_b64_tr_b16 v[100:101], v7 offset:0
v_mfma_f32_16x16x32_bf16 v[124:127], v[76:79], v[44:47], v[124:127]
s_waitcnt lgkmcnt(2)
buffer_load_dwordx4 v13, s[52:55], s11 offen lds
v_mfma_f32_16x16x32_bf16 v[128:131], v[76:79], v[48:51], v[128:131]
ds_read_b64_tr_b16 v[104:105], v8 offset:0
v_mfma_f32_16x16x32_bf16 v[132:135], v[76:79], v[52:55], v[132:135]
ds_read_b64_tr_b16 v[108:109], v9 offset:0
v_mfma_f32_16x16x32_bf16 v[152:155], v[80:83], v[52:55], v[152:155]
ds_read_b64_tr_b16 v[112:113], v10 offset:32768
v_mfma_f32_16x16x32_bf16 v[148:151], v[80:83], v[48:51], v[148:151]
ds_read_b64_tr_b16 v[114:115], v10 offset:34816
v_mfma_f32_16x16x32_bf16 v[144:147], v[80:83], v[44:47], v[144:147]
buffer_load_dwordx4 v14, s[52:55], s11 offen offset:1024 lds
v_mfma_f32_16x16x32_bf16 v[140:143], v[80:83], v[40:43], v[140:143]
ds_read_b128 v[56:59], v3 offset:0
s_add_u32 m0, s6, 0
v_mfma_f32_16x16x32_bf16 v[136:139], v[80:83], v[36:39], v[136:139]
ds_read_b128 v[60:63], v3 offset:1024
s_mov_b32 s11, 516096
v_mfma_f32_16x16x32_bf16 v[156:159], v[84:87], v[36:39], v[156:159]
ds_read_b32 v23, v20
v_mfma_f32_16x16x32_bf16 v[160:163], v[84:87], v[40:43], v[160:163]
ds_read_b128 v[64:67], v3 offset:2048
v_mov_b32 v24, 15
v_mfma_f32_16x16x32_bf16 v[164:167], v[84:87], v[44:47], v[164:167]
s_waitcnt lgkmcnt(5)
buffer_load_dwordx4 v13, s[52:55], s11 offen lds
v_mfma_f32_16x16x32_bf16 v[168:171], v[84:87], v[48:51], v[168:171]
s_waitcnt vmcnt(8) lgkmcnt(4)
ds_write_b32 v22, v24
v_mfma_f32_16x16x32_bf16 v[172:175], v[84:87], v[52:55], v[172:175]
s_waitcnt vmcnt(6)
ds_read_b64_tr_b16 v[98:99], v6 offset:2048
v_mfma_f32_16x16x32_bf16 v[192:195], v[88:91], v[52:55], v[192:195]
ds_read_b64_tr_b16 v[102:103], v7 offset:2048
v_mfma_f32_16x16x32_bf16 v[188:191], v[88:91], v[48:51], v[188:191]
ds_read_b64_tr_b16 v[106:107], v8 offset:2048
v_mfma_f32_16x16x32_bf16 v[184:187], v[88:91], v[44:47], v[184:187]
buffer_load_dwordx4 v14, s[52:55], s11 offen offset:1024 lds
v_mfma_f32_16x16x32_bf16 v[180:183], v[88:91], v[40:43], v[180:183]
ds_read_b64_tr_b16 v[110:111], v9 offset:2048
s_add_u32 m0, s20, 16384
v_mfma_f32_16x16x32_bf16 v[176:179], v[88:91], v[36:39], v[176:179]
ds_read_b128 v[68:71], v3 offset:3072
s_waitcnt lgkmcnt(6)
v_cmp_gt_u32 vcc, 14, v23
v_mfma_f32_16x16x32_bf16 v[196:199], v[92:95], v[36:39], v[196:199]
ds_read_b128 v[72:75], v3 offset:4096
s_mov_b32 s11, 405504
v_mfma_f32_16x16x32_bf16 v[200:203], v[92:95], v[40:43], v[200:203]
s_cbranch_vccnz LwPo8
LrPo8:
v_mfma_f32_16x16x32_bf16 v[204:207], v[92:95], v[44:47], v[204:207]
buffer_load_dwordx4 v15, s[52:55], s11 offen lds
v_mfma_f32_16x16x32_bf16 v[208:211], v[92:95], v[48:51], v[208:211]
s_add_u32 m0, s6, 2048
s_mov_b32 s11, 534528
v_mfma_f32_16x16x32_bf16 v[212:215], v[92:95], v[52:55], v[212:215]
s_waitcnt lgkmcnt(3)
v_mfma_f32_16x16x32_bf16 v[116:119], v[96:99], v[56:59], v[116:119]
s_waitcnt vmcnt(6)
ds_read_b64_tr_b16 v[76:77], v6 offset:4096
v_mfma_f32_16x16x32_bf16 v[120:123], v[96:99], v[60:63], v[120:123]
ds_read_b64_tr_b16 v[80:81], v7 offset:4096
v_mfma_f32_16x16x32_bf16 v[124:127], v[96:99], v[64:67], v[124:127]
s_waitcnt lgkmcnt(2)
buffer_load_dwordx4 v13, s[52:55], s11 offen lds
v_mfma_f32_16x16x32_bf16 v[128:131], v[96:99], v[68:71], v[128:131]
ds_read_b64_tr_b16 v[84:85], v8 offset:4096
v_mfma_f32_16x16x32_bf16 v[132:135], v[96:99], v[72:75], v[132:135]
ds_read_b64_tr_b16 v[88:89], v9 offset:4096
v_mfma_f32_16x16x32_bf16 v[152:155], v[100:103], v[72:75], v[152:155]
ds_read_b64_tr_b16 v[92:93], v10 offset:49152
v_mfma_f32_16x16x32_bf16 v[148:151], v[100:103], v[68:71], v[148:151]
ds_read_b64_tr_b16 v[94:95], v10 offset:51200
v_mfma_f32_16x16x32_bf16 v[144:147], v[100:103], v[64:67], v[144:147]
buffer_load_dwordx4 v14, s[52:55], s11 offen offset:1024 lds
v_mfma_f32_16x16x32_bf16 v[140:143], v[100:103], v[60:63], v[140:143]
ds_read_b128 v[36:39], v3 offset:5120
s_add_u32 m0, s6, 4096
v_mfma_f32_16x16x32_bf16 v[136:139], v[100:103], v[56:59], v[136:139]
ds_read_b128 v[40:43], v3 offset:6144
s_mov_b32 s11, 331776
v_mfma_f32_16x16x32_bf16 v[156:159], v[104:107], v[56:59], v[156:159]
ds_read_b32 v23, v20
v_mfma_f32_16x16x32_bf16 v[160:163], v[104:107], v[60:63], v[160:163]
ds_read_b128 v[44:47], v3 offset:7168
v_mov_b32 v24, 16
v_mfma_f32_16x16x32_bf16 v[164:167], v[104:107], v[64:67], v[164:167]
s_waitcnt lgkmcnt(5)
buffer_load_dwordx4 v13, s[52:55], s11 offen lds
v_mfma_f32_16x16x32_bf16 v[168:171], v[104:107], v[68:71], v[168:171]
s_waitcnt vmcnt(8) lgkmcnt(4)
ds_write_b32 v22, v24
v_mfma_f32_16x16x32_bf16 v[172:175], v[104:107], v[72:75], v[172:175]
s_waitcnt vmcnt(6)
ds_read_b64_tr_b16 v[78:79], v6 offset:6144
v_mfma_f32_16x16x32_bf16 v[192:195], v[108:111], v[72:75], v[192:195]
ds_read_b64_tr_b16 v[82:83], v7 offset:6144
v_mfma_f32_16x16x32_bf16 v[188:191], v[108:111], v[68:71], v[188:191]
ds_read_b64_tr_b16 v[86:87], v8 offset:6144
v_mfma_f32_16x16x32_bf16 v[184:187], v[108:111], v[64:67], v[184:187]
buffer_load_dwordx4 v14, s[52:55], s11 offen offset:1024 lds
v_mfma_f32_16x16x32_bf16 v[180:183], v[108:111], v[60:63], v[180:183]
ds_read_b64_tr_b16 v[90:91], v9 offset:6144
s_add_u32 m0, s20, 32768
v_mfma_f32_16x16x32_bf16 v[176:179], v[108:111], v[56:59], v[176:179]
ds_read_b128 v[48:51], v3 offset:8192
s_waitcnt lgkmcnt(6)
v_cmp_gt_u32 vcc, 15, v23
v_mfma_f32_16x16x32_bf16 v[196:199], v[112:115], v[56:59], v[196:199]
ds_read_b128 v[52:55], v3 offset:9216
s_mov_b32 s11, 479232
v_mfma_f32_16x16x32_bf16 v[200:203], v[112:115], v[60:63], v[200:203]
s_cbranch_vccnz LwPo9
LrPo9:
v_mfma_f32_16x16x32_bf16 v[204:207], v[112:115], v[64:67], v[204:207]
buffer_load_dwordx4 v15, s[52:55], s11 offen lds
v_mfma_f32_16x16x32_bf16 v[208:211], v[112:115], v[68:71], v[208:211]
s_add_u32 m0, s6, 6144
s_mov_b32 s11, 350208
v_mfma_f32_16x16x32_bf16 v[212:215], v[112:115], v[72:75], v[212:215]
s_waitcnt lgkmcnt(3)
v_mfma_f32_16x16x32_bf16 v[116:119], v[76:79], v[36:39], v[116:119]
s_waitcnt vmcnt(6)
ds_read_b64_tr_b16 v[96:97], v6 offset:0
v_mfma_f32_16x16x32_bf16 v[120:123], v[76:79], v[40:43], v[120:123]
ds_read_b64_tr_b16 v[100:101], v7 offset:0
v_mfma_f32_16x16x32_bf16 v[124:127], v[76:79], v[44:47], v[124:127]
s_waitcnt lgkmcnt(2)
buffer_load_dwordx4 v13, s[52:55], s11 offen lds
v_mfma_f32_16x16x32_bf16 v[128:131], v[76:79], v[48:51], v[128:131]
ds_read_b64_tr_b16 v[104:105], v8 offset:0
v_mfma_f32_16x16x32_bf16 v[132:135], v[76:79], v[52:55], v[132:135]
ds_read_b64_tr_b16 v[108:109], v9 offset:0
v_mfma_f32_16x16x32_bf16 v[152:155], v[80:83], v[52:55], v[152:155]
ds_read_b64_tr_b16 v[112:113], v10 offset:53248
v_mfma_f32_16x16x32_bf16 v[148:151], v[80:83], v[48:51], v[148:151]
ds_read_b64_tr_b16 v[114:115], v10 offset:55296
v_mfma_f32_16x16x32_bf16 v[144:147], v[80:83], v[44:47], v[144:147]
buffer_load_dwordx4 v14, s[52:55], s11 offen offset:1024 lds
v_mfma_f32_16x16x32_bf16 v[140:143], v[80:83], v[40:43], v[140:143]
ds_read_b128 v[56:59], v3 offset:10240
s_add_u32 m0, s6, 0
v_mfma_f32_16x16x32_bf16 v[136:139], v[80:83], v[36:39], v[136:139]
ds_read_b128 v[60:63], v3 offset:11264
s_mov_b32 s11, 405504
v_mfma_f32_16x16x32_bf16 v[156:159], v[84:87], v[36:39], v[156:159]
ds_read_b32 v23, v20
v_mfma_f32_16x16x32_bf16 v[160:163], v[84:87], v[40:43], v[160:163]
ds_read_b128 v[64:67], v3 offset:12288
v_mov_b32 v24, 17
v_mfma_f32_16x16x32_bf16 v[164:167], v[84:87], v[44:47], v[164:167]
s_waitcnt lgkmcnt(5)
buffer_load_dwordx4 v13, s[52:55], s11 offen lds
v_mfma_f32_16x16x32_bf16 v[168:171], v[84:87], v[48:51], v[168:171]
s_waitcnt vmcnt(8) lgkmcnt(4)
ds_write_b32 v22, v24
v_mfma_f32_16x16x32_bf16 v[172:175], v[84:87], v[52:55], v[172:175]
s_waitcnt vmcnt(6)
ds_read_b64_tr_b16 v[98:99], v6 offset:2048
v_mfma_f32_16x16x32_bf16 v[192:195], v[88:91], v[52:55], v[192:195]
ds_read_b64_tr_b16 v[102:103], v7 offset:2048
v_mfma_f32_16x16x32_bf16 v[188:191], v[88:91], v[48:51], v[188:191]
ds_read_b64_tr_b16 v[106:107], v8 offset:2048
v_mfma_f32_16x16x32_bf16 v[184:187], v[88:91], v[44:47], v[184:187]
buffer_load_dwordx4 v14, s[52:55], s11 offen offset:1024 lds
v_mfma_f32_16x16x32_bf16 v[180:183], v[88:91], v[40:43], v[180:183]
ds_read_b64_tr_b16 v[110:111], v9 offset:2048
s_add_u32 m0, s20, 49152
v_mfma_f32_16x16x32_bf16 v[176:179], v[88:91], v[36:39], v[176:179]
ds_read_b128 v[68:71], v3 offset:13312
s_waitcnt lgkmcnt(6)
v_cmp_gt_u32 vcc, 16, v23
v_mfma_f32_16x16x32_bf16 v[196:199], v[92:95], v[36:39], v[196:199]
ds_read_b128 v[72:75], v3 offset:14336
s_mov_b32 s11, 552960
v_mfma_f32_16x16x32_bf16 v[200:203], v[92:95], v[40:43], v[200:203]
s_cbranch_vccnz LwPo10
LrPo10:
ds_read_b32 v27, v21
v_mfma_f32_16x16x32_bf16 v[204:207], v[92:95], v[44:47], v[204:207]
buffer_load_dwordx4 v15, s[52:55], s11 offen lds
v_mfma_f32_16x16x32_bf16 v[208:211], v[92:95], v[48:51], v[208:211]
s_add_u32 m0, s6, 2048
s_mov_b32 s11, 423936
v_mfma_f32_16x16x32_bf16 v[212:215], v[92:95], v[52:55], v[212:215]
s_waitcnt lgkmcnt(4)
v_mfma_f32_16x16x32_bf16 v[116:119], v[96:99], v[56:59], v[116:119]
s_waitcnt vmcnt(6)
ds_read_b64_tr_b16 v[76:77], v6 offset:4096
v_mfma_f32_16x16x32_bf16 v[120:123], v[96:99], v[60:63], v[120:123]
ds_read_b64_tr_b16 v[80:81], v7 offset:4096
v_mfma_f32_16x16x32_bf16 v[124:127], v[96:99], v[64:67], v[124:127]
s_waitcnt lgkmcnt(3)
buffer_load_dwordx4 v13, s[52:55], s11 offen lds
v_mfma_f32_16x16x32_bf16 v[128:131], v[96:99], v[68:71], v[128:131]
ds_read_b64_tr_b16 v[84:85], v8 offset:4096
s_waitcnt lgkmcnt(3)
v_cmp_gt_u32 vcc, 32, v27
v_mfma_f32_16x16x32_bf16 v[132:135], v[96:99], v[72:75], v[132:135]
ds_read_b64_tr_b16 v[88:89], v9 offset:4096
v_mfma_f32_16x16x32_bf16 v[152:155], v[100:103], v[72:75], v[152:155]
s_cbranch_vccnz LwPg29
LrPg29:
ds_read_b64_tr_b16 v[92:93], v10 offset:0
v_mfma_f32_16x16x32_bf16 v[148:151], v[100:103], v[68:71], v[148:151]
ds_read_b64_tr_b16 v[94:95], v10 offset:2048
v_mfma_f32_16x16x32_bf16 v[144:147], v[100:103], v[64:67], v[144:147]
buffer_load_dwordx4 v14, s[52:55], s11 offen offset:1024 lds
v_mfma_f32_16x16x32_bf16 v[140:143], v[100:103], v[60:63], v[140:143]
ds_read_b128 v[36:39], v3 offset:15360
s_add_u32 m0, s6, 4096
v_mfma_f32_16x16x32_bf16 v[136:139], v[100:103], v[56:59], v[136:139]
ds_read_b128 v[40:43], v3 offset:16384
s_mov_b32 s11, 479232
v_mfma_f32_16x16x32_bf16 v[156:159], v[104:107], v[56:59], v[156:159]
ds_read_b32 v23, v20
v_mfma_f32_16x16x32_bf16 v[160:163], v[104:107], v[60:63], v[160:163]
ds_read_b128 v[44:47], v3 offset:17408
v_mov_b32 v24, 18
v_mfma_f32_16x16x32_bf16 v[164:167], v[104:107], v[64:67], v[164:167]
s_waitcnt lgkmcnt(5)
buffer_load_dwordx4 v13, s[52:55], s11 offen lds
v_mfma_f32_16x16x32_bf16 v[168:171], v[104:107], v[68:71], v[168:171]
s_waitcnt vmcnt(8) lgkmcnt(4)
ds_write_b32 v22, v24
v_mfma_f32_16x16x32_bf16 v[172:175], v[104:107], v[72:75], v[172:175]
s_waitcnt vmcnt(6)
ds_read_b64_tr_b16 v[78:79], v6 offset:6144
v_mfma_f32_16x16x32_bf16 v[192:195], v[108:111], v[72:75], v[192:195]
ds_read_b64_tr_b16 v[82:83], v7 offset:6144
v_mfma_f32_16x16x32_bf16 v[188:191], v[108:111], v[68:71], v[188:191]
ds_read_b64_tr_b16 v[86:87], v8 offset:6144
v_mfma_f32_16x16x32_bf16 v[184:187], v[108:111], v[64:67], v[184:187]
buffer_load_dwordx4 v14, s[52:55], s11 offen offset:1024 lds
v_mfma_f32_16x16x32_bf16 v[180:183], v[108:111], v[60:63], v[180:183]
ds_read_b64_tr_b16 v[90:91], v9 offset:6144
s_add_u32 m0, s20, 53248
v_mfma_f32_16x16x32_bf16 v[176:179], v[108:111], v[56:59], v[176:179]
ds_read_b128 v[48:51], v3 offset:18432
s_waitcnt lgkmcnt(6)
v_cmp_gt_u32 vcc, 17, v23
v_mfma_f32_16x16x32_bf16 v[196:199], v[112:115], v[56:59], v[196:199]
ds_read_b128 v[52:55], v3 offset:19456
s_mov_b32 s11, 589824
v_mfma_f32_16x16x32_bf16 v[200:203], v[112:115], v[60:63], v[200:203]
s_cbranch_vccnz LwPo11
LrPo11:
v_mfma_f32_16x16x32_bf16 v[204:207], v[112:115], v[64:67], v[204:207]
buffer_load_dwordx4 v15, s[52:55], s11 offen lds
v_mfma_f32_16x16x32_bf16 v[208:211], v[112:115], v[68:71], v[208:211]
s_add_u32 m0, s6, 6144
s_mov_b32 s11, 497664
v_mfma_f32_16x16x32_bf16 v[212:215], v[112:115], v[72:75], v[212:215]
s_waitcnt lgkmcnt(3)
v_mfma_f32_16x16x32_bf16 v[116:119], v[76:79], v[36:39], v[116:119]
s_waitcnt vmcnt(6)
ds_read_b64_tr_b16 v[96:97], v6 offset:0
v_mfma_f32_16x16x32_bf16 v[120:123], v[76:79], v[40:43], v[120:123]
ds_read_b64_tr_b16 v[100:101], v7 offset:0
v_mfma_f32_16x16x32_bf16 v[124:127], v[76:79], v[44:47], v[124:127]
s_waitcnt lgkmcnt(2)
buffer_load_dwordx4 v13, s[52:55], s11 offen lds
v_mfma_f32_16x16x32_bf16 v[128:131], v[76:79], v[48:51], v[128:131]
ds_read_b64_tr_b16 v[104:105], v8 offset:0
v_mfma_f32_16x16x32_bf16 v[132:135], v[76:79], v[52:55], v[132:135]
ds_read_b64_tr_b16 v[108:109], v9 offset:0
v_mfma_f32_16x16x32_bf16 v[152:155], v[80:83], v[52:55], v[152:155]
ds_read_b64_tr_b16 v[112:113], v10 offset:16384
v_mfma_f32_16x16x32_bf16 v[148:151], v[80:83], v[48:51], v[148:151]
ds_read_b64_tr_b16 v[114:115], v10 offset:18432
v_mfma_f32_16x16x32_bf16 v[144:147], v[80:83], v[44:47], v[144:147]
buffer_load_dwordx4 v14, s[52:55], s11 offen offset:1024 lds
v_mfma_f32_16x16x32_bf16 v[140:143], v[80:83], v[40:43], v[140:143]
ds_read_b128 v[56:59], v3 offset:20480
s_add_u32 m0, s6, 0
v_mfma_f32_16x16x32_bf16 v[136:139], v[80:83], v[36:39], v[136:139]
ds_read_b128 v[60:63], v3 offset:21504
s_mov_b32 s11, 552960
v_mfma_f32_16x16x32_bf16 v[156:159], v[84:87], v[36:39], v[156:159]
ds_read_b32 v23, v20
v_mfma_f32_16x16x32_bf16 v[160:163], v[84:87], v[40:43], v[160:163]
ds_read_b128 v[64:67], v3 offset:22528
v_mov_b32 v24, 19
v_mfma_f32_16x16x32_bf16 v[164:167], v[84:87], v[44:47], v[164:167]
s_waitcnt lgkmcnt(5)
buffer_load_dwordx4 v13, s[52:55], s11 offen lds
v_mfma_f32_16x16x32_bf16 v[168:171], v[84:87], v[48:51], v[168:171]
s_waitcnt vmcnt(8) lgkmcnt(4)
ds_write_b32 v22, v24
v_mfma_f32_16x16x32_bf16 v[172:175], v[84:87], v[52:55], v[172:175]
s_waitcnt vmcnt(6)
ds_read_b64_tr_b16 v[98:99], v6 offset:2048
v_mfma_f32_16x16x32_bf16 v[192:195], v[88:91], v[52:55], v[192:195]
ds_read_b64_tr_b16 v[102:103], v7 offset:2048
v_mfma_f32_16x16x32_bf16 v[188:191], v[88:91], v[48:51], v[188:191]
ds_read_b64_tr_b16 v[106:107], v8 offset:2048
v_mfma_f32_16x16x32_bf16 v[184:187], v[88:91], v[44:47], v[184:187]
buffer_load_dwordx4 v14, s[52:55], s11 offen offset:1024 lds
v_mfma_f32_16x16x32_bf16 v[180:183], v[88:91], v[40:43], v[180:183]
ds_read_b64_tr_b16 v[110:111], v9 offset:2048
s_add_u32 m0, s20, 0
v_mfma_f32_16x16x32_bf16 v[176:179], v[88:91], v[36:39], v[176:179]
ds_read_b128 v[68:71], v3 offset:23552
s_waitcnt lgkmcnt(6)
v_cmp_gt_u32 vcc, 18, v23
v_mfma_f32_16x16x32_bf16 v[196:199], v[92:95], v[36:39], v[196:199]
ds_read_b128 v[72:75], v3 offset:24576
s_mov_b32 s11, 626688
v_mfma_f32_16x16x32_bf16 v[200:203], v[92:95], v[40:43], v[200:203]
s_cbranch_vccnz LwPo12
LrPo12:
v_mfma_f32_16x16x32_bf16 v[204:207], v[92:95], v[44:47], v[204:207]
buffer_load_dwordx4 v15, s[52:55], s11 offen lds
v_mfma_f32_16x16x32_bf16 v[208:211], v[92:95], v[48:51], v[208:211]
s_add_u32 m0, s6, 2048
s_mov_b32 s11, 571392
v_mfma_f32_16x16x32_bf16 v[212:215], v[92:95], v[52:55], v[212:215]
s_waitcnt lgkmcnt(3)
v_mfma_f32_16x16x32_bf16 v[116:119], v[96:99], v[56:59], v[116:119]
s_waitcnt vmcnt(6)
ds_read_b64_tr_b16 v[76:77], v6 offset:4096
v_mfma_f32_16x16x32_bf16 v[120:123], v[96:99], v[60:63], v[120:123]
ds_read_b64_tr_b16 v[80:81], v7 offset:4096
v_mfma_f32_16x16x32_bf16 v[124:127], v[96:99], v[64:67], v[124:127]
s_waitcnt lgkmcnt(2)
buffer_load_dwordx4 v13, s[52:55], s11 offen lds
v_mfma_f32_16x16x32_bf16 v[128:131], v[96:99], v[68:71], v[128:131]
ds_read_b64_tr_b16 v[84:85], v8 offset:4096
v_mfma_f32_16x16x32_bf16 v[132:135], v[96:99], v[72:75], v[132:135]
ds_read_b64_tr_b16 v[88:89], v9 offset:4096
v_mfma_f32_16x16x32_bf16 v[152:155], v[100:103], v[72:75], v[152:155]
ds_read_b64_tr_b16 v[92:93], v10 offset:32768
v_mfma_f32_16x16x32_bf16 v[148:151], v[100:103], v[68:71], v[148:151]
ds_read_b64_tr_b16 v[94:95], v10 offset:34816
v_mfma_f32_16x16x32_bf16 v[144:147], v[100:103], v[64:67], v[144:147]
buffer_load_dwordx4 v14, s[52:55], s11 offen offset:1024 lds
v_mfma_f32_16x16x32_bf16 v[140:143], v[100:103], v[60:63], v[140:143]
ds_read_b128 v[36:39], v3 offset:25600
s_add_u32 m0, s6, 4096
v_mfma_f32_16x16x32_bf16 v[136:139], v[100:103], v[56:59], v[136:139]
ds_read_b128 v[40:43], v3 offset:26624
s_mov_b32 s11, 589824
v_mfma_f32_16x16x32_bf16 v[156:159], v[104:107], v[56:59], v[156:159]
ds_read_b32 v23, v20
v_mfma_f32_16x16x32_bf16 v[160:163], v[104:107], v[60:63], v[160:163]
ds_read_b128 v[44:47], v3 offset:27648
v_mov_b32 v24, 20
v_mfma_f32_16x16x32_bf16 v[164:167], v[104:107], v[64:67], v[164:167]
s_waitcnt lgkmcnt(5)
buffer_load_dwordx4 v13, s[52:55], s11 offen lds
v_mfma_f32_16x16x32_bf16 v[168:171], v[104:107], v[68:71], v[168:171]
s_waitcnt vmcnt(8) lgkmcnt(4)
ds_write_b32 v22, v24
v_mfma_f32_16x16x32_bf16 v[172:175], v[104:107], v[72:75], v[172:175]
s_waitcnt vmcnt(6)
ds_read_b64_tr_b16 v[78:79], v6 offset:6144
v_mfma_f32_16x16x32_bf16 v[192:195], v[108:111], v[72:75], v[192:195]
ds_read_b64_tr_b16 v[82:83], v7 offset:6144
v_mfma_f32_16x16x32_bf16 v[188:191], v[108:111], v[68:71], v[188:191]
ds_read_b64_tr_b16 v[86:87], v8 offset:6144
v_mfma_f32_16x16x32_bf16 v[184:187], v[108:111], v[64:67], v[184:187]
buffer_load_dwordx4 v14, s[52:55], s11 offen offset:1024 lds
v_mfma_f32_16x16x32_bf16 v[180:183], v[108:111], v[60:63], v[180:183]
ds_read_b64_tr_b16 v[90:91], v9 offset:6144
v_mfma_f32_16x16x32_bf16 v[176:179], v[108:111], v[56:59], v[176:179]
ds_read_b128 v[48:51], v3 offset:28672
s_waitcnt lgkmcnt(6)
v_cmp_gt_u32 vcc, 19, v23
v_mfma_f32_16x16x32_bf16 v[196:199], v[112:115], v[56:59], v[196:199]
ds_read_b128 v[52:55], v3 offset:29696
v_mfma_f32_16x16x32_bf16 v[200:203], v[112:115], v[60:63], v[200:203]
s_cbranch_vccnz LwPo13
LrPo13:
v_mfma_f32_16x16x32_bf16 v[204:207], v[112:115], v[64:67], v[204:207]
v_mfma_f32_16x16x32_bf16 v[208:211], v[112:115], v[68:71], v[208:211]
s_add_u32 m0, s6, 6144
s_mov_b32 s11, 608256
v_mfma_f32_16x16x32_bf16 v[212:215], v[112:115], v[72:75], v[212:215]
s_waitcnt lgkmcnt(3)
v_mfma_f32_16x16x32_bf16 v[116:119], v[76:79], v[36:39], v[116:119]
s_waitcnt vmcnt(5)
ds_read_b64_tr_b16 v[96:97], v6 offset:0
v_mfma_f32_16x16x32_bf16 v[120:123], v[76:79], v[40:43], v[120:123]
ds_read_b64_tr_b16 v[100:101], v7 offset:0
v_mfma_f32_16x16x32_bf16 v[124:127], v[76:79], v[44:47], v[124:127]
s_waitcnt lgkmcnt(2)
buffer_load_dwordx4 v13, s[52:55], s11 offen lds
v_mfma_f32_16x16x32_bf16 v[128:131], v[76:79], v[48:51], v[128:131]
ds_read_b64_tr_b16 v[104:105], v8 offset:0
v_mfma_f32_16x16x32_bf16 v[132:135], v[76:79], v[52:55], v[132:135]
ds_read_b64_tr_b16 v[108:109], v9 offset:0
v_mfma_f32_16x16x32_bf16 v[152:155], v[80:83], v[52:55], v[152:155]
ds_read_b64_tr_b16 v[112:113], v10 offset:49152
v_mfma_f32_16x16x32_bf16 v[148:151], v[80:83], v[48:51], v[148:151]
ds_read_b64_tr_b16 v[114:115], v10 offset:51200
v_mfma_f32_16x16x32_bf16 v[144:147], v[80:83], v[44:47], v[144:147]
buffer_load_dwordx4 v14, s[52:55], s11 offen offset:1024 lds
v_mfma_f32_16x16x32_bf16 v[140:143], v[80:83], v[40:43], v[140:143]
ds_read_b128 v[56:59], v3 offset:30720
s_add_u32 m0, s6, 0
v_mfma_f32_16x16x32_bf16 v[136:139], v[80:83], v[36:39], v[136:139]
ds_read_b128 v[60:63], v3 offset:31744
s_mov_b32 s11, 626688
v_mfma_f32_16x16x32_bf16 v[156:159], v[84:87], v[36:39], v[156:159]
ds_read_b32 v23, v20
v_mfma_f32_16x16x32_bf16 v[160:163], v[84:87], v[40:43], v[160:163]
ds_read_b128 v[64:67], v3 offset:32768
v_mov_b32 v24, 21
v_mfma_f32_16x16x32_bf16 v[164:167], v[84:87], v[44:47], v[164:167]
s_waitcnt lgkmcnt(5)
buffer_load_dwordx4 v13, s[52:55], s11 offen lds
v_mfma_f32_16x16x32_bf16 v[168:171], v[84:87], v[48:51], v[168:171]
s_waitcnt vmcnt(7) lgkmcnt(4)
ds_write_b32 v22, v24
v_mfma_f32_16x16x32_bf16 v[172:175], v[84:87], v[52:55], v[172:175]
s_waitcnt vmcnt(5)
ds_read_b64_tr_b16 v[98:99], v6 offset:2048
v_mfma_f32_16x16x32_bf16 v[192:195], v[88:91], v[52:55], v[192:195]
ds_read_b64_tr_b16 v[102:103], v7 offset:2048
v_mfma_f32_16x16x32_bf16 v[188:191], v[88:91], v[48:51], v[188:191]
ds_read_b64_tr_b16 v[106:107], v8 offset:2048
v_mfma_f32_16x16x32_bf16 v[184:187], v[88:91], v[44:47], v[184:187]
buffer_load_dwordx4 v14, s[52:55], s11 offen offset:1024 lds
v_mfma_f32_16x16x32_bf16 v[180:183], v[88:91], v[40:43], v[180:183]
ds_read_b64_tr_b16 v[110:111], v9 offset:2048
v_mfma_f32_16x16x32_bf16 v[176:179], v[88:91], v[36:39], v[176:179]
ds_read_b128 v[68:71], v3 offset:33792
s_waitcnt lgkmcnt(6)
v_cmp_gt_u32 vcc, 20, v23
v_mfma_f32_16x16x32_bf16 v[196:199], v[92:95], v[36:39], v[196:199]
ds_read_b128 v[72:75], v3 offset:34816
v_mfma_f32_16x16x32_bf16 v[200:203], v[92:95], v[40:43], v[200:203]
s_cbranch_vccnz LwPo14
LrPo14:
ds_read_b32 v27, v21
v_mfma_f32_16x16x32_bf16 v[204:207], v[92:95], v[44:47], v[204:207]
v_mfma_f32_16x16x32_bf16 v[208:211], v[92:95], v[48:51], v[208:211]
s_add_u32 m0, s6, 2048
s_mov_b32 s11, 645120
v_mfma_f32_16x16x32_bf16 v[212:215], v[92:95], v[52:55], v[212:215]
s_waitcnt lgkmcnt(4)
v_mfma_f32_16x16x32_bf16 v[116:119], v[96:99], v[56:59], v[116:119]
s_waitcnt vmcnt(4)
ds_read_b64_tr_b16 v[76:77], v6 offset:4096
v_mfma_f32_16x16x32_bf16 v[120:123], v[96:99], v[60:63], v[120:123]
ds_read_b64_tr_b16 v[80:81], v7 offset:4096
v_mfma_f32_16x16x32_bf16 v[124:127], v[96:99], v[64:67], v[124:127]
s_waitcnt lgkmcnt(3)
buffer_load_dwordx4 v13, s[52:55], s11 offen lds
v_mfma_f32_16x16x32_bf16 v[128:131], v[96:99], v[68:71], v[128:131]
ds_read_b64_tr_b16 v[84:85], v8 offset:4096
s_waitcnt lgkmcnt(3)
v_cmp_gt_u32 vcc, 33, v27
v_mfma_f32_16x16x32_bf16 v[132:135], v[96:99], v[72:75], v[132:135]
ds_read_b64_tr_b16 v[88:89], v9 offset:4096
v_mfma_f32_16x16x32_bf16 v[152:155], v[100:103], v[72:75], v[152:155]
s_cbranch_vccnz LwPg33
LrPg33:
ds_read_b64_tr_b16 v[92:93], v10 offset:53248
v_mfma_f32_16x16x32_bf16 v[148:151], v[100:103], v[68:71], v[148:151]
ds_read_b64_tr_b16 v[94:95], v10 offset:55296
v_mfma_f32_16x16x32_bf16 v[144:147], v[100:103], v[64:67], v[144:147]
buffer_load_dwordx4 v14, s[52:55], s11 offen offset:1024 lds
v_mfma_f32_16x16x32_bf16 v[140:143], v[100:103], v[60:63], v[140:143]
ds_read_b128 v[36:39], v3 offset:35840
v_mfma_f32_16x16x32_bf16 v[136:139], v[100:103], v[56:59], v[136:139]
ds_read_b128 v[40:43], v3 offset:36864
v_mfma_f32_16x16x32_bf16 v[156:159], v[104:107], v[56:59], v[156:159]
ds_read_b32 v23, v20
v_mfma_f32_16x16x32_bf16 v[160:163], v[104:107], v[60:63], v[160:163]
ds_read_b128 v[44:47], v3 offset:37888
v_mov_b32 v24, 22
v_mfma_f32_16x16x32_bf16 v[164:167], v[104:107], v[64:67], v[164:167]
v_mfma_f32_16x16x32_bf16 v[168:171], v[104:107], v[68:71], v[168:171]
s_waitcnt lgkmcnt(4)
ds_write_b32 v22, v24
v_mfma_f32_16x16x32_bf16 v[172:175], v[104:107], v[72:75], v[172:175]
s_waitcnt vmcnt(4)
ds_read_b64_tr_b16 v[78:79], v6 offset:6144
v_mfma_f32_16x16x32_bf16 v[192:195], v[108:111], v[72:75], v[192:195]
ds_read_b64_tr_b16 v[82:83], v7 offset:6144
v_mfma_f32_16x16x32_bf16 v[188:191], v[108:111], v[68:71], v[188:191]
ds_read_b64_tr_b16 v[86:87], v8 offset:6144
v_mfma_f32_16x16x32_bf16 v[184:187], v[108:111], v[64:67], v[184:187]
v_mfma_f32_16x16x32_bf16 v[180:183], v[108:111], v[60:63], v[180:183]
ds_read_b64_tr_b16 v[90:91], v9 offset:6144
v_mfma_f32_16x16x32_bf16 v[176:179], v[108:111], v[56:59], v[176:179]
ds_read_b128 v[48:51], v3 offset:38912
s_waitcnt lgkmcnt(6)
v_cmp_gt_u32 vcc, 21, v23
v_mfma_f32_16x16x32_bf16 v[196:199], v[112:115], v[56:59], v[196:199]
ds_read_b128 v[52:55], v3 offset:39936
v_mfma_f32_16x16x32_bf16 v[200:203], v[112:115], v[60:63], v[200:203]
s_cbranch_vccnz LwPo15
LrPo15:
v_mfma_f32_16x16x32_bf16 v[204:207], v[112:115], v[64:67], v[204:207]
v_mfma_f32_16x16x32_bf16 v[208:211], v[112:115], v[68:71], v[208:211]
v_mfma_f32_16x16x32_bf16 v[212:215], v[112:115], v[72:75], v[212:215]
s_waitcnt lgkmcnt(3)
v_mfma_f32_16x16x32_bf16 v[116:119], v[76:79], v[36:39], v[116:119]
s_waitcnt vmcnt(2)
ds_read_b64_tr_b16 v[96:97], v6 offset:0
v_mfma_f32_16x16x32_bf16 v[120:123], v[76:79], v[40:43], v[120:123]
ds_read_b64_tr_b16 v[100:101], v7 offset:0
v_mfma_f32_16x16x32_bf16 v[124:127], v[76:79], v[44:47], v[124:127]
s_waitcnt lgkmcnt(2)
v_mfma_f32_16x16x32_bf16 v[128:131], v[76:79], v[48:51], v[128:131]
ds_read_b64_tr_b16 v[104:105], v8 offset:0
v_mfma_f32_16x16x32_bf16 v[132:135], v[76:79], v[52:55], v[132:135]
ds_read_b64_tr_b16 v[108:109], v9 offset:0
v_mfma_f32_16x16x32_bf16 v[152:155], v[80:83], v[52:55], v[152:155]
ds_read_b64_tr_b16 v[112:113], v10 offset:0
v_mfma_f32_16x16x32_bf16 v[148:151], v[80:83], v[48:51], v[148:151]
ds_read_b64_tr_b16 v[114:115], v10 offset:2048
v_mfma_f32_16x16x32_bf16 v[144:147], v[80:83], v[44:47], v[144:147]
v_mfma_f32_16x16x32_bf16 v[140:143], v[80:83], v[40:43], v[140:143]
ds_read_b128 v[56:59], v3 offset:40960
v_mfma_f32_16x16x32_bf16 v[136:139], v[80:83], v[36:39], v[136:139]
ds_read_b128 v[60:63], v3 offset:41984
v_mfma_f32_16x16x32_bf16 v[156:159], v[84:87], v[36:39], v[156:159]
v_mfma_f32_16x16x32_bf16 v[160:163], v[84:87], v[40:43], v[160:163]
ds_read_b128 v[64:67], v3 offset:43008
v_mov_b32 v24, 23
v_mfma_f32_16x16x32_bf16 v[164:167], v[84:87], v[44:47], v[164:167]
v_mfma_f32_16x16x32_bf16 v[168:171], v[84:87], v[48:51], v[168:171]
s_waitcnt lgkmcnt(3)
ds_write_b32 v22, v24
v_mfma_f32_16x16x32_bf16 v[172:175], v[84:87], v[52:55], v[172:175]
s_waitcnt vmcnt(0)
ds_read_b64_tr_b16 v[98:99], v6 offset:2048
v_mfma_f32_16x16x32_bf16 v[192:195], v[88:91], v[52:55], v[192:195]
ds_read_b64_tr_b16 v[102:103], v7 offset:2048
v_mfma_f32_16x16x32_bf16 v[188:191], v[88:91], v[48:51], v[188:191]
ds_read_b64_tr_b16 v[106:107], v8 offset:2048
v_mfma_f32_16x16x32_bf16 v[184:187], v[88:91], v[44:47], v[184:187]
v_mfma_f32_16x16x32_bf16 v[180:183], v[88:91], v[40:43], v[180:183]
ds_read_b64_tr_b16 v[110:111], v9 offset:2048
v_mfma_f32_16x16x32_bf16 v[176:179], v[88:91], v[36:39], v[176:179]
ds_read_b128 v[68:71], v3 offset:44032
v_mfma_f32_16x16x32_bf16 v[196:199], v[92:95], v[36:39], v[196:199]
ds_read_b128 v[72:75], v3 offset:45056
v_mfma_f32_16x16x32_bf16 v[200:203], v[92:95], v[40:43], v[200:203]
v_mfma_f32_16x16x32_bf16 v[204:207], v[92:95], v[44:47], v[204:207]
v_mfma_f32_16x16x32_bf16 v[208:211], v[92:95], v[48:51], v[208:211]
v_mfma_f32_16x16x32_bf16 v[212:215], v[92:95], v[52:55], v[212:215]
s_waitcnt lgkmcnt(3)
v_mfma_f32_16x16x32_bf16 v[116:119], v[96:99], v[56:59], v[116:119]
v_mfma_f32_16x16x32_bf16 v[120:123], v[96:99], v[60:63], v[120:123]
v_mfma_f32_16x16x32_bf16 v[124:127], v[96:99], v[64:67], v[124:127]
s_waitcnt lgkmcnt(0)
v_mfma_f32_16x16x32_bf16 v[128:131], v[96:99], v[68:71], v[128:131]
v_mfma_f32_16x16x32_bf16 v[132:135], v[96:99], v[72:75], v[132:135]
v_mfma_f32_16x16x32_bf16 v[152:155], v[100:103], v[72:75], v[152:155]
v_mfma_f32_16x16x32_bf16 v[148:151], v[100:103], v[68:71], v[148:151]
v_mfma_f32_16x16x32_bf16 v[144:147], v[100:103], v[64:67], v[144:147]
v_mfma_f32_16x16x32_bf16 v[140:143], v[100:103], v[60:63], v[140:143]
v_mfma_f32_16x16x32_bf16 v[136:139], v[100:103], v[56:59], v[136:139]
v_mfma_f32_16x16x32_bf16 v[156:159], v[104:107], v[56:59], v[156:159]
v_mfma_f32_16x16x32_bf16 v[160:163], v[104:107], v[60:63], v[160:163]
v_mov_b32 v24, 24
v_mfma_f32_16x16x32_bf16 v[164:167], v[104:107], v[64:67], v[164:167]
v_mfma_f32_16x16x32_bf16 v[168:171], v[104:107], v[68:71], v[168:171]
ds_write_b32 v22, v24
v_mfma_f32_16x16x32_bf16 v[172:175], v[104:107], v[72:75], v[172:175]
v_mfma_f32_16x16x32_bf16 v[192:195], v[108:111], v[72:75], v[192:195]
v_mfma_f32_16x16x32_bf16 v[188:191], v[108:111], v[68:71], v[188:191]
v_mfma_f32_16x16x32_bf16 v[184:187], v[108:111], v[64:67], v[184:187]
v_mfma_f32_16x16x32_bf16 v[180:183], v[108:111], v[60:63], v[180:183]
v_mfma_f32_16x16x32_bf16 v[176:179], v[108:111], v[56:59], v[176:179]
v_mfma_f32_16x16x32_bf16 v[196:199], v[112:115], v[56:59], v[196:199]
v_mfma_f32_16x16x32_bf16 v[200:203], v[112:115], v[60:63], v[200:203]
v_mfma_f32_16x16x32_bf16 v[204:207], v[112:115], v[64:67], v[204:207]
v_mfma_f32_16x16x32_bf16 v[208:211], v[112:115], v[68:71], v[208:211]
v_mfma_f32_16x16x32_bf16 v[212:215], v[112:115], v[72:75], v[212:215]
s_setprio 0
s_nop 6
v_cvt_pk_bf16_f32 v116, v116, v117
v_cvt_pk_bf16_f32 v117, v118, v119
v_cvt_pk_bf16_f32 v118, v136, v137
v_cvt_pk_bf16_f32 v119, v138, v139
s_mov_b32 s7, 0
buffer_store_dwordx4 v[116:119], v18, s[60:63], s7 offen offset:0 sc1
v_cvt_pk_bf16_f32 v120, v120, v121
v_cvt_pk_bf16_f32 v121, v122, v123
v_cvt_pk_bf16_f32 v122, v140, v141
v_cvt_pk_bf16_f32 v123, v142, v143
s_mov_b32 s7, 18432
buffer_store_dwordx4 v[120:123], v18, s[60:63], s7 offen offset:0 sc1
v_cvt_pk_bf16_f32 v124, v124, v125
v_cvt_pk_bf16_f32 v125, v126, v127
v_cvt_pk_bf16_f32 v126, v144, v145
v_cvt_pk_bf16_f32 v127, v146, v147
s_mov_b32 s7, 36864
buffer_store_dwordx4 v[124:127], v18, s[60:63], s7 offen offset:0 sc1
v_cvt_pk_bf16_f32 v128, v128, v129
v_cvt_pk_bf16_f32 v129, v130, v131
v_cvt_pk_bf16_f32 v130, v148, v149
v_cvt_pk_bf16_f32 v131, v150, v151
s_mov_b32 s7, 55296
buffer_store_dwordx4 v[128:131], v18, s[60:63], s7 offen offset:0 sc1
v_cvt_pk_bf16_f32 v132, v132, v133
v_cvt_pk_bf16_f32 v133, v134, v135
v_cvt_pk_bf16_f32 v134, v152, v153
v_cvt_pk_bf16_f32 v135, v154, v155
s_mov_b32 s7, 73728
buffer_store_dwordx4 v[132:135], v18, s[60:63], s7 offen offset:0 sc1
v_cvt_pk_bf16_f32 v156, v156, v157
v_cvt_pk_bf16_f32 v157, v158, v159
v_cvt_pk_bf16_f32 v158, v176, v177
v_cvt_pk_bf16_f32 v159, v178, v179
s_mov_b32 s7, 0
buffer_store_dwordx4 v[156:159], v18, s[60:63], s7 offen offset:1024 sc1
v_cvt_pk_bf16_f32 v160, v160, v161
v_cvt_pk_bf16_f32 v161, v162, v163
v_cvt_pk_bf16_f32 v162, v180, v181
v_cvt_pk_bf16_f32 v163, v182, v183
s_mov_b32 s7, 18432
s_waitcnt vmcnt(5)
buffer_store_dwordx4 v[160:163], v18, s[60:63], s7 offen offset:1024 sc1
v_cvt_pk_bf16_f32 v164, v164, v165
v_cvt_pk_bf16_f32 v165, v166, v167
v_cvt_pk_bf16_f32 v166, v184, v185
v_cvt_pk_bf16_f32 v167, v186, v187
s_mov_b32 s7, 36864
s_waitcnt vmcnt(5)
buffer_store_dwordx4 v[164:167], v18, s[60:63], s7 offen offset:1024 sc1
v_cvt_pk_bf16_f32 v168, v168, v169
v_cvt_pk_bf16_f32 v169, v170, v171
v_cvt_pk_bf16_f32 v170, v188, v189
v_cvt_pk_bf16_f32 v171, v190, v191
s_mov_b32 s7, 55296
s_waitcnt vmcnt(5)
buffer_store_dwordx4 v[168:171], v18, s[60:63], s7 offen offset:1024 sc1
v_cvt_pk_bf16_f32 v172, v172, v173
v_cvt_pk_bf16_f32 v173, v174, v175
v_cvt_pk_bf16_f32 v174, v192, v193
v_cvt_pk_bf16_f32 v175, v194, v195
s_mov_b32 s7, 73728
s_waitcnt vmcnt(5)
buffer_store_dwordx4 v[172:175], v18, s[60:63], s7 offen offset:1024 sc1
v_cvt_pk_bf16_f32 v196, v196, v197
v_cvt_pk_bf16_f32 v197, v198, v199
s_mov_b32 s7, 0
s_waitcnt vmcnt(5)
buffer_store_dwordx2 v[196:197], v19, s[60:63], s7 offen sc1
v_cvt_pk_bf16_f32 v200, v200, v201
v_cvt_pk_bf16_f32 v201, v202, v203
s_mov_b32 s7, 18432
s_waitcnt vmcnt(5)
buffer_store_dwordx2 v[200:201], v19, s[60:63], s7 offen sc1
v_cvt_pk_bf16_f32 v204, v204, v205
v_cvt_pk_bf16_f32 v205, v206, v207
s_mov_b32 s7, 36864
s_waitcnt vmcnt(5)
buffer_store_dwordx2 v[204:205], v19, s[60:63], s7 offen sc1
v_cvt_pk_bf16_f32 v208, v208, v209
v_cvt_pk_bf16_f32 v209, v210, v211
s_mov_b32 s7, 55296
s_waitcnt vmcnt(5)
buffer_store_dwordx2 v[208:209], v19, s[60:63], s7 offen sc1
v_cvt_pk_bf16_f32 v212, v212, v213
v_cvt_pk_bf16_f32 v213, v214, v215
s_mov_b32 s7, 73728
s_waitcnt vmcnt(5)
buffer_store_dwordx2 v[212:213], v19, s[60:63], s7 offen sc1
s_mov_b32 s56, s36
s_and_b32 s57, s37, 0xffff
s_mov_b32 s58, 2359296
s_mov_b32 s59, 0x20000
s_mov_b32 s30, 0x10101010
s_and_b32 s7, s4, 1
s_lshl_b32 s7, s7, 2
s_lshr_b32 s30, s30, s7
s_mov_b32 s31, 0
s_mov_b32 s43, 0
s_mov_b64 s[28:29], 0
v_lshlrev_b32 v236, 2, v1
s_mul_i32 s27, s5, 2304
s_add_u32 s27, s27, 27262976
s_lshl_b32 s26, s23, 8
s_add_u32 s26, s26, s27
s_add_u32 s27, s27, 2048
s_mov_b32 s32, 0x3f80
s_mov_b32 s33, 0x3f800000
s_mov_b32 s40, 0x3f317218
v_and_b32 v4, 15, v1
v_lshrrev_b32 v5, 4, v1
v_and_b32 v6, 1, v5
v_lshrrev_b32 v5, 1, v5
v_lshlrev_b32 v7, 4, v1
s_add_u32 s13, s18, 0
s_lshl_b32 s14, s23, 1
s_cmp_ge_u32 s13, 5
s_cselect_b32 s7, 5, 0
s_addc_u32 s14, s14, 0
s_sub_u32 s15, s13, s7
s_lshl_b32 s37, s13, 10
s_min_u32 s7, s15, 4
s_lshl_b32 s7, s7, 4
v_add_u32 v8, s7, v4
v_lshlrev_b32 v9, 4, v8
v_add_u32 v9, 161792, v9
ds_read_b128 v[52:55], v9
v_cmp_eq_u32 vcc, 79, v8
s_mul_i32 s7, s5, 79
v_add_u32 v8, s7, v8
v_mov_b32 v9, 4096
v_cndmask_b32 v8, v8, v9, vcc
v_mul_u32_u24 v42, 1152, v8
v_lshl_add_u32 v42, v6, 5, v42
v_lshl_add_u32 v42, v5, 4, v42
s_lshl_b32 s7, s14, 6
v_add_u32 v42, s7, v42
v_lshlrev_b32 v43, 4, v8
v_lshl_add_u32 v43, v5, 15, v43
v_lshl_add_u32 v43, v6, 16, v43
s_lshl_b32 s7, s14, 17
s_add_u32 s7, s7, 20971520
v_add_u32 v43, s7, v43
s_mul_i32 s34, s5, 5
s_add_u32 s34, s34, s15
s_mul_i32 s34, s34, 18432
s_lshl_b32 s8, s14, 10
s_add_u32 s34, s34, s8
s_add_u32 s13, s18, 4
s_lshl_b32 s14, s23, 1
s_cmp_ge_u32 s13, 5
s_cselect_b32 s7, 5, 0
s_addc_u32 s14, s14, 0
s_sub_u32 s15, s13, s7
s_lshl_b32 s38, s13, 10
s_min_u32 s7, s15, 4
s_lshl_b32 s7, s7, 4
v_add_u32 v8, s7, v4
v_lshlrev_b32 v9, 4, v8
v_add_u32 v9, 161792, v9
ds_read_b128 v[76:79], v9
v_cmp_eq_u32 vcc, 79, v8
s_mul_i32 s7, s5, 79
v_add_u32 v8, s7, v8
v_mov_b32 v9, 4096
v_cndmask_b32 v8, v8, v9, vcc
v_mul_u32_u24 v66, 1152, v8
v_lshl_add_u32 v66, v6, 5, v66
v_lshl_add_u32 v66, v5, 4, v66
s_lshl_b32 s7, s14, 6
v_add_u32 v66, s7, v66
v_lshlrev_b32 v67, 4, v8
v_lshl_add_u32 v67, v5, 15, v67
v_lshl_add_u32 v67, v6, 16, v67
s_lshl_b32 s7, s14, 17
s_add_u32 s7, s7, 20971520
v_add_u32 v67, s7, v67
s_mul_i32 s35, s5, 5
s_add_u32 s35, s35, s15
s_mul_i32 s35, s35, 18432
s_lshl_b32 s8, s14, 10
s_add_u32 s35, s35, s8
s_add_u32 s13, s18, 8
s_lshl_b32 s14, s23, 1
s_cmp_ge_u32 s13, 5
s_cselect_b32 s7, 5, 0
s_addc_u32 s14, s14, 0
s_sub_u32 s15, s13, s7
s_lshl_b32 s39, s13, 10
s_cmp_lt_u32 s18, 2
s_cbranch_scc1 Ls3_done
s_sub_u32 s7, s18, 2
s_lshl_b32 s7, s7, 3
s_add_u32 s7, s7, s4
s_cmp_ge_u32 s7, 5
s_cselect_b32 s8, 5, 0
s_cselect_b32 s14, 17, 16
s_sub_u32 s15, s7, s8
s_cmp_lt_u32 s15, 5
s_cselect_b32 s28, -1, 0
s_cselect_b32 s43, 0xff, 0
Ls3_done:
s_mov_b32 s42, s15
s_min_u32 s7, s15, 4
s_lshl_b32 s7, s7, 4
v_add_u32 v8, s7, v4
v_lshlrev_b32 v9, 4, v8
v_add_u32 v9, 161792, v9
ds_read_b128 v[100:103], v9
v_cmp_eq_u32 vcc, 79, v8
s_mul_i32 s7, s5, 79
v_add_u32 v8, s7, v8
v_mov_b32 v9, 4096
v_cndmask_b32 v8, v8, v9, vcc
v_mul_u32_u24 v90, 1152, v8
v_lshl_add_u32 v90, v6, 5, v90
v_lshl_add_u32 v90, v5, 4, v90
s_lshl_b32 s7, s14, 6
v_add_u32 v90, s7, v90
v_lshlrev_b32 v91, 4, v8
v_lshl_add_u32 v91, v5, 15, v91
v_lshl_add_u32 v91, v6, 16, v91
s_lshl_b32 s7, s14, 17
s_add_u32 s7, s7, 20971520
v_add_u32 v91, s7, v91
s_mul_i32 s36, s5, 5
s_add_u32 s36, s36, s15
s_mul_i32 s36, s36, 18432
s_lshl_b32 s8, s14, 10
s_add_u32 s36, s36, s8
s_add_u32 s64, s4, 2
s_and_b32 s64, s64, 7
s_mul_i32 s64, s64, 2396160
s_add_u32 s65, s4, 4
s_and_b32 s65, s65, 7
s_mul_i32 s65, s65, 2396160
s_add_u32 s66, s4, 6
s_and_b32 s66, s66, 7
s_mul_i32 s66, s66, 2396160
s_and_b32 s67, s4, 1
s_xor_b32 s67, s67, 1
s_mul_i32 s67, s67, 2396160
v_mov_b32 v28, 0
s_add_u32 s24, s24, 1
s_add_u32 s25, s25, 1
v_mov_b32 v29, s24
v_mov_b32 v30, s25
s_mov_b64 exec, 1
s_waitcnt vmcnt(5)
buffer_store_dword v29, v28, s[60:63], s21 offen sc1
s_waitcnt vmcnt(1)
buffer_store_dword v30, v28, s[60:63], s22 offen sc1
s_mov_b64 exec, -1
s_waitcnt lgkmcnt(2)
v_add_f32 v52, v52, v54
v_add_f32 v53, v53, v55
v_mul_f32 v52, 0x3ae38e39, v52
v_mul_f32 v53, 0x3ae38e39, v53
v_fma_f32 v53, -v52, v52, v53
v_max_f32 v53, 0, v53
v_cvt_pk_bf16_f32 v54, v52, v53
v_and_b32 v53, 0xffff0000, v54
v_add_f32 v53, 0x3727c5ac, v53
v_cvt_pk_bf16_f32 v53, v53, v53
v_and_b32 v53, 0xffff0000, v53
v_sqrt_f32 v53, v53
v_lshlrev_b32 v40, 16, v54
v_cvt_pk_bf16_f32 v53, v53, v53
v_and_b32 v53, 0xffff0000, v53
v_rcp_f32 v41, v53
v_lshlrev_b32 v44, 16, v240
v_and_b32 v45, 0xffff0000, v240
v_lshlrev_b32 v46, 16, v241
v_and_b32 v47, 0xffff0000, v241
v_lshlrev_b32 v48, 16, v242
v_and_b32 v49, 0xffff0000, v242
v_lshlrev_b32 v50, 16, v243
v_and_b32 v51, 0xffff0000, v243
v_sub_f32 v52, v44, v40
v_sub_f32 v53, v45, v40
v_sub_f32 v54, v46, v40
v_sub_f32 v55, v47, v40
v_sub_f32 v56, v48, v40
v_sub_f32 v57, v49, v40
v_sub_f32 v58, v50, v40
v_sub_f32 v59, v51, v40
v_cvt_pk_bf16_f32 v28, v52, v53
v_cvt_pk_bf16_f32 v29, v54, v55
v_cvt_pk_bf16_f32 v30, v56, v57
v_cvt_pk_bf16_f32 v31, v58, v59
v_lshlrev_b32 v52, 16, v28
v_and_b32 v53, 0xffff0000, v28
v_lshlrev_b32 v54, 16, v29
v_and_b32 v55, 0xffff0000, v29
v_lshlrev_b32 v56, 16, v30
v_and_b32 v57, 0xffff0000, v30
v_lshlrev_b32 v58, 16, v31
v_and_b32 v59, 0xffff0000, v31
v_mul_f32 v52, v52, v41
v_mul_f32 v53, v53, v41
v_mul_f32 v54, v54, v41
v_mul_f32 v55, v55, v41
v_mul_f32 v56, v56, v41
v_mul_f32 v57, v57, v41
v_mul_f32 v58, v58, v41
v_mul_f32 v59, v59, v41
v_cvt_pk_bf16_f32 v28, v52, v53
v_cvt_pk_bf16_f32 v29, v54, v55
v_cvt_pk_bf16_f32 v30, v56, v57
v_cvt_pk_bf16_f32 v31, v58, v59
v_lshlrev_b32 v52, 16, v28
v_and_b32 v53, 0xffff0000, v28
v_lshlrev_b32 v54, 16, v29
v_and_b32 v55, 0xffff0000, v29
v_lshlrev_b32 v56, 16, v30
v_and_b32 v57, 0xffff0000, v30
v_lshlrev_b32 v58, 16, v31
v_and_b32 v59, 0xffff0000, v31
s_waitcnt lgkmcnt(1)
v_add_f32 v76, v76, v78
v_add_f32 v77, v77, v79
v_mul_f32 v76, 0x3ae38e39, v76
v_mul_f32 v77, 0x3ae38e39, v77
v_fma_f32 v77, -v76, v76, v77
v_max_f32 v77, 0, v77
v_cvt_pk_bf16_f32 v78, v76, v77
v_and_b32 v77, 0xffff0000, v78
v_add_f32 v77, 0x3727c5ac, v77
v_cvt_pk_bf16_f32 v77, v77, v77
v_and_b32 v77, 0xffff0000, v77
v_sqrt_f32 v77, v77
v_lshlrev_b32 v64, 16, v78
v_cvt_pk_bf16_f32 v77, v77, v77
v_and_b32 v77, 0xffff0000, v77
v_rcp_f32 v65, v77
v_lshlrev_b32 v68, 16, v244
v_and_b32 v69, 0xffff0000, v244
v_lshlrev_b32 v70, 16, v245
v_and_b32 v71, 0xffff0000, v245
v_lshlrev_b32 v72, 16, v246
v_and_b32 v73, 0xffff0000, v246
v_lshlrev_b32 v74, 16, v247
v_and_b32 v75, 0xffff0000, v247
v_sub_f32 v76, v68, v64
v_sub_f32 v77, v69, v64
v_sub_f32 v78, v70, v64
v_sub_f32 v79, v71, v64
v_sub_f32 v80, v72, v64
v_sub_f32 v81, v73, v64
v_sub_f32 v82, v74, v64
v_sub_f32 v83, v75, v64
v_cvt_pk_bf16_f32 v28, v76, v77
v_cvt_pk_bf16_f32 v29, v78, v79
v_cvt_pk_bf16_f32 v30, v80, v81
v_cvt_pk_bf16_f32 v31, v82, v83
v_lshlrev_b32 v76, 16, v28
v_and_b32 v77, 0xffff0000, v28
v_lshlrev_b32 v78, 16, v29
v_and_b32 v79, 0xffff0000, v29
v_lshlrev_b32 v80, 16, v30
v_and_b32 v81, 0xffff0000, v30
v_lshlrev_b32 v82, 16, v31
v_and_b32 v83, 0xffff0000, v31
v_mul_f32 v76, v76, v65
v_mul_f32 v77, v77, v65
v_mul_f32 v78, v78, v65
v_mul_f32 v79, v79, v65
v_mul_f32 v80, v80, v65
v_mul_f32 v81, v81, v65
v_mul_f32 v82, v82, v65
v_mul_f32 v83, v83, v65
v_cvt_pk_bf16_f32 v28, v76, v77
v_cvt_pk_bf16_f32 v29, v78, v79
v_cvt_pk_bf16_f32 v30, v80, v81
v_cvt_pk_bf16_f32 v31, v82, v83
v_lshlrev_b32 v76, 16, v28
v_and_b32 v77, 0xffff0000, v28
v_lshlrev_b32 v78, 16, v29
v_and_b32 v79, 0xffff0000, v29
v_lshlrev_b32 v80, 16, v30
v_and_b32 v81, 0xffff0000, v30
v_lshlrev_b32 v82, 16, v31
v_and_b32 v83, 0xffff0000, v31
s_waitcnt lgkmcnt(0)
v_add_f32 v100, v100, v102
v_add_f32 v101, v101, v103
v_mul_f32 v100, 0x3ae38e39, v100
v_mul_f32 v101, 0x3ae38e39, v101
v_fma_f32 v101, -v100, v100, v101
v_max_f32 v101, 0, v101
v_cvt_pk_bf16_f32 v102, v100, v101
v_and_b32 v101, 0xffff0000, v102
v_add_f32 v101, 0x3727c5ac, v101
v_cvt_pk_bf16_f32 v101, v101, v101
v_and_b32 v101, 0xffff0000, v101
v_sqrt_f32 v101, v101
v_lshlrev_b32 v88, 16, v102
v_cvt_pk_bf16_f32 v101, v101, v101
v_and_b32 v101, 0xffff0000, v101
v_rcp_f32 v89, v101
v_lshlrev_b32 v92, 16, v248
v_and_b32 v93, 0xffff0000, v248
v_lshlrev_b32 v94, 16, v249
v_and_b32 v95, 0xffff0000, v249
v_lshlrev_b32 v96, 16, v250
v_and_b32 v97, 0xffff0000, v250
v_lshlrev_b32 v98, 16, v251
v_and_b32 v99, 0xffff0000, v251
v_sub_f32 v100, v92, v88
v_sub_f32 v101, v93, v88
v_sub_f32 v102, v94, v88
v_sub_f32 v103, v95, v88
v_sub_f32 v104, v96, v88
v_sub_f32 v105, v97, v88
v_sub_f32 v106, v98, v88
v_sub_f32 v107, v99, v88
v_cvt_pk_bf16_f32 v28, v100, v101
v_cvt_pk_bf16_f32 v29, v102, v103
v_cvt_pk_bf16_f32 v30, v104, v105
v_cvt_pk_bf16_f32 v31, v106, v107
v_lshlrev_b32 v100, 16, v28
v_and_b32 v101, 0xffff0000, v28
v_lshlrev_b32 v102, 16, v29
v_and_b32 v103, 0xffff0000, v29
v_lshlrev_b32 v104, 16, v30
v_and_b32 v105, 0xffff0000, v30
v_lshlrev_b32 v106, 16, v31
v_and_b32 v107, 0xffff0000, v31
v_mul_f32 v100, v100, v89
v_mul_f32 v101, v101, v89
v_mul_f32 v102, v102, v89
v_mul_f32 v103, v103, v89
v_mul_f32 v104, v104, v89
v_mul_f32 v105, v105, v89
v_mul_f32 v106, v106, v89
v_mul_f32 v107, v107, v89
v_cvt_pk_bf16_f32 v28, v100, v101
v_cvt_pk_bf16_f32 v29, v102, v103
v_cvt_pk_bf16_f32 v30, v104, v105
v_cvt_pk_bf16_f32 v31, v106, v107
v_lshlrev_b32 v100, 16, v28
v_and_b32 v101, 0xffff0000, v28
v_lshlrev_b32 v102, 16, v29
v_and_b32 v103, 0xffff0000, v29
v_lshlrev_b32 v104, 16, v30
v_and_b32 v105, 0xffff0000, v30
v_lshlrev_b32 v106, 16, v31
v_and_b32 v107, 0xffff0000, v31
ds_read_b32 v27, v21
s_waitcnt lgkmcnt(0)
v_cmp_gt_u32 vcc, 34, v27
s_cbranch_vccnz LwPt
LrPt:
s_mov_b32 s10, 0
Lpe:
buffer_load_dword v237, v236, s[60:63], s26 offen sc1
buffer_load_dword v238, v236, s[60:63], s27 offen sc1
s_waitcnt vmcnt(0)
Lpe_c:
v_cmp_eq_u32 vcc, v237, v0
v_cmp_eq_u32 s[12:13], v238, v25
s_and_b64 vcc, vcc, s[30:31]
s_and_b64 s[12:13], s[12:13], s[28:29]
s_or_b64 s[12:13], s[12:13], vcc
s_cbranch_scc0 Lpe_ok
s_sleep 2
s_add_u32 s10, s10, 1
s_cmp_lt_u32 s10, 0x20000
s_cbranch_scc1 Lpe
Lpe_ok:
v_mov_b32 v24, 25
ds_write_b32 v22, v24
s_mov_b32 s30, 0
s_mov_b32 s31, 0x55
s_mov_b32 s28, 0
s_mov_b32 s29, s43
s_cmp_ge_u32 s18, 2
s_cbranch_scc1 Ltail2
s_add_u32 s7, s34, s67
buffer_load_dwordx4 v[116:119], v7, s[60:63], s7 offen sc1
s_add_u32 s7, s7, 4792320
buffer_load_dwordx4 v[120:123], v7, s[60:63], s7 offen sc1
s_add_u32 s7, s7, 4792320
buffer_load_dwordx4 v[124:127], v7, s[60:63], s7 offen sc1
s_add_u32 s7, s7, 4792320
buffer_load_dwordx4 v[128:131], v7, s[60:63], s7 offen sc1
s_add_u32 s7, s35, s67
buffer_load_dwordx4 v[156:159], v7, s[60:63], s7 offen sc1
s_add_u32 s7, s7, 4792320
buffer_load_dwordx4 v[160:163], v7, s[60:63], s7 offen sc1
s_add_u32 s7, s7, 4792320
buffer_load_dwordx4 v[164:167], v7, s[60:63], s7 offen sc1
s_add_u32 s7, s7, 4792320
buffer_load_dwordx4 v[168:171], v7, s[60:63], s7 offen sc1
s_add_u32 s7, s36, s67
buffer_load_dwordx4 v[196:199], v7, s[60:63], s7 offen sc1
s_add_u32 s7, s7, 4792320
buffer_load_dwordx4 v[200:203], v7, s[60:63], s7 offen sc1
s_add_u32 s7, s7, 4792320
buffer_load_dwordx4 v[204:207], v7, s[60:63], s7 offen sc1
s_add_u32 s7, s7, 4792320
buffer_load_dwordx4 v[208:211], v7, s[60:63], s7 offen sc1
s_waitcnt vmcnt(11)
v_dot2_f32_bf16 v148, v116, s32, 0
v_dot2_f32_bf16 v149, v116, s33, 0
v_dot2_f32_bf16 v150, v117, s32, 0
v_dot2_f32_bf16 v151, v117, s33, 0
v_dot2_f32_bf16 v152, v118, s32, 0
v_dot2_f32_bf16 v153, v118, s33, 0
v_dot2_f32_bf16 v154, v119, s32, 0
v_dot2_f32_bf16 v155, v119, s33, 0
s_waitcnt vmcnt(10)
v_dot2_f32_bf16 v148, v120, s32, v148
v_dot2_f32_bf16 v149, v120, s33, v149
v_dot2_f32_bf16 v150, v121, s32, v150
v_dot2_f32_bf16 v151, v121, s33, v151
v_dot2_f32_bf16 v152, v122, s32, v152
v_dot2_f32_bf16 v153, v122, s33, v153
v_dot2_f32_bf16 v154, v123, s32, v154
v_dot2_f32_bf16 v155, v123, s33, v155
s_waitcnt vmcnt(9)
v_dot2_f32_bf16 v148, v124, s32, v148
v_dot2_f32_bf16 v149, v124, s33, v149
v_dot2_f32_bf16 v150, v125, s32, v150
v_dot2_f32_bf16 v151, v125, s33, v151
v_dot2_f32_bf16 v152, v126, s32, v152
v_dot2_f32_bf16 v153, v126, s33, v153
v_dot2_f32_bf16 v154, v127, s32, v154
v_dot2_f32_bf16 v155, v127, s33, v155
s_waitcnt vmcnt(8)
v_dot2_f32_bf16 v148, v128, s32, v148
v_dot2_f32_bf16 v149, v128, s33, v149
v_dot2_f32_bf16 v150, v129, s32, v150
v_dot2_f32_bf16 v151, v129, s33, v151
v_dot2_f32_bf16 v152, v130, s32, v152
v_dot2_f32_bf16 v153, v130, s33, v153
v_dot2_f32_bf16 v154, v131, s32, v154
v_dot2_f32_bf16 v155, v131, s33, v155
s_waitcnt vmcnt(7)
v_dot2_f32_bf16 v188, v156, s32, 0
v_dot2_f32_bf16 v189, v156, s33, 0
v_dot2_f32_bf16 v190, v157, s32, 0
v_dot2_f32_bf16 v191, v157, s33, 0
v_dot2_f32_bf16 v192, v158, s32, 0
v_dot2_f32_bf16 v193, v158, s33, 0
v_dot2_f32_bf16 v194, v159, s32, 0
v_dot2_f32_bf16 v195, v159, s33, 0
s_waitcnt vmcnt(6)
v_dot2_f32_bf16 v188, v160, s32, v188
v_dot2_f32_bf16 v189, v160, s33, v189
v_dot2_f32_bf16 v190, v161, s32, v190
v_dot2_f32_bf16 v191, v161, s33, v191
v_dot2_f32_bf16 v192, v162, s32, v192
v_dot2_f32_bf16 v193, v162, s33, v193
v_dot2_f32_bf16 v194, v163, s32, v194
v_dot2_f32_bf16 v195, v163, s33, v195
s_waitcnt vmcnt(5)
v_dot2_f32_bf16 v188, v164, s32, v188
v_dot2_f32_bf16 v189, v164, s33, v189
v_dot2_f32_bf16 v190, v165, s32, v190
v_dot2_f32_bf16 v191, v165, s33, v191
v_dot2_f32_bf16 v192, v166, s32, v192
v_dot2_f32_bf16 v193, v166, s33, v193
v_dot2_f32_bf16 v194, v167, s32, v194
v_dot2_f32_bf16 v195, v167, s33, v195
s_waitcnt vmcnt(4)
v_dot2_f32_bf16 v188, v168, s32, v188
v_dot2_f32_bf16 v189, v168, s33, v189
v_dot2_f32_bf16 v190, v169, s32, v190
v_dot2_f32_bf16 v191, v169, s33, v191
v_dot2_f32_bf16 v192, v170, s32, v192
v_dot2_f32_bf16 v193, v170, s33, v193
v_dot2_f32_bf16 v194, v171, s32, v194
v_dot2_f32_bf16 v195, v171, s33, v195
s_waitcnt vmcnt(3)
v_dot2_f32_bf16 v228, v196, s32, 0
v_dot2_f32_bf16 v229, v196, s33, 0
v_dot2_f32_bf16 v230, v197, s32, 0
v_dot2_f32_bf16 v231, v197, s33, 0
v_dot2_f32_bf16 v232, v198, s32, 0
v_dot2_f32_bf16 v233, v198, s33, 0
v_dot2_f32_bf16 v234, v199, s32, 0
v_dot2_f32_bf16 v235, v199, s33, 0
s_waitcnt vmcnt(2)
v_dot2_f32_bf16 v228, v200, s32, v228
v_dot2_f32_bf16 v229, v200, s33, v229
v_dot2_f32_bf16 v230, v201, s32, v230
v_dot2_f32_bf16 v231, v201, s33, v231
v_dot2_f32_bf16 v232, v202, s32, v232
v_dot2_f32_bf16 v233, v202, s33, v233
v_dot2_f32_bf16 v234, v203, s32, v234
v_dot2_f32_bf16 v235, v203, s33, v235
s_waitcnt vmcnt(1)
v_dot2_f32_bf16 v228, v204, s32, v228
v_dot2_f32_bf16 v229, v204, s33, v229
v_dot2_f32_bf16 v230, v205, s32, v230
v_dot2_f32_bf16 v231, v205, s33, v231
v_dot2_f32_bf16 v232, v206, s32, v232
v_dot2_f32_bf16 v233, v206, s33, v233
v_dot2_f32_bf16 v234, v207, s32, v234
v_dot2_f32_bf16 v235, v207, s33, v235
s_waitcnt vmcnt(0)
v_dot2_f32_bf16 v228, v208, s32, v228
v_dot2_f32_bf16 v229, v208, s33, v229
v_dot2_f32_bf16 v230, v209, s32, v230
v_dot2_f32_bf16 v231, v209, s33, v231
v_dot2_f32_bf16 v232, v210, s32, v232
v_dot2_f32_bf16 v233, v210, s33, v233
v_dot2_f32_bf16 v234, v211, s32, v234
v_dot2_f32_bf16 v235, v211, s33, v235
s_mov_b32 s10, 0
s_branch Lpy3_c
Lpy3:
buffer_load_dword v237, v236, s[60:63], s26 offen sc1
buffer_load_dword v238, v236, s[60:63], s27 offen sc1
s_waitcnt vmcnt(0)
Lpy3_c:
v_cmp_eq_u32 vcc, v237, v0
v_cmp_eq_u32 s[12:13], v238, v25
s_and_b64 vcc, vcc, s[30:31]
s_and_b64 s[12:13], s[12:13], s[28:29]
s_or_b64 s[12:13], s[12:13], vcc
s_cbranch_scc0 Lpy3_ok
s_sleep 2
s_add_u32 s10, s10, 1
s_cmp_lt_u32 s10, 0x20000
s_cbranch_scc1 Lpy3
Lpy3_ok:
buffer_load_dwordx4 v[36:39], v43, s[60:63], 0 offen sc1
buffer_load_dwordx4 v[60:63], v67, s[60:63], 0 offen sc1
buffer_load_dwordx4 v[84:87], v91, s[60:63], 0 offen sc1
Lg2w3:
ds_read_b32 v27, v21
s_waitcnt lgkmcnt(0)
v_cmp_gt_u32 vcc, 35, v27
s_cbranch_vccz Lg2k3
s_sleep 1
s_branch Lg2w3
Lg2k3:
s_setprio 3
s_mov_b32 s10, 0
s_lshr_b32 s7, s4, 1
s_lshl_b32 s7, s7, 14
s_add_u32 s7, s7, 92160
v_add_u32 v10, s7, v7
v_add_u32 v11, s37, v10
ds_read_b128 v[144:147], v11
v_add_u32 v11, s38, v10
ds_read_b128 v[184:187], v11
v_add_u32 v11, s39, v10
ds_read_b128 v[224:227], v11
Llate3:
s_add_u32 s7, s34, s64
buffer_load_dwordx4 v[132:135], v7, s[60:63], s7 offen sc1
s_add_u32 s7, s34, s65
buffer_load_dwordx4 v[136:139], v7, s[60:63], s7 offen sc1
s_add_u32 s7, s34, s66
buffer_load_dwordx4 v[140:143], v7, s[60:63], s7 offen sc1
s_add_u32 s7, s35, s64
buffer_load_dwordx4 v[172:175], v7, s[60:63], s7 offen sc1
s_add_u32 s7, s35, s65
buffer_load_dwordx4 v[176:179], v7, s[60:63], s7 offen sc1
s_add_u32 s7, s35, s66
buffer_load_dwordx4 v[180:183], v7, s[60:63], s7 offen sc1
s_add_u32 s7, s36, s64
buffer_load_dwordx4 v[212:215], v7, s[60:63], s7 offen sc1
s_add_u32 s7, s36, s65
buffer_load_dwordx4 v[216:219], v7, s[60:63], s7 offen sc1
s_add_u32 s7, s36, s66
buffer_load_dwordx4 v[220:223], v7, s[60:63], s7 offen sc1
s_cmp_lg_u32 s10, 0
s_cbranch_scc1 Llw3
s_waitcnt lgkmcnt(2)
v_dot2_f32_bf16 v148, v144, s32, v148
v_dot2_f32_bf16 v149, v144, s33, v149
v_dot2_f32_bf16 v150, v145, s32, v150
v_dot2_f32_bf16 v151, v145, s33, v151
v_dot2_f32_bf16 v152, v146, s32, v152
v_dot2_f32_bf16 v153, v146, s33, v153
v_dot2_f32_bf16 v154, v147, s32, v154
v_dot2_f32_bf16 v155, v147, s33, v155
s_waitcnt lgkmcnt(1)
v_dot2_f32_bf16 v188, v184, s32, v188
v_dot2_f32_bf16 v189, v184, s33, v189
v_dot2_f32_bf16 v190, v185, s32, v190
v_dot2_f32_bf16 v191, v185, s33, v191
v_dot2_f32_bf16 v192, v186, s32, v192
v_dot2_f32_bf16 v193, v186, s33, v193
v_dot2_f32_bf16 v194, v187, s32, v194
v_dot2_f32_bf16 v195, v187, s33, v195
s_waitcnt lgkmcnt(0)
v_dot2_f32_bf16 v228, v224, s32, v228
v_dot2_f32_bf16 v229, v224, s33, v229
v_dot2_f32_bf16 v230, v225, s32, v230
v_dot2_f32_bf16 v231, v225, s33, v231
v_dot2_f32_bf16 v232, v226, s32, v232
v_dot2_f32_bf16 v233, v226, s33, v233
v_dot2_f32_bf16 v234, v227, s32, v234
v_dot2_f32_bf16 v235, v227, s33, v235
s_waitcnt vmcnt(9)
v_lshlrev_b32 v28, 16, v36
v_and_b32 v29, 0xffff0000, v36
v_lshlrev_b32 v30, 16, v37
v_and_b32 v31, 0xffff0000, v37
v_lshlrev_b32 v32, 16, v38
v_and_b32 v33, 0xffff0000, v38
v_lshlrev_b32 v34, 16, v39
v_and_b32 v35, 0xffff0000, v39
v_fma_f32 v52, v52, v28, v44
v_fma_f32 v53, v53, v29, v45
v_fma_f32 v54, v54, v30, v46
v_fma_f32 v55, v55, v31, v47
v_fma_f32 v56, v56, v32, v48
v_fma_f32 v57, v57, v33, v49
v_fma_f32 v58, v58, v34, v50
v_fma_f32 v59, v59, v35, v51
v_lshlrev_b32 v28, 16, v60
v_and_b32 v29, 0xffff0000, v60
v_lshlrev_b32 v30, 16, v61
v_and_b32 v31, 0xffff0000, v61
v_lshlrev_b32 v32, 16, v62
v_and_b32 v33, 0xffff0000, v62
v_lshlrev_b32 v34, 16, v63
v_and_b32 v35, 0xffff0000, v63
v_fma_f32 v76, v76, v28, v68
v_fma_f32 v77, v77, v29, v69
v_fma_f32 v78, v78, v30, v70
v_fma_f32 v79, v79, v31, v71
v_fma_f32 v80, v80, v32, v72
v_fma_f32 v81, v81, v33, v73
v_fma_f32 v82, v82, v34, v74
v_fma_f32 v83, v83, v35, v75
v_lshlrev_b32 v28, 16, v84
v_and_b32 v29, 0xffff0000, v84
v_lshlrev_b32 v30, 16, v85
v_and_b32 v31, 0xffff0000, v85
v_lshlrev_b32 v32, 16, v86
v_and_b32 v33, 0xffff0000, v86
v_lshlrev_b32 v34, 16, v87
v_and_b32 v35, 0xffff0000, v87
v_fma_f32 v100, v100, v28, v92
v_fma_f32 v101, v101, v29, v93
v_fma_f32 v102, v102, v30, v94
v_fma_f32 v103, v103, v31, v95
v_fma_f32 v104, v104, v32, v96
v_fma_f32 v105, v105, v33, v97
v_fma_f32 v106, v106, v34, v98
v_fma_f32 v107, v107, v35, v99
Llw3:
v_mov_b32 v10, 0
s_waitcnt vmcnt(8)
v_max3_u32 v10, v10, v132, v133
v_max3_u32 v10, v10, v134, v135
s_waitcnt vmcnt(7)
v_max3_u32 v10, v10, v136, v137
v_max3_u32 v10, v10, v138, v139
s_waitcnt vmcnt(6)
v_max3_u32 v10, v10, v140, v141
v_max3_u32 v10, v10, v142, v143
s_waitcnt vmcnt(5)
v_max3_u32 v10, v10, v172, v173
v_max3_u32 v10, v10, v174, v175
s_waitcnt vmcnt(4)
v_max3_u32 v10, v10, v176, v177
v_max3_u32 v10, v10, v178, v179
s_waitcnt vmcnt(3)
v_max3_u32 v10, v10, v180, v181
v_max3_u32 v10, v10, v182, v183
s_waitcnt vmcnt(2)
v_max3_u32 v10, v10, v212, v213
v_max3_u32 v10, v10, v214, v215
s_waitcnt vmcnt(1)
v_max3_u32 v10, v10, v216, v217
v_max3_u32 v10, v10, v218, v219
s_waitcnt vmcnt(0)
v_max3_u32 v10, v10, v220, v221
v_max3_u32 v10, v10, v222, v223
v_cmp_eq_u32 vcc, -1, v10
s_cbranch_vccz Llok3
s_add_u32 s10, s10, 1
s_cmp_lt_u32 s10, 0x8000
s_cbranch_scc1 Llate3
Llok3:
v_dot2_f32_bf16 v148, v132, s32, v148
v_dot2_f32_bf16 v149, v132, s33, v149
v_dot2_f32_bf16 v150, v133, s32, v150
v_dot2_f32_bf16 v151, v133, s33, v151
v_dot2_f32_bf16 v152, v134, s32, v152
v_dot2_f32_bf16 v153, v134, s33, v153
v_dot2_f32_bf16 v154, v135, s32, v154
v_dot2_f32_bf16 v155, v135, s33, v155
v_dot2_f32_bf16 v148, v136, s32, v148
v_dot2_f32_bf16 v149, v136, s33, v149
v_dot2_f32_bf16 v150, v137, s32, v150
v_dot2_f32_bf16 v151, v137, s33, v151
v_dot2_f32_bf16 v152, v138, s32, v152
v_dot2_f32_bf16 v153, v138, s33, v153
v_dot2_f32_bf16 v154, v139, s32, v154
v_dot2_f32_bf16 v155, v139, s33, v155
v_dot2_f32_bf16 v148, v140, s32, v148
v_dot2_f32_bf16 v149, v140, s33, v149
v_dot2_f32_bf16 v150, v141, s32, v150
v_dot2_f32_bf16 v151, v141, s33, v151
v_dot2_f32_bf16 v152, v142, s32, v152
v_dot2_f32_bf16 v153, v142, s33, v153
v_dot2_f32_bf16 v154, v143, s32, v154
v_dot2_f32_bf16 v155, v143, s33, v155
s_nop 2
v_permlane16_swap_b32 v148, v152
v_permlane16_swap_b32 v149, v153
v_permlane16_swap_b32 v150, v154
v_permlane16_swap_b32 v151, v155
v_fma_f32 v52, v148, s40, v52
v_fma_f32 v53, v149, s40, v53
v_fma_f32 v54, v150, s40, v54
v_fma_f32 v55, v151, s40, v55
v_fma_f32 v56, v152, s40, v56
v_fma_f32 v57, v153, s40, v57
v_fma_f32 v58, v154, s40, v58
v_fma_f32 v59, v155, s40, v59
v_cvt_pk_bf16_f32 v44, v52, v53
v_cvt_pk_bf16_f32 v45, v54, v55
v_cvt_pk_bf16_f32 v46, v56, v57
v_cvt_pk_bf16_f32 v47, v58, v59
buffer_store_dwordx4 v[44:47], v42, s[56:59], 0 offen
v_dot2_f32_bf16 v188, v172, s32, v188
v_dot2_f32_bf16 v189, v172, s33, v189
v_dot2_f32_bf16 v190, v173, s32, v190
v_dot2_f32_bf16 v191, v173, s33, v191
v_dot2_f32_bf16 v192, v174, s32, v192
v_dot2_f32_bf16 v193, v174, s33, v193
v_dot2_f32_bf16 v194, v175, s32, v194
v_dot2_f32_bf16 v195, v175, s33, v195
v_dot2_f32_bf16 v188, v176, s32, v188
v_dot2_f32_bf16 v189, v176, s33, v189
v_dot2_f32_bf16 v190, v177, s32, v190
v_dot2_f32_bf16 v191, v177, s33, v191
v_dot2_f32_bf16 v192, v178, s32, v192
v_dot2_f32_bf16 v193, v178, s33, v193
v_dot2_f32_bf16 v194, v179, s32, v194
v_dot2_f32_bf16 v195, v179, s33, v195
v_dot2_f32_bf16 v188, v180, s32, v188
v_dot2_f32_bf16 v189, v180, s33, v189
v_dot2_f32_bf16 v190, v181, s32, v190
v_dot2_f32_bf16 v191, v181, s33, v191
v_dot2_f32_bf16 v192, v182, s32, v192
v_dot2_f32_bf16 v193, v182, s33, v193
v_dot2_f32_bf16 v194, v183, s32, v194
v_dot2_f32_bf16 v195, v183, s33, v195
s_nop 2
v_permlane16_swap_b32 v188, v192
v_permlane16_swap_b32 v189, v193
v_permlane16_swap_b32 v190, v194
v_permlane16_swap_b32 v191, v195
v_fma_f32 v76, v188, s40, v76
v_fma_f32 v77, v189, s40, v77
v_fma_f32 v78, v190, s40, v78
v_fma_f32 v79, v191, s40, v79
v_fma_f32 v80, v192, s40, v80
v_fma_f32 v81, v193, s40, v81
v_fma_f32 v82, v194, s40, v82
v_fma_f32 v83, v195, s40, v83
v_cvt_pk_bf16_f32 v68, v76, v77
v_cvt_pk_bf16_f32 v69, v78, v79
v_cvt_pk_bf16_f32 v70, v80, v81
v_cvt_pk_bf16_f32 v71, v82, v83
buffer_store_dwordx4 v[68:71], v66, s[56:59], 0 offen
v_dot2_f32_bf16 v228, v212, s32, v228
v_dot2_f32_bf16 v229, v212, s33, v229
v_dot2_f32_bf16 v230, v213, s32, v230
v_dot2_f32_bf16 v231, v213, s33, v231
v_dot2_f32_bf16 v232, v214, s32, v232
v_dot2_f32_bf16 v233, v214, s33, v233
v_dot2_f32_bf16 v234, v215, s32, v234
v_dot2_f32_bf16 v235, v215, s33, v235
v_dot2_f32_bf16 v228, v216, s32, v228
v_dot2_f32_bf16 v229, v216, s33, v229
v_dot2_f32_bf16 v230, v217, s32, v230
v_dot2_f32_bf16 v231, v217, s33, v231
v_dot2_f32_bf16 v232, v218, s32, v232
v_dot2_f32_bf16 v233, v218, s33, v233
v_dot2_f32_bf16 v234, v219, s32, v234
v_dot2_f32_bf16 v235, v219, s33, v235
v_dot2_f32_bf16 v228, v220, s32, v228
v_dot2_f32_bf16 v229, v220, s33, v229
v_dot2_f32_bf16 v230, v221, s32, v230
v_dot2_f32_bf16 v231, v221, s33, v231
v_dot2_f32_bf16 v232, v222, s32, v232
v_dot2_f32_bf16 v233, v222, s33, v233
v_dot2_f32_bf16 v234, v223, s32, v234
v_dot2_f32_bf16 v235, v223, s33, v235
s_nop 2
v_permlane16_swap_b32 v228, v232
v_permlane16_swap_b32 v229, v233
v_permlane16_swap_b32 v230, v234
v_permlane16_swap_b32 v231, v235
v_fma_f32 v100, v228, s40, v100
v_fma_f32 v101, v229, s40, v101
v_fma_f32 v102, v230, s40, v102
v_fma_f32 v103, v231, s40, v103
v_fma_f32 v104, v232, s40, v104
v_fma_f32 v105, v233, s40, v105
v_fma_f32 v106, v234, s40, v106
v_fma_f32 v107, v235, s40, v107
v_cvt_pk_bf16_f32 v92, v100, v101
v_cvt_pk_bf16_f32 v93, v102, v103
v_cvt_pk_bf16_f32 v94, v104, v105
v_cvt_pk_bf16_f32 v95, v106, v107
buffer_store_dwordx4 v[92:95], v90, s[56:59], 0 offen
s_endpgm
Ltail2:
s_add_u32 s7, s34, s67
buffer_load_dwordx4 v[116:119], v7, s[60:63], s7 offen sc1
s_add_u32 s7, s7, 4792320
buffer_load_dwordx4 v[120:123], v7, s[60:63], s7 offen sc1
s_add_u32 s7, s7, 4792320
buffer_load_dwordx4 v[124:127], v7, s[60:63], s7 offen sc1
s_add_u32 s7, s7, 4792320
buffer_load_dwordx4 v[128:131], v7, s[60:63], s7 offen sc1
s_add_u32 s7, s35, s67
buffer_load_dwordx4 v[156:159], v7, s[60:63], s7 offen sc1
s_add_u32 s7, s7, 4792320
buffer_load_dwordx4 v[160:163], v7, s[60:63], s7 offen sc1
s_add_u32 s7, s7, 4792320
buffer_load_dwordx4 v[164:167], v7, s[60:63], s7 offen sc1
s_add_u32 s7, s7, 4792320
buffer_load_dwordx4 v[168:171], v7, s[60:63], s7 offen sc1
s_cmp_ge_u32 s42, 5
s_cselect_b32 s7, 0x40000000, s36
s_cselect_b32 s42, 0x40000000, 0
v_lshlrev_b32 v10, 3, v1
buffer_load_dwordx2 v[196:197], v10, s[60:63], s7 offen sc1
buffer_load_dwordx2 v[198:199], v10, s[60:63], s7 offen offset:512 sc1
s_add_u32 s7, s7, 2396160
buffer_load_dwordx2 v[200:201], v10, s[60:63], s7 offen sc1
buffer_load_dwordx2 v[202:203], v10, s[60:63], s7 offen offset:512 sc1
s_add_u32 s7, s7, 2396160
buffer_load_dwordx2 v[204:205], v10, s[60:63], s7 offen sc1
buffer_load_dwordx2 v[206:207], v10, s[60:63], s7 offen offset:512 sc1
s_add_u32 s7, s7, 2396160
buffer_load_dwordx2 v[208:209], v10, s[60:63], s7 offen sc1
buffer_load_dwordx2 v[210:211], v10, s[60:63], s7 offen offset:512 sc1
s_add_u32 s7, s7, 2396160
buffer_load_dwordx2 v[212:213], v10, s[60:63], s7 offen sc1
buffer_load_dwordx2 v[214:215], v10, s[60:63], s7 offen offset:512 sc1
s_add_u32 s7, s7, 2396160
buffer_load_dwordx2 v[216:217], v10, s[60:63], s7 offen sc1
buffer_load_dwordx2 v[218:219], v10, s[60:63], s7 offen offset:512 sc1
s_add_u32 s7, s7, 2396160
buffer_load_dwordx2 v[220:221], v10, s[60:63], s7 offen sc1
buffer_load_dwordx2 v[222:223], v10, s[60:63], s7 offen offset:512 sc1
s_add_u32 s7, s7, 2396160
buffer_load_dwordx2 v[224:225], v10, s[60:63], s7 offen sc1
buffer_load_dwordx2 v[226:227], v10, s[60:63], s7 offen offset:512 sc1
s_waitcnt vmcnt(23)
v_dot2_f32_bf16 v148, v116, s32, 0
v_dot2_f32_bf16 v149, v116, s33, 0
v_dot2_f32_bf16 v150, v117, s32, 0
v_dot2_f32_bf16 v151, v117, s33, 0
v_dot2_f32_bf16 v152, v118, s32, 0
v_dot2_f32_bf16 v153, v118, s33, 0
v_dot2_f32_bf16 v154, v119, s32, 0
v_dot2_f32_bf16 v155, v119, s33, 0
s_waitcnt vmcnt(22)
v_dot2_f32_bf16 v148, v120, s32, v148
v_dot2_f32_bf16 v149, v120, s33, v149
v_dot2_f32_bf16 v150, v121, s32, v150
v_dot2_f32_bf16 v151, v121, s33, v151
v_dot2_f32_bf16 v152, v122, s32, v152
v_dot2_f32_bf16 v153, v122, s33, v153
v_dot2_f32_bf16 v154, v123, s32, v154
v_dot2_f32_bf16 v155, v123, s33, v155
s_waitcnt vmcnt(21)
v_dot2_f32_bf16 v148, v124, s32, v148
v_dot2_f32_bf16 v149, v124, s33, v149
v_dot2_f32_bf16 v150, v125, s32, v150
v_dot2_f32_bf16 v151, v125, s33, v151
v_dot2_f32_bf16 v152, v126, s32, v152
v_dot2_f32_bf16 v153, v126, s33, v153
v_dot2_f32_bf16 v154, v127, s32, v154
v_dot2_f32_bf16 v155, v127, s33, v155
s_waitcnt vmcnt(20)
v_dot2_f32_bf16 v148, v128, s32, v148
v_dot2_f32_bf16 v149, v128, s33, v149
v_dot2_f32_bf16 v150, v129, s32, v150
v_dot2_f32_bf16 v151, v129, s33, v151
v_dot2_f32_bf16 v152, v130, s32, v152
v_dot2_f32_bf16 v153, v130, s33, v153
v_dot2_f32_bf16 v154, v131, s32, v154
v_dot2_f32_bf16 v155, v131, s33, v155
s_waitcnt vmcnt(19)
v_dot2_f32_bf16 v188, v156, s32, 0
v_dot2_f32_bf16 v189, v156, s33, 0
v_dot2_f32_bf16 v190, v157, s32, 0
v_dot2_f32_bf16 v191, v157, s33, 0
v_dot2_f32_bf16 v192, v158, s32, 0
v_dot2_f32_bf16 v193, v158, s33, 0
v_dot2_f32_bf16 v194, v159, s32, 0
v_dot2_f32_bf16 v195, v159, s33, 0
s_waitcnt vmcnt(18)
v_dot2_f32_bf16 v188, v160, s32, v188
v_dot2_f32_bf16 v189, v160, s33, v189
v_dot2_f32_bf16 v190, v161, s32, v190
v_dot2_f32_bf16 v191, v161, s33, v191
v_dot2_f32_bf16 v192, v162, s32, v192
v_dot2_f32_bf16 v193, v162, s33, v193
v_dot2_f32_bf16 v194, v163, s32, v194
v_dot2_f32_bf16 v195, v163, s33, v195
s_waitcnt vmcnt(17)
v_dot2_f32_bf16 v188, v164, s32, v188
v_dot2_f32_bf16 v189, v164, s33, v189
v_dot2_f32_bf16 v190, v165, s32, v190
v_dot2_f32_bf16 v191, v165, s33, v191
v_dot2_f32_bf16 v192, v166, s32, v192
v_dot2_f32_bf16 v193, v166, s33, v193
v_dot2_f32_bf16 v194, v167, s32, v194
v_dot2_f32_bf16 v195, v167, s33, v195
s_waitcnt vmcnt(16)
v_dot2_f32_bf16 v188, v168, s32, v188
v_dot2_f32_bf16 v189, v168, s33, v189
v_dot2_f32_bf16 v190, v169, s32, v190
v_dot2_f32_bf16 v191, v169, s33, v191
v_dot2_f32_bf16 v192, v170, s32, v192
v_dot2_f32_bf16 v193, v170, s33, v193
v_dot2_f32_bf16 v194, v171, s32, v194
v_dot2_f32_bf16 v195, v171, s33, v195
s_waitcnt vmcnt(14)
v_dot2_f32_bf16 v228, v196, s32, 0
v_dot2_f32_bf16 v229, v196, s33, 0
v_dot2_f32_bf16 v230, v197, s32, 0
v_dot2_f32_bf16 v231, v197, s33, 0
v_dot2_f32_bf16 v232, v198, s32, 0
v_dot2_f32_bf16 v233, v198, s33, 0
v_dot2_f32_bf16 v234, v199, s32, 0
v_dot2_f32_bf16 v235, v199, s33, 0
s_waitcnt vmcnt(12)
v_dot2_f32_bf16 v228, v200, s32, v228
v_dot2_f32_bf16 v229, v200, s33, v229
v_dot2_f32_bf16 v230, v201, s32, v230
v_dot2_f32_bf16 v231, v201, s33, v231
v_dot2_f32_bf16 v232, v202, s32, v232
v_dot2_f32_bf16 v233, v202, s33, v233
v_dot2_f32_bf16 v234, v203, s32, v234
v_dot2_f32_bf16 v235, v203, s33, v235
s_waitcnt vmcnt(10)
v_dot2_f32_bf16 v228, v204, s32, v228
v_dot2_f32_bf16 v229, v204, s33, v229
v_dot2_f32_bf16 v230, v205, s32, v230
v_dot2_f32_bf16 v231, v205, s33, v231
v_dot2_f32_bf16 v232, v206, s32, v232
v_dot2_f32_bf16 v233, v206, s33, v233
v_dot2_f32_bf16 v234, v207, s32, v234
v_dot2_f32_bf16 v235, v207, s33, v235
s_waitcnt vmcnt(8)
v_dot2_f32_bf16 v228, v208, s32, v228
v_dot2_f32_bf16 v229, v208, s33, v229
v_dot2_f32_bf16 v230, v209, s32, v230
v_dot2_f32_bf16 v231, v209, s33, v231
v_dot2_f32_bf16 v232, v210, s32, v232
v_dot2_f32_bf16 v233, v210, s33, v233
v_dot2_f32_bf16 v234, v211, s32, v234
v_dot2_f32_bf16 v235, v211, s33, v235
s_waitcnt vmcnt(6)
v_dot2_f32_bf16 v228, v212, s32, v228
v_dot2_f32_bf16 v229, v212, s33, v229
v_dot2_f32_bf16 v230, v213, s32, v230
v_dot2_f32_bf16 v231, v213, s33, v231
v_dot2_f32_bf16 v232, v214, s32, v232
v_dot2_f32_bf16 v233, v214, s33, v233
v_dot2_f32_bf16 v234, v215, s32, v234
v_dot2_f32_bf16 v235, v215, s33, v235
s_waitcnt vmcnt(4)
v_dot2_f32_bf16 v228, v216, s32, v228
v_dot2_f32_bf16 v229, v216, s33, v229
v_dot2_f32_bf16 v230, v217, s32, v230
v_dot2_f32_bf16 v231, v217, s33, v231
v_dot2_f32_bf16 v232, v218, s32, v232
v_dot2_f32_bf16 v233, v218, s33, v233
v_dot2_f32_bf16 v234, v219, s32, v234
v_dot2_f32_bf16 v235, v219, s33, v235
s_waitcnt vmcnt(2)
v_dot2_f32_bf16 v228, v220, s32, v228
v_dot2_f32_bf16 v229, v220, s33, v229
v_dot2_f32_bf16 v230, v221, s32, v230
v_dot2_f32_bf16 v231, v221, s33, v231
v_dot2_f32_bf16 v232, v222, s32, v232
v_dot2_f32_bf16 v233, v222, s33, v233
v_dot2_f32_bf16 v234, v223, s32, v234
v_dot2_f32_bf16 v235, v223, s33, v235
s_waitcnt vmcnt(0)
v_dot2_f32_bf16 v228, v224, s32, v228
v_dot2_f32_bf16 v229, v224, s33, v229
v_dot2_f32_bf16 v230, v225, s32, v230
v_dot2_f32_bf16 v231, v225, s33, v231
v_dot2_f32_bf16 v232, v226, s32, v232
v_dot2_f32_bf16 v233, v226, s33, v233
v_dot2_f32_bf16 v234, v227, s32, v234
v_dot2_f32_bf16 v235, v227, s33, v235
s_mov_b32 s10, 0
s_branch Lpy2_c
Lpy2:
buffer_load_dword v237, v236, s[60:63], s26 offen sc1
buffer_load_dword v238, v236, s[60:63], s27 offen sc1
s_waitcnt vmcnt(0)
Lpy2_c:
v_cmp_eq_u32 vcc, v237, v0
v_cmp_eq_u32 s[12:13], v238, v25
s_and_b64 vcc, vcc, s[30:31]
s_and_b64 s[12:13], s[12:13], s[28:29]
s_or_b64 s[12:13], s[12:13], vcc
s_cbranch_scc0 Lpy2_ok
s_sleep 2
s_add_u32 s10, s10, 1
s_cmp_lt_u32 s10, 0x20000
s_cbranch_scc1 Lpy2
Lpy2_ok:
buffer_load_dwordx4 v[36:39], v43, s[60:63], 0 offen sc1
buffer_load_dwordx4 v[60:63], v67, s[60:63], 0 offen sc1
buffer_load_dwordx4 v[84:87], v91, s[60:63], 0 offen sc1
Lg2w2:
ds_read_b32 v27, v21
s_waitcnt lgkmcnt(0)
v_cmp_gt_u32 vcc, 35, v27
s_cbranch_vccz Lg2k2
s_sleep 1
s_branch Lg2w2
Lg2k2:
s_setprio 3
s_mov_b32 s10, 0
s_lshr_b32 s7, s4, 1
s_lshl_b32 s7, s7, 14
s_add_u32 s7, s7, 92160
v_add_u32 v10, s7, v7
v_add_u32 v11, s37, v10
ds_read_b128 v[144:147], v11
v_add_u32 v11, s38, v10
ds_read_b128 v[184:187], v11
Llate2:
s_add_u32 s7, s34, s64
buffer_load_dwordx4 v[132:135], v7, s[60:63], s7 offen sc1
s_add_u32 s7, s34, s65
buffer_load_dwordx4 v[136:139], v7, s[60:63], s7 offen sc1
s_add_u32 s7, s34, s66
buffer_load_dwordx4 v[140:143], v7, s[60:63], s7 offen sc1
s_add_u32 s7, s35, s64
buffer_load_dwordx4 v[172:175], v7, s[60:63], s7 offen sc1
s_add_u32 s7, s35, s65
buffer_load_dwordx4 v[176:179], v7, s[60:63], s7 offen sc1
s_add_u32 s7, s35, s66
buffer_load_dwordx4 v[180:183], v7, s[60:63], s7 offen sc1
s_cmp_lg_u32 s10, 0
s_cbranch_scc1 Llw2
s_waitcnt lgkmcnt(1)
v_dot2_f32_bf16 v148, v144, s32, v148
v_dot2_f32_bf16 v149, v144, s33, v149
v_dot2_f32_bf16 v150, v145, s32, v150
v_dot2_f32_bf16 v151, v145, s33, v151
v_dot2_f32_bf16 v152, v146, s32, v152
v_dot2_f32_bf16 v153, v146, s33, v153
v_dot2_f32_bf16 v154, v147, s32, v154
v_dot2_f32_bf16 v155, v147, s33, v155
s_waitcnt lgkmcnt(0)
v_dot2_f32_bf16 v188, v184, s32, v188
v_dot2_f32_bf16 v189, v184, s33, v189
v_dot2_f32_bf16 v190, v185, s32, v190
v_dot2_f32_bf16 v191, v185, s33, v191
v_dot2_f32_bf16 v192, v186, s32, v192
v_dot2_f32_bf16 v193, v186, s33, v193
v_dot2_f32_bf16 v194, v187, s32, v194
v_dot2_f32_bf16 v195, v187, s33, v195
s_waitcnt vmcnt(6)
v_lshlrev_b32 v28, 16, v36
v_and_b32 v29, 0xffff0000, v36
v_lshlrev_b32 v30, 16, v37
v_and_b32 v31, 0xffff0000, v37
v_lshlrev_b32 v32, 16, v38
v_and_b32 v33, 0xffff0000, v38
v_lshlrev_b32 v34, 16, v39
v_and_b32 v35, 0xffff0000, v39
v_fma_f32 v52, v52, v28, v44
v_fma_f32 v53, v53, v29, v45
v_fma_f32 v54, v54, v30, v46
v_fma_f32 v55, v55, v31, v47
v_fma_f32 v56, v56, v32, v48
v_fma_f32 v57, v57, v33, v49
v_fma_f32 v58, v58, v34, v50
v_fma_f32 v59, v59, v35, v51
v_lshlrev_b32 v28, 16, v60
v_and_b32 v29, 0xffff0000, v60
v_lshlrev_b32 v30, 16, v61
v_and_b32 v31, 0xffff0000, v61
v_lshlrev_b32 v32, 16, v62
v_and_b32 v33, 0xffff0000, v62
v_lshlrev_b32 v34, 16, v63
v_and_b32 v35, 0xffff0000, v63
v_fma_f32 v76, v76, v28, v68
v_fma_f32 v77, v77, v29, v69
v_fma_f32 v78, v78, v30, v70
v_fma_f32 v79, v79, v31, v71
v_fma_f32 v80, v80, v32, v72
v_fma_f32 v81, v81, v33, v73
v_fma_f32 v82, v82, v34, v74
v_fma_f32 v83, v83, v35, v75
v_lshlrev_b32 v28, 16, v84
v_and_b32 v29, 0xffff0000, v84
v_lshlrev_b32 v30, 16, v85
v_and_b32 v31, 0xffff0000, v85
v_lshlrev_b32 v32, 16, v86
v_and_b32 v33, 0xffff0000, v86
v_lshlrev_b32 v34, 16, v87
v_and_b32 v35, 0xffff0000, v87
v_fma_f32 v100, v100, v28, v92
v_fma_f32 v101, v101, v29, v93
v_fma_f32 v102, v102, v30, v94
v_fma_f32 v103, v103, v31, v95
v_fma_f32 v104, v104, v32, v96
v_fma_f32 v105, v105, v33, v97
v_fma_f32 v106, v106, v34, v98
v_fma_f32 v107, v107, v35, v99
Llw2:
v_mov_b32 v10, 0
s_waitcnt vmcnt(5)
v_max3_u32 v10, v10, v132, v133
v_max3_u32 v10, v10, v134, v135
s_waitcnt vmcnt(4)
v_max3_u32 v10, v10, v136, v137
v_max3_u32 v10, v10, v138, v139
s_waitcnt vmcnt(3)
v_max3_u32 v10, v10, v140, v141
v_max3_u32 v10, v10, v142, v143
s_waitcnt vmcnt(2)
v_max3_u32 v10, v10, v172, v173
v_max3_u32 v10, v10, v174, v175
s_waitcnt vmcnt(1)
v_max3_u32 v10, v10, v176, v177
v_max3_u32 v10, v10, v178, v179
s_waitcnt vmcnt(0)
v_max3_u32 v10, v10, v180, v181
v_max3_u32 v10, v10, v182, v183
v_cmp_eq_u32 vcc, -1, v10
s_cbranch_vccz Llok2
s_add_u32 s10, s10, 1
s_cmp_lt_u32 s10, 0x8000
s_cbranch_scc1 Llate2
Llok2:
v_dot2_f32_bf16 v148, v132, s32, v148
v_dot2_f32_bf16 v149, v132, s33, v149
v_dot2_f32_bf16 v150, v133, s32, v150
v_dot2_f32_bf16 v151, v133, s33, v151
v_dot2_f32_bf16 v152, v134, s32, v152
v_dot2_f32_bf16 v153, v134, s33, v153
v_dot2_f32_bf16 v154, v135, s32, v154
v_dot2_f32_bf16 v155, v135, s33, v155
v_dot2_f32_bf16 v148, v136, s32, v148
v_dot2_f32_bf16 v149, v136, s33, v149
v_dot2_f32_bf16 v150, v137, s32, v150
v_dot2_f32_bf16 v151, v137, s33, v151
v_dot2_f32_bf16 v152, v138, s32, v152
v_dot2_f32_bf16 v153, v138, s33, v153
v_dot2_f32_bf16 v154, v139, s32, v154
v_dot2_f32_bf16 v155, v139, s33, v155
v_dot2_f32_bf16 v148, v140, s32, v148
v_dot2_f32_bf16 v149, v140, s33, v149
v_dot2_f32_bf16 v150, v141, s32, v150
v_dot2_f32_bf16 v151, v141, s33, v151
v_dot2_f32_bf16 v152, v142, s32, v152
v_dot2_f32_bf16 v153, v142, s33, v153
v_dot2_f32_bf16 v154, v143, s32, v154
v_dot2_f32_bf16 v155, v143, s33, v155
s_nop 2
v_permlane16_swap_b32 v148, v152
v_permlane16_swap_b32 v149, v153
v_permlane16_swap_b32 v150, v154
v_permlane16_swap_b32 v151, v155
v_fma_f32 v52, v148, s40, v52
v_fma_f32 v53, v149, s40, v53
v_fma_f32 v54, v150, s40, v54
v_fma_f32 v55, v151, s40, v55
v_fma_f32 v56, v152, s40, v56
v_fma_f32 v57, v153, s40, v57
v_fma_f32 v58, v154, s40, v58
v_fma_f32 v59, v155, s40, v59
v_cvt_pk_bf16_f32 v44, v52, v53
v_cvt_pk_bf16_f32 v45, v54, v55
v_cvt_pk_bf16_f32 v46, v56, v57
v_cvt_pk_bf16_f32 v47, v58, v59
buffer_store_dwordx4 v[44:47], v42, s[56:59], 0 offen
v_dot2_f32_bf16 v188, v172, s32, v188
v_dot2_f32_bf16 v189, v172, s33, v189
v_dot2_f32_bf16 v190, v173, s32, v190
v_dot2_f32_bf16 v191, v173, s33, v191
v_dot2_f32_bf16 v192, v174, s32, v192
v_dot2_f32_bf16 v193, v174, s33, v193
v_dot2_f32_bf16 v194, v175, s32, v194
v_dot2_f32_bf16 v195, v175, s33, v195
v_dot2_f32_bf16 v188, v176, s32, v188
v_dot2_f32_bf16 v189, v176, s33, v189
v_dot2_f32_bf16 v190, v177, s32, v190
v_dot2_f32_bf16 v191, v177, s33, v191
v_dot2_f32_bf16 v192, v178, s32, v192
v_dot2_f32_bf16 v193, v178, s33, v193
v_dot2_f32_bf16 v194, v179, s32, v194
v_dot2_f32_bf16 v195, v179, s33, v195
v_dot2_f32_bf16 v188, v180, s32, v188
v_dot2_f32_bf16 v189, v180, s33, v189
v_dot2_f32_bf16 v190, v181, s32, v190
v_dot2_f32_bf16 v191, v181, s33, v191
v_dot2_f32_bf16 v192, v182, s32, v192
v_dot2_f32_bf16 v193, v182, s33, v193
v_dot2_f32_bf16 v194, v183, s32, v194
v_dot2_f32_bf16 v195, v183, s33, v195
s_nop 2
v_permlane16_swap_b32 v188, v192
v_permlane16_swap_b32 v189, v193
v_permlane16_swap_b32 v190, v194
v_permlane16_swap_b32 v191, v195
v_fma_f32 v76, v188, s40, v76
v_fma_f32 v77, v189, s40, v77
v_fma_f32 v78, v190, s40, v78
v_fma_f32 v79, v191, s40, v79
v_fma_f32 v80, v192, s40, v80
v_fma_f32 v81, v193, s40, v81
v_fma_f32 v82, v194, s40, v82
v_fma_f32 v83, v195, s40, v83
v_cvt_pk_bf16_f32 v68, v76, v77
v_cvt_pk_bf16_f32 v69, v78, v79
v_cvt_pk_bf16_f32 v70, v80, v81
v_cvt_pk_bf16_f32 v71, v82, v83
buffer_store_dwordx4 v[68:71], v66, s[56:59], 0 offen
s_nop 2
v_permlane16_swap_b32 v228, v232
v_permlane16_swap_b32 v229, v233
v_permlane16_swap_b32 v230, v234
v_permlane16_swap_b32 v231, v235
v_fma_f32 v100, v228, s40, v100
v_fma_f32 v101, v229, s40, v101
v_fma_f32 v102, v230, s40, v102
v_fma_f32 v103, v231, s40, v103
v_fma_f32 v104, v232, s40, v104
v_fma_f32 v105, v233, s40, v105
v_fma_f32 v106, v234, s40, v106
v_fma_f32 v107, v235, s40, v107
v_cvt_pk_bf16_f32 v92, v100, v101
v_cvt_pk_bf16_f32 v93, v102, v103
v_cvt_pk_bf16_f32 v94, v104, v105
v_cvt_pk_bf16_f32 v95, v106, v107
buffer_store_dwordx4 v[92:95], v90, s[56:59], s42 offen
s_endpgm
LwQst:
ds_read_b32 v27, v21
s_add_u32 s100, s100, 1
s_cmp_gt_u32 s100, 0x800000
s_cbranch_scc1 LrQst
s_waitcnt lgkmcnt(0)
v_cmp_gt_u32 vcc, 10, v27
s_cbranch_vccz LrQst
s_sleep 1
s_branch LwQst
LwQo:
ds_read_b32 v27, v20
s_add_u32 s100, s100, 1
s_cmp_gt_u32 s100, 0x800000
s_cbranch_scc1 LrQo
s_waitcnt lgkmcnt(0)
v_cmp_gt_u32 vcc, 1, v27
s_cbranch_vccz LrQo
s_sleep 1
s_branch LwQo
LwQr:
ds_read_b32 v27, v21
s_add_u32 s100, s100, 1
s_cmp_gt_u32 s100, 0x800000
s_cbranch_scc1 LrQr
s_waitcnt lgkmcnt(0)
v_cmp_gt_u32 vcc, 11, v27
s_cbranch_vccz LrQr
s_sleep 1
s_branch LwQr
LwQs:
ds_read_b32 v27, v20
s_add_u32 s100, s100, 1
s_cmp_gt_u32 s100, 0x800000
s_cbranch_scc1 LrQs
s_waitcnt lgkmcnt(0)
v_cmp_gt_u32 vcc, 2, v27
s_cbranch_vccz LrQs
s_sleep 1
s_branch LwQs
LwQo0:
ds_read_b32 v23, v21
s_add_u32 s100, s100, 1
s_cmp_gt_u32 s100, 0x800000
s_cbranch_scc1 LrQo0
s_waitcnt lgkmcnt(0)
v_cmp_gt_u32 vcc, 12, v23
s_cbranch_vccz LrQo0
s_sleep 1
s_branch LwQo0
LwQo1:
ds_read_b32 v23, v21
s_add_u32 s100, s100, 1
s_cmp_gt_u32 s100, 0x800000
s_cbranch_scc1 LrQo1
s_waitcnt lgkmcnt(0)
v_cmp_gt_u32 vcc, 13, v23
s_cbranch_vccz LrQo1
s_sleep 1
s_branch LwQo1
LwQo2:
ds_read_b32 v23, v21
s_add_u32 s100, s100, 1
s_cmp_gt_u32 s100, 0x800000
s_cbranch_scc1 LrQo2
s_waitcnt lgkmcnt(0)
v_cmp_gt_u32 vcc, 14, v23
s_cbranch_vccz LrQo2
s_sleep 1
s_branch LwQo2
LwQo3:
ds_read_b32 v23, v21
s_add_u32 s100, s100, 1
s_cmp_gt_u32 s100, 0x800000
s_cbranch_scc1 LrQo3
s_waitcnt lgkmcnt(0)
v_cmp_gt_u32 vcc, 15, v23
s_cbranch_vccz LrQo3
s_sleep 1
s_branch LwQo3
LwQo4:
ds_read_b32 v23, v21
s_add_u32 s100, s100, 1
s_cmp_gt_u32 s100, 0x800000
s_cbranch_scc1 LrQo4
s_waitcnt lgkmcnt(0)
v_cmp_gt_u32 vcc, 16, v23
s_cbranch_vccz LrQo4
s_sleep 1
s_branch LwQo4
LwQo5:
ds_read_b32 v23, v21
s_add_u32 s100, s100, 1
s_cmp_gt_u32 s100, 0x800000
s_cbranch_scc1 LrQo5
s_waitcnt lgkmcnt(0)
v_cmp_gt_u32 vcc, 17, v23
s_cbranch_vccz LrQo5
s_sleep 1
s_branch LwQo5
LwQo6:
ds_read_b32 v23, v21
s_add_u32 s100, s100, 1
s_cmp_gt_u32 s100, 0x800000
s_cbranch_scc1 LrQo6
s_waitcnt lgkmcnt(0)
v_cmp_gt_u32 vcc, 18, v23
s_cbranch_vccz LrQo6
s_sleep 1
s_branch LwQo6
LwQo7:
ds_read_b32 v23, v21
s_add_u32 s100, s100, 1
s_cmp_gt_u32 s100, 0x800000
s_cbranch_scc1 LrQo7
s_waitcnt lgkmcnt(0)
v_cmp_gt_u32 vcc, 19, v23
s_cbranch_vccz LrQo7
s_sleep 1
s_branch LwQo7
LwQo8:
ds_read_b32 v23, v21
s_add_u32 s100, s100, 1
s_cmp_gt_u32 s100, 0x800000
s_cbranch_scc1 LrQo8
s_waitcnt lgkmcnt(0)
v_cmp_gt_u32 vcc, 20, v23
s_cbranch_vccz LrQo8
s_sleep 1
s_branch LwQo8
LwQo9:
ds_read_b32 v23, v21
s_add_u32 s100, s100, 1
s_cmp_gt_u32 s100, 0x800000
s_cbranch_scc1 LrQo9
s_waitcnt lgkmcnt(0)
v_cmp_gt_u32 vcc, 21, v23
s_cbranch_vccz LrQo9
s_sleep 1
s_branch LwQo9
LwQo10:
ds_read_b32 v23, v21
s_add_u32 s100, s100, 1
s_cmp_gt_u32 s100, 0x800000
s_cbranch_scc1 LrQo10
s_waitcnt lgkmcnt(0)
v_cmp_gt_u32 vcc, 22, v23
s_cbranch_vccz LrQo10
s_sleep 1
s_branch LwQo10
LwQo11:
ds_read_b32 v23, v21
s_add_u32 s100, s100, 1
s_cmp_gt_u32 s100, 0x800000
s_cbranch_scc1 LrQo11
s_waitcnt lgkmcnt(0)
v_cmp_gt_u32 vcc, 23, v23
s_cbranch_vccz LrQo11
s_sleep 1
s_branch LwQo11
LwQo12:
ds_read_b32 v23, v21
s_add_u32 s100, s100, 1
s_cmp_gt_u32 s100, 0x800000
s_cbranch_scc1 LrQo12
s_waitcnt lgkmcnt(0)
v_cmp_gt_u32 vcc, 24, v23
s_cbranch_vccz LrQo12
s_sleep 1
s_branch LwQo12
LwQo13:
ds_read_b32 v23, v21
s_add_u32 s100, s100, 1
s_cmp_gt_u32 s100, 0x800000
s_cbranch_scc1 LrQo13
s_waitcnt lgkmcnt(0)
v_cmp_gt_u32 vcc, 25, v23
s_cbranch_vccz LrQo13
s_sleep 1
s_branch LwQo13
LwQo14:
ds_read_b32 v23, v21
s_add_u32 s100, s100, 1
s_cmp_gt_u32 s100, 0x800000
s_cbranch_scc1 LrQo14
s_waitcnt lgkmcnt(0)
v_cmp_gt_u32 vcc, 26, v23
s_cbranch_vccz LrQo14
s_sleep 1
s_branch LwQo14
LwQo15:
ds_read_b32 v23, v21
s_add_u32 s100, s100, 1
s_cmp_gt_u32 s100, 0x800000
s_cbranch_scc1 LrQo15
s_waitcnt lgkmcnt(0)
v_cmp_gt_u32 vcc, 27, v23
s_cbranch_vccz LrQo15
s_sleep 1
s_branch LwQo15
LwQa:
ds_read_b32 v27, v21
s_add_u32 s100, s100, 1
s_cmp_gt_u32 s100, 0x800000
s_cbranch_scc1 LrQa
s_waitcnt lgkmcnt(0)
v_cmp_gt_u32 vcc, 30, v27
s_cbranch_vccz LrQa
s_sleep 1
s_branch LwQa
LwQp:
ds_read_b32 v27, v20
s_add_u32 s100, s100, 1
s_cmp_gt_u32 s100, 0x800000
s_cbranch_scc1 LrQp
s_waitcnt lgkmcnt(0)
v_cmp_gt_u32 vcc, 3, v27
s_cbranch_vccz LrQp
s_sleep 1
s_branch LwQp
LwQc:
ds_read_b32 v27, v21
s_add_u32 s100, s100, 1
s_cmp_gt_u32 s100, 0x800000
s_cbranch_scc1 LrQc
s_waitcnt lgkmcnt(0)
v_cmp_gt_u32 vcc, 33, v27
s_cbranch_vccz LrQc
s_sleep 1
s_branch LwQc
LwQd:
ds_read_b32 v27, v20
s_add_u32 s100, s100, 1
s_cmp_gt_u32 s100, 0x800000
s_cbranch_scc1 LrQd
s_waitcnt lgkmcnt(0)
v_cmp_gt_u32 vcc, 4, v27
s_cbranch_vccz LrQd
s_sleep 1
s_branch LwQd
LwQb:
ds_read_b32 v27, v20
s_add_u32 s100, s100, 1
s_cmp_gt_u32 s100, 0x800000
s_cbranch_scc1 LrQb
s_waitcnt lgkmcnt(0)
v_cmp_gt_u32 vcc, 23, v27
s_cbranch_vccz LrQb
s_sleep 1
s_branch LwQb
LwQz:
ds_read_b32 v27, v20
s_add_u32 s100, s100, 1
s_cmp_gt_u32 s100, 0x800000
s_cbranch_scc1 LrQz
s_waitcnt lgkmcnt(0)
v_cmp_gt_u32 vcc, 25, v27
s_cbranch_vccz LrQz
s_sleep 1
s_branch LwQz
LwP0:
ds_read_b32 v27, v21
s_add_u32 s100, s100, 1
s_cmp_gt_u32 s100, 0x800000
s_cbranch_scc1 LrP0
s_waitcnt lgkmcnt(0)
v_cmp_gt_u32 vcc, 1, v27
s_cbranch_vccz LrP0
s_sleep 1
s_branch LwP0
LwPg1:
ds_read_b32 v27, v21
s_add_u32 s100, s100, 1
s_cmp_gt_u32 s100, 0x800000
s_cbranch_scc1 LrPg1
s_waitcnt lgkmcnt(0)
v_cmp_gt_u32 vcc, 2, v27
s_cbranch_vccz LrPg1
s_sleep 1
s_branch LwPg1
LwPg3:
ds_read_b32 v27, v21
s_add_u32 s100, s100, 1
s_cmp_gt_u32 s100, 0x800000
s_cbranch_scc1 LrPg3
s_waitcnt lgkmcnt(0)
v_cmp_gt_u32 vcc, 3, v27
s_cbranch_vccz LrPg3
s_sleep 1
s_branch LwPg3
LwPg5:
ds_read_b32 v27, v21
s_add_u32 s100, s100, 1
s_cmp_gt_u32 s100, 0x800000
s_cbranch_scc1 LrPg5
s_waitcnt lgkmcnt(0)
v_cmp_gt_u32 vcc, 4, v27
s_cbranch_vccz LrPg5
s_sleep 1
s_branch LwPg5
LwPg7:
ds_read_b32 v27, v21
s_add_u32 s100, s100, 1
s_cmp_gt_u32 s100, 0x800000
s_cbranch_scc1 LrPg7
s_waitcnt lgkmcnt(0)
v_cmp_gt_u32 vcc, 5, v27
s_cbranch_vccz LrPg7
s_sleep 1
s_branch LwPg7
LwPg9:
ds_read_b32 v27, v21
s_add_u32 s100, s100, 1
s_cmp_gt_u32 s100, 0x800000
s_cbranch_scc1 LrPg9
s_waitcnt lgkmcnt(0)
v_cmp_gt_u32 vcc, 6, v27
s_cbranch_vccz LrPg9
s_sleep 1
s_branch LwPg9
LwPg11:
ds_read_b32 v27, v21
s_add_u32 s100, s100, 1
s_cmp_gt_u32 s100, 0x800000
s_cbranch_scc1 LrPg11
s_waitcnt lgkmcnt(0)
v_cmp_gt_u32 vcc, 7, v27
s_cbranch_vccz LrPg11
s_sleep 1
s_branch LwPg11
LwPg13:
ds_read_b32 v27, v21
s_add_u32 s100, s100, 1
s_cmp_gt_u32 s100, 0x800000
s_cbranch_scc1 LrPg13
s_waitcnt lgkmcnt(0)
v_cmp_gt_u32 vcc, 8, v27
s_cbranch_vccz LrPg13
s_sleep 1
s_branch LwPg13
LwPg15:
ds_read_b32 v27, v21
s_add_u32 s100, s100, 1
s_cmp_gt_u32 s100, 0x800000
s_cbranch_scc1 LrPg15
s_waitcnt lgkmcnt(0)
v_cmp_gt_u32 vcc, 9, v27
s_cbranch_vccz LrPg15
s_sleep 1
s_branch LwPg15
LwPst:
ds_read_b32 v27, v21
s_add_u32 s100, s100, 1
s_cmp_gt_u32 s100, 0x800000
s_cbranch_scc1 LrPst
s_waitcnt lgkmcnt(0)
v_cmp_gt_u32 vcc, 10, v27
s_cbranch_vccz LrPst
s_sleep 1
s_branch LwPst
LwPa:
ds_read_b32 v27, v20
s_add_u32 s100, s100, 1
s_cmp_gt_u32 s100, 0x800000
s_cbranch_scc1 LrPa
s_waitcnt lgkmcnt(0)
v_cmp_gt_u32 vcc, 3, v27
s_cbranch_vccz LrPa
s_sleep 1
s_branch LwPa
LwPb:
ds_read_b32 v27, v21
s_add_u32 s100, s100, 1
s_cmp_gt_u32 s100, 0x800000
s_cbranch_scc1 LrPb
s_waitcnt lgkmcnt(0)
v_cmp_gt_u32 vcc, 16, v27
s_cbranch_vccz LrPb
s_sleep 1
s_branch LwPb
LwPb2:
ds_read_b32 v27, v21
s_add_u32 s100, s100, 1
s_cmp_gt_u32 s100, 0x800000
s_cbranch_scc1 LrPb2
s_waitcnt lgkmcnt(0)
v_cmp_gt_u32 vcc, 20, v27
s_cbranch_vccz LrPb2
s_sleep 1
s_branch LwPb2
LwPc0:
ds_read_b32 v27, v21
s_add_u32 s100, s100, 1
s_cmp_gt_u32 s100, 0x800000
s_cbranch_scc1 LrPc0
s_waitcnt lgkmcnt(0)
v_cmp_gt_u32 vcc, 27, v27
s_cbranch_vccz LrPc0
s_sleep 1
s_branch LwPc0
LwPd:
ds_read_b32 v27, v20
s_add_u32 s100, s100, 1
s_cmp_gt_u32 s100, 0x800000
s_cbranch_scc1 LrPd
s_waitcnt lgkmcnt(0)
v_cmp_gt_u32 vcc, 5, v27
s_cbranch_vccz LrPd
s_sleep 1
s_branch LwPd
LwPc3:
ds_read_b32 v27, v21
s_add_u32 s100, s100, 1
s_cmp_gt_u32 s100, 0x800000
s_cbranch_scc1 LrPc3
s_waitcnt lgkmcnt(0)
v_cmp_gt_u32 vcc, 29, v27
s_cbranch_vccz LrPc3
s_sleep 1
s_branch LwPc3
LwPo0:
ds_read_b32 v23, v20
s_add_u32 s100, s100, 1
s_cmp_gt_u32 s100, 0x800000
s_cbranch_scc1 LrPo0
s_waitcnt lgkmcnt(0)
v_cmp_gt_u32 vcc, 6, v23
s_cbranch_vccz LrPo0
s_sleep 1
s_branch LwPo0
LwPo1:
ds_read_b32 v23, v20
s_add_u32 s100, s100, 1
s_cmp_gt_u32 s100, 0x800000
s_cbranch_scc1 LrPo1
s_waitcnt lgkmcnt(0)
v_cmp_gt_u32 vcc, 7, v23
s_cbranch_vccz LrPo1
s_sleep 1
s_branch LwPo1
LwPo2:
ds_read_b32 v23, v20
s_add_u32 s100, s100, 1
s_cmp_gt_u32 s100, 0x800000
s_cbranch_scc1 LrPo2
s_waitcnt lgkmcnt(0)
v_cmp_gt_u32 vcc, 8, v23
s_cbranch_vccz LrPo2
s_sleep 1
s_branch LwPo2
LwPo3:
ds_read_b32 v23, v20
s_add_u32 s100, s100, 1
s_cmp_gt_u32 s100, 0x800000
s_cbranch_scc1 LrPo3
s_waitcnt lgkmcnt(0)
v_cmp_gt_u32 vcc, 9, v23
s_cbranch_vccz LrPo3
s_sleep 1
s_branch LwPo3
LwPo4:
ds_read_b32 v23, v20
s_add_u32 s100, s100, 1
s_cmp_gt_u32 s100, 0x800000
s_cbranch_scc1 LrPo4
s_waitcnt lgkmcnt(0)
v_cmp_gt_u32 vcc, 10, v23
s_cbranch_vccz LrPo4
s_sleep 1
s_branch LwPo4
LwPo5:
ds_read_b32 v23, v20
s_add_u32 s100, s100, 1
s_cmp_gt_u32 s100, 0x800000
s_cbranch_scc1 LrPo5
s_waitcnt lgkmcnt(0)
v_cmp_gt_u32 vcc, 11, v23
s_cbranch_vccz LrPo5
s_sleep 1
s_branch LwPo5
LwPo6:
ds_read_b32 v23, v20
s_add_u32 s100, s100, 1
s_cmp_gt_u32 s100, 0x800000
s_cbranch_scc1 LrPo6
s_waitcnt lgkmcnt(0)
v_cmp_gt_u32 vcc, 12, v23
s_cbranch_vccz LrPo6
s_sleep 1
s_branch LwPo6
LwPg25:
ds_read_b32 v27, v21
s_add_u32 s100, s100, 1
s_cmp_gt_u32 s100, 0x800000
s_cbranch_scc1 LrPg25
s_waitcnt lgkmcnt(0)
v_cmp_gt_u32 vcc, 31, v27
s_cbranch_vccz LrPg25
s_sleep 1
s_branch LwPg25
LwPo7:
ds_read_b32 v23, v20
s_add_u32 s100, s100, 1
s_cmp_gt_u32 s100, 0x800000
s_cbranch_scc1 LrPo7
s_waitcnt lgkmcnt(0)
v_cmp_gt_u32 vcc, 13, v23
s_cbranch_vccz LrPo7
s_sleep 1
s_branch LwPo7
LwPo8:
ds_read_b32 v23, v20
s_add_u32 s100, s100, 1
s_cmp_gt_u32 s100, 0x800000
s_cbranch_scc1 LrPo8
s_waitcnt lgkmcnt(0)
v_cmp_gt_u32 vcc, 14, v23
s_cbranch_vccz LrPo8
s_sleep 1
s_branch LwPo8
LwPo9:
ds_read_b32 v23, v20
s_add_u32 s100, s100, 1
s_cmp_gt_u32 s100, 0x800000
s_cbranch_scc1 LrPo9
s_waitcnt lgkmcnt(0)
v_cmp_gt_u32 vcc, 15, v23
s_cbranch_vccz LrPo9
s_sleep 1
s_branch LwPo9
LwPo10:
ds_read_b32 v23, v20
s_add_u32 s100, s100, 1
s_cmp_gt_u32 s100, 0x800000
s_cbranch_scc1 LrPo10
s_waitcnt lgkmcnt(0)
v_cmp_gt_u32 vcc, 16, v23
s_cbranch_vccz LrPo10
s_sleep 1
s_branch LwPo10
LwPg29:
ds_read_b32 v27, v21
s_add_u32 s100, s100, 1
s_cmp_gt_u32 s100, 0x800000
s_cbranch_scc1 LrPg29
s_waitcnt lgkmcnt(0)
v_cmp_gt_u32 vcc, 32, v27
s_cbranch_vccz LrPg29
s_sleep 1
s_branch LwPg29
LwPo11:
ds_read_b32 v23, v20
s_add_u32 s100, s100, 1
s_cmp_gt_u32 s100, 0x800000
s_cbranch_scc1 LrPo11
s_waitcnt lgkmcnt(0)
v_cmp_gt_u32 vcc, 17, v23
s_cbranch_vccz LrPo11
s_sleep 1
s_branch LwPo11
LwPo12:
ds_read_b32 v23, v20
s_add_u32 s100, s100, 1
s_cmp_gt_u32 s100, 0x800000
s_cbranch_scc1 LrPo12
s_waitcnt lgkmcnt(0)
v_cmp_gt_u32 vcc, 18, v23
s_cbranch_vccz LrPo12
s_sleep 1
s_branch LwPo12
LwPo13:
ds_read_b32 v23, v20
s_add_u32 s100, s100, 1
s_cmp_gt_u32 s100, 0x800000
s_cbranch_scc1 LrPo13
s_waitcnt lgkmcnt(0)
v_cmp_gt_u32 vcc, 19, v23
s_cbranch_vccz LrPo13
s_sleep 1
s_branch LwPo13
LwPo14:
ds_read_b32 v23, v20
s_add_u32 s100, s100, 1
s_cmp_gt_u32 s100, 0x800000
s_cbranch_scc1 LrPo14
s_waitcnt lgkmcnt(0)
v_cmp_gt_u32 vcc, 20, v23
s_cbranch_vccz LrPo14
s_sleep 1
s_branch LwPo14
LwPg33:
ds_read_b32 v27, v21
s_add_u32 s100, s100, 1
s_cmp_gt_u32 s100, 0x800000
s_cbranch_scc1 LrPg33
s_waitcnt lgkmcnt(0)
v_cmp_gt_u32 vcc, 33, v27
s_cbranch_vccz LrPg33
s_sleep 1
s_branch LwPg33
LwPo15:
ds_read_b32 v23, v20
s_add_u32 s100, s100, 1
s_cmp_gt_u32 s100, 0x800000
s_cbranch_scc1 LrPo15
s_waitcnt lgkmcnt(0)
v_cmp_gt_u32 vcc, 21, v23
s_cbranch_vccz LrPo15
s_sleep 1
s_branch LwPo15
LwPt:
ds_read_b32 v27, v21
s_add_u32 s100, s100, 1
s_cmp_gt_u32 s100, 0x800000
s_cbranch_scc1 LrPt
s_waitcnt lgkmcnt(0)
v_cmp_gt_u32 vcc, 34, v27
s_cbranch_vccz LrPt
s_sleep 1
s_branch LwPt
Lmlp_end:
Lconv:
s_cmp_eq_u32 s5, 5
s_cbranch_scc1 Lhelper
s_lshl_b32 s10, s4, 2
s_add_u32 s10, s10, s5
s_and_b32 s42, s3, 3
s_mov_b32 s12, 0
s_mov_b32 s14, 0
s_lshl_b32 s13, s42, 2
s_cmp_lt_u32 s5, 4
s_cbranch_scc1 Lconv_go
s_lshr_b32 s10, s4, 1
s_add_u32 s10, s10, 32
s_mov_b32 s12, 1
s_and_b32 s14, s4, 1
s_lshl_b32 s13, s14, 2
s_add_u32 s13, s13, s42
s_lshl_b32 s13, s13, 1
Lconv_go:
s_mov_b32 s56, s24
s_and_b32 s57, s25, 0xffff
s_mov_b32 s58, 2359296
s_mov_b32 s59, 0x20000
s_lshl_b32 s11, s10, 4
s_add_u32 s11, s11, s13
v_lshlrev_b32 v12, 7, v1
s_lshl_b32 s15, s11, 12
s_cmp_ge_u32 s3, 4
s_cbranch_scc1 Lconv_nw
s_mov_b32 exec_hi, 0
buffer_load_dword v15, v12, s[56:59], s15 offen
s_mov_b32 exec_hi, -1
Lconv_nw:
v_mov_b32 v244, 0
v_mov_b32 v245, 0
v_mov_b32 v246, 0
v_mov_b32 v247, 0
s_mul_i32 s6, s42, 16640
s_add_u32 s6, s6, 0
s_mul_i32 s7, s42, 4224
s_add_u32 s7, s7, 66560
s_movk_i32 s8, 2112
s_cmp_ge_u32 s3, 4
s_cselect_b32 s6, s7, s6
s_cselect_b32 s43, s8, 4160
s_cselect_b32 s7, 3, 7
v_lshrrev_b32 v13, 5, v0
v_mul_u32_u24 v13, 4672, v13
v_and_b32 v14, 31, v0
v_lshl_add_u32 v13, v14, 4, v13
v_add_u32 v13, 83456, v13
ds_write_b128 v13, v[244:247] offset:4096
v_and_b32 v13, s7, v1
v_lshrrev_b32 v14, 1, v13
v_mul_lo_u32 v14, v14, s43
v_and_b32 v13, 1, v13
v_lshl_add_u32 v13, v13, 4, v14
v_add_u32 v13, s6, v13
ds_write_b128 v13, v[244:247]
v_mov_b32 v240, 163776
ds_write_b128 v240, v[244:247]
ds_write_b128 v240, v[244:247] offset:16
ds_write_b128 v240, v[244:247] offset:32
ds_write_b128 v240, v[244:247] offset:48
s_lshl_b32 s7, s42, 2
v_add_u32 v243, s7, v240
s_mul_i32 s101, s42, 16640
s_add_u32 s7, s101, 4160
v_mov_b32 v250, s7
s_mov_b32 s100, s11
s_mov_b32 s44, s18
s_and_b32 s45, s19, 0xffff
s_mov_b32 s46, 2359296
s_mov_b32 s47, 0x20000
s_mov_b32 s48, s20
s_and_b32 s49, s21, 0xffff
s_mov_b32 s50, 2359296
s_mov_b32 s51, 0x20000
v_lshrrev_b32 v2, 1, v0
v_and_b32 v3, 1, v0
v_mul_u32_u24 v5, 9216, v2
v_lshl_add_u32 v5, v3, 4, v5
s_lshl_b32 s7, s10, 5
v_add_u32 v5, s7, v5
v_subrev_u32 v4, 3456, v5
v_add_u32 v6, 4608, v5
s_mov_b32 s52, s22
s_and_b32 s53, s23, 0xffff
s_mov_b32 s54, 4608
s_mov_b32 s55, 0x20000
s_lshl_b32 s7, s10, 7
v_lshlrev_b32 v7, 6, v3
buffer_load_dwordx4 v[92:95], v7, s[52:55], s7 offen offset:0
buffer_load_dwordx4 v[96:99], v7, s[52:55], s7 offen offset:16
buffer_load_dwordx4 v[100:103], v7, s[52:55], s7 offen offset:32
buffer_load_dwordx4 v[104:107], v7, s[52:55], s7 offen offset:48
s_mov_b32 s64, s26
s_and_b32 s65, s27, 0xffff
s_mov_b32 s66, 1152
s_mov_b32 s67, 0x20000
s_mov_b32 s60, s40
s_and_b32 s61, s41, 0xffff
s_mov_b32 s62, 33554432
s_mov_b32 s63, 0x20000
v_lshlrev_b32 v8, 4, v1
s_lshl_b32 s7, s11, 1
buffer_load_dwordx2 v[248:249], v244, s[64:67], s7 offen
v_mul_u32_u24 v242, 2304, v1
s_lshr_b32 s7, s10, 2
s_lshl_b32 s7, s7, 8
s_and_b32 s8, s10, 3
s_lshl_b32 s8, s8, 1
s_add_u32 s8, s8, s14
s_lshl_b32 s8, s8, 2
s_add_u32 s7, s7, s8
s_add_u32 s7, s7, 27263104
v_add_u32 v242, s7, v242
s_waitcnt lgkmcnt(0)
s_barrier
s_cmp_lt_u32 s3, 4
s_cbranch_scc1 Lconv_a
Lcpollb:
ds_read_b32 v252, v240 offset:8
s_waitcnt lgkmcnt(0)
v_readfirstlane_b32 s7, v252
s_cmp_ge_u32 s7, 4
s_cbranch_scc1 Lcpollb_ok
s_sleep 2
s_branch Lcpollb
Lcpollb_ok:
s_add_u32 s100, s100, 1
s_lshl_b32 s7, s100, 12
s_add_u32 m0, s101, 8352
s_add_u32 s8, s7, 2
buffer_load_dwordx4 v8, s[56:59], s7 offen offset:0 lds
buffer_load_dwordx4 v8, s[56:59], s7 offen offset:1024 lds
buffer_load_dwordx4 v8, s[56:59], s7 offen offset:2048 lds
buffer_load_dwordx4 v8, s[56:59], s7 offen offset:3072 lds
s_add_u32 m0, m0, 4160
s_nop 0
buffer_load_dwordx4 v8, s[56:59], s8 offen offset:0 lds
buffer_load_dwordx4 v8, s[56:59], s8 offen offset:1024 lds
buffer_load_dwordx4 v8, s[56:59], s8 offen offset:2048 lds
buffer_load_dwordx4 v8, s[56:59], s8 offen offset:3072 lds
buffer_load_ushort v11, v244, s[56:59], s7 offen
s_cmp_lg_u32 s12, 0
s_cbranch_scc1 Lconv_ld
s_add_u32 s15, s15, 8192
buffer_load_dword v15, v12, s[56:59], s15 offen
s_branch Lconv_ld
Lconv_a:
s_waitcnt vmcnt(0)
Lconv_ld:
buffer_load_dwordx4 v[28:31], v5, s[44:47], 0 offen offset:0
buffer_load_dwordx4 v[32:35], v5, s[44:47], 0 offen offset:1152
buffer_load_dwordx4 v[36:39], v5, s[44:47], 0 offen offset:2304
buffer_load_dwordx4 v[40:43], v5, s[44:47], 0 offen offset:3456
buffer_load_dwordx4 v[44:47], v6, s[44:47], 0 offen offset:0
buffer_load_dwordx4 v[48:51], v6, s[44:47], 0 offen offset:1152
buffer_load_dwordx4 v[52:55], v6, s[44:47], 0 offen offset:2304
buffer_load_dwordx4 v[56:59], v6, s[44:47], 0 offen offset:3456
s_cmp_lt_u32 s3, 4
s_cbranch_scc1 LoB1
s_waitcnt vmcnt(8)
s_lshl_b32 s7, s12, 1
s_add_u32 s7, s7, 1
ds_write_b16 v250, v11 offset:8350
v_mov_b32 v251, s7
s_waitcnt lgkmcnt(0)
ds_write_b32 v243, v251 offset:32
LoB1:
buffer_load_dwordx4 v[60:63], v5, s[48:51], 0 offen offset:0
buffer_load_dwordx4 v[64:67], v5, s[48:51], 0 offen offset:1152
buffer_load_dwordx4 v[68:71], v5, s[48:51], 0 offen offset:2304
buffer_load_dwordx4 v[72:75], v5, s[48:51], 0 offen offset:3456
buffer_load_dwordx4 v[76:79], v6, s[48:51], 0 offen offset:0
buffer_load_dwordx4 v[80:83], v6, s[48:51], 0 offen offset:1152
buffer_load_dwordx4 v[84:87], v6, s[48:51], 0 offen offset:2304
buffer_load_dwordx4 v[88:91], v6, s[48:51], 0 offen offset:3456
s_mov_b32 exec_lo, 0x00030003
s_mov_b32 exec_hi, 0x00030003
buffer_load_dwordx4 v[16:19], v4, s[44:47], 0 offen offset:0
buffer_load_dwordx4 v[20:23], v4, s[44:47], 0 offen offset:1152
buffer_load_dwordx4 v[24:27], v4, s[44:47], 0 offen offset:2304
s_mov_b64 exec, -1
s_lshl_b32 s7, s11, 12
s_add_u32 m0, s6, 32
s_add_u32 s8, s7, 2
buffer_load_dwordx4 v8, s[56:59], s7 offen offset:0 lds
buffer_load_dwordx4 v8, s[56:59], s7 offen offset:1024 lds
s_cmp_ge_u32 s3, 4
s_cbranch_scc1 Lh0a
buffer_load_dwordx4 v8, s[56:59], s7 offen offset:2048 lds
buffer_load_dwordx4 v8, s[56:59], s7 offen offset:3072 lds
Lh0a:
s_add_u32 m0, m0, s43
s_nop 0
buffer_load_dwordx4 v8, s[56:59], s8 offen offset:0 lds
buffer_load_dwordx4 v8, s[56:59], s8 offen offset:1024 lds
s_cmp_ge_u32 s3, 4
s_cbranch_scc1 Lh0b
buffer_load_dwordx4 v8, s[56:59], s8 offen offset:2048 lds
buffer_load_dwordx4 v8, s[56:59], s8 offen offset:3072 lds
Lh0b:
buffer_load_ushort v9, v244, s[56:59], s7 offen
v_mov_b32 v12, 1
s_mov_b64 exec, 1
ds_add_u32 v240, v12 offset:8
s_mov_b64 exec, 67108863
s_cmp_eq_u32 s3, 7
s_cselect_b32 s7, 0, 0x40000000
buffer_load_dword v241, v242, s[60:63], s7 offen sc1
s_mov_b64 exec, -1
v_mul_u32_u24 v14, 37376, v3
v_lshlrev_b32 v12, 4, v2
v_sub_u32 v14, v14, v12
v_add_u32 v14, 87536, v14
s_cmp_lt_u32 s3, 4
s_cbranch_scc1 LoB2
s_cmp_lg_u32 s12, 0
s_cbranch_scc1 LoB2
Lcpa1:
ds_read_b32 v252, v243 offset:48
s_waitcnt lgkmcnt(0)
v_readfirstlane_b32 s7, v252
s_cmp_ge_u32 s7, 1
s_cbranch_scc1 Lcpa1_ok
s_sleep 2
s_branch Lcpa1
Lcpa1_ok:
s_add_u32 s100, s100, 1
s_lshl_b32 s7, s100, 12
s_add_u32 m0, s101, 32
s_add_u32 s8, s7, 2
buffer_load_dwordx4 v8, s[56:59], s7 offen offset:0 lds
buffer_load_dwordx4 v8, s[56:59], s7 offen offset:1024 lds
buffer_load_dwordx4 v8, s[56:59], s7 offen offset:2048 lds
buffer_load_dwordx4 v8, s[56:59], s7 offen offset:3072 lds
s_add_u32 m0, m0, 4160
s_nop 0
buffer_load_dwordx4 v8, s[56:59], s8 offen offset:0 lds
buffer_load_dwordx4 v8, s[56:59], s8 offen offset:1024 lds
buffer_load_dwordx4 v8, s[56:59], s8 offen offset:2048 lds
buffer_load_dwordx4 v8, s[56:59], s8 offen offset:3072 lds
buffer_load_ushort v11, v244, s[56:59], s7 offen
s_waitcnt vmcnt(0)
ds_write_b16 v250, v11 offset:30
v_mov_b32 v251, 2
s_waitcnt lgkmcnt(0)
ds_write_b32 v243, v251 offset:32
LoB2:
s_waitcnt vmcnt(6)
v_mov_b32_dpp v16, v48 row_shr:2 row_mask:0xf bank_mask:0xf
v_mov_b32_dpp v17, v49 row_shr:2 row_mask:0xf bank_mask:0xf
v_mov_b32_dpp v18, v50 row_shr:2 row_mask:0xf bank_mask:0xf
v_mov_b32_dpp v19, v51 row_shr:2 row_mask:0xf bank_mask:0xf
v_mov_b32_dpp v20, v52 row_shr:2 row_mask:0xf bank_mask:0xf
v_mov_b32_dpp v21, v53 row_shr:2 row_mask:0xf bank_mask:0xf
v_mov_b32_dpp v22, v54 row_shr:2 row_mask:0xf bank_mask:0xf
v_mov_b32_dpp v23, v55 row_shr:2 row_mask:0xf bank_mask:0xf
v_mov_b32_dpp v24, v56 row_shr:2 row_mask:0xf bank_mask:0xf
v_mov_b32_dpp v25, v57 row_shr:2 row_mask:0xf bank_mask:0xf
v_mov_b32_dpp v26, v58 row_shr:2 row_mask:0xf bank_mask:0xf
v_mov_b32_dpp v27, v59 row_shr:2 row_mask:0xf bank_mask:0xf
v_lshlrev_b32 v108, 16, v92
v_and_b32 v109, 0xffff0000, v92
v_lshlrev_b32 v110, 16, v93
v_and_b32 v111, 0xffff0000, v93
v_lshlrev_b32 v112, 16, v94
v_and_b32 v113, 0xffff0000, v94
v_lshlrev_b32 v114, 16, v95
v_and_b32 v115, 0xffff0000, v95
v_lshlrev_b32 v116, 16, v96
v_and_b32 v117, 0xffff0000, v96
v_lshlrev_b32 v118, 16, v97
v_and_b32 v119, 0xffff0000, v97
v_lshlrev_b32 v120, 16, v98
v_and_b32 v121, 0xffff0000, v98
v_lshlrev_b32 v122, 16, v99
v_and_b32 v123, 0xffff0000, v99
v_lshlrev_b32 v124, 16, v100
v_and_b32 v125, 0xffff0000, v100
v_lshlrev_b32 v126, 16, v101
v_and_b32 v127, 0xffff0000, v101
v_lshlrev_b32 v128, 16, v102
v_and_b32 v129, 0xffff0000, v102
v_lshlrev_b32 v130, 16, v103
v_and_b32 v131, 0xffff0000, v103
v_lshlrev_b32 v132, 16, v104
v_and_b32 v133, 0xffff0000, v104
v_lshlrev_b32 v134, 16, v105
v_and_b32 v135, 0xffff0000, v105
v_lshlrev_b32 v136, 16, v106
v_and_b32 v137, 0xffff0000, v106
v_lshlrev_b32 v138, 16, v107
v_and_b32 v139, 0xffff0000, v107
v_lshlrev_b32 v144, 16, v16
v_lshlrev_b32 v145, 16, v20
v_lshlrev_b32 v146, 16, v24
v_lshlrev_b32 v147, 16, v28
v_lshlrev_b32 v148, 16, v32
v_lshlrev_b32 v149, 16, v36
v_lshlrev_b32 v150, 16, v40
v_lshlrev_b32 v151, 16, v44
v_lshlrev_b32 v152, 16, v48
v_lshlrev_b32 v153, 16, v52
v_lshlrev_b32 v154, 16, v56
v_mul_f32 v156, v144, v111
v_mul_f32 v157, v145, v111
v_mul_f32 v158, v146, v111
v_mul_f32 v159, v147, v111
v_mul_f32 v160, v148, v111
v_mul_f32 v161, v149, v111
v_mul_f32 v162, v150, v111
v_mul_f32 v163, v151, v111
v_fmac_f32 v156, v145, v110
v_fmac_f32 v157, v146, v110
v_fmac_f32 v158, v147, v110
v_fmac_f32 v159, v148, v110
v_fmac_f32 v160, v149, v110
v_fmac_f32 v161, v150, v110
v_fmac_f32 v162, v151, v110
v_fmac_f32 v163, v152, v110
v_fmac_f32 v156, v146, v109
v_fmac_f32 v157, v147, v109
v_fmac_f32 v158, v148, v109
v_fmac_f32 v159, v149, v109
v_fmac_f32 v160, v150, v109
v_fmac_f32 v161, v151, v109
v_fmac_f32 v162, v152, v109
v_fmac_f32 v163, v153, v109
v_fmac_f32 v156, v147, v108
v_fmac_f32 v157, v148, v108
v_fmac_f32 v158, v149, v108
v_fmac_f32 v159, v150, v108
v_fmac_f32 v160, v151, v108
v_fmac_f32 v161, v152, v108
v_fmac_f32 v162, v153, v108
v_fmac_f32 v163, v154, v108
v_lshlrev_b32 v144, 16, v60
v_lshlrev_b32 v145, 16, v64
v_lshlrev_b32 v146, 16, v68
v_lshlrev_b32 v147, 16, v72
v_lshlrev_b32 v148, 16, v76
v_lshlrev_b32 v149, 16, v80
v_lshlrev_b32 v150, 16, v84
v_lshlrev_b32 v151, 16, v88
v_mul_f32 v156, v156, v144
v_mul_f32 v157, v157, v145
v_mul_f32 v158, v158, v146
v_mul_f32 v159, v159, v147
v_mul_f32 v160, v160, v148
v_mul_f32 v161, v161, v149
v_mul_f32 v162, v162, v150
v_mul_f32 v163, v163, v151
v_cvt_pk_bf16_f32 v164, v163, v162
v_cvt_pk_bf16_f32 v165, v161, v160
v_cvt_pk_bf16_f32 v166, v159, v158
v_cvt_pk_bf16_f32 v167, v157, v156
ds_write_b128 v14, v[164:167] offset:0
v_and_b32 v144, 0xffff0000, v16
v_and_b32 v145, 0xffff0000, v20
v_and_b32 v146, 0xffff0000, v24
v_and_b32 v147, 0xffff0000, v28
v_and_b32 v148, 0xffff0000, v32
v_and_b32 v149, 0xffff0000, v36
v_and_b32 v150, 0xffff0000, v40
v_and_b32 v151, 0xffff0000, v44
v_and_b32 v152, 0xffff0000, v48
v_and_b32 v153, 0xffff0000, v52
v_and_b32 v154, 0xffff0000, v56
v_mul_f32 v156, v144, v115
v_mul_f32 v157, v145, v115
v_mul_f32 v158, v146, v115
v_mul_f32 v159, v147, v115
v_mul_f32 v160, v148, v115
v_mul_f32 v161, v149, v115
v_mul_f32 v162, v150, v115
v_mul_f32 v163, v151, v115
v_fmac_f32 v156, v145, v114
v_fmac_f32 v157, v146, v114
v_fmac_f32 v158, v147, v114
v_fmac_f32 v159, v148, v114
v_fmac_f32 v160, v149, v114
v_fmac_f32 v161, v150, v114
v_fmac_f32 v162, v151, v114
v_fmac_f32 v163, v152, v114
v_fmac_f32 v156, v146, v113
v_fmac_f32 v157, v147, v113
v_fmac_f32 v158, v148, v113
v_fmac_f32 v159, v149, v113
v_fmac_f32 v160, v150, v113
v_fmac_f32 v161, v151, v113
v_fmac_f32 v162, v152, v113
v_fmac_f32 v163, v153, v113
v_fmac_f32 v156, v147, v112
v_fmac_f32 v157, v148, v112
v_fmac_f32 v158, v149, v112
v_fmac_f32 v159, v150, v112
v_fmac_f32 v160, v151, v112
v_fmac_f32 v161, v152, v112
v_fmac_f32 v162, v153, v112
v_fmac_f32 v163, v154, v112
v_and_b32 v144, 0xffff0000, v60
v_and_b32 v145, 0xffff0000, v64
v_and_b32 v146, 0xffff0000, v68
v_and_b32 v147, 0xffff0000, v72
v_and_b32 v148, 0xffff0000, v76
v_and_b32 v149, 0xffff0000, v80
v_and_b32 v150, 0xffff0000, v84
v_and_b32 v151, 0xffff0000, v88
v_mul_f32 v156, v156, v144
v_mul_f32 v157, v157, v145
v_mul_f32 v158, v158, v146
v_mul_f32 v159, v159, v147
v_mul_f32 v160, v160, v148
v_mul_f32 v161, v161, v149
v_mul_f32 v162, v162, v150
v_mul_f32 v163, v163, v151
v_cvt_pk_bf16_f32 v168, v163, v162
v_cvt_pk_bf16_f32 v169, v161, v160
v_cvt_pk_bf16_f32 v170, v159, v158
v_cvt_pk_bf16_f32 v171, v157, v156
ds_write_b128 v14, v[168:171] offset:4672
v_lshlrev_b32 v144, 16, v17
v_lshlrev_b32 v145, 16, v21
v_lshlrev_b32 v146, 16, v25
v_lshlrev_b32 v147, 16, v29
v_lshlrev_b32 v148, 16, v33
v_lshlrev_b32 v149, 16, v37
v_lshlrev_b32 v150, 16, v41
v_lshlrev_b32 v151, 16, v45
v_lshlrev_b32 v152, 16, v49
v_lshlrev_b32 v153, 16, v53
v_lshlrev_b32 v154, 16, v57
v_mul_f32 v156, v144, v119
v_mul_f32 v157, v145, v119
v_mul_f32 v158, v146, v119
v_mul_f32 v159, v147, v119
v_mul_f32 v160, v148, v119
v_mul_f32 v161, v149, v119
v_mul_f32 v162, v150, v119
v_mul_f32 v163, v151, v119
v_fmac_f32 v156, v145, v118
v_fmac_f32 v157, v146, v118
v_fmac_f32 v158, v147, v118
v_fmac_f32 v159, v148, v118
v_fmac_f32 v160, v149, v118
v_fmac_f32 v161, v150, v118
v_fmac_f32 v162, v151, v118
v_fmac_f32 v163, v152, v118
v_fmac_f32 v156, v146, v117
v_fmac_f32 v157, v147, v117
v_fmac_f32 v158, v148, v117
v_fmac_f32 v159, v149, v117
v_fmac_f32 v160, v150, v117
v_fmac_f32 v161, v151, v117
v_fmac_f32 v162, v152, v117
v_fmac_f32 v163, v153, v117
v_fmac_f32 v156, v147, v116
v_fmac_f32 v157, v148, v116
v_fmac_f32 v158, v149, v116
v_fmac_f32 v159, v150, v116
v_fmac_f32 v160, v151, v116
v_fmac_f32 v161, v152, v116
v_fmac_f32 v162, v153, v116
v_fmac_f32 v163, v154, v116
v_lshlrev_b32 v144, 16, v61
v_lshlrev_b32 v145, 16, v65
v_lshlrev_b32 v146, 16, v69
v_lshlrev_b32 v147, 16, v73
v_lshlrev_b32 v148, 16, v77
v_lshlrev_b32 v149, 16, v81
v_lshlrev_b32 v150, 16, v85
v_lshlrev_b32 v151, 16, v89
v_mul_f32 v156, v156, v144
v_mul_f32 v157, v157, v145
v_mul_f32 v158, v158, v146
v_mul_f32 v159, v159, v147
v_mul_f32 v160, v160, v148
v_mul_f32 v161, v161, v149
v_mul_f32 v162, v162, v150
v_mul_f32 v163, v163, v151
v_cvt_pk_bf16_f32 v164, v163, v162
v_cvt_pk_bf16_f32 v165, v161, v160
v_cvt_pk_bf16_f32 v166, v159, v158
v_cvt_pk_bf16_f32 v167, v157, v156
ds_write_b128 v14, v[164:167] offset:9344
v_and_b32 v144, 0xffff0000, v17
v_and_b32 v145, 0xffff0000, v21
v_and_b32 v146, 0xffff0000, v25
v_and_b32 v147, 0xffff0000, v29
v_and_b32 v148, 0xffff0000, v33
v_and_b32 v149, 0xffff0000, v37
v_and_b32 v150, 0xffff0000, v41
v_and_b32 v151, 0xffff0000, v45
v_and_b32 v152, 0xffff0000, v49
v_and_b32 v153, 0xffff0000, v53
v_and_b32 v154, 0xffff0000, v57
v_mul_f32 v156, v144, v123
v_mul_f32 v157, v145, v123
v_mul_f32 v158, v146, v123
v_mul_f32 v159, v147, v123
v_mul_f32 v160, v148, v123
v_mul_f32 v161, v149, v123
v_mul_f32 v162, v150, v123
v_mul_f32 v163, v151, v123
v_fmac_f32 v156, v145, v122
v_fmac_f32 v157, v146, v122
v_fmac_f32 v158, v147, v122
v_fmac_f32 v159, v148, v122
v_fmac_f32 v160, v149, v122
v_fmac_f32 v161, v150, v122
v_fmac_f32 v162, v151, v122
v_fmac_f32 v163, v152, v122
v_fmac_f32 v156, v146, v121
v_fmac_f32 v157, v147, v121
v_fmac_f32 v158, v148, v121
v_fmac_f32 v159, v149, v121
v_fmac_f32 v160, v150, v121
v_fmac_f32 v161, v151, v121
v_fmac_f32 v162, v152, v121
v_fmac_f32 v163, v153, v121
v_fmac_f32 v156, v147, v120
v_fmac_f32 v157, v148, v120
v_fmac_f32 v158, v149, v120
v_fmac_f32 v159, v150, v120
v_fmac_f32 v160, v151, v120
v_fmac_f32 v161, v152, v120
v_fmac_f32 v162, v153, v120
v_fmac_f32 v163, v154, v120
v_and_b32 v144, 0xffff0000, v61
v_and_b32 v145, 0xffff0000, v65
v_and_b32 v146, 0xffff0000, v69
v_and_b32 v147, 0xffff0000, v73
v_and_b32 v148, 0xffff0000, v77
v_and_b32 v149, 0xffff0000, v81
v_and_b32 v150, 0xffff0000, v85
v_and_b32 v151, 0xffff0000, v89
v_mul_f32 v156, v156, v144
v_mul_f32 v157, v157, v145
v_mul_f32 v158, v158, v146
v_mul_f32 v159, v159, v147
v_mul_f32 v160, v160, v148
v_mul_f32 v161, v161, v149
v_mul_f32 v162, v162, v150
v_mul_f32 v163, v163, v151
v_cvt_pk_bf16_f32 v168, v163, v162
v_cvt_pk_bf16_f32 v169, v161, v160
v_cvt_pk_bf16_f32 v170, v159, v158
v_cvt_pk_bf16_f32 v171, v157, v156
ds_write_b128 v14, v[168:171] offset:14016
s_cmp_lt_u32 s3, 4
s_cbranch_scc1 LoB3
s_cmp_lg_u32 s12, 0
s_cbranch_scc1 LoB3
Lcpa2:
ds_read_b32 v252, v243 offset:48
s_waitcnt lgkmcnt(0)
v_readfirstlane_b32 s7, v252
s_cmp_ge_u32 s7, 2
s_cbranch_scc1 Lcpa2_ok
s_sleep 2
s_branch Lcpa2
Lcpa2_ok:
s_add_u32 s100, s100, 1
s_lshl_b32 s7, s100, 12
s_add_u32 m0, s101, 8352
s_add_u32 s8, s7, 2
buffer_load_dwordx4 v8, s[56:59], s7 offen offset:0 lds
buffer_load_dwordx4 v8, s[56:59], s7 offen offset:1024 lds
buffer_load_dwordx4 v8, s[56:59], s7 offen offset:2048 lds
buffer_load_dwordx4 v8, s[56:59], s7 offen offset:3072 lds
s_add_u32 m0, m0, 4160
s_nop 0
buffer_load_dwordx4 v8, s[56:59], s8 offen offset:0 lds
buffer_load_dwordx4 v8, s[56:59], s8 offen offset:1024 lds
buffer_load_dwordx4 v8, s[56:59], s8 offen offset:2048 lds
buffer_load_dwordx4 v8, s[56:59], s8 offen offset:3072 lds
buffer_load_ushort v11, v244, s[56:59], s7 offen
LoB3:
v_lshlrev_b32 v144, 16, v18
v_lshlrev_b32 v145, 16, v22
v_lshlrev_b32 v146, 16, v26
v_lshlrev_b32 v147, 16, v30
v_lshlrev_b32 v148, 16, v34
v_lshlrev_b32 v149, 16, v38
v_lshlrev_b32 v150, 16, v42
v_lshlrev_b32 v151, 16, v46
v_lshlrev_b32 v152, 16, v50
v_lshlrev_b32 v153, 16, v54
v_lshlrev_b32 v154, 16, v58
v_mul_f32 v156, v144, v127
v_mul_f32 v157, v145, v127
v_mul_f32 v158, v146, v127
v_mul_f32 v159, v147, v127
v_mul_f32 v160, v148, v127
v_mul_f32 v161, v149, v127
v_mul_f32 v162, v150, v127
v_mul_f32 v163, v151, v127
v_fmac_f32 v156, v145, v126
v_fmac_f32 v157, v146, v126
v_fmac_f32 v158, v147, v126
v_fmac_f32 v159, v148, v126
v_fmac_f32 v160, v149, v126
v_fmac_f32 v161, v150, v126
v_fmac_f32 v162, v151, v126
v_fmac_f32 v163, v152, v126
v_fmac_f32 v156, v146, v125
v_fmac_f32 v157, v147, v125
v_fmac_f32 v158, v148, v125
v_fmac_f32 v159, v149, v125
v_fmac_f32 v160, v150, v125
v_fmac_f32 v161, v151, v125
v_fmac_f32 v162, v152, v125
v_fmac_f32 v163, v153, v125
v_fmac_f32 v156, v147, v124
v_fmac_f32 v157, v148, v124
v_fmac_f32 v158, v149, v124
v_fmac_f32 v159, v150, v124
v_fmac_f32 v160, v151, v124
v_fmac_f32 v161, v152, v124
v_fmac_f32 v162, v153, v124
v_fmac_f32 v163, v154, v124
v_lshlrev_b32 v144, 16, v62
v_lshlrev_b32 v145, 16, v66
v_lshlrev_b32 v146, 16, v70
v_lshlrev_b32 v147, 16, v74
v_lshlrev_b32 v148, 16, v78
v_lshlrev_b32 v149, 16, v82
v_lshlrev_b32 v150, 16, v86
v_lshlrev_b32 v151, 16, v90
v_mul_f32 v156, v156, v144
v_mul_f32 v157, v157, v145
v_mul_f32 v158, v158, v146
v_mul_f32 v159, v159, v147
v_mul_f32 v160, v160, v148
v_mul_f32 v161, v161, v149
v_mul_f32 v162, v162, v150
v_mul_f32 v163, v163, v151
v_cvt_pk_bf16_f32 v164, v163, v162
v_cvt_pk_bf16_f32 v165, v161, v160
v_cvt_pk_bf16_f32 v166, v159, v158
v_cvt_pk_bf16_f32 v167, v157, v156
ds_write_b128 v14, v[164:167] offset:18688
v_and_b32 v144, 0xffff0000, v18
v_and_b32 v145, 0xffff0000, v22
v_and_b32 v146, 0xffff0000, v26
v_and_b32 v147, 0xffff0000, v30
v_and_b32 v148, 0xffff0000, v34
v_and_b32 v149, 0xffff0000, v38
v_and_b32 v150, 0xffff0000, v42
v_and_b32 v151, 0xffff0000, v46
v_and_b32 v152, 0xffff0000, v50
v_and_b32 v153, 0xffff0000, v54
v_and_b32 v154, 0xffff0000, v58
v_mul_f32 v156, v144, v131
v_mul_f32 v157, v145, v131
v_mul_f32 v158, v146, v131
v_mul_f32 v159, v147, v131
v_mul_f32 v160, v148, v131
v_mul_f32 v161, v149, v131
v_mul_f32 v162, v150, v131
v_mul_f32 v163, v151, v131
v_fmac_f32 v156, v145, v130
v_fmac_f32 v157, v146, v130
v_fmac_f32 v158, v147, v130
v_fmac_f32 v159, v148, v130
v_fmac_f32 v160, v149, v130
v_fmac_f32 v161, v150, v130
v_fmac_f32 v162, v151, v130
v_fmac_f32 v163, v152, v130
v_fmac_f32 v156, v146, v129
v_fmac_f32 v157, v147, v129
v_fmac_f32 v158, v148, v129
v_fmac_f32 v159, v149, v129
v_fmac_f32 v160, v150, v129
v_fmac_f32 v161, v151, v129
v_fmac_f32 v162, v152, v129
v_fmac_f32 v163, v153, v129
v_fmac_f32 v156, v147, v128
v_fmac_f32 v157, v148, v128
v_fmac_f32 v158, v149, v128
v_fmac_f32 v159, v150, v128
v_fmac_f32 v160, v151, v128
v_fmac_f32 v161, v152, v128
v_fmac_f32 v162, v153, v128
v_fmac_f32 v163, v154, v128
v_and_b32 v144, 0xffff0000, v62
v_and_b32 v145, 0xffff0000, v66
v_and_b32 v146, 0xffff0000, v70
v_and_b32 v147, 0xffff0000, v74
v_and_b32 v148, 0xffff0000, v78
v_and_b32 v149, 0xffff0000, v82
v_and_b32 v150, 0xffff0000, v86
v_and_b32 v151, 0xffff0000, v90
v_mul_f32 v156, v156, v144
v_mul_f32 v157, v157, v145
v_mul_f32 v158, v158, v146
v_mul_f32 v159, v159, v147
v_mul_f32 v160, v160, v148
v_mul_f32 v161, v161, v149
v_mul_f32 v162, v162, v150
v_mul_f32 v163, v163, v151
v_cvt_pk_bf16_f32 v168, v163, v162
v_cvt_pk_bf16_f32 v169, v161, v160
v_cvt_pk_bf16_f32 v170, v159, v158
v_cvt_pk_bf16_f32 v171, v157, v156
ds_write_b128 v14, v[168:171] offset:23360
v_lshlrev_b32 v144, 16, v19
v_lshlrev_b32 v145, 16, v23
v_lshlrev_b32 v146, 16, v27
v_lshlrev_b32 v147, 16, v31
v_lshlrev_b32 v148, 16, v35
v_lshlrev_b32 v149, 16, v39
v_lshlrev_b32 v150, 16, v43
v_lshlrev_b32 v151, 16, v47
v_lshlrev_b32 v152, 16, v51
v_lshlrev_b32 v153, 16, v55
v_lshlrev_b32 v154, 16, v59
v_mul_f32 v156, v144, v135
v_mul_f32 v157, v145, v135
v_mul_f32 v158, v146, v135
v_mul_f32 v159, v147, v135
v_mul_f32 v160, v148, v135
v_mul_f32 v161, v149, v135
v_mul_f32 v162, v150, v135
v_mul_f32 v163, v151, v135
v_fmac_f32 v156, v145, v134
v_fmac_f32 v157, v146, v134
v_fmac_f32 v158, v147, v134
v_fmac_f32 v159, v148, v134
v_fmac_f32 v160, v149, v134
v_fmac_f32 v161, v150, v134
v_fmac_f32 v162, v151, v134
v_fmac_f32 v163, v152, v134
v_fmac_f32 v156, v146, v133
v_fmac_f32 v157, v147, v133
v_fmac_f32 v158, v148, v133
v_fmac_f32 v159, v149, v133
v_fmac_f32 v160, v150, v133
v_fmac_f32 v161, v151, v133
v_fmac_f32 v162, v152, v133
v_fmac_f32 v163, v153, v133
v_fmac_f32 v156, v147, v132
v_fmac_f32 v157, v148, v132
v_fmac_f32 v158, v149, v132
v_fmac_f32 v159, v150, v132
v_fmac_f32 v160, v151, v132
v_fmac_f32 v161, v152, v132
v_fmac_f32 v162, v153, v132
v_fmac_f32 v163, v154, v132
v_lshlrev_b32 v144, 16, v63
v_lshlrev_b32 v145, 16, v67
v_lshlrev_b32 v146, 16, v71
v_lshlrev_b32 v147, 16, v75
v_lshlrev_b32 v148, 16, v79
v_lshlrev_b32 v149, 16, v83
v_lshlrev_b32 v150, 16, v87
v_lshlrev_b32 v151, 16, v91
v_mul_f32 v156, v156, v144
v_mul_f32 v157, v157, v145
v_mul_f32 v158, v158, v146
v_mul_f32 v159, v159, v147
v_mul_f32 v160, v160, v148
v_mul_f32 v161, v161, v149
v_mul_f32 v162, v162, v150
v_mul_f32 v163, v163, v151
v_cvt_pk_bf16_f32 v164, v163, v162
v_cvt_pk_bf16_f32 v165, v161, v160
v_cvt_pk_bf16_f32 v166, v159, v158
v_cvt_pk_bf16_f32 v167, v157, v156
ds_write_b128 v14, v[164:167] offset:28032
v_and_b32 v144, 0xffff0000, v19
v_and_b32 v145, 0xffff0000, v23
v_and_b32 v146, 0xffff0000, v27
v_and_b32 v147, 0xffff0000, v31
v_and_b32 v148, 0xffff0000, v35
v_and_b32 v149, 0xffff0000, v39
v_and_b32 v150, 0xffff0000, v43
v_and_b32 v151, 0xffff0000, v47
v_and_b32 v152, 0xffff0000, v51
v_and_b32 v153, 0xffff0000, v55
v_and_b32 v154, 0xffff0000, v59
v_mul_f32 v156, v144, v139
v_mul_f32 v157, v145, v139
v_mul_f32 v158, v146, v139
v_mul_f32 v159, v147, v139
v_mul_f32 v160, v148, v139
v_mul_f32 v161, v149, v139
v_mul_f32 v162, v150, v139
v_mul_f32 v163, v151, v139
v_fmac_f32 v156, v145, v138
v_fmac_f32 v157, v146, v138
v_fmac_f32 v158, v147, v138
v_fmac_f32 v159, v148, v138
v_fmac_f32 v160, v149, v138
v_fmac_f32 v161, v150, v138
v_fmac_f32 v162, v151, v138
v_fmac_f32 v163, v152, v138
v_fmac_f32 v156, v146, v137
v_fmac_f32 v157, v147, v137
v_fmac_f32 v158, v148, v137
v_fmac_f32 v159, v149, v137
v_fmac_f32 v160, v150, v137
v_fmac_f32 v161, v151, v137
v_fmac_f32 v162, v152, v137
v_fmac_f32 v163, v153, v137
v_fmac_f32 v156, v147, v136
v_fmac_f32 v157, v148, v136
v_fmac_f32 v158, v149, v136
v_fmac_f32 v159, v150, v136
v_fmac_f32 v160, v151, v136
v_fmac_f32 v161, v152, v136
v_fmac_f32 v162, v153, v136
v_fmac_f32 v163, v154, v136
v_and_b32 v144, 0xffff0000, v63
v_and_b32 v145, 0xffff0000, v67
v_and_b32 v146, 0xffff0000, v71
v_and_b32 v147, 0xffff0000, v75
v_and_b32 v148, 0xffff0000, v79
v_and_b32 v149, 0xffff0000, v83
v_and_b32 v150, 0xffff0000, v87
v_and_b32 v151, 0xffff0000, v91
v_mul_f32 v156, v156, v144
v_mul_f32 v157, v157, v145
v_mul_f32 v158, v158, v146
v_mul_f32 v159, v159, v147
v_mul_f32 v160, v160, v148
v_mul_f32 v161, v161, v149
v_mul_f32 v162, v162, v150
v_mul_f32 v163, v163, v151
v_cvt_pk_bf16_f32 v168, v163, v162
v_cvt_pk_bf16_f32 v169, v161, v160
v_cvt_pk_bf16_f32 v170, v159, v158
v_cvt_pk_bf16_f32 v171, v157, v156
ds_write_b128 v14, v[168:171] offset:32704
s_cmp_lt_u32 s3, 4
s_cbranch_scc1 LoB4
s_cmp_lg_u32 s12, 0
s_cbranch_scc1 LoB4
s_waitcnt vmcnt(0)
ds_write_b16 v250, v11 offset:8350
v_mov_b32 v251, 3
s_waitcnt lgkmcnt(0)
ds_write_b32 v243, v251 offset:32
LoB4:
v_and_b32 v12, 15, v1
v_lshrrev_b32 v13, 4, v1
v_and_b32 v14, 1, v12
v_add_u32 v2, v12, v14
v_lshl_add_u32 v2, v13, 3, v2
v_lshlrev_b32 v2, 1, v2
v_xor_b32 v14, 1, v14
v_mul_lo_u32 v14, v14, s43
v_add3_u32 v2, v2, v14, s6
v_add_u32 v3, 1024, v2
v_add_u32 v4, 2048, v2
v_add_u32 v5, 3072, v2
s_mul_i32 s7, s13, 4672
v_lshlrev_b32 v14, 5, v12
v_lshlrev_b32 v6, 4, v13
v_sub_u32 v6, v6, v14
v_add_u32 v6, 83936, v6
v_add_u32 v6, s7, v6
v_lshl_add_u32 v14, v13, 3, v14
v_sub_u32 v7, 83960, v14
v_add_u32 v7, s7, v7
s_add_u32 s7, s6, s43
v_mov_b32 v12, s7
s_and_b32 s7, s3, 4
v_add_u32 v13, s7, v240
v_mov_b32 v14, 1
s_waitcnt lgkmcnt(0)
s_mov_b64 exec, 1
ds_add_u32 v13, v14
s_mov_b64 exec, -1
Lcpoll0:
ds_read_b32 v252, v240 offset:0
s_waitcnt lgkmcnt(0)
v_readfirstlane_b32 s7, v252
s_cmp_ge_u32 s7, 4
s_cbranch_scc1 Lcpoll0_ok
s_sleep 2
s_branch Lcpoll0
Lcpoll0_ok:
s_cmp_ge_u32 s3, 4
s_cbranch_scc1 Lconv_B
s_mov_b32 s44, s34
s_and_b32 s45, s35, 0xffff
s_add_u32 s7, s4, 1
s_mul_i32 s7, s7, 663552
s_cmp_eq_u32 s12, 0
s_cselect_b32 s46, s7, 0
s_mov_b32 s47, 0x20000
s_mul_i32 s15, s4, 663552
s_lshl_b32 s8, s5, 2
s_add_u32 s8, s8, s42
s_mul_i32 s8, s8, 18432
s_add_u32 s15, s15, s8
s_and_b32 s8, s4, 1
s_lshl_b32 s8, s8, 9
s_add_u32 s15, s15, s8
v_lshrrev_b32 v13, 2, v1
v_mul_u32_u24 v13, 1152, v13
v_and_b32 v14, 3, v1
v_lshl_add_u32 v13, v14, 7, v13
s_cmp_eq_u32 s12, 0
s_cbranch_scc1 LcA0
v_subrev_u32 v6, 9344, v6
v_subrev_u32 v7, 9344, v7
s_waitcnt vmcnt(0)
v_mov_b32 v249, v248
s_branch LcA2
LcA0:
s_waitcnt vmcnt(0)
ds_write_b16 v12, v9 offset:30
s_waitcnt lgkmcnt(0)
ds_read_b128 v[80:83], v6 offset:4032
ds_read2_b32 v[16:17], v2 offset0:112 offset1:113
ds_read2_b32 v[18:19], v2 offset0:114 offset1:115
ds_read2_b32 v[20:21], v2 offset0:240 offset1:241
ds_read2_b32 v[22:23], v2 offset0:242 offset1:243
ds_read2_b32 v[24:25], v3 offset0:112 offset1:113
ds_read2_b32 v[26:27], v3 offset0:114 offset1:115
ds_read2_b32 v[28:29], v3 offset0:240 offset1:241
ds_read2_b32 v[30:31], v3 offset0:242 offset1:243
ds_read2_b32 v[32:33], v4 offset0:112 offset1:113
ds_read2_b32 v[34:35], v4 offset0:114 offset1:115
ds_read2_b32 v[36:37], v4 offset0:240 offset1:241
ds_read2_b32 v[38:39], v4 offset0:242 offset1:243
ds_read2_b32 v[40:41], v5 offset0:112 offset1:113
ds_read2_b32 v[42:43], v5 offset0:114 offset1:115
ds_read2_b32 v[44:45], v5 offset0:240 offset1:241
ds_read2_b32 v[46:47], v5 offset0:242 offset1:243
ds_read_b128 v[84:87], v6 offset:3520
ds_read_b128 v[88:91], v6 offset:3008
ds_read_b128 v[92:95], v6 offset:2496
s_waitcnt lgkmcnt(15)
v_mfma_f32_16x16x32_bf16 v[112:115], v[16:19], v[80:83], 0
ds_read_b128 v[96:99], v6 offset:3968
v_mfma_f32_16x16x32_bf16 v[116:119], v[20:23], v[80:83], 0
ds_read2_b32 v[48:49], v2 offset0:96 offset1:97
s_waitcnt lgkmcnt(15)
v_mfma_f32_16x16x32_bf16 v[120:123], v[24:27], v[80:83], 0
ds_read2_b32 v[50:51], v2 offset0:98 offset1:99
s_waitcnt lgkmcnt(14)
v_mfma_f32_16x16x32_bf16 v[124:127], v[28:31], v[80:83], 0
ds_read2_b32 v[52:53], v2 offset0:224 offset1:225
s_waitcnt lgkmcnt(13)
v_mfma_f32_16x16x32_bf16 v[128:131], v[32:35], v[80:83], 0
ds_read2_b32 v[54:55], v2 offset0:226 offset1:227
s_waitcnt lgkmcnt(12)
v_mfma_f32_16x16x32_bf16 v[132:135], v[36:39], v[80:83], 0
s_waitcnt lgkmcnt(10)
v_mfma_f32_16x16x32_bf16 v[136:139], v[40:43], v[80:83], 0
ds_read2_b32 v[56:57], v3 offset0:96 offset1:97
s_waitcnt lgkmcnt(9)
v_mfma_f32_16x16x32_bf16 v[140:143], v[44:47], v[80:83], 0
ds_read2_b32 v[58:59], v3 offset0:98 offset1:99
s_waitcnt lgkmcnt(9)
v_mfma_f32_16x16x32_bf16 v[116:119], v[16:19], v[84:87], v[116:119]
ds_read2_b32 v[60:61], v3 offset0:224 offset1:225
v_mfma_f32_16x16x32_bf16 v[120:123], v[20:23], v[84:87], v[120:123]
ds_read2_b32 v[62:63], v3 offset0:226 offset1:227
v_mfma_f32_16x16x32_bf16 v[124:127], v[24:27], v[84:87], v[124:127]
ds_read2_b32 v[64:65], v4 offset0:96 offset1:97
v_mfma_f32_16x16x32_bf16 v[128:131], v[28:31], v[84:87], v[128:131]
v_mfma_f32_16x16x32_bf16 v[132:135], v[32:35], v[84:87], v[132:135]
ds_read2_b32 v[66:67], v4 offset0:98 offset1:99
v_mfma_f32_16x16x32_bf16 v[136:139], v[36:39], v[84:87], v[136:139]
ds_read2_b32 v[68:69], v4 offset0:224 offset1:225
v_mfma_f32_16x16x32_bf16 v[140:143], v[40:43], v[84:87], v[140:143]
ds_read2_b32 v[70:71], v4 offset0:226 offset1:227
s_waitcnt lgkmcnt(14)
v_mfma_f32_16x16x32_bf16 v[120:123], v[16:19], v[88:91], v[120:123]
ds_read2_b32 v[72:73], v5 offset0:96 offset1:97
v_mfma_f32_16x16x32_bf16 v[124:127], v[20:23], v[88:91], v[124:127]
ds_read2_b32 v[74:75], v5 offset0:98 offset1:99
v_mfma_f32_16x16x32_bf16 v[128:131], v[24:27], v[88:91], v[128:131]
v_mfma_f32_16x16x32_bf16 v[132:135], v[28:31], v[88:91], v[132:135]
ds_read2_b32 v[76:77], v5 offset0:224 offset1:225
v_mfma_f32_16x16x32_bf16 v[136:139], v[32:35], v[88:91], v[136:139]
ds_read2_b32 v[78:79], v5 offset0:226 offset1:227
v_mfma_f32_16x16x32_bf16 v[140:143], v[36:39], v[88:91], v[140:143]
ds_read_b128 v[100:103], v6 offset:3456
s_waitcnt lgkmcnt(15)
v_mfma_f32_16x16x32_bf16 v[124:127], v[16:19], v[92:95], v[124:127]
ds_read_b128 v[104:107], v6 offset:2944
v_mfma_f32_16x16x32_bf16 v[128:131], v[20:23], v[92:95], v[128:131]
ds_read_b128 v[108:111], v6 offset:2432
v_mfma_f32_16x16x32_bf16 v[132:135], v[24:27], v[92:95], v[132:135]
v_mfma_f32_16x16x32_bf16 v[136:139], v[28:31], v[92:95], v[136:139]
v_mfma_f32_16x16x32_bf16 v[140:143], v[32:35], v[92:95], v[140:143]
v_mfma_f32_16x16x32_bf16 v[112:115], v[48:51], v[96:99], v[112:115]
ds_read_b128 v[80:83], v6 offset:3904
s_waitcnt lgkmcnt(15)
v_mfma_f32_16x16x32_bf16 v[116:119], v[52:55], v[96:99], v[116:119]
ds_read2_b32 v[16:17], v2 offset0:80 offset1:81
s_waitcnt lgkmcnt(15)
v_mfma_f32_16x16x32_bf16 v[120:123], v[56:59], v[96:99], v[120:123]
ds_read2_b32 v[18:19], v2 offset0:82 offset1:83
s_waitcnt lgkmcnt(14)
v_mfma_f32_16x16x32_bf16 v[124:127], v[60:63], v[96:99], v[124:127]
ds_read2_b32 v[20:21], v2 offset0:208 offset1:209
s_waitcnt lgkmcnt(13)
v_mfma_f32_16x16x32_bf16 v[128:131], v[64:67], v[96:99], v[128:131]
ds_read2_b32 v[22:23], v2 offset0:210 offset1:211
s_waitcnt lgkmcnt(12)
v_mfma_f32_16x16x32_bf16 v[132:135], v[68:71], v[96:99], v[132:135]
s_waitcnt lgkmcnt(10)
v_mfma_f32_16x16x32_bf16 v[136:139], v[72:75], v[96:99], v[136:139]
ds_read2_b32 v[24:25], v3 offset0:80 offset1:81
s_waitcnt lgkmcnt(9)
v_mfma_f32_16x16x32_bf16 v[140:143], v[76:79], v[96:99], v[140:143]
ds_read2_b32 v[26:27], v3 offset0:82 offset1:83
s_waitcnt lgkmcnt(9)
v_mfma_f32_16x16x32_bf16 v[116:119], v[48:51], v[100:103], v[116:119]
ds_read2_b32 v[28:29], v3 offset0:208 offset1:209
v_mfma_f32_16x16x32_bf16 v[120:123], v[52:55], v[100:103], v[120:123]
ds_read2_b32 v[30:31], v3 offset0:210 offset1:211
v_mfma_f32_16x16x32_bf16 v[124:127], v[56:59], v[100:103], v[124:127]
ds_read2_b32 v[32:33], v4 offset0:80 offset1:81
v_mfma_f32_16x16x32_bf16 v[128:131], v[60:63], v[100:103], v[128:131]
v_mfma_f32_16x16x32_bf16 v[132:135], v[64:67], v[100:103], v[132:135]
ds_read2_b32 v[34:35], v4 offset0:82 offset1:83
v_mfma_f32_16x16x32_bf16 v[136:139], v[68:71], v[100:103], v[136:139]
ds_read2_b32 v[36:37], v4 offset0:208 offset1:209
v_mfma_f32_16x16x32_bf16 v[140:143], v[72:75], v[100:103], v[140:143]
ds_read2_b32 v[38:39], v4 offset0:210 offset1:211
s_waitcnt lgkmcnt(14)
v_mfma_f32_16x16x32_bf16 v[120:123], v[48:51], v[104:107], v[120:123]
ds_read2_b32 v[40:41], v5 offset0:80 offset1:81
v_mfma_f32_16x16x32_bf16 v[124:127], v[52:55], v[104:107], v[124:127]
ds_read2_b32 v[42:43], v5 offset0:82 offset1:83
v_mfma_f32_16x16x32_bf16 v[128:131], v[56:59], v[104:107], v[128:131]
v_mfma_f32_16x16x32_bf16 v[132:135], v[60:63], v[104:107], v[132:135]
ds_read2_b32 v[44:45], v5 offset0:208 offset1:209
v_mfma_f32_16x16x32_bf16 v[136:139], v[64:67], v[104:107], v[136:139]
ds_read2_b32 v[46:47], v5 offset0:210 offset1:211
v_mfma_f32_16x16x32_bf16 v[140:143], v[68:71], v[104:107], v[140:143]
ds_read_b128 v[84:87], v6 offset:3392
s_waitcnt lgkmcnt(15)
v_mfma_f32_16x16x32_bf16 v[124:127], v[48:51], v[108:111], v[124:127]
ds_read_b128 v[88:91], v6 offset:2880
v_mfma_f32_16x16x32_bf16 v[128:131], v[52:55], v[108:111], v[128:131]
ds_read_b128 v[92:95], v6 offset:2368
v_mfma_f32_16x16x32_bf16 v[132:135], v[56:59], v[108:111], v[132:135]
v_mfma_f32_16x16x32_bf16 v[136:139], v[60:63], v[108:111], v[136:139]
v_mfma_f32_16x16x32_bf16 v[140:143], v[64:67], v[108:111], v[140:143]
v_mfma_f32_16x16x32_bf16 v[112:115], v[16:19], v[80:83], v[112:115]
ds_read_b128 v[96:99], v6 offset:3840
s_waitcnt lgkmcnt(15)
v_mfma_f32_16x16x32_bf16 v[116:119], v[20:23], v[80:83], v[116:119]
ds_read2_b32 v[48:49], v2 offset0:64 offset1:65
s_waitcnt lgkmcnt(15)
v_mfma_f32_16x16x32_bf16 v[120:123], v[24:27], v[80:83], v[120:123]
ds_read2_b32 v[50:51], v2 offset0:66 offset1:67
s_waitcnt lgkmcnt(14)
v_mfma_f32_16x16x32_bf16 v[124:127], v[28:31], v[80:83], v[124:127]
ds_read2_b32 v[52:53], v2 offset0:192 offset1:193
s_waitcnt lgkmcnt(13)
v_mfma_f32_16x16x32_bf16 v[128:131], v[32:35], v[80:83], v[128:131]
ds_read2_b32 v[54:55], v2 offset0:194 offset1:195
s_waitcnt lgkmcnt(12)
v_mfma_f32_16x16x32_bf16 v[132:135], v[36:39], v[80:83], v[132:135]
s_waitcnt lgkmcnt(10)
v_mfma_f32_16x16x32_bf16 v[136:139], v[40:43], v[80:83], v[136:139]
ds_read2_b32 v[56:57], v3 offset0:64 offset1:65
s_waitcnt lgkmcnt(9)
v_mfma_f32_16x16x32_bf16 v[140:143], v[44:47], v[80:83], v[140:143]
ds_read2_b32 v[58:59], v3 offset0:66 offset1:67
s_waitcnt lgkmcnt(9)
v_mfma_f32_16x16x32_bf16 v[116:119], v[16:19], v[84:87], v[116:119]
ds_read2_b32 v[60:61], v3 offset0:192 offset1:193
v_mfma_f32_16x16x32_bf16 v[120:123], v[20:23], v[84:87], v[120:123]
ds_read2_b32 v[62:63], v3 offset0:194 offset1:195
v_mfma_f32_16x16x32_bf16 v[124:127], v[24:27], v[84:87], v[124:127]
ds_read2_b32 v[64:65], v4 offset0:64 offset1:65
v_mfma_f32_16x16x32_bf16 v[128:131], v[28:31], v[84:87], v[128:131]
v_mfma_f32_16x16x32_bf16 v[132:135], v[32:35], v[84:87], v[132:135]
ds_read2_b32 v[66:67], v4 offset0:66 offset1:67
v_mfma_f32_16x16x32_bf16 v[136:139], v[36:39], v[84:87], v[136:139]
ds_read2_b32 v[68:69], v4 offset0:192 offset1:193
v_mfma_f32_16x16x32_bf16 v[140:143], v[40:43], v[84:87], v[140:143]
ds_read2_b32 v[70:71], v4 offset0:194 offset1:195
s_waitcnt lgkmcnt(14)
v_mfma_f32_16x16x32_bf16 v[120:123], v[16:19], v[88:91], v[120:123]
ds_read2_b32 v[72:73], v5 offset0:64 offset1:65
v_mfma_f32_16x16x32_bf16 v[124:127], v[20:23], v[88:91], v[124:127]
ds_read2_b32 v[74:75], v5 offset0:66 offset1:67
v_mfma_f32_16x16x32_bf16 v[128:131], v[24:27], v[88:91], v[128:131]
v_mfma_f32_16x16x32_bf16 v[132:135], v[28:31], v[88:91], v[132:135]
ds_read2_b32 v[76:77], v5 offset0:192 offset1:193
v_mfma_f32_16x16x32_bf16 v[136:139], v[32:35], v[88:91], v[136:139]
ds_read2_b32 v[78:79], v5 offset0:194 offset1:195
v_mfma_f32_16x16x32_bf16 v[140:143], v[36:39], v[88:91], v[140:143]
ds_read_b128 v[100:103], v6 offset:3328
s_waitcnt lgkmcnt(15)
v_mfma_f32_16x16x32_bf16 v[124:127], v[16:19], v[92:95], v[124:127]
ds_read_b128 v[104:107], v6 offset:2816
v_mfma_f32_16x16x32_bf16 v[128:131], v[20:23], v[92:95], v[128:131]
ds_read_b128 v[108:111], v6 offset:2304
v_mfma_f32_16x16x32_bf16 v[132:135], v[24:27], v[92:95], v[132:135]
v_mfma_f32_16x16x32_bf16 v[136:139], v[28:31], v[92:95], v[136:139]
v_mfma_f32_16x16x32_bf16 v[140:143], v[32:35], v[92:95], v[140:143]
v_mfma_f32_16x16x32_bf16 v[112:115], v[48:51], v[96:99], v[112:115]
ds_read_b128 v[80:83], v6 offset:3776
s_waitcnt lgkmcnt(15)
v_mfma_f32_16x16x32_bf16 v[116:119], v[52:55], v[96:99], v[116:119]
ds_read2_b32 v[16:17], v2 offset0:48 offset1:49
s_waitcnt lgkmcnt(15)
v_mfma_f32_16x16x32_bf16 v[120:123], v[56:59], v[96:99], v[120:123]
ds_read2_b32 v[18:19], v2 offset0:50 offset1:51
s_waitcnt lgkmcnt(14)
v_mfma_f32_16x16x32_bf16 v[124:127], v[60:63], v[96:99], v[124:127]
ds_read2_b32 v[20:21], v2 offset0:176 offset1:177
s_waitcnt lgkmcnt(13)
v_mfma_f32_16x16x32_bf16 v[128:131], v[64:67], v[96:99], v[128:131]
ds_read2_b32 v[22:23], v2 offset0:178 offset1:179
s_waitcnt lgkmcnt(12)
v_mfma_f32_16x16x32_bf16 v[132:135], v[68:71], v[96:99], v[132:135]
s_waitcnt lgkmcnt(10)
v_mfma_f32_16x16x32_bf16 v[136:139], v[72:75], v[96:99], v[136:139]
ds_read2_b32 v[24:25], v3 offset0:48 offset1:49
s_waitcnt lgkmcnt(9)
v_mfma_f32_16x16x32_bf16 v[140:143], v[76:79], v[96:99], v[140:143]
ds_read2_b32 v[26:27], v3 offset0:50 offset1:51
s_waitcnt lgkmcnt(9)
v_mfma_f32_16x16x32_bf16 v[116:119], v[48:51], v[100:103], v[116:119]
ds_read2_b32 v[28:29], v3 offset0:176 offset1:177
v_mfma_f32_16x16x32_bf16 v[120:123], v[52:55], v[100:103], v[120:123]
ds_read2_b32 v[30:31], v3 offset0:178 offset1:179
v_mfma_f32_16x16x32_bf16 v[124:127], v[56:59], v[100:103], v[124:127]
ds_read2_b32 v[32:33], v4 offset0:48 offset1:49
v_mfma_f32_16x16x32_bf16 v[128:131], v[60:63], v[100:103], v[128:131]
v_mfma_f32_16x16x32_bf16 v[132:135], v[64:67], v[100:103], v[132:135]
ds_read2_b32 v[34:35], v4 offset0:50 offset1:51
v_mfma_f32_16x16x32_bf16 v[136:139], v[68:71], v[100:103], v[136:139]
ds_read2_b32 v[36:37], v4 offset0:176 offset1:177
v_mfma_f32_16x16x32_bf16 v[140:143], v[72:75], v[100:103], v[140:143]
ds_read2_b32 v[38:39], v4 offset0:178 offset1:179
s_waitcnt lgkmcnt(14)
v_mfma_f32_16x16x32_bf16 v[120:123], v[48:51], v[104:107], v[120:123]
ds_read2_b32 v[40:41], v5 offset0:48 offset1:49
v_mfma_f32_16x16x32_bf16 v[124:127], v[52:55], v[104:107], v[124:127]
ds_read2_b32 v[42:43], v5 offset0:50 offset1:51
v_mfma_f32_16x16x32_bf16 v[128:131], v[56:59], v[104:107], v[128:131]
v_mfma_f32_16x16x32_bf16 v[132:135], v[60:63], v[104:107], v[132:135]
ds_read2_b32 v[44:45], v5 offset0:176 offset1:177
v_mfma_f32_16x16x32_bf16 v[136:139], v[64:67], v[104:107], v[136:139]
ds_read2_b32 v[46:47], v5 offset0:178 offset1:179
v_mfma_f32_16x16x32_bf16 v[140:143], v[68:71], v[104:107], v[140:143]
ds_read_b128 v[84:87], v6 offset:3264
s_waitcnt lgkmcnt(15)
v_mfma_f32_16x16x32_bf16 v[124:127], v[48:51], v[108:111], v[124:127]
ds_read_b128 v[88:91], v6 offset:2752
v_mfma_f32_16x16x32_bf16 v[128:131], v[52:55], v[108:111], v[128:131]
ds_read_b128 v[92:95], v6 offset:2240
v_mfma_f32_16x16x32_bf16 v[132:135], v[56:59], v[108:111], v[132:135]
v_mfma_f32_16x16x32_bf16 v[136:139], v[60:63], v[108:111], v[136:139]
v_mfma_f32_16x16x32_bf16 v[140:143], v[64:67], v[108:111], v[140:143]
v_mfma_f32_16x16x32_bf16 v[112:115], v[16:19], v[80:83], v[112:115]
ds_read_b128 v[96:99], v6 offset:3712
s_waitcnt lgkmcnt(15)
v_mfma_f32_16x16x32_bf16 v[116:119], v[20:23], v[80:83], v[116:119]
ds_read2_b32 v[48:49], v2 offset0:32 offset1:33
s_waitcnt lgkmcnt(15)
v_mfma_f32_16x16x32_bf16 v[120:123], v[24:27], v[80:83], v[120:123]
ds_read2_b32 v[50:51], v2 offset0:34 offset1:35
s_waitcnt lgkmcnt(14)
v_mfma_f32_16x16x32_bf16 v[124:127], v[28:31], v[80:83], v[124:127]
ds_read2_b32 v[52:53], v2 offset0:160 offset1:161
s_waitcnt lgkmcnt(13)
v_mfma_f32_16x16x32_bf16 v[128:131], v[32:35], v[80:83], v[128:131]
ds_read2_b32 v[54:55], v2 offset0:162 offset1:163
s_waitcnt lgkmcnt(12)
v_mfma_f32_16x16x32_bf16 v[132:135], v[36:39], v[80:83], v[132:135]
s_waitcnt lgkmcnt(10)
v_mfma_f32_16x16x32_bf16 v[136:139], v[40:43], v[80:83], v[136:139]
ds_read2_b32 v[56:57], v3 offset0:32 offset1:33
s_waitcnt lgkmcnt(9)
v_mfma_f32_16x16x32_bf16 v[140:143], v[44:47], v[80:83], v[140:143]
ds_read2_b32 v[58:59], v3 offset0:34 offset1:35
s_waitcnt lgkmcnt(9)
v_mfma_f32_16x16x32_bf16 v[116:119], v[16:19], v[84:87], v[116:119]
ds_read2_b32 v[60:61], v3 offset0:160 offset1:161
v_mfma_f32_16x16x32_bf16 v[120:123], v[20:23], v[84:87], v[120:123]
ds_read2_b32 v[62:63], v3 offset0:162 offset1:163
v_mfma_f32_16x16x32_bf16 v[124:127], v[24:27], v[84:87], v[124:127]
ds_read2_b32 v[64:65], v4 offset0:32 offset1:33
v_mfma_f32_16x16x32_bf16 v[128:131], v[28:31], v[84:87], v[128:131]
v_mfma_f32_16x16x32_bf16 v[132:135], v[32:35], v[84:87], v[132:135]
ds_read2_b32 v[66:67], v4 offset0:34 offset1:35
v_mfma_f32_16x16x32_bf16 v[136:139], v[36:39], v[84:87], v[136:139]
ds_read2_b32 v[68:69], v4 offset0:160 offset1:161
v_mfma_f32_16x16x32_bf16 v[140:143], v[40:43], v[84:87], v[140:143]
ds_read2_b32 v[70:71], v4 offset0:162 offset1:163
s_waitcnt lgkmcnt(14)
v_mfma_f32_16x16x32_bf16 v[120:123], v[16:19], v[88:91], v[120:123]
ds_read2_b32 v[72:73], v5 offset0:32 offset1:33
v_mfma_f32_16x16x32_bf16 v[124:127], v[20:23], v[88:91], v[124:127]
ds_read2_b32 v[74:75], v5 offset0:34 offset1:35
v_mfma_f32_16x16x32_bf16 v[128:131], v[24:27], v[88:91], v[128:131]
v_mfma_f32_16x16x32_bf16 v[132:135], v[28:31], v[88:91], v[132:135]
ds_read2_b32 v[76:77], v5 offset0:160 offset1:161
v_mfma_f32_16x16x32_bf16 v[136:139], v[32:35], v[88:91], v[136:139]
ds_read2_b32 v[78:79], v5 offset0:162 offset1:163
v_mfma_f32_16x16x32_bf16 v[140:143], v[36:39], v[88:91], v[140:143]
ds_read_b128 v[100:103], v6 offset:3200
s_waitcnt lgkmcnt(15)
v_mfma_f32_16x16x32_bf16 v[124:127], v[16:19], v[92:95], v[124:127]
ds_read_b128 v[104:107], v6 offset:2688
v_mfma_f32_16x16x32_bf16 v[128:131], v[20:23], v[92:95], v[128:131]
ds_read_b128 v[108:111], v6 offset:2176
v_mfma_f32_16x16x32_bf16 v[132:135], v[24:27], v[92:95], v[132:135]
v_mfma_f32_16x16x32_bf16 v[136:139], v[28:31], v[92:95], v[136:139]
v_mfma_f32_16x16x32_bf16 v[140:143], v[32:35], v[92:95], v[140:143]
v_mfma_f32_16x16x32_bf16 v[112:115], v[48:51], v[96:99], v[112:115]
ds_read_b128 v[80:83], v6 offset:3648
s_waitcnt lgkmcnt(15)
v_mfma_f32_16x16x32_bf16 v[116:119], v[52:55], v[96:99], v[116:119]
ds_read2_b32 v[16:17], v2 offset0:16 offset1:17
s_waitcnt lgkmcnt(15)
v_mfma_f32_16x16x32_bf16 v[120:123], v[56:59], v[96:99], v[120:123]
ds_read2_b32 v[18:19], v2 offset0:18 offset1:19
s_waitcnt lgkmcnt(14)
v_mfma_f32_16x16x32_bf16 v[124:127], v[60:63], v[96:99], v[124:127]
ds_read2_b32 v[20:21], v2 offset0:144 offset1:145
s_waitcnt lgkmcnt(13)
v_mfma_f32_16x16x32_bf16 v[128:131], v[64:67], v[96:99], v[128:131]
ds_read2_b32 v[22:23], v2 offset0:146 offset1:147
s_waitcnt lgkmcnt(12)
v_mfma_f32_16x16x32_bf16 v[132:135], v[68:71], v[96:99], v[132:135]
s_waitcnt lgkmcnt(10)
v_mfma_f32_16x16x32_bf16 v[136:139], v[72:75], v[96:99], v[136:139]
ds_read2_b32 v[24:25], v3 offset0:16 offset1:17
s_waitcnt lgkmcnt(9)
v_mfma_f32_16x16x32_bf16 v[140:143], v[76:79], v[96:99], v[140:143]
ds_read2_b32 v[26:27], v3 offset0:18 offset1:19
s_waitcnt lgkmcnt(9)
v_mfma_f32_16x16x32_bf16 v[116:119], v[48:51], v[100:103], v[116:119]
ds_read2_b32 v[28:29], v3 offset0:144 offset1:145
v_mfma_f32_16x16x32_bf16 v[120:123], v[52:55], v[100:103], v[120:123]
ds_read2_b32 v[30:31], v3 offset0:146 offset1:147
v_mfma_f32_16x16x32_bf16 v[124:127], v[56:59], v[100:103], v[124:127]
ds_read2_b32 v[32:33], v4 offset0:16 offset1:17
v_mfma_f32_16x16x32_bf16 v[128:131], v[60:63], v[100:103], v[128:131]
v_mfma_f32_16x16x32_bf16 v[132:135], v[64:67], v[100:103], v[132:135]
ds_read2_b32 v[34:35], v4 offset0:18 offset1:19
v_mfma_f32_16x16x32_bf16 v[136:139], v[68:71], v[100:103], v[136:139]
ds_read2_b32 v[36:37], v4 offset0:144 offset1:145
v_mfma_f32_16x16x32_bf16 v[140:143], v[72:75], v[100:103], v[140:143]
ds_read2_b32 v[38:39], v4 offset0:146 offset1:147
s_waitcnt lgkmcnt(14)
v_mfma_f32_16x16x32_bf16 v[120:123], v[48:51], v[104:107], v[120:123]
ds_read2_b32 v[40:41], v5 offset0:16 offset1:17
v_mfma_f32_16x16x32_bf16 v[124:127], v[52:55], v[104:107], v[124:127]
ds_read2_b32 v[42:43], v5 offset0:18 offset1:19
v_mfma_f32_16x16x32_bf16 v[128:131], v[56:59], v[104:107], v[128:131]
v_mfma_f32_16x16x32_bf16 v[132:135], v[60:63], v[104:107], v[132:135]
ds_read2_b32 v[44:45], v5 offset0:144 offset1:145
v_mfma_f32_16x16x32_bf16 v[136:139], v[64:67], v[104:107], v[136:139]
ds_read2_b32 v[46:47], v5 offset0:146 offset1:147
v_mfma_f32_16x16x32_bf16 v[140:143], v[68:71], v[104:107], v[140:143]
ds_read_b128 v[84:87], v6 offset:3136
s_waitcnt lgkmcnt(15)
v_mfma_f32_16x16x32_bf16 v[124:127], v[48:51], v[108:111], v[124:127]
ds_read_b128 v[88:91], v6 offset:2624
v_mfma_f32_16x16x32_bf16 v[128:131], v[52:55], v[108:111], v[128:131]
ds_read_b128 v[92:95], v6 offset:2112
v_mfma_f32_16x16x32_bf16 v[132:135], v[56:59], v[108:111], v[132:135]
v_mfma_f32_16x16x32_bf16 v[136:139], v[60:63], v[108:111], v[136:139]
v_mfma_f32_16x16x32_bf16 v[140:143], v[64:67], v[108:111], v[140:143]
v_mfma_f32_16x16x32_bf16 v[112:115], v[16:19], v[80:83], v[112:115]
ds_read_b128 v[96:99], v6 offset:3584
s_waitcnt lgkmcnt(15)
v_mfma_f32_16x16x32_bf16 v[116:119], v[20:23], v[80:83], v[116:119]
ds_read2_b32 v[48:49], v2 offset0:0 offset1:1
s_waitcnt lgkmcnt(15)
v_mfma_f32_16x16x32_bf16 v[120:123], v[24:27], v[80:83], v[120:123]
ds_read2_b32 v[50:51], v2 offset0:2 offset1:3
s_waitcnt lgkmcnt(14)
v_mfma_f32_16x16x32_bf16 v[124:127], v[28:31], v[80:83], v[124:127]
ds_read2_b32 v[52:53], v2 offset0:128 offset1:129
s_waitcnt lgkmcnt(13)
v_mfma_f32_16x16x32_bf16 v[128:131], v[32:35], v[80:83], v[128:131]
ds_read2_b32 v[54:55], v2 offset0:130 offset1:131
s_waitcnt lgkmcnt(12)
v_mfma_f32_16x16x32_bf16 v[132:135], v[36:39], v[80:83], v[132:135]
s_waitcnt lgkmcnt(10)
v_mfma_f32_16x16x32_bf16 v[136:139], v[40:43], v[80:83], v[136:139]
ds_read2_b32 v[56:57], v3 offset0:0 offset1:1
s_waitcnt lgkmcnt(9)
v_mfma_f32_16x16x32_bf16 v[140:143], v[44:47], v[80:83], v[140:143]
ds_read2_b32 v[58:59], v3 offset0:2 offset1:3
s_waitcnt lgkmcnt(9)
v_mfma_f32_16x16x32_bf16 v[116:119], v[16:19], v[84:87], v[116:119]
ds_read2_b32 v[60:61], v3 offset0:128 offset1:129
v_mfma_f32_16x16x32_bf16 v[120:123], v[20:23], v[84:87], v[120:123]
ds_read2_b32 v[62:63], v3 offset0:130 offset1:131
v_mfma_f32_16x16x32_bf16 v[124:127], v[24:27], v[84:87], v[124:127]
ds_read2_b32 v[64:65], v4 offset0:0 offset1:1
v_mfma_f32_16x16x32_bf16 v[128:131], v[28:31], v[84:87], v[128:131]
v_mfma_f32_16x16x32_bf16 v[132:135], v[32:35], v[84:87], v[132:135]
ds_read2_b32 v[66:67], v4 offset0:2 offset1:3
v_mfma_f32_16x16x32_bf16 v[136:139], v[36:39], v[84:87], v[136:139]
ds_read2_b32 v[68:69], v4 offset0:128 offset1:129
v_mfma_f32_16x16x32_bf16 v[140:143], v[40:43], v[84:87], v[140:143]
ds_read2_b32 v[70:71], v4 offset0:130 offset1:131
s_waitcnt lgkmcnt(14)
v_mfma_f32_16x16x32_bf16 v[120:123], v[16:19], v[88:91], v[120:123]
ds_read2_b32 v[72:73], v5 offset0:0 offset1:1
v_mfma_f32_16x16x32_bf16 v[124:127], v[20:23], v[88:91], v[124:127]
ds_read2_b32 v[74:75], v5 offset0:2 offset1:3
v_mfma_f32_16x16x32_bf16 v[128:131], v[24:27], v[88:91], v[128:131]
v_mfma_f32_16x16x32_bf16 v[132:135], v[28:31], v[88:91], v[132:135]
ds_read2_b32 v[76:77], v5 offset0:128 offset1:129
v_mfma_f32_16x16x32_bf16 v[136:139], v[32:35], v[88:91], v[136:139]
ds_read2_b32 v[78:79], v5 offset0:130 offset1:131
v_mfma_f32_16x16x32_bf16 v[140:143], v[36:39], v[88:91], v[140:143]
ds_read_b128 v[100:103], v6 offset:3072
s_waitcnt lgkmcnt(15)
v_mfma_f32_16x16x32_bf16 v[124:127], v[16:19], v[92:95], v[124:127]
ds_read_b128 v[104:107], v6 offset:2560
v_mfma_f32_16x16x32_bf16 v[128:131], v[20:23], v[92:95], v[128:131]
ds_read_b128 v[108:111], v6 offset:2048
v_mfma_f32_16x16x32_bf16 v[132:135], v[24:27], v[92:95], v[132:135]
v_mfma_f32_16x16x32_bf16 v[136:139], v[28:31], v[92:95], v[136:139]
v_mfma_f32_16x16x32_bf16 v[140:143], v[32:35], v[92:95], v[140:143]
v_mfma_f32_16x16x32_bf16 v[112:115], v[48:51], v[96:99], v[112:115]
s_waitcnt lgkmcnt(15)
v_mfma_f32_16x16x32_bf16 v[116:119], v[52:55], v[96:99], v[116:119]
s_waitcnt lgkmcnt(13)
v_mfma_f32_16x16x32_bf16 v[120:123], v[56:59], v[96:99], v[120:123]
s_waitcnt lgkmcnt(11)
v_mfma_f32_16x16x32_bf16 v[124:127], v[60:63], v[96:99], v[124:127]
s_waitcnt lgkmcnt(9)
v_mfma_f32_16x16x32_bf16 v[128:131], v[64:67], v[96:99], v[128:131]
s_waitcnt lgkmcnt(7)
v_mfma_f32_16x16x32_bf16 v[132:135], v[68:71], v[96:99], v[132:135]
s_waitcnt lgkmcnt(5)
v_mfma_f32_16x16x32_bf16 v[136:139], v[72:75], v[96:99], v[136:139]
s_waitcnt lgkmcnt(3)
v_mfma_f32_16x16x32_bf16 v[140:143], v[76:79], v[96:99], v[140:143]
s_waitcnt lgkmcnt(2)
v_mfma_f32_16x16x32_bf16 v[116:119], v[48:51], v[100:103], v[116:119]
v_mov_b32 v251, 1
ds_write_b32 v243, v251 offset:48
v_mfma_f32_16x16x32_bf16 v[120:123], v[52:55], v[100:103], v[120:123]
v_mfma_f32_16x16x32_bf16 v[124:127], v[56:59], v[100:103], v[124:127]
v_mfma_f32_16x16x32_bf16 v[128:131], v[60:63], v[100:103], v[128:131]
v_mfma_f32_16x16x32_bf16 v[132:135], v[64:67], v[100:103], v[132:135]
v_mfma_f32_16x16x32_bf16 v[136:139], v[68:71], v[100:103], v[136:139]
v_mfma_f32_16x16x32_bf16 v[140:143], v[72:75], v[100:103], v[140:143]
s_waitcnt lgkmcnt(2)
v_mfma_f32_16x16x32_bf16 v[120:123], v[48:51], v[104:107], v[120:123]
v_mfma_f32_16x16x32_bf16 v[124:127], v[52:55], v[104:107], v[124:127]
v_mfma_f32_16x16x32_bf16 v[128:131], v[56:59], v[104:107], v[128:131]
v_mfma_f32_16x16x32_bf16 v[132:135], v[60:63], v[104:107], v[132:135]
v_mfma_f32_16x16x32_bf16 v[136:139], v[64:67], v[104:107], v[136:139]
v_mfma_f32_16x16x32_bf16 v[140:143], v[68:71], v[104:107], v[140:143]
s_waitcnt lgkmcnt(1)
v_mfma_f32_16x16x32_bf16 v[124:127], v[48:51], v[108:111], v[124:127]
v_mfma_f32_16x16x32_bf16 v[128:131], v[52:55], v[108:111], v[128:131]
v_mfma_f32_16x16x32_bf16 v[132:135], v[56:59], v[108:111], v[132:135]
v_mfma_f32_16x16x32_bf16 v[136:139], v[60:63], v[108:111], v[136:139]
v_mfma_f32_16x16x32_bf16 v[140:143], v[64:67], v[108:111], v[140:143]
v_add_u32 v2, 8320, v2
v_add_u32 v3, 8320, v3
v_add_u32 v4, 8320, v4
v_add_u32 v5, 8320, v5
LcA1:
Lcph1:
ds_read_b32 v252, v243 offset:32
s_waitcnt lgkmcnt(0)
v_readfirstlane_b32 s7, v252
s_cmp_ge_u32 s7, 1
s_cbranch_scc1 Lcph1_ok
s_sleep 2
s_branch Lcph1
Lcph1_ok:
ds_read_b128 v[80:83], v6 offset:8704
ds_read2_b32 v[16:17], v2 offset0:112 offset1:113
ds_read2_b32 v[18:19], v2 offset0:114 offset1:115
ds_read2_b32 v[20:21], v2 offset0:240 offset1:241
ds_read2_b32 v[22:23], v2 offset0:242 offset1:243
ds_read2_b32 v[24:25], v3 offset0:112 offset1:113
ds_read2_b32 v[26:27], v3 offset0:114 offset1:115
ds_read2_b32 v[28:29], v3 offset0:240 offset1:241
ds_read2_b32 v[30:31], v3 offset0:242 offset1:243
ds_read2_b32 v[32:33], v4 offset0:112 offset1:113
ds_read2_b32 v[34:35], v4 offset0:114 offset1:115
ds_read2_b32 v[36:37], v4 offset0:240 offset1:241
ds_read2_b32 v[38:39], v4 offset0:242 offset1:243
ds_read2_b32 v[40:41], v5 offset0:112 offset1:113
ds_read2_b32 v[42:43], v5 offset0:114 offset1:115
ds_read2_b32 v[44:45], v5 offset0:240 offset1:241
ds_read2_b32 v[46:47], v5 offset0:242 offset1:243
ds_read_b128 v[84:87], v6 offset:8192
ds_read_b128 v[88:91], v6 offset:7680
ds_read_b128 v[92:95], v6 offset:7168
s_waitcnt lgkmcnt(15)
v_mfma_f32_16x16x32_bf16 v[144:147], v[16:19], v[80:83], 0
ds_read_b128 v[96:99], v6 offset:8640
v_mfma_f32_16x16x32_bf16 v[148:151], v[20:23], v[80:83], 0
ds_read2_b32 v[48:49], v2 offset0:96 offset1:97
s_waitcnt lgkmcnt(15)
v_mfma_f32_16x16x32_bf16 v[152:155], v[24:27], v[80:83], 0
ds_read2_b32 v[50:51], v2 offset0:98 offset1:99
s_waitcnt lgkmcnt(14)
v_mfma_f32_16x16x32_bf16 v[156:159], v[28:31], v[80:83], 0
ds_read2_b32 v[52:53], v2 offset0:224 offset1:225
s_waitcnt lgkmcnt(13)
v_mfma_f32_16x16x32_bf16 v[160:163], v[32:35], v[80:83], 0
ds_read2_b32 v[54:55], v2 offset0:226 offset1:227
s_waitcnt lgkmcnt(12)
v_mfma_f32_16x16x32_bf16 v[164:167], v[36:39], v[80:83], 0
s_waitcnt lgkmcnt(10)
v_mfma_f32_16x16x32_bf16 v[168:171], v[40:43], v[80:83], 0
ds_read2_b32 v[56:57], v3 offset0:96 offset1:97
s_waitcnt lgkmcnt(9)
v_mfma_f32_16x16x32_bf16 v[172:175], v[44:47], v[80:83], 0
ds_read2_b32 v[58:59], v3 offset0:98 offset1:99
s_waitcnt lgkmcnt(9)
v_mfma_f32_16x16x32_bf16 v[148:151], v[16:19], v[84:87], v[148:151]
ds_read2_b32 v[60:61], v3 offset0:224 offset1:225
v_mfma_f32_16x16x32_bf16 v[152:155], v[20:23], v[84:87], v[152:155]
ds_read2_b32 v[62:63], v3 offset0:226 offset1:227
v_mfma_f32_16x16x32_bf16 v[156:159], v[24:27], v[84:87], v[156:159]
ds_read2_b32 v[64:65], v4 offset0:96 offset1:97
v_mfma_f32_16x16x32_bf16 v[160:163], v[28:31], v[84:87], v[160:163]
v_mfma_f32_16x16x32_bf16 v[164:167], v[32:35], v[84:87], v[164:167]
ds_read2_b32 v[66:67], v4 offset0:98 offset1:99
v_mfma_f32_16x16x32_bf16 v[168:171], v[36:39], v[84:87], v[168:171]
ds_read2_b32 v[68:69], v4 offset0:224 offset1:225
v_mfma_f32_16x16x32_bf16 v[172:175], v[40:43], v[84:87], v[172:175]
ds_read2_b32 v[70:71], v4 offset0:226 offset1:227
s_waitcnt lgkmcnt(14)
v_mfma_f32_16x16x32_bf16 v[152:155], v[16:19], v[88:91], v[152:155]
ds_read2_b32 v[72:73], v5 offset0:96 offset1:97
v_mfma_f32_16x16x32_bf16 v[156:159], v[20:23], v[88:91], v[156:159]
ds_read2_b32 v[74:75], v5 offset0:98 offset1:99
v_mfma_f32_16x16x32_bf16 v[160:163], v[24:27], v[88:91], v[160:163]
v_mfma_f32_16x16x32_bf16 v[164:167], v[28:31], v[88:91], v[164:167]
ds_read2_b32 v[76:77], v5 offset0:224 offset1:225
v_mfma_f32_16x16x32_bf16 v[168:171], v[32:35], v[88:91], v[168:171]
ds_read2_b32 v[78:79], v5 offset0:226 offset1:227
v_mfma_f32_16x16x32_bf16 v[172:175], v[36:39], v[88:91], v[172:175]
ds_read_b128 v[100:103], v6 offset:8128
s_waitcnt lgkmcnt(15)
v_mfma_f32_16x16x32_bf16 v[156:159], v[16:19], v[92:95], v[156:159]
ds_read_b128 v[104:107], v6 offset:7616
v_mfma_f32_16x16x32_bf16 v[160:163], v[20:23], v[92:95], v[160:163]
ds_read_b128 v[108:111], v6 offset:7104
v_mfma_f32_16x16x32_bf16 v[164:167], v[24:27], v[92:95], v[164:167]
v_mfma_f32_16x16x32_bf16 v[168:171], v[28:31], v[92:95], v[168:171]
v_mfma_f32_16x16x32_bf16 v[172:175], v[32:35], v[92:95], v[172:175]
v_mfma_f32_16x16x32_bf16 v[144:147], v[48:51], v[96:99], v[144:147]
ds_read_b128 v[80:83], v6 offset:8576
s_waitcnt lgkmcnt(15)
v_mfma_f32_16x16x32_bf16 v[148:151], v[52:55], v[96:99], v[148:151]
ds_read2_b32 v[16:17], v2 offset0:80 offset1:81
s_waitcnt lgkmcnt(15)
v_mfma_f32_16x16x32_bf16 v[152:155], v[56:59], v[96:99], v[152:155]
ds_read2_b32 v[18:19], v2 offset0:82 offset1:83
s_waitcnt lgkmcnt(14)
v_mfma_f32_16x16x32_bf16 v[156:159], v[60:63], v[96:99], v[156:159]
ds_read2_b32 v[20:21], v2 offset0:208 offset1:209
s_waitcnt lgkmcnt(13)
v_mfma_f32_16x16x32_bf16 v[160:163], v[64:67], v[96:99], v[160:163]
ds_read2_b32 v[22:23], v2 offset0:210 offset1:211
s_waitcnt lgkmcnt(12)
v_mfma_f32_16x16x32_bf16 v[164:167], v[68:71], v[96:99], v[164:167]
s_waitcnt lgkmcnt(10)
v_mfma_f32_16x16x32_bf16 v[168:171], v[72:75], v[96:99], v[168:171]
ds_read2_b32 v[24:25], v3 offset0:80 offset1:81
s_waitcnt lgkmcnt(9)
v_mfma_f32_16x16x32_bf16 v[172:175], v[76:79], v[96:99], v[172:175]
ds_read2_b32 v[26:27], v3 offset0:82 offset1:83
s_waitcnt lgkmcnt(9)
v_mfma_f32_16x16x32_bf16 v[148:151], v[48:51], v[100:103], v[148:151]
ds_read2_b32 v[28:29], v3 offset0:208 offset1:209
v_mfma_f32_16x16x32_bf16 v[152:155], v[52:55], v[100:103], v[152:155]
ds_read2_b32 v[30:31], v3 offset0:210 offset1:211
v_mfma_f32_16x16x32_bf16 v[156:159], v[56:59], v[100:103], v[156:159]
ds_read2_b32 v[32:33], v4 offset0:80 offset1:81
v_mfma_f32_16x16x32_bf16 v[160:163], v[60:63], v[100:103], v[160:163]
v_mfma_f32_16x16x32_bf16 v[164:167], v[64:67], v[100:103], v[164:167]
ds_read2_b32 v[34:35], v4 offset0:82 offset1:83
v_mfma_f32_16x16x32_bf16 v[168:171], v[68:71], v[100:103], v[168:171]
ds_read2_b32 v[36:37], v4 offset0:208 offset1:209
v_mfma_f32_16x16x32_bf16 v[172:175], v[72:75], v[100:103], v[172:175]
ds_read2_b32 v[38:39], v4 offset0:210 offset1:211
s_waitcnt lgkmcnt(14)
v_mfma_f32_16x16x32_bf16 v[152:155], v[48:51], v[104:107], v[152:155]
ds_read2_b32 v[40:41], v5 offset0:80 offset1:81
v_mfma_f32_16x16x32_bf16 v[156:159], v[52:55], v[104:107], v[156:159]
ds_read2_b32 v[42:43], v5 offset0:82 offset1:83
v_mfma_f32_16x16x32_bf16 v[160:163], v[56:59], v[104:107], v[160:163]
v_mfma_f32_16x16x32_bf16 v[164:167], v[60:63], v[104:107], v[164:167]
ds_read2_b32 v[44:45], v5 offset0:208 offset1:209
v_mfma_f32_16x16x32_bf16 v[168:171], v[64:67], v[104:107], v[168:171]
ds_read2_b32 v[46:47], v5 offset0:210 offset1:211
v_mfma_f32_16x16x32_bf16 v[172:175], v[68:71], v[104:107], v[172:175]
ds_read_b128 v[84:87], v6 offset:8064
s_waitcnt lgkmcnt(15)
v_mfma_f32_16x16x32_bf16 v[156:159], v[48:51], v[108:111], v[156:159]
ds_read_b128 v[88:91], v6 offset:7552
v_mfma_f32_16x16x32_bf16 v[160:163], v[52:55], v[108:111], v[160:163]
ds_read_b128 v[92:95], v6 offset:7040
v_mfma_f32_16x16x32_bf16 v[164:167], v[56:59], v[108:111], v[164:167]
v_mfma_f32_16x16x32_bf16 v[168:171], v[60:63], v[108:111], v[168:171]
v_mfma_f32_16x16x32_bf16 v[172:175], v[64:67], v[108:111], v[172:175]
v_mfma_f32_16x16x32_bf16 v[144:147], v[16:19], v[80:83], v[144:147]
ds_read_b128 v[96:99], v6 offset:8512
s_waitcnt lgkmcnt(15)
v_mfma_f32_16x16x32_bf16 v[148:151], v[20:23], v[80:83], v[148:151]
ds_read2_b32 v[48:49], v2 offset0:64 offset1:65
s_waitcnt lgkmcnt(15)
v_mfma_f32_16x16x32_bf16 v[152:155], v[24:27], v[80:83], v[152:155]
ds_read2_b32 v[50:51], v2 offset0:66 offset1:67
s_waitcnt lgkmcnt(14)
v_mfma_f32_16x16x32_bf16 v[156:159], v[28:31], v[80:83], v[156:159]
ds_read2_b32 v[52:53], v2 offset0:192 offset1:193
s_waitcnt lgkmcnt(13)
v_mfma_f32_16x16x32_bf16 v[160:163], v[32:35], v[80:83], v[160:163]
ds_read2_b32 v[54:55], v2 offset0:194 offset1:195
s_waitcnt lgkmcnt(12)
v_mfma_f32_16x16x32_bf16 v[164:167], v[36:39], v[80:83], v[164:167]
s_waitcnt lgkmcnt(10)
v_mfma_f32_16x16x32_bf16 v[168:171], v[40:43], v[80:83], v[168:171]
ds_read2_b32 v[56:57], v3 offset0:64 offset1:65
s_waitcnt lgkmcnt(9)
v_mfma_f32_16x16x32_bf16 v[172:175], v[44:47], v[80:83], v[172:175]
ds_read2_b32 v[58:59], v3 offset0:66 offset1:67
s_waitcnt lgkmcnt(9)
v_mfma_f32_16x16x32_bf16 v[148:151], v[16:19], v[84:87], v[148:151]
ds_read2_b32 v[60:61], v3 offset0:192 offset1:193
v_mfma_f32_16x16x32_bf16 v[152:155], v[20:23], v[84:87], v[152:155]
ds_read2_b32 v[62:63], v3 offset0:194 offset1:195
v_mfma_f32_16x16x32_bf16 v[156:159], v[24:27], v[84:87], v[156:159]
ds_read2_b32 v[64:65], v4 offset0:64 offset1:65
v_mfma_f32_16x16x32_bf16 v[160:163], v[28:31], v[84:87], v[160:163]
v_mfma_f32_16x16x32_bf16 v[164:167], v[32:35], v[84:87], v[164:167]
ds_read2_b32 v[66:67], v4 offset0:66 offset1:67
v_mfma_f32_16x16x32_bf16 v[168:171], v[36:39], v[84:87], v[168:171]
ds_read2_b32 v[68:69], v4 offset0:192 offset1:193
v_mfma_f32_16x16x32_bf16 v[172:175], v[40:43], v[84:87], v[172:175]
ds_read2_b32 v[70:71], v4 offset0:194 offset1:195
s_waitcnt lgkmcnt(14)
v_mfma_f32_16x16x32_bf16 v[152:155], v[16:19], v[88:91], v[152:155]
ds_read2_b32 v[72:73], v5 offset0:64 offset1:65
v_mfma_f32_16x16x32_bf16 v[156:159], v[20:23], v[88:91], v[156:159]
ds_read2_b32 v[74:75], v5 offset0:66 offset1:67
v_mfma_f32_16x16x32_bf16 v[160:163], v[24:27], v[88:91], v[160:163]
v_mfma_f32_16x16x32_bf16 v[164:167], v[28:31], v[88:91], v[164:167]
ds_read2_b32 v[76:77], v5 offset0:192 offset1:193
v_mfma_f32_16x16x32_bf16 v[168:171], v[32:35], v[88:91], v[168:171]
ds_read2_b32 v[78:79], v5 offset0:194 offset1:195
v_mfma_f32_16x16x32_bf16 v[172:175], v[36:39], v[88:91], v[172:175]
ds_read_b128 v[100:103], v6 offset:8000
s_waitcnt lgkmcnt(15)
v_mfma_f32_16x16x32_bf16 v[156:159], v[16:19], v[92:95], v[156:159]
ds_read_b128 v[104:107], v6 offset:7488
v_mfma_f32_16x16x32_bf16 v[160:163], v[20:23], v[92:95], v[160:163]
ds_read_b128 v[108:111], v6 offset:6976
v_mfma_f32_16x16x32_bf16 v[164:167], v[24:27], v[92:95], v[164:167]
v_mfma_f32_16x16x32_bf16 v[168:171], v[28:31], v[92:95], v[168:171]
v_mfma_f32_16x16x32_bf16 v[172:175], v[32:35], v[92:95], v[172:175]
v_mfma_f32_16x16x32_bf16 v[144:147], v[48:51], v[96:99], v[144:147]
ds_read_b128 v[80:83], v6 offset:8448
s_waitcnt lgkmcnt(15)
v_mfma_f32_16x16x32_bf16 v[148:151], v[52:55], v[96:99], v[148:151]
ds_read2_b32 v[16:17], v2 offset0:48 offset1:49
s_waitcnt lgkmcnt(15)
v_mfma_f32_16x16x32_bf16 v[152:155], v[56:59], v[96:99], v[152:155]
ds_read2_b32 v[18:19], v2 offset0:50 offset1:51
s_waitcnt lgkmcnt(14)
v_mfma_f32_16x16x32_bf16 v[156:159], v[60:63], v[96:99], v[156:159]
ds_read2_b32 v[20:21], v2 offset0:176 offset1:177
s_waitcnt lgkmcnt(13)
v_mfma_f32_16x16x32_bf16 v[160:163], v[64:67], v[96:99], v[160:163]
ds_read2_b32 v[22:23], v2 offset0:178 offset1:179
s_waitcnt lgkmcnt(12)
v_mfma_f32_16x16x32_bf16 v[164:167], v[68:71], v[96:99], v[164:167]
s_waitcnt lgkmcnt(10)
v_mfma_f32_16x16x32_bf16 v[168:171], v[72:75], v[96:99], v[168:171]
ds_read2_b32 v[24:25], v3 offset0:48 offset1:49
s_waitcnt lgkmcnt(9)
v_mfma_f32_16x16x32_bf16 v[172:175], v[76:79], v[96:99], v[172:175]
ds_read2_b32 v[26:27], v3 offset0:50 offset1:51
s_waitcnt lgkmcnt(9)
v_mfma_f32_16x16x32_bf16 v[148:151], v[48:51], v[100:103], v[148:151]
ds_read2_b32 v[28:29], v3 offset0:176 offset1:177
v_mfma_f32_16x16x32_bf16 v[152:155], v[52:55], v[100:103], v[152:155]
ds_read2_b32 v[30:31], v3 offset0:178 offset1:179
v_mfma_f32_16x16x32_bf16 v[156:159], v[56:59], v[100:103], v[156:159]
ds_read2_b32 v[32:33], v4 offset0:48 offset1:49
v_mfma_f32_16x16x32_bf16 v[160:163], v[60:63], v[100:103], v[160:163]
v_mfma_f32_16x16x32_bf16 v[164:167], v[64:67], v[100:103], v[164:167]
ds_read2_b32 v[34:35], v4 offset0:50 offset1:51
v_mfma_f32_16x16x32_bf16 v[168:171], v[68:71], v[100:103], v[168:171]
ds_read2_b32 v[36:37], v4 offset0:176 offset1:177
v_mfma_f32_16x16x32_bf16 v[172:175], v[72:75], v[100:103], v[172:175]
ds_read2_b32 v[38:39], v4 offset0:178 offset1:179
s_waitcnt lgkmcnt(14)
v_mfma_f32_16x16x32_bf16 v[152:155], v[48:51], v[104:107], v[152:155]
ds_read2_b32 v[40:41], v5 offset0:48 offset1:49
v_mfma_f32_16x16x32_bf16 v[156:159], v[52:55], v[104:107], v[156:159]
ds_read2_b32 v[42:43], v5 offset0:50 offset1:51
v_mfma_f32_16x16x32_bf16 v[160:163], v[56:59], v[104:107], v[160:163]
v_mfma_f32_16x16x32_bf16 v[164:167], v[60:63], v[104:107], v[164:167]
ds_read2_b32 v[44:45], v5 offset0:176 offset1:177
v_mfma_f32_16x16x32_bf16 v[168:171], v[64:67], v[104:107], v[168:171]
ds_read2_b32 v[46:47], v5 offset0:178 offset1:179
v_mfma_f32_16x16x32_bf16 v[172:175], v[68:71], v[104:107], v[172:175]
ds_read_b128 v[84:87], v6 offset:7936
s_waitcnt lgkmcnt(15)
v_mfma_f32_16x16x32_bf16 v[156:159], v[48:51], v[108:111], v[156:159]
ds_read_b128 v[88:91], v6 offset:7424
v_mfma_f32_16x16x32_bf16 v[160:163], v[52:55], v[108:111], v[160:163]
ds_read_b128 v[92:95], v6 offset:6912
v_mfma_f32_16x16x32_bf16 v[164:167], v[56:59], v[108:111], v[164:167]
v_mfma_f32_16x16x32_bf16 v[168:171], v[60:63], v[108:111], v[168:171]
v_mfma_f32_16x16x32_bf16 v[172:175], v[64:67], v[108:111], v[172:175]
v_mfma_f32_16x16x32_bf16 v[144:147], v[16:19], v[80:83], v[144:147]
ds_read_b128 v[96:99], v6 offset:8384
s_waitcnt lgkmcnt(15)
v_mfma_f32_16x16x32_bf16 v[148:151], v[20:23], v[80:83], v[148:151]
ds_read2_b32 v[48:49], v2 offset0:32 offset1:33
s_waitcnt lgkmcnt(15)
v_mfma_f32_16x16x32_bf16 v[152:155], v[24:27], v[80:83], v[152:155]
ds_read2_b32 v[50:51], v2 offset0:34 offset1:35
s_waitcnt lgkmcnt(14)
v_mfma_f32_16x16x32_bf16 v[156:159], v[28:31], v[80:83], v[156:159]
ds_read2_b32 v[52:53], v2 offset0:160 offset1:161
s_waitcnt lgkmcnt(13)
v_mfma_f32_16x16x32_bf16 v[160:163], v[32:35], v[80:83], v[160:163]
ds_read2_b32 v[54:55], v2 offset0:162 offset1:163
s_waitcnt lgkmcnt(12)
v_mfma_f32_16x16x32_bf16 v[164:167], v[36:39], v[80:83], v[164:167]
s_waitcnt lgkmcnt(10)
v_mfma_f32_16x16x32_bf16 v[168:171], v[40:43], v[80:83], v[168:171]
ds_read2_b32 v[56:57], v3 offset0:32 offset1:33
s_waitcnt lgkmcnt(9)
v_mfma_f32_16x16x32_bf16 v[172:175], v[44:47], v[80:83], v[172:175]
ds_read2_b32 v[58:59], v3 offset0:34 offset1:35
s_waitcnt lgkmcnt(9)
v_mfma_f32_16x16x32_bf16 v[148:151], v[16:19], v[84:87], v[148:151]
ds_read2_b32 v[60:61], v3 offset0:160 offset1:161
v_mfma_f32_16x16x32_bf16 v[152:155], v[20:23], v[84:87], v[152:155]
ds_read2_b32 v[62:63], v3 offset0:162 offset1:163
v_mfma_f32_16x16x32_bf16 v[156:159], v[24:27], v[84:87], v[156:159]
ds_read2_b32 v[64:65], v4 offset0:32 offset1:33
v_mfma_f32_16x16x32_bf16 v[160:163], v[28:31], v[84:87], v[160:163]
v_mfma_f32_16x16x32_bf16 v[164:167], v[32:35], v[84:87], v[164:167]
ds_read2_b32 v[66:67], v4 offset0:34 offset1:35
v_mfma_f32_16x16x32_bf16 v[168:171], v[36:39], v[84:87], v[168:171]
ds_read2_b32 v[68:69], v4 offset0:160 offset1:161
v_mfma_f32_16x16x32_bf16 v[172:175], v[40:43], v[84:87], v[172:175]
ds_read2_b32 v[70:71], v4 offset0:162 offset1:163
s_waitcnt lgkmcnt(14)
v_mfma_f32_16x16x32_bf16 v[152:155], v[16:19], v[88:91], v[152:155]
ds_read2_b32 v[72:73], v5 offset0:32 offset1:33
v_mfma_f32_16x16x32_bf16 v[156:159], v[20:23], v[88:91], v[156:159]
ds_read2_b32 v[74:75], v5 offset0:34 offset1:35
v_mfma_f32_16x16x32_bf16 v[160:163], v[24:27], v[88:91], v[160:163]
v_mfma_f32_16x16x32_bf16 v[164:167], v[28:31], v[88:91], v[164:167]
ds_read2_b32 v[76:77], v5 offset0:160 offset1:161
v_mfma_f32_16x16x32_bf16 v[168:171], v[32:35], v[88:91], v[168:171]
ds_read2_b32 v[78:79], v5 offset0:162 offset1:163
v_mfma_f32_16x16x32_bf16 v[172:175], v[36:39], v[88:91], v[172:175]
ds_read_b128 v[100:103], v6 offset:7872
s_waitcnt lgkmcnt(15)
v_mfma_f32_16x16x32_bf16 v[156:159], v[16:19], v[92:95], v[156:159]
ds_read_b128 v[104:107], v6 offset:7360
v_mfma_f32_16x16x32_bf16 v[160:163], v[20:23], v[92:95], v[160:163]
ds_read_b128 v[108:111], v6 offset:6848
v_mfma_f32_16x16x32_bf16 v[164:167], v[24:27], v[92:95], v[164:167]
v_mfma_f32_16x16x32_bf16 v[168:171], v[28:31], v[92:95], v[168:171]
v_mfma_f32_16x16x32_bf16 v[172:175], v[32:35], v[92:95], v[172:175]
v_mfma_f32_16x16x32_bf16 v[144:147], v[48:51], v[96:99], v[144:147]
ds_read_b128 v[80:83], v6 offset:8320
s_waitcnt lgkmcnt(15)
v_mfma_f32_16x16x32_bf16 v[148:151], v[52:55], v[96:99], v[148:151]
ds_read2_b32 v[16:17], v2 offset0:16 offset1:17
s_waitcnt lgkmcnt(15)
v_mfma_f32_16x16x32_bf16 v[152:155], v[56:59], v[96:99], v[152:155]
ds_read2_b32 v[18:19], v2 offset0:18 offset1:19
s_waitcnt lgkmcnt(14)
v_mfma_f32_16x16x32_bf16 v[156:159], v[60:63], v[96:99], v[156:159]
ds_read2_b32 v[20:21], v2 offset0:144 offset1:145
s_waitcnt lgkmcnt(13)
v_mfma_f32_16x16x32_bf16 v[160:163], v[64:67], v[96:99], v[160:163]
ds_read2_b32 v[22:23], v2 offset0:146 offset1:147
s_waitcnt lgkmcnt(12)
v_mfma_f32_16x16x32_bf16 v[164:167], v[68:71], v[96:99], v[164:167]
s_waitcnt lgkmcnt(10)
v_mfma_f32_16x16x32_bf16 v[168:171], v[72:75], v[96:99], v[168:171]
ds_read2_b32 v[24:25], v3 offset0:16 offset1:17
s_waitcnt lgkmcnt(9)
v_mfma_f32_16x16x32_bf16 v[172:175], v[76:79], v[96:99], v[172:175]
ds_read2_b32 v[26:27], v3 offset0:18 offset1:19
s_waitcnt lgkmcnt(9)
v_mfma_f32_16x16x32_bf16 v[148:151], v[48:51], v[100:103], v[148:151]
ds_read2_b32 v[28:29], v3 offset0:144 offset1:145
v_mfma_f32_16x16x32_bf16 v[152:155], v[52:55], v[100:103], v[152:155]
ds_read2_b32 v[30:31], v3 offset0:146 offset1:147
v_mfma_f32_16x16x32_bf16 v[156:159], v[56:59], v[100:103], v[156:159]
ds_read2_b32 v[32:33], v4 offset0:16 offset1:17
v_mfma_f32_16x16x32_bf16 v[160:163], v[60:63], v[100:103], v[160:163]
v_mfma_f32_16x16x32_bf16 v[164:167], v[64:67], v[100:103], v[164:167]
ds_read2_b32 v[34:35], v4 offset0:18 offset1:19
v_mfma_f32_16x16x32_bf16 v[168:171], v[68:71], v[100:103], v[168:171]
ds_read2_b32 v[36:37], v4 offset0:144 offset1:145
v_mfma_f32_16x16x32_bf16 v[172:175], v[72:75], v[100:103], v[172:175]
ds_read2_b32 v[38:39], v4 offset0:146 offset1:147
s_waitcnt lgkmcnt(14)
v_mfma_f32_16x16x32_bf16 v[152:155], v[48:51], v[104:107], v[152:155]
ds_read2_b32 v[40:41], v5 offset0:16 offset1:17
v_mfma_f32_16x16x32_bf16 v[156:159], v[52:55], v[104:107], v[156:159]
ds_read2_b32 v[42:43], v5 offset0:18 offset1:19
v_mfma_f32_16x16x32_bf16 v[160:163], v[56:59], v[104:107], v[160:163]
v_mfma_f32_16x16x32_bf16 v[164:167], v[60:63], v[104:107], v[164:167]
ds_read2_b32 v[44:45], v5 offset0:144 offset1:145
v_mfma_f32_16x16x32_bf16 v[168:171], v[64:67], v[104:107], v[168:171]
ds_read2_b32 v[46:47], v5 offset0:146 offset1:147
v_mfma_f32_16x16x32_bf16 v[172:175], v[68:71], v[104:107], v[172:175]
ds_read_b128 v[84:87], v6 offset:7808
s_waitcnt lgkmcnt(15)
v_mfma_f32_16x16x32_bf16 v[156:159], v[48:51], v[108:111], v[156:159]
ds_read_b128 v[88:91], v6 offset:7296
v_mfma_f32_16x16x32_bf16 v[160:163], v[52:55], v[108:111], v[160:163]
ds_read_b128 v[92:95], v6 offset:6784
v_mfma_f32_16x16x32_bf16 v[164:167], v[56:59], v[108:111], v[164:167]
v_mfma_f32_16x16x32_bf16 v[168:171], v[60:63], v[108:111], v[168:171]
v_mfma_f32_16x16x32_bf16 v[172:175], v[64:67], v[108:111], v[172:175]
v_mfma_f32_16x16x32_bf16 v[144:147], v[16:19], v[80:83], v[144:147]
ds_read_b128 v[96:99], v6 offset:8256
s_waitcnt lgkmcnt(15)
v_mfma_f32_16x16x32_bf16 v[148:151], v[20:23], v[80:83], v[148:151]
ds_read2_b32 v[48:49], v2 offset0:0 offset1:1
s_waitcnt lgkmcnt(15)
v_mfma_f32_16x16x32_bf16 v[152:155], v[24:27], v[80:83], v[152:155]
ds_read2_b32 v[50:51], v2 offset0:2 offset1:3
s_waitcnt lgkmcnt(14)
v_mfma_f32_16x16x32_bf16 v[156:159], v[28:31], v[80:83], v[156:159]
ds_read2_b32 v[52:53], v2 offset0:128 offset1:129
s_waitcnt lgkmcnt(13)
v_mfma_f32_16x16x32_bf16 v[160:163], v[32:35], v[80:83], v[160:163]
ds_read2_b32 v[54:55], v2 offset0:130 offset1:131
s_waitcnt lgkmcnt(12)
v_mfma_f32_16x16x32_bf16 v[164:167], v[36:39], v[80:83], v[164:167]
s_waitcnt lgkmcnt(10)
v_mfma_f32_16x16x32_bf16 v[168:171], v[40:43], v[80:83], v[168:171]
ds_read2_b32 v[56:57], v3 offset0:0 offset1:1
s_waitcnt lgkmcnt(9)
v_mfma_f32_16x16x32_bf16 v[172:175], v[44:47], v[80:83], v[172:175]
ds_read2_b32 v[58:59], v3 offset0:2 offset1:3
s_waitcnt lgkmcnt(9)
v_mfma_f32_16x16x32_bf16 v[148:151], v[16:19], v[84:87], v[148:151]
ds_read2_b32 v[60:61], v3 offset0:128 offset1:129
v_mfma_f32_16x16x32_bf16 v[152:155], v[20:23], v[84:87], v[152:155]
ds_read2_b32 v[62:63], v3 offset0:130 offset1:131
v_mfma_f32_16x16x32_bf16 v[156:159], v[24:27], v[84:87], v[156:159]
ds_read2_b32 v[64:65], v4 offset0:0 offset1:1
v_mfma_f32_16x16x32_bf16 v[160:163], v[28:31], v[84:87], v[160:163]
v_mfma_f32_16x16x32_bf16 v[164:167], v[32:35], v[84:87], v[164:167]
ds_read2_b32 v[66:67], v4 offset0:2 offset1:3
v_mfma_f32_16x16x32_bf16 v[168:171], v[36:39], v[84:87], v[168:171]
ds_read2_b32 v[68:69], v4 offset0:128 offset1:129
v_mfma_f32_16x16x32_bf16 v[172:175], v[40:43], v[84:87], v[172:175]
ds_read2_b32 v[70:71], v4 offset0:130 offset1:131
s_waitcnt lgkmcnt(14)
v_mfma_f32_16x16x32_bf16 v[152:155], v[16:19], v[88:91], v[152:155]
ds_read2_b32 v[72:73], v5 offset0:0 offset1:1
v_mfma_f32_16x16x32_bf16 v[156:159], v[20:23], v[88:91], v[156:159]
ds_read2_b32 v[74:75], v5 offset0:2 offset1:3
v_mfma_f32_16x16x32_bf16 v[160:163], v[24:27], v[88:91], v[160:163]
v_mfma_f32_16x16x32_bf16 v[164:167], v[28:31], v[88:91], v[164:167]
ds_read2_b32 v[76:77], v5 offset0:128 offset1:129
v_mfma_f32_16x16x32_bf16 v[168:171], v[32:35], v[88:91], v[168:171]
ds_read2_b32 v[78:79], v5 offset0:130 offset1:131
v_mfma_f32_16x16x32_bf16 v[172:175], v[36:39], v[88:91], v[172:175]
ds_read_b128 v[100:103], v6 offset:7744
s_waitcnt lgkmcnt(15)
v_mfma_f32_16x16x32_bf16 v[156:159], v[16:19], v[92:95], v[156:159]
ds_read_b128 v[104:107], v6 offset:7232
v_mfma_f32_16x16x32_bf16 v[160:163], v[20:23], v[92:95], v[160:163]
ds_read_b128 v[108:111], v6 offset:6720
v_mfma_f32_16x16x32_bf16 v[164:167], v[24:27], v[92:95], v[164:167]
v_mfma_f32_16x16x32_bf16 v[168:171], v[28:31], v[92:95], v[168:171]
v_mfma_f32_16x16x32_bf16 v[172:175], v[32:35], v[92:95], v[172:175]
v_mfma_f32_16x16x32_bf16 v[144:147], v[48:51], v[96:99], v[144:147]
s_waitcnt lgkmcnt(15)
v_mfma_f32_16x16x32_bf16 v[148:151], v[52:55], v[96:99], v[148:151]
s_waitcnt lgkmcnt(13)
v_mfma_f32_16x16x32_bf16 v[152:155], v[56:59], v[96:99], v[152:155]
s_waitcnt lgkmcnt(11)
v_mfma_f32_16x16x32_bf16 v[156:159], v[60:63], v[96:99], v[156:159]
s_waitcnt lgkmcnt(9)
v_mfma_f32_16x16x32_bf16 v[160:163], v[64:67], v[96:99], v[160:163]
s_waitcnt lgkmcnt(7)
v_mfma_f32_16x16x32_bf16 v[164:167], v[68:71], v[96:99], v[164:167]
s_waitcnt lgkmcnt(5)
v_mfma_f32_16x16x32_bf16 v[168:171], v[72:75], v[96:99], v[168:171]
s_waitcnt lgkmcnt(3)
v_mfma_f32_16x16x32_bf16 v[172:175], v[76:79], v[96:99], v[172:175]
s_waitcnt lgkmcnt(2)
v_mfma_f32_16x16x32_bf16 v[148:151], v[48:51], v[100:103], v[148:151]
v_mov_b32 v251, 2
ds_write_b32 v243, v251 offset:48
v_mfma_f32_16x16x32_bf16 v[152:155], v[52:55], v[100:103], v[152:155]
v_mfma_f32_16x16x32_bf16 v[156:159], v[56:59], v[100:103], v[156:159]
v_mfma_f32_16x16x32_bf16 v[160:163], v[60:63], v[100:103], v[160:163]
v_mfma_f32_16x16x32_bf16 v[164:167], v[64:67], v[100:103], v[164:167]
v_mfma_f32_16x16x32_bf16 v[168:171], v[68:71], v[100:103], v[168:171]
v_mfma_f32_16x16x32_bf16 v[172:175], v[72:75], v[100:103], v[172:175]
s_waitcnt lgkmcnt(2)
v_mfma_f32_16x16x32_bf16 v[152:155], v[48:51], v[104:107], v[152:155]
v_mfma_f32_16x16x32_bf16 v[156:159], v[52:55], v[104:107], v[156:159]
v_mfma_f32_16x16x32_bf16 v[160:163], v[56:59], v[104:107], v[160:163]
v_mfma_f32_16x16x32_bf16 v[164:167], v[60:63], v[104:107], v[164:167]
v_mfma_f32_16x16x32_bf16 v[168:171], v[64:67], v[104:107], v[168:171]
v_mfma_f32_16x16x32_bf16 v[172:175], v[68:71], v[104:107], v[172:175]
s_waitcnt lgkmcnt(1)
v_mfma_f32_16x16x32_bf16 v[156:159], v[48:51], v[108:111], v[156:159]
v_mfma_f32_16x16x32_bf16 v[160:163], v[52:55], v[108:111], v[160:163]
v_mfma_f32_16x16x32_bf16 v[164:167], v[56:59], v[108:111], v[164:167]
v_mfma_f32_16x16x32_bf16 v[168:171], v[60:63], v[108:111], v[168:171]
v_mfma_f32_16x16x32_bf16 v[172:175], v[64:67], v[108:111], v[172:175]
v_subrev_u32 v2, 8320, v2
v_subrev_u32 v3, 8320, v3
v_subrev_u32 v4, 8320, v4
v_subrev_u32 v5, 8320, v5
LcA2:
s_cmp_eq_u32 s12, 0
s_cbranch_scc1 LcAx2
s_waitcnt vmcnt(0)
ds_write_b16 v12, v9 offset:30
s_waitcnt lgkmcnt(0)
s_branch Lcph2_ok
LcAx2:
Lcph2:
ds_read_b32 v252, v243 offset:32
s_waitcnt lgkmcnt(0)
v_readfirstlane_b32 s7, v252
s_cmp_ge_u32 s7, 2
s_cbranch_scc1 Lcph2_ok
s_sleep 2
s_branch Lcph2
Lcph2_ok:
ds_read_b128 v[80:83], v6 offset:13376
ds_read2_b32 v[16:17], v2 offset0:112 offset1:113
ds_read2_b32 v[18:19], v2 offset0:114 offset1:115
ds_read2_b32 v[20:21], v2 offset0:240 offset1:241
ds_read2_b32 v[22:23], v2 offset0:242 offset1:243
ds_read2_b32 v[24:25], v3 offset0:112 offset1:113
ds_read2_b32 v[26:27], v3 offset0:114 offset1:115
ds_read2_b32 v[28:29], v3 offset0:240 offset1:241
ds_read2_b32 v[30:31], v3 offset0:242 offset1:243
ds_read2_b32 v[32:33], v4 offset0:112 offset1:113
ds_read2_b32 v[34:35], v4 offset0:114 offset1:115
ds_read2_b32 v[36:37], v4 offset0:240 offset1:241
ds_read2_b32 v[38:39], v4 offset0:242 offset1:243
ds_read2_b32 v[40:41], v5 offset0:112 offset1:113
ds_read2_b32 v[42:43], v5 offset0:114 offset1:115
ds_read2_b32 v[44:45], v5 offset0:240 offset1:241
ds_read2_b32 v[46:47], v5 offset0:242 offset1:243
ds_read_b128 v[84:87], v6 offset:12864
ds_read_b128 v[88:91], v6 offset:12352
ds_read_b128 v[92:95], v6 offset:11840
s_waitcnt lgkmcnt(15)
v_mfma_f32_16x16x32_bf16 v[176:179], v[16:19], v[80:83], 0
ds_read_b128 v[96:99], v6 offset:13312
v_mfma_f32_16x16x32_bf16 v[180:183], v[20:23], v[80:83], 0
ds_read2_b32 v[48:49], v2 offset0:96 offset1:97
s_waitcnt lgkmcnt(15)
v_mfma_f32_16x16x32_bf16 v[184:187], v[24:27], v[80:83], 0
ds_read2_b32 v[50:51], v2 offset0:98 offset1:99
s_waitcnt lgkmcnt(14)
v_mfma_f32_16x16x32_bf16 v[188:191], v[28:31], v[80:83], 0
ds_read2_b32 v[52:53], v2 offset0:224 offset1:225
s_waitcnt lgkmcnt(13)
v_mfma_f32_16x16x32_bf16 v[192:195], v[32:35], v[80:83], 0
ds_read2_b32 v[54:55], v2 offset0:226 offset1:227
s_waitcnt lgkmcnt(12)
v_mfma_f32_16x16x32_bf16 v[196:199], v[36:39], v[80:83], 0
s_waitcnt lgkmcnt(10)
v_mfma_f32_16x16x32_bf16 v[200:203], v[40:43], v[80:83], 0
ds_read2_b32 v[56:57], v3 offset0:96 offset1:97
s_waitcnt lgkmcnt(9)
v_mfma_f32_16x16x32_bf16 v[204:207], v[44:47], v[80:83], 0
ds_read2_b32 v[58:59], v3 offset0:98 offset1:99
s_waitcnt lgkmcnt(9)
v_mfma_f32_16x16x32_bf16 v[180:183], v[16:19], v[84:87], v[180:183]
ds_read2_b32 v[60:61], v3 offset0:224 offset1:225
v_mfma_f32_16x16x32_bf16 v[184:187], v[20:23], v[84:87], v[184:187]
ds_read2_b32 v[62:63], v3 offset0:226 offset1:227
v_mfma_f32_16x16x32_bf16 v[188:191], v[24:27], v[84:87], v[188:191]
ds_read2_b32 v[64:65], v4 offset0:96 offset1:97
v_mfma_f32_16x16x32_bf16 v[192:195], v[28:31], v[84:87], v[192:195]
v_mfma_f32_16x16x32_bf16 v[196:199], v[32:35], v[84:87], v[196:199]
ds_read2_b32 v[66:67], v4 offset0:98 offset1:99
v_mfma_f32_16x16x32_bf16 v[200:203], v[36:39], v[84:87], v[200:203]
ds_read2_b32 v[68:69], v4 offset0:224 offset1:225
v_mfma_f32_16x16x32_bf16 v[204:207], v[40:43], v[84:87], v[204:207]
ds_read2_b32 v[70:71], v4 offset0:226 offset1:227
s_waitcnt lgkmcnt(14)
v_mfma_f32_16x16x32_bf16 v[184:187], v[16:19], v[88:91], v[184:187]
ds_read2_b32 v[72:73], v5 offset0:96 offset1:97
v_mfma_f32_16x16x32_bf16 v[188:191], v[20:23], v[88:91], v[188:191]
ds_read2_b32 v[74:75], v5 offset0:98 offset1:99
v_mfma_f32_16x16x32_bf16 v[192:195], v[24:27], v[88:91], v[192:195]
v_mfma_f32_16x16x32_bf16 v[196:199], v[28:31], v[88:91], v[196:199]
ds_read2_b32 v[76:77], v5 offset0:224 offset1:225
v_mfma_f32_16x16x32_bf16 v[200:203], v[32:35], v[88:91], v[200:203]
ds_read2_b32 v[78:79], v5 offset0:226 offset1:227
v_mfma_f32_16x16x32_bf16 v[204:207], v[36:39], v[88:91], v[204:207]
ds_read_b128 v[100:103], v6 offset:12800
s_waitcnt lgkmcnt(15)
v_mfma_f32_16x16x32_bf16 v[188:191], v[16:19], v[92:95], v[188:191]
ds_read_b128 v[104:107], v6 offset:12288
v_mfma_f32_16x16x32_bf16 v[192:195], v[20:23], v[92:95], v[192:195]
ds_read_b128 v[108:111], v6 offset:11776
v_mfma_f32_16x16x32_bf16 v[196:199], v[24:27], v[92:95], v[196:199]
v_mfma_f32_16x16x32_bf16 v[200:203], v[28:31], v[92:95], v[200:203]
v_mfma_f32_16x16x32_bf16 v[204:207], v[32:35], v[92:95], v[204:207]
v_mfma_f32_16x16x32_bf16 v[176:179], v[48:51], v[96:99], v[176:179]
ds_read_b128 v[80:83], v6 offset:13248
s_waitcnt lgkmcnt(15)
v_mfma_f32_16x16x32_bf16 v[180:183], v[52:55], v[96:99], v[180:183]
ds_read2_b32 v[16:17], v2 offset0:80 offset1:81
s_waitcnt lgkmcnt(15)
v_mfma_f32_16x16x32_bf16 v[184:187], v[56:59], v[96:99], v[184:187]
ds_read2_b32 v[18:19], v2 offset0:82 offset1:83
s_waitcnt lgkmcnt(14)
v_mfma_f32_16x16x32_bf16 v[188:191], v[60:63], v[96:99], v[188:191]
ds_read2_b32 v[20:21], v2 offset0:208 offset1:209
s_waitcnt lgkmcnt(13)
v_mfma_f32_16x16x32_bf16 v[192:195], v[64:67], v[96:99], v[192:195]
ds_read2_b32 v[22:23], v2 offset0:210 offset1:211
s_waitcnt lgkmcnt(12)
v_mfma_f32_16x16x32_bf16 v[196:199], v[68:71], v[96:99], v[196:199]
s_waitcnt lgkmcnt(10)
v_mfma_f32_16x16x32_bf16 v[200:203], v[72:75], v[96:99], v[200:203]
ds_read2_b32 v[24:25], v3 offset0:80 offset1:81
s_waitcnt lgkmcnt(9)
v_mfma_f32_16x16x32_bf16 v[204:207], v[76:79], v[96:99], v[204:207]
ds_read2_b32 v[26:27], v3 offset0:82 offset1:83
s_waitcnt lgkmcnt(9)
v_mfma_f32_16x16x32_bf16 v[180:183], v[48:51], v[100:103], v[180:183]
ds_read2_b32 v[28:29], v3 offset0:208 offset1:209
v_mfma_f32_16x16x32_bf16 v[184:187], v[52:55], v[100:103], v[184:187]
ds_read2_b32 v[30:31], v3 offset0:210 offset1:211
v_mfma_f32_16x16x32_bf16 v[188:191], v[56:59], v[100:103], v[188:191]
ds_read2_b32 v[32:33], v4 offset0:80 offset1:81
v_mfma_f32_16x16x32_bf16 v[192:195], v[60:63], v[100:103], v[192:195]
v_mfma_f32_16x16x32_bf16 v[196:199], v[64:67], v[100:103], v[196:199]
ds_read2_b32 v[34:35], v4 offset0:82 offset1:83
v_mfma_f32_16x16x32_bf16 v[200:203], v[68:71], v[100:103], v[200:203]
ds_read2_b32 v[36:37], v4 offset0:208 offset1:209
v_mfma_f32_16x16x32_bf16 v[204:207], v[72:75], v[100:103], v[204:207]
ds_read2_b32 v[38:39], v4 offset0:210 offset1:211
s_waitcnt lgkmcnt(14)
v_mfma_f32_16x16x32_bf16 v[184:187], v[48:51], v[104:107], v[184:187]
ds_read2_b32 v[40:41], v5 offset0:80 offset1:81
v_mfma_f32_16x16x32_bf16 v[188:191], v[52:55], v[104:107], v[188:191]
ds_read2_b32 v[42:43], v5 offset0:82 offset1:83
v_mfma_f32_16x16x32_bf16 v[192:195], v[56:59], v[104:107], v[192:195]
v_mfma_f32_16x16x32_bf16 v[196:199], v[60:63], v[104:107], v[196:199]
ds_read2_b32 v[44:45], v5 offset0:208 offset1:209
v_mfma_f32_16x16x32_bf16 v[200:203], v[64:67], v[104:107], v[200:203]
ds_read2_b32 v[46:47], v5 offset0:210 offset1:211
v_mfma_f32_16x16x32_bf16 v[204:207], v[68:71], v[104:107], v[204:207]
ds_read_b128 v[84:87], v6 offset:12736
s_waitcnt lgkmcnt(15)
v_mfma_f32_16x16x32_bf16 v[188:191], v[48:51], v[108:111], v[188:191]
ds_read_b128 v[88:91], v6 offset:12224
v_mfma_f32_16x16x32_bf16 v[192:195], v[52:55], v[108:111], v[192:195]
ds_read_b128 v[92:95], v6 offset:11712
v_mfma_f32_16x16x32_bf16 v[196:199], v[56:59], v[108:111], v[196:199]
v_mfma_f32_16x16x32_bf16 v[200:203], v[60:63], v[108:111], v[200:203]
buffer_load_dword v15, v13, s[44:47], s15 offen
s_add_u32 s15, s15, 294912
v_mfma_f32_16x16x32_bf16 v[204:207], v[64:67], v[108:111], v[204:207]
v_mfma_f32_16x16x32_bf16 v[176:179], v[16:19], v[80:83], v[176:179]
ds_read_b128 v[96:99], v6 offset:13184
s_waitcnt lgkmcnt(15)
v_mfma_f32_16x16x32_bf16 v[180:183], v[20:23], v[80:83], v[180:183]
ds_read2_b32 v[48:49], v2 offset0:64 offset1:65
s_waitcnt lgkmcnt(15)
v_mfma_f32_16x16x32_bf16 v[184:187], v[24:27], v[80:83], v[184:187]
ds_read2_b32 v[50:51], v2 offset0:66 offset1:67
s_waitcnt lgkmcnt(14)
v_mfma_f32_16x16x32_bf16 v[188:191], v[28:31], v[80:83], v[188:191]
ds_read2_b32 v[52:53], v2 offset0:192 offset1:193
s_waitcnt lgkmcnt(13)
v_mfma_f32_16x16x32_bf16 v[192:195], v[32:35], v[80:83], v[192:195]
ds_read2_b32 v[54:55], v2 offset0:194 offset1:195
s_waitcnt lgkmcnt(12)
v_mfma_f32_16x16x32_bf16 v[196:199], v[36:39], v[80:83], v[196:199]
s_waitcnt lgkmcnt(10)
v_mfma_f32_16x16x32_bf16 v[200:203], v[40:43], v[80:83], v[200:203]
ds_read2_b32 v[56:57], v3 offset0:64 offset1:65
s_waitcnt lgkmcnt(9)
v_mfma_f32_16x16x32_bf16 v[204:207], v[44:47], v[80:83], v[204:207]
ds_read2_b32 v[58:59], v3 offset0:66 offset1:67
s_waitcnt lgkmcnt(9)
v_mfma_f32_16x16x32_bf16 v[180:183], v[16:19], v[84:87], v[180:183]
ds_read2_b32 v[60:61], v3 offset0:192 offset1:193
v_mfma_f32_16x16x32_bf16 v[184:187], v[20:23], v[84:87], v[184:187]
ds_read2_b32 v[62:63], v3 offset0:194 offset1:195
v_mfma_f32_16x16x32_bf16 v[188:191], v[24:27], v[84:87], v[188:191]
ds_read2_b32 v[64:65], v4 offset0:64 offset1:65
v_mfma_f32_16x16x32_bf16 v[192:195], v[28:31], v[84:87], v[192:195]
v_mfma_f32_16x16x32_bf16 v[196:199], v[32:35], v[84:87], v[196:199]
ds_read2_b32 v[66:67], v4 offset0:66 offset1:67
v_mfma_f32_16x16x32_bf16 v[200:203], v[36:39], v[84:87], v[200:203]
ds_read2_b32 v[68:69], v4 offset0:192 offset1:193
v_mfma_f32_16x16x32_bf16 v[204:207], v[40:43], v[84:87], v[204:207]
ds_read2_b32 v[70:71], v4 offset0:194 offset1:195
s_waitcnt lgkmcnt(14)
v_mfma_f32_16x16x32_bf16 v[184:187], v[16:19], v[88:91], v[184:187]
ds_read2_b32 v[72:73], v5 offset0:64 offset1:65
v_mfma_f32_16x16x32_bf16 v[188:191], v[20:23], v[88:91], v[188:191]
ds_read2_b32 v[74:75], v5 offset0:66 offset1:67
v_mfma_f32_16x16x32_bf16 v[192:195], v[24:27], v[88:91], v[192:195]
v_mfma_f32_16x16x32_bf16 v[196:199], v[28:31], v[88:91], v[196:199]
ds_read2_b32 v[76:77], v5 offset0:192 offset1:193
v_mfma_f32_16x16x32_bf16 v[200:203], v[32:35], v[88:91], v[200:203]
ds_read2_b32 v[78:79], v5 offset0:194 offset1:195
v_mfma_f32_16x16x32_bf16 v[204:207], v[36:39], v[88:91], v[204:207]
ds_read_b128 v[100:103], v6 offset:12672
s_waitcnt lgkmcnt(15)
v_mfma_f32_16x16x32_bf16 v[188:191], v[16:19], v[92:95], v[188:191]
ds_read_b128 v[104:107], v6 offset:12160
v_mfma_f32_16x16x32_bf16 v[192:195], v[20:23], v[92:95], v[192:195]
ds_read_b128 v[108:111], v6 offset:11648
v_mfma_f32_16x16x32_bf16 v[196:199], v[24:27], v[92:95], v[196:199]
v_mfma_f32_16x16x32_bf16 v[200:203], v[28:31], v[92:95], v[200:203]
v_mfma_f32_16x16x32_bf16 v[204:207], v[32:35], v[92:95], v[204:207]
v_mfma_f32_16x16x32_bf16 v[176:179], v[48:51], v[96:99], v[176:179]
ds_read_b128 v[80:83], v6 offset:13120
s_waitcnt lgkmcnt(15)
v_mfma_f32_16x16x32_bf16 v[180:183], v[52:55], v[96:99], v[180:183]
ds_read2_b32 v[16:17], v2 offset0:48 offset1:49
s_waitcnt lgkmcnt(15)
v_mfma_f32_16x16x32_bf16 v[184:187], v[56:59], v[96:99], v[184:187]
ds_read2_b32 v[18:19], v2 offset0:50 offset1:51
s_waitcnt lgkmcnt(14)
v_mfma_f32_16x16x32_bf16 v[188:191], v[60:63], v[96:99], v[188:191]
ds_read2_b32 v[20:21], v2 offset0:176 offset1:177
s_waitcnt lgkmcnt(13)
v_mfma_f32_16x16x32_bf16 v[192:195], v[64:67], v[96:99], v[192:195]
ds_read2_b32 v[22:23], v2 offset0:178 offset1:179
s_waitcnt lgkmcnt(12)
v_mfma_f32_16x16x32_bf16 v[196:199], v[68:71], v[96:99], v[196:199]
s_waitcnt lgkmcnt(10)
v_mfma_f32_16x16x32_bf16 v[200:203], v[72:75], v[96:99], v[200:203]
ds_read2_b32 v[24:25], v3 offset0:48 offset1:49
s_waitcnt lgkmcnt(9)
v_mfma_f32_16x16x32_bf16 v[204:207], v[76:79], v[96:99], v[204:207]
ds_read2_b32 v[26:27], v3 offset0:50 offset1:51
s_waitcnt lgkmcnt(9)
v_mfma_f32_16x16x32_bf16 v[180:183], v[48:51], v[100:103], v[180:183]
ds_read2_b32 v[28:29], v3 offset0:176 offset1:177
v_mfma_f32_16x16x32_bf16 v[184:187], v[52:55], v[100:103], v[184:187]
ds_read2_b32 v[30:31], v3 offset0:178 offset1:179
v_mfma_f32_16x16x32_bf16 v[188:191], v[56:59], v[100:103], v[188:191]
ds_read2_b32 v[32:33], v4 offset0:48 offset1:49
v_mfma_f32_16x16x32_bf16 v[192:195], v[60:63], v[100:103], v[192:195]
v_mfma_f32_16x16x32_bf16 v[196:199], v[64:67], v[100:103], v[196:199]
ds_read2_b32 v[34:35], v4 offset0:50 offset1:51
v_mfma_f32_16x16x32_bf16 v[200:203], v[68:71], v[100:103], v[200:203]
ds_read2_b32 v[36:37], v4 offset0:176 offset1:177
v_mfma_f32_16x16x32_bf16 v[204:207], v[72:75], v[100:103], v[204:207]
ds_read2_b32 v[38:39], v4 offset0:178 offset1:179
s_waitcnt lgkmcnt(14)
v_mfma_f32_16x16x32_bf16 v[184:187], v[48:51], v[104:107], v[184:187]
ds_read2_b32 v[40:41], v5 offset0:48 offset1:49
v_mfma_f32_16x16x32_bf16 v[188:191], v[52:55], v[104:107], v[188:191]
ds_read2_b32 v[42:43], v5 offset0:50 offset1:51
v_mfma_f32_16x16x32_bf16 v[192:195], v[56:59], v[104:107], v[192:195]
v_mfma_f32_16x16x32_bf16 v[196:199], v[60:63], v[104:107], v[196:199]
ds_read2_b32 v[44:45], v5 offset0:176 offset1:177
v_mfma_f32_16x16x32_bf16 v[200:203], v[64:67], v[104:107], v[200:203]
ds_read2_b32 v[46:47], v5 offset0:178 offset1:179
v_mfma_f32_16x16x32_bf16 v[204:207], v[68:71], v[104:107], v[204:207]
ds_read_b128 v[84:87], v6 offset:12608
s_waitcnt lgkmcnt(15)
v_mfma_f32_16x16x32_bf16 v[188:191], v[48:51], v[108:111], v[188:191]
ds_read_b128 v[88:91], v6 offset:12096
v_mfma_f32_16x16x32_bf16 v[192:195], v[52:55], v[108:111], v[192:195]
ds_read_b128 v[92:95], v6 offset:11584
v_mfma_f32_16x16x32_bf16 v[196:199], v[56:59], v[108:111], v[196:199]
v_mfma_f32_16x16x32_bf16 v[200:203], v[60:63], v[108:111], v[200:203]
buffer_load_dword v15, v13, s[44:47], s15 offen
s_add_u32 s15, s15, 294912
v_mfma_f32_16x16x32_bf16 v[204:207], v[64:67], v[108:111], v[204:207]
v_mfma_f32_16x16x32_bf16 v[176:179], v[16:19], v[80:83], v[176:179]
ds_read_b128 v[96:99], v6 offset:13056
s_waitcnt lgkmcnt(15)
v_mfma_f32_16x16x32_bf16 v[180:183], v[20:23], v[80:83], v[180:183]
ds_read2_b32 v[48:49], v2 offset0:32 offset1:33
s_waitcnt lgkmcnt(15)
v_mfma_f32_16x16x32_bf16 v[184:187], v[24:27], v[80:83], v[184:187]
ds_read2_b32 v[50:51], v2 offset0:34 offset1:35
s_waitcnt lgkmcnt(14)
v_mfma_f32_16x16x32_bf16 v[188:191], v[28:31], v[80:83], v[188:191]
ds_read2_b32 v[52:53], v2 offset0:160 offset1:161
s_waitcnt lgkmcnt(13)
v_mfma_f32_16x16x32_bf16 v[192:195], v[32:35], v[80:83], v[192:195]
ds_read2_b32 v[54:55], v2 offset0:162 offset1:163
s_waitcnt lgkmcnt(12)
v_mfma_f32_16x16x32_bf16 v[196:199], v[36:39], v[80:83], v[196:199]
s_waitcnt lgkmcnt(10)
v_mfma_f32_16x16x32_bf16 v[200:203], v[40:43], v[80:83], v[200:203]
ds_read2_b32 v[56:57], v3 offset0:32 offset1:33
s_waitcnt lgkmcnt(9)
v_mfma_f32_16x16x32_bf16 v[204:207], v[44:47], v[80:83], v[204:207]
ds_read2_b32 v[58:59], v3 offset0:34 offset1:35
s_waitcnt lgkmcnt(9)
v_mfma_f32_16x16x32_bf16 v[180:183], v[16:19], v[84:87], v[180:183]
ds_read2_b32 v[60:61], v3 offset0:160 offset1:161
v_mfma_f32_16x16x32_bf16 v[184:187], v[20:23], v[84:87], v[184:187]
ds_read2_b32 v[62:63], v3 offset0:162 offset1:163
v_mfma_f32_16x16x32_bf16 v[188:191], v[24:27], v[84:87], v[188:191]
ds_read2_b32 v[64:65], v4 offset0:32 offset1:33
v_mfma_f32_16x16x32_bf16 v[192:195], v[28:31], v[84:87], v[192:195]
v_mfma_f32_16x16x32_bf16 v[196:199], v[32:35], v[84:87], v[196:199]
ds_read2_b32 v[66:67], v4 offset0:34 offset1:35
v_mfma_f32_16x16x32_bf16 v[200:203], v[36:39], v[84:87], v[200:203]
ds_read2_b32 v[68:69], v4 offset0:160 offset1:161
v_mfma_f32_16x16x32_bf16 v[204:207], v[40:43], v[84:87], v[204:207]
ds_read2_b32 v[70:71], v4 offset0:162 offset1:163
s_waitcnt lgkmcnt(14)
v_mfma_f32_16x16x32_bf16 v[184:187], v[16:19], v[88:91], v[184:187]
ds_read2_b32 v[72:73], v5 offset0:32 offset1:33
v_mfma_f32_16x16x32_bf16 v[188:191], v[20:23], v[88:91], v[188:191]
ds_read2_b32 v[74:75], v5 offset0:34 offset1:35
v_mfma_f32_16x16x32_bf16 v[192:195], v[24:27], v[88:91], v[192:195]
v_mfma_f32_16x16x32_bf16 v[196:199], v[28:31], v[88:91], v[196:199]
ds_read2_b32 v[76:77], v5 offset0:160 offset1:161
v_mfma_f32_16x16x32_bf16 v[200:203], v[32:35], v[88:91], v[200:203]
ds_read2_b32 v[78:79], v5 offset0:162 offset1:163
v_mfma_f32_16x16x32_bf16 v[204:207], v[36:39], v[88:91], v[204:207]
ds_read_b128 v[100:103], v6 offset:12544
s_waitcnt lgkmcnt(15)
v_mfma_f32_16x16x32_bf16 v[188:191], v[16:19], v[92:95], v[188:191]
ds_read_b128 v[104:107], v6 offset:12032
v_mfma_f32_16x16x32_bf16 v[192:195], v[20:23], v[92:95], v[192:195]
ds_read_b128 v[108:111], v6 offset:11520
v_mfma_f32_16x16x32_bf16 v[196:199], v[24:27], v[92:95], v[196:199]
v_mfma_f32_16x16x32_bf16 v[200:203], v[28:31], v[92:95], v[200:203]
v_mfma_f32_16x16x32_bf16 v[204:207], v[32:35], v[92:95], v[204:207]
v_mfma_f32_16x16x32_bf16 v[176:179], v[48:51], v[96:99], v[176:179]
ds_read_b128 v[80:83], v6 offset:12992
s_waitcnt lgkmcnt(15)
v_mfma_f32_16x16x32_bf16 v[180:183], v[52:55], v[96:99], v[180:183]
ds_read2_b32 v[16:17], v2 offset0:16 offset1:17
s_waitcnt lgkmcnt(15)
v_mfma_f32_16x16x32_bf16 v[184:187], v[56:59], v[96:99], v[184:187]
ds_read2_b32 v[18:19], v2 offset0:18 offset1:19
s_waitcnt lgkmcnt(14)
v_mfma_f32_16x16x32_bf16 v[188:191], v[60:63], v[96:99], v[188:191]
ds_read2_b32 v[20:21], v2 offset0:144 offset1:145
s_waitcnt lgkmcnt(13)
v_mfma_f32_16x16x32_bf16 v[192:195], v[64:67], v[96:99], v[192:195]
ds_read2_b32 v[22:23], v2 offset0:146 offset1:147
s_waitcnt lgkmcnt(12)
v_mfma_f32_16x16x32_bf16 v[196:199], v[68:71], v[96:99], v[196:199]
s_waitcnt lgkmcnt(10)
v_mfma_f32_16x16x32_bf16 v[200:203], v[72:75], v[96:99], v[200:203]
ds_read2_b32 v[24:25], v3 offset0:16 offset1:17
s_waitcnt lgkmcnt(9)
v_mfma_f32_16x16x32_bf16 v[204:207], v[76:79], v[96:99], v[204:207]
ds_read2_b32 v[26:27], v3 offset0:18 offset1:19
s_waitcnt lgkmcnt(9)
v_mfma_f32_16x16x32_bf16 v[180:183], v[48:51], v[100:103], v[180:183]
ds_read2_b32 v[28:29], v3 offset0:144 offset1:145
v_mfma_f32_16x16x32_bf16 v[184:187], v[52:55], v[100:103], v[184:187]
ds_read2_b32 v[30:31], v3 offset0:146 offset1:147
v_mfma_f32_16x16x32_bf16 v[188:191], v[56:59], v[100:103], v[188:191]
ds_read2_b32 v[32:33], v4 offset0:16 offset1:17
v_mfma_f32_16x16x32_bf16 v[192:195], v[60:63], v[100:103], v[192:195]
v_mfma_f32_16x16x32_bf16 v[196:199], v[64:67], v[100:103], v[196:199]
ds_read2_b32 v[34:35], v4 offset0:18 offset1:19
v_mfma_f32_16x16x32_bf16 v[200:203], v[68:71], v[100:103], v[200:203]
ds_read2_b32 v[36:37], v4 offset0:144 offset1:145
v_mfma_f32_16x16x32_bf16 v[204:207], v[72:75], v[100:103], v[204:207]
ds_read2_b32 v[38:39], v4 offset0:146 offset1:147
s_waitcnt lgkmcnt(14)
v_mfma_f32_16x16x32_bf16 v[184:187], v[48:51], v[104:107], v[184:187]
ds_read2_b32 v[40:41], v5 offset0:16 offset1:17
v_mfma_f32_16x16x32_bf16 v[188:191], v[52:55], v[104:107], v[188:191]
ds_read2_b32 v[42:43], v5 offset0:18 offset1:19
v_mfma_f32_16x16x32_bf16 v[192:195], v[56:59], v[104:107], v[192:195]
v_mfma_f32_16x16x32_bf16 v[196:199], v[60:63], v[104:107], v[196:199]
ds_read2_b32 v[44:45], v5 offset0:144 offset1:145
v_mfma_f32_16x16x32_bf16 v[200:203], v[64:67], v[104:107], v[200:203]
ds_read2_b32 v[46:47], v5 offset0:146 offset1:147
v_mfma_f32_16x16x32_bf16 v[204:207], v[68:71], v[104:107], v[204:207]
ds_read_b128 v[84:87], v6 offset:12480
s_waitcnt lgkmcnt(15)
v_mfma_f32_16x16x32_bf16 v[188:191], v[48:51], v[108:111], v[188:191]
ds_read_b128 v[88:91], v6 offset:11968
v_mfma_f32_16x16x32_bf16 v[192:195], v[52:55], v[108:111], v[192:195]
ds_read_b128 v[92:95], v6 offset:11456
v_mfma_f32_16x16x32_bf16 v[196:199], v[56:59], v[108:111], v[196:199]
v_mfma_f32_16x16x32_bf16 v[200:203], v[60:63], v[108:111], v[200:203]
buffer_load_dword v15, v13, s[44:47], s15 offen
s_add_u32 s15, s15, 294912
v_mfma_f32_16x16x32_bf16 v[204:207], v[64:67], v[108:111], v[204:207]
v_mfma_f32_16x16x32_bf16 v[176:179], v[16:19], v[80:83], v[176:179]
ds_read_b128 v[96:99], v6 offset:12928
s_waitcnt lgkmcnt(15)
v_mfma_f32_16x16x32_bf16 v[180:183], v[20:23], v[80:83], v[180:183]
ds_read2_b32 v[48:49], v2 offset0:0 offset1:1
s_waitcnt lgkmcnt(15)
v_mfma_f32_16x16x32_bf16 v[184:187], v[24:27], v[80:83], v[184:187]
ds_read2_b32 v[50:51], v2 offset0:2 offset1:3
s_waitcnt lgkmcnt(14)
v_mfma_f32_16x16x32_bf16 v[188:191], v[28:31], v[80:83], v[188:191]
ds_read2_b32 v[52:53], v2 offset0:128 offset1:129
s_waitcnt lgkmcnt(13)
v_mfma_f32_16x16x32_bf16 v[192:195], v[32:35], v[80:83], v[192:195]
ds_read2_b32 v[54:55], v2 offset0:130 offset1:131
s_waitcnt lgkmcnt(12)
v_mfma_f32_16x16x32_bf16 v[196:199], v[36:39], v[80:83], v[196:199]
s_waitcnt lgkmcnt(10)
v_mfma_f32_16x16x32_bf16 v[200:203], v[40:43], v[80:83], v[200:203]
ds_read2_b32 v[56:57], v3 offset0:0 offset1:1
s_waitcnt lgkmcnt(9)
v_mfma_f32_16x16x32_bf16 v[204:207], v[44:47], v[80:83], v[204:207]
ds_read2_b32 v[58:59], v3 offset0:2 offset1:3
s_waitcnt lgkmcnt(9)
v_mfma_f32_16x16x32_bf16 v[180:183], v[16:19], v[84:87], v[180:183]
ds_read2_b32 v[60:61], v3 offset0:128 offset1:129
v_mfma_f32_16x16x32_bf16 v[184:187], v[20:23], v[84:87], v[184:187]
ds_read2_b32 v[62:63], v3 offset0:130 offset1:131
v_mfma_f32_16x16x32_bf16 v[188:191], v[24:27], v[84:87], v[188:191]
ds_read2_b32 v[64:65], v4 offset0:0 offset1:1
v_mfma_f32_16x16x32_bf16 v[192:195], v[28:31], v[84:87], v[192:195]
v_mfma_f32_16x16x32_bf16 v[196:199], v[32:35], v[84:87], v[196:199]
ds_read2_b32 v[66:67], v4 offset0:2 offset1:3
v_mfma_f32_16x16x32_bf16 v[200:203], v[36:39], v[84:87], v[200:203]
ds_read2_b32 v[68:69], v4 offset0:128 offset1:129
v_mfma_f32_16x16x32_bf16 v[204:207], v[40:43], v[84:87], v[204:207]
ds_read2_b32 v[70:71], v4 offset0:130 offset1:131
s_waitcnt lgkmcnt(14)
v_mfma_f32_16x16x32_bf16 v[184:187], v[16:19], v[88:91], v[184:187]
ds_read2_b32 v[72:73], v5 offset0:0 offset1:1
v_mfma_f32_16x16x32_bf16 v[188:191], v[20:23], v[88:91], v[188:191]
ds_read2_b32 v[74:75], v5 offset0:2 offset1:3
v_mfma_f32_16x16x32_bf16 v[192:195], v[24:27], v[88:91], v[192:195]
v_mfma_f32_16x16x32_bf16 v[196:199], v[28:31], v[88:91], v[196:199]
ds_read2_b32 v[76:77], v5 offset0:128 offset1:129
v_mfma_f32_16x16x32_bf16 v[200:203], v[32:35], v[88:91], v[200:203]
ds_read2_b32 v[78:79], v5 offset0:130 offset1:131
v_mfma_f32_16x16x32_bf16 v[204:207], v[36:39], v[88:91], v[204:207]
ds_read_b128 v[100:103], v6 offset:12416
s_waitcnt lgkmcnt(15)
v_mfma_f32_16x16x32_bf16 v[188:191], v[16:19], v[92:95], v[188:191]
ds_read_b128 v[104:107], v6 offset:11904
v_mfma_f32_16x16x32_bf16 v[192:195], v[20:23], v[92:95], v[192:195]
ds_read_b128 v[108:111], v6 offset:11392
v_mfma_f32_16x16x32_bf16 v[196:199], v[24:27], v[92:95], v[196:199]
v_mfma_f32_16x16x32_bf16 v[200:203], v[28:31], v[92:95], v[200:203]
v_mfma_f32_16x16x32_bf16 v[204:207], v[32:35], v[92:95], v[204:207]
v_mfma_f32_16x16x32_bf16 v[176:179], v[48:51], v[96:99], v[176:179]
s_waitcnt lgkmcnt(15)
v_mfma_f32_16x16x32_bf16 v[180:183], v[52:55], v[96:99], v[180:183]
s_waitcnt lgkmcnt(13)
v_mfma_f32_16x16x32_bf16 v[184:187], v[56:59], v[96:99], v[184:187]
s_waitcnt lgkmcnt(11)
v_mfma_f32_16x16x32_bf16 v[188:191], v[60:63], v[96:99], v[188:191]
s_waitcnt lgkmcnt(9)
v_mfma_f32_16x16x32_bf16 v[192:195], v[64:67], v[96:99], v[192:195]
s_waitcnt lgkmcnt(7)
v_mfma_f32_16x16x32_bf16 v[196:199], v[68:71], v[96:99], v[196:199]
s_waitcnt lgkmcnt(5)
v_mfma_f32_16x16x32_bf16 v[200:203], v[72:75], v[96:99], v[200:203]
s_waitcnt lgkmcnt(3)
v_mfma_f32_16x16x32_bf16 v[204:207], v[76:79], v[96:99], v[204:207]
s_waitcnt lgkmcnt(2)
v_mfma_f32_16x16x32_bf16 v[180:183], v[48:51], v[100:103], v[180:183]
v_mfma_f32_16x16x32_bf16 v[184:187], v[52:55], v[100:103], v[184:187]
v_mfma_f32_16x16x32_bf16 v[188:191], v[56:59], v[100:103], v[188:191]
v_mfma_f32_16x16x32_bf16 v[192:195], v[60:63], v[100:103], v[192:195]
v_mfma_f32_16x16x32_bf16 v[196:199], v[64:67], v[100:103], v[196:199]
v_mfma_f32_16x16x32_bf16 v[200:203], v[68:71], v[100:103], v[200:203]
v_mfma_f32_16x16x32_bf16 v[204:207], v[72:75], v[100:103], v[204:207]
s_waitcnt lgkmcnt(1)
v_mfma_f32_16x16x32_bf16 v[184:187], v[48:51], v[104:107], v[184:187]
v_mfma_f32_16x16x32_bf16 v[188:191], v[52:55], v[104:107], v[188:191]
v_mfma_f32_16x16x32_bf16 v[192:195], v[56:59], v[104:107], v[192:195]
v_mfma_f32_16x16x32_bf16 v[196:199], v[60:63], v[104:107], v[196:199]
v_mfma_f32_16x16x32_bf16 v[200:203], v[64:67], v[104:107], v[200:203]
v_mfma_f32_16x16x32_bf16 v[204:207], v[68:71], v[104:107], v[204:207]
s_waitcnt lgkmcnt(0)
v_mfma_f32_16x16x32_bf16 v[188:191], v[48:51], v[108:111], v[188:191]
v_mfma_f32_16x16x32_bf16 v[192:195], v[52:55], v[108:111], v[192:195]
v_mfma_f32_16x16x32_bf16 v[196:199], v[56:59], v[108:111], v[196:199]
v_mfma_f32_16x16x32_bf16 v[200:203], v[60:63], v[108:111], v[200:203]
v_mfma_f32_16x16x32_bf16 v[204:207], v[64:67], v[108:111], v[204:207]
v_add_u32 v2, 8320, v2
v_add_u32 v3, 8320, v3
v_add_u32 v4, 8320, v4
v_add_u32 v5, 8320, v5
LcA3:
Lcph3:
ds_read_b32 v252, v243 offset:32
s_waitcnt lgkmcnt(0)
v_readfirstlane_b32 s7, v252
s_cmp_ge_u32 s7, 3
s_cbranch_scc1 Lcph3_ok
s_sleep 2
s_branch Lcph3
Lcph3_ok:
ds_read_b128 v[80:83], v6 offset:18048
ds_read2_b32 v[16:17], v2 offset0:112 offset1:113
ds_read2_b32 v[18:19], v2 offset0:114 offset1:115
ds_read2_b32 v[20:21], v2 offset0:240 offset1:241
ds_read2_b32 v[22:23], v2 offset0:242 offset1:243
ds_read2_b32 v[24:25], v3 offset0:112 offset1:113
ds_read2_b32 v[26:27], v3 offset0:114 offset1:115
ds_read2_b32 v[28:29], v3 offset0:240 offset1:241
ds_read2_b32 v[30:31], v3 offset0:242 offset1:243
ds_read2_b32 v[32:33], v4 offset0:112 offset1:113
ds_read2_b32 v[34:35], v4 offset0:114 offset1:115
ds_read2_b32 v[36:37], v4 offset0:240 offset1:241
ds_read2_b32 v[38:39], v4 offset0:242 offset1:243
ds_read2_b32 v[40:41], v5 offset0:112 offset1:113
ds_read2_b32 v[42:43], v5 offset0:114 offset1:115
ds_read2_b32 v[44:45], v5 offset0:240 offset1:241
ds_read2_b32 v[46:47], v5 offset0:242 offset1:243
ds_read_b128 v[84:87], v6 offset:17536
ds_read_b128 v[88:91], v6 offset:17024
ds_read_b128 v[92:95], v6 offset:16512
s_waitcnt lgkmcnt(15)
v_mfma_f32_16x16x32_bf16 v[208:211], v[16:19], v[80:83], 0
ds_read_b128 v[96:99], v6 offset:17984
v_mfma_f32_16x16x32_bf16 v[212:215], v[20:23], v[80:83], 0
ds_read2_b32 v[48:49], v2 offset0:96 offset1:97
s_waitcnt lgkmcnt(15)
v_mfma_f32_16x16x32_bf16 v[216:219], v[24:27], v[80:83], 0
ds_read2_b32 v[50:51], v2 offset0:98 offset1:99
s_waitcnt lgkmcnt(14)
v_mfma_f32_16x16x32_bf16 v[220:223], v[28:31], v[80:83], 0
ds_read2_b32 v[52:53], v2 offset0:224 offset1:225
s_waitcnt lgkmcnt(13)
v_mfma_f32_16x16x32_bf16 v[224:227], v[32:35], v[80:83], 0
ds_read2_b32 v[54:55], v2 offset0:226 offset1:227
s_waitcnt lgkmcnt(12)
v_mfma_f32_16x16x32_bf16 v[228:231], v[36:39], v[80:83], 0
s_waitcnt lgkmcnt(10)
v_mfma_f32_16x16x32_bf16 v[232:235], v[40:43], v[80:83], 0
ds_read2_b32 v[56:57], v3 offset0:96 offset1:97
s_waitcnt lgkmcnt(9)
v_mfma_f32_16x16x32_bf16 v[236:239], v[44:47], v[80:83], 0
ds_read2_b32 v[58:59], v3 offset0:98 offset1:99
s_waitcnt lgkmcnt(9)
v_mfma_f32_16x16x32_bf16 v[212:215], v[16:19], v[84:87], v[212:215]
ds_read2_b32 v[60:61], v3 offset0:224 offset1:225
v_mfma_f32_16x16x32_bf16 v[216:219], v[20:23], v[84:87], v[216:219]
ds_read2_b32 v[62:63], v3 offset0:226 offset1:227
v_mfma_f32_16x16x32_bf16 v[220:223], v[24:27], v[84:87], v[220:223]
ds_read2_b32 v[64:65], v4 offset0:96 offset1:97
v_mfma_f32_16x16x32_bf16 v[224:227], v[28:31], v[84:87], v[224:227]
v_mfma_f32_16x16x32_bf16 v[228:231], v[32:35], v[84:87], v[228:231]
ds_read2_b32 v[66:67], v4 offset0:98 offset1:99
v_mfma_f32_16x16x32_bf16 v[232:235], v[36:39], v[84:87], v[232:235]
ds_read2_b32 v[68:69], v4 offset0:224 offset1:225
v_mfma_f32_16x16x32_bf16 v[236:239], v[40:43], v[84:87], v[236:239]
ds_read2_b32 v[70:71], v4 offset0:226 offset1:227
s_waitcnt lgkmcnt(14)
v_mfma_f32_16x16x32_bf16 v[216:219], v[16:19], v[88:91], v[216:219]
ds_read2_b32 v[72:73], v5 offset0:96 offset1:97
v_mfma_f32_16x16x32_bf16 v[220:223], v[20:23], v[88:91], v[220:223]
ds_read2_b32 v[74:75], v5 offset0:98 offset1:99
v_mfma_f32_16x16x32_bf16 v[224:227], v[24:27], v[88:91], v[224:227]
v_mfma_f32_16x16x32_bf16 v[228:231], v[28:31], v[88:91], v[228:231]
ds_read2_b32 v[76:77], v5 offset0:224 offset1:225
v_mfma_f32_16x16x32_bf16 v[232:235], v[32:35], v[88:91], v[232:235]
ds_read2_b32 v[78:79], v5 offset0:226 offset1:227
v_mfma_f32_16x16x32_bf16 v[236:239], v[36:39], v[88:91], v[236:239]
ds_read_b128 v[100:103], v6 offset:17472
s_waitcnt lgkmcnt(15)
v_mfma_f32_16x16x32_bf16 v[220:223], v[16:19], v[92:95], v[220:223]
ds_read_b128 v[104:107], v6 offset:16960
v_mfma_f32_16x16x32_bf16 v[224:227], v[20:23], v[92:95], v[224:227]
ds_read_b128 v[108:111], v6 offset:16448
v_mfma_f32_16x16x32_bf16 v[228:231], v[24:27], v[92:95], v[228:231]
v_mfma_f32_16x16x32_bf16 v[232:235], v[28:31], v[92:95], v[232:235]
v_mfma_f32_16x16x32_bf16 v[236:239], v[32:35], v[92:95], v[236:239]
v_mfma_f32_16x16x32_bf16 v[208:211], v[48:51], v[96:99], v[208:211]
ds_read_b128 v[80:83], v6 offset:17920
s_waitcnt lgkmcnt(15)
v_mfma_f32_16x16x32_bf16 v[212:215], v[52:55], v[96:99], v[212:215]
ds_read2_b32 v[16:17], v2 offset0:80 offset1:81
s_waitcnt lgkmcnt(15)
v_mfma_f32_16x16x32_bf16 v[216:219], v[56:59], v[96:99], v[216:219]
ds_read2_b32 v[18:19], v2 offset0:82 offset1:83
s_waitcnt lgkmcnt(14)
v_mfma_f32_16x16x32_bf16 v[220:223], v[60:63], v[96:99], v[220:223]
ds_read2_b32 v[20:21], v2 offset0:208 offset1:209
s_waitcnt lgkmcnt(13)
v_mfma_f32_16x16x32_bf16 v[224:227], v[64:67], v[96:99], v[224:227]
ds_read2_b32 v[22:23], v2 offset0:210 offset1:211
s_waitcnt lgkmcnt(12)
v_mfma_f32_16x16x32_bf16 v[228:231], v[68:71], v[96:99], v[228:231]
s_waitcnt lgkmcnt(10)
v_mfma_f32_16x16x32_bf16 v[232:235], v[72:75], v[96:99], v[232:235]
ds_read2_b32 v[24:25], v3 offset0:80 offset1:81
s_waitcnt lgkmcnt(9)
v_mfma_f32_16x16x32_bf16 v[236:239], v[76:79], v[96:99], v[236:239]
ds_read2_b32 v[26:27], v3 offset0:82 offset1:83
s_waitcnt lgkmcnt(9)
v_mfma_f32_16x16x32_bf16 v[212:215], v[48:51], v[100:103], v[212:215]
ds_read2_b32 v[28:29], v3 offset0:208 offset1:209
v_mfma_f32_16x16x32_bf16 v[216:219], v[52:55], v[100:103], v[216:219]
ds_read2_b32 v[30:31], v3 offset0:210 offset1:211
v_mfma_f32_16x16x32_bf16 v[220:223], v[56:59], v[100:103], v[220:223]
ds_read2_b32 v[32:33], v4 offset0:80 offset1:81
v_mfma_f32_16x16x32_bf16 v[224:227], v[60:63], v[100:103], v[224:227]
v_mfma_f32_16x16x32_bf16 v[228:231], v[64:67], v[100:103], v[228:231]
ds_read2_b32 v[34:35], v4 offset0:82 offset1:83
v_mfma_f32_16x16x32_bf16 v[232:235], v[68:71], v[100:103], v[232:235]
ds_read2_b32 v[36:37], v4 offset0:208 offset1:209
v_mfma_f32_16x16x32_bf16 v[236:239], v[72:75], v[100:103], v[236:239]
ds_read2_b32 v[38:39], v4 offset0:210 offset1:211
s_waitcnt lgkmcnt(14)
v_mfma_f32_16x16x32_bf16 v[216:219], v[48:51], v[104:107], v[216:219]
ds_read2_b32 v[40:41], v5 offset0:80 offset1:81
v_mfma_f32_16x16x32_bf16 v[220:223], v[52:55], v[104:107], v[220:223]
ds_read2_b32 v[42:43], v5 offset0:82 offset1:83
v_mfma_f32_16x16x32_bf16 v[224:227], v[56:59], v[104:107], v[224:227]
v_mfma_f32_16x16x32_bf16 v[228:231], v[60:63], v[104:107], v[228:231]
ds_read2_b32 v[44:45], v5 offset0:208 offset1:209
v_mfma_f32_16x16x32_bf16 v[232:235], v[64:67], v[104:107], v[232:235]
ds_read2_b32 v[46:47], v5 offset0:210 offset1:211
v_mfma_f32_16x16x32_bf16 v[236:239], v[68:71], v[104:107], v[236:239]
ds_read_b128 v[84:87], v6 offset:17408
s_waitcnt lgkmcnt(15)
v_mfma_f32_16x16x32_bf16 v[220:223], v[48:51], v[108:111], v[220:223]
ds_read_b128 v[88:91], v6 offset:16896
v_mfma_f32_16x16x32_bf16 v[224:227], v[52:55], v[108:111], v[224:227]
ds_read_b128 v[92:95], v6 offset:16384
v_mfma_f32_16x16x32_bf16 v[228:231], v[56:59], v[108:111], v[228:231]
v_mfma_f32_16x16x32_bf16 v[232:235], v[60:63], v[108:111], v[232:235]
v_mfma_f32_16x16x32_bf16 v[236:239], v[64:67], v[108:111], v[236:239]
v_mfma_f32_16x16x32_bf16 v[208:211], v[16:19], v[80:83], v[208:211]
ds_read_b128 v[96:99], v6 offset:17856
s_waitcnt lgkmcnt(15)
v_mfma_f32_16x16x32_bf16 v[212:215], v[20:23], v[80:83], v[212:215]
ds_read2_b32 v[48:49], v2 offset0:64 offset1:65
s_waitcnt lgkmcnt(15)
v_mfma_f32_16x16x32_bf16 v[216:219], v[24:27], v[80:83], v[216:219]
ds_read2_b32 v[50:51], v2 offset0:66 offset1:67
s_waitcnt lgkmcnt(14)
v_mfma_f32_16x16x32_bf16 v[220:223], v[28:31], v[80:83], v[220:223]
ds_read2_b32 v[52:53], v2 offset0:192 offset1:193
s_waitcnt lgkmcnt(13)
v_mfma_f32_16x16x32_bf16 v[224:227], v[32:35], v[80:83], v[224:227]
ds_read2_b32 v[54:55], v2 offset0:194 offset1:195
s_waitcnt lgkmcnt(12)
v_mfma_f32_16x16x32_bf16 v[228:231], v[36:39], v[80:83], v[228:231]
s_waitcnt lgkmcnt(10)
v_mfma_f32_16x16x32_bf16 v[232:235], v[40:43], v[80:83], v[232:235]
ds_read2_b32 v[56:57], v3 offset0:64 offset1:65
s_waitcnt lgkmcnt(9)
v_mfma_f32_16x16x32_bf16 v[236:239], v[44:47], v[80:83], v[236:239]
ds_read2_b32 v[58:59], v3 offset0:66 offset1:67
s_waitcnt lgkmcnt(9)
v_mfma_f32_16x16x32_bf16 v[212:215], v[16:19], v[84:87], v[212:215]
ds_read2_b32 v[60:61], v3 offset0:192 offset1:193
v_mfma_f32_16x16x32_bf16 v[216:219], v[20:23], v[84:87], v[216:219]
ds_read2_b32 v[62:63], v3 offset0:194 offset1:195
v_mfma_f32_16x16x32_bf16 v[220:223], v[24:27], v[84:87], v[220:223]
ds_read2_b32 v[64:65], v4 offset0:64 offset1:65
v_mfma_f32_16x16x32_bf16 v[224:227], v[28:31], v[84:87], v[224:227]
v_mfma_f32_16x16x32_bf16 v[228:231], v[32:35], v[84:87], v[228:231]
ds_read2_b32 v[66:67], v4 offset0:66 offset1:67
v_mfma_f32_16x16x32_bf16 v[232:235], v[36:39], v[84:87], v[232:235]
ds_read2_b32 v[68:69], v4 offset0:192 offset1:193
v_mfma_f32_16x16x32_bf16 v[236:239], v[40:43], v[84:87], v[236:239]
ds_read2_b32 v[70:71], v4 offset0:194 offset1:195
s_waitcnt lgkmcnt(14)
v_mfma_f32_16x16x32_bf16 v[216:219], v[16:19], v[88:91], v[216:219]
ds_read2_b32 v[72:73], v5 offset0:64 offset1:65
v_mfma_f32_16x16x32_bf16 v[220:223], v[20:23], v[88:91], v[220:223]
ds_read2_b32 v[74:75], v5 offset0:66 offset1:67
v_mfma_f32_16x16x32_bf16 v[224:227], v[24:27], v[88:91], v[224:227]
v_mfma_f32_16x16x32_bf16 v[228:231], v[28:31], v[88:91], v[228:231]
ds_read2_b32 v[76:77], v5 offset0:192 offset1:193
v_mfma_f32_16x16x32_bf16 v[232:235], v[32:35], v[88:91], v[232:235]
ds_read2_b32 v[78:79], v5 offset0:194 offset1:195
v_mfma_f32_16x16x32_bf16 v[236:239], v[36:39], v[88:91], v[236:239]
ds_read_b128 v[100:103], v6 offset:17344
s_waitcnt lgkmcnt(15)
v_mfma_f32_16x16x32_bf16 v[220:223], v[16:19], v[92:95], v[220:223]
ds_read_b128 v[104:107], v6 offset:16832
v_mfma_f32_16x16x32_bf16 v[224:227], v[20:23], v[92:95], v[224:227]
ds_read_b128 v[108:111], v6 offset:16320
v_mfma_f32_16x16x32_bf16 v[228:231], v[24:27], v[92:95], v[228:231]
v_mfma_f32_16x16x32_bf16 v[232:235], v[28:31], v[92:95], v[232:235]
v_mfma_f32_16x16x32_bf16 v[236:239], v[32:35], v[92:95], v[236:239]
v_mfma_f32_16x16x32_bf16 v[208:211], v[48:51], v[96:99], v[208:211]
ds_read_b128 v[80:83], v6 offset:17792
s_waitcnt lgkmcnt(15)
v_mfma_f32_16x16x32_bf16 v[212:215], v[52:55], v[96:99], v[212:215]
ds_read2_b32 v[16:17], v2 offset0:48 offset1:49
s_waitcnt lgkmcnt(15)
v_mfma_f32_16x16x32_bf16 v[216:219], v[56:59], v[96:99], v[216:219]
ds_read2_b32 v[18:19], v2 offset0:50 offset1:51
s_waitcnt lgkmcnt(14)
v_mfma_f32_16x16x32_bf16 v[220:223], v[60:63], v[96:99], v[220:223]
ds_read2_b32 v[20:21], v2 offset0:176 offset1:177
s_waitcnt lgkmcnt(13)
v_mfma_f32_16x16x32_bf16 v[224:227], v[64:67], v[96:99], v[224:227]
ds_read2_b32 v[22:23], v2 offset0:178 offset1:179
s_waitcnt lgkmcnt(12)
v_mfma_f32_16x16x32_bf16 v[228:231], v[68:71], v[96:99], v[228:231]
s_waitcnt lgkmcnt(10)
v_mfma_f32_16x16x32_bf16 v[232:235], v[72:75], v[96:99], v[232:235]
ds_read2_b32 v[24:25], v3 offset0:48 offset1:49
s_waitcnt lgkmcnt(9)
v_mfma_f32_16x16x32_bf16 v[236:239], v[76:79], v[96:99], v[236:239]
ds_read2_b32 v[26:27], v3 offset0:50 offset1:51
s_waitcnt lgkmcnt(9)
v_mfma_f32_16x16x32_bf16 v[212:215], v[48:51], v[100:103], v[212:215]
ds_read2_b32 v[28:29], v3 offset0:176 offset1:177
v_mfma_f32_16x16x32_bf16 v[216:219], v[52:55], v[100:103], v[216:219]
ds_read2_b32 v[30:31], v3 offset0:178 offset1:179
v_mfma_f32_16x16x32_bf16 v[220:223], v[56:59], v[100:103], v[220:223]
ds_read2_b32 v[32:33], v4 offset0:48 offset1:49
v_mfma_f32_16x16x32_bf16 v[224:227], v[60:63], v[100:103], v[224:227]
v_mfma_f32_16x16x32_bf16 v[228:231], v[64:67], v[100:103], v[228:231]
ds_read2_b32 v[34:35], v4 offset0:50 offset1:51
v_mfma_f32_16x16x32_bf16 v[232:235], v[68:71], v[100:103], v[232:235]
ds_read2_b32 v[36:37], v4 offset0:176 offset1:177
v_mfma_f32_16x16x32_bf16 v[236:239], v[72:75], v[100:103], v[236:239]
ds_read2_b32 v[38:39], v4 offset0:178 offset1:179
s_waitcnt lgkmcnt(14)
v_mfma_f32_16x16x32_bf16 v[216:219], v[48:51], v[104:107], v[216:219]
ds_read2_b32 v[40:41], v5 offset0:48 offset1:49
v_mfma_f32_16x16x32_bf16 v[220:223], v[52:55], v[104:107], v[220:223]
ds_read2_b32 v[42:43], v5 offset0:50 offset1:51
v_mfma_f32_16x16x32_bf16 v[224:227], v[56:59], v[104:107], v[224:227]
v_mfma_f32_16x16x32_bf16 v[228:231], v[60:63], v[104:107], v[228:231]
ds_read2_b32 v[44:45], v5 offset0:176 offset1:177
v_mfma_f32_16x16x32_bf16 v[232:235], v[64:67], v[104:107], v[232:235]
ds_read2_b32 v[46:47], v5 offset0:178 offset1:179
v_mfma_f32_16x16x32_bf16 v[236:239], v[68:71], v[104:107], v[236:239]
ds_read_b128 v[84:87], v6 offset:17280
s_waitcnt lgkmcnt(15)
v_mfma_f32_16x16x32_bf16 v[220:223], v[48:51], v[108:111], v[220:223]
ds_read_b128 v[88:91], v6 offset:16768
v_mfma_f32_16x16x32_bf16 v[224:227], v[52:55], v[108:111], v[224:227]
ds_read_b128 v[92:95], v6 offset:16256
v_mfma_f32_16x16x32_bf16 v[228:231], v[56:59], v[108:111], v[228:231]
v_mfma_f32_16x16x32_bf16 v[232:235], v[60:63], v[108:111], v[232:235]
v_mfma_f32_16x16x32_bf16 v[236:239], v[64:67], v[108:111], v[236:239]
v_mfma_f32_16x16x32_bf16 v[208:211], v[16:19], v[80:83], v[208:211]
ds_read_b128 v[96:99], v6 offset:17728
s_waitcnt lgkmcnt(15)
v_mfma_f32_16x16x32_bf16 v[212:215], v[20:23], v[80:83], v[212:215]
ds_read2_b32 v[48:49], v2 offset0:32 offset1:33
s_waitcnt lgkmcnt(15)
v_mfma_f32_16x16x32_bf16 v[216:219], v[24:27], v[80:83], v[216:219]
ds_read2_b32 v[50:51], v2 offset0:34 offset1:35
s_waitcnt lgkmcnt(14)
v_mfma_f32_16x16x32_bf16 v[220:223], v[28:31], v[80:83], v[220:223]
ds_read2_b32 v[52:53], v2 offset0:160 offset1:161
s_waitcnt lgkmcnt(13)
v_mfma_f32_16x16x32_bf16 v[224:227], v[32:35], v[80:83], v[224:227]
ds_read2_b32 v[54:55], v2 offset0:162 offset1:163
s_waitcnt lgkmcnt(12)
v_mfma_f32_16x16x32_bf16 v[228:231], v[36:39], v[80:83], v[228:231]
s_waitcnt lgkmcnt(10)
v_mfma_f32_16x16x32_bf16 v[232:235], v[40:43], v[80:83], v[232:235]
ds_read2_b32 v[56:57], v3 offset0:32 offset1:33
s_waitcnt lgkmcnt(9)
v_mfma_f32_16x16x32_bf16 v[236:239], v[44:47], v[80:83], v[236:239]
ds_read2_b32 v[58:59], v3 offset0:34 offset1:35
s_waitcnt lgkmcnt(9)
v_mfma_f32_16x16x32_bf16 v[212:215], v[16:19], v[84:87], v[212:215]
ds_read2_b32 v[60:61], v3 offset0:160 offset1:161
v_mfma_f32_16x16x32_bf16 v[216:219], v[20:23], v[84:87], v[216:219]
ds_read2_b32 v[62:63], v3 offset0:162 offset1:163
v_mfma_f32_16x16x32_bf16 v[220:223], v[24:27], v[84:87], v[220:223]
ds_read2_b32 v[64:65], v4 offset0:32 offset1:33
v_mfma_f32_16x16x32_bf16 v[224:227], v[28:31], v[84:87], v[224:227]
v_mfma_f32_16x16x32_bf16 v[228:231], v[32:35], v[84:87], v[228:231]
ds_read2_b32 v[66:67], v4 offset0:34 offset1:35
v_mfma_f32_16x16x32_bf16 v[232:235], v[36:39], v[84:87], v[232:235]
ds_read2_b32 v[68:69], v4 offset0:160 offset1:161
v_mfma_f32_16x16x32_bf16 v[236:239], v[40:43], v[84:87], v[236:239]
ds_read2_b32 v[70:71], v4 offset0:162 offset1:163
s_waitcnt lgkmcnt(14)
v_mfma_f32_16x16x32_bf16 v[216:219], v[16:19], v[88:91], v[216:219]
ds_read2_b32 v[72:73], v5 offset0:32 offset1:33
v_mfma_f32_16x16x32_bf16 v[220:223], v[20:23], v[88:91], v[220:223]
ds_read2_b32 v[74:75], v5 offset0:34 offset1:35
v_mfma_f32_16x16x32_bf16 v[224:227], v[24:27], v[88:91], v[224:227]
v_mfma_f32_16x16x32_bf16 v[228:231], v[28:31], v[88:91], v[228:231]
ds_read2_b32 v[76:77], v5 offset0:160 offset1:161
v_mfma_f32_16x16x32_bf16 v[232:235], v[32:35], v[88:91], v[232:235]
ds_read2_b32 v[78:79], v5 offset0:162 offset1:163
v_mfma_f32_16x16x32_bf16 v[236:239], v[36:39], v[88:91], v[236:239]
ds_read_b128 v[100:103], v6 offset:17216
s_waitcnt lgkmcnt(15)
v_mfma_f32_16x16x32_bf16 v[220:223], v[16:19], v[92:95], v[220:223]
ds_read_b128 v[104:107], v6 offset:16704
v_mfma_f32_16x16x32_bf16 v[224:227], v[20:23], v[92:95], v[224:227]
ds_read_b128 v[108:111], v6 offset:16192
v_mfma_f32_16x16x32_bf16 v[228:231], v[24:27], v[92:95], v[228:231]
v_mfma_f32_16x16x32_bf16 v[232:235], v[28:31], v[92:95], v[232:235]
v_mfma_f32_16x16x32_bf16 v[236:239], v[32:35], v[92:95], v[236:239]
v_mfma_f32_16x16x32_bf16 v[208:211], v[48:51], v[96:99], v[208:211]
ds_read_b128 v[80:83], v6 offset:17664
s_waitcnt lgkmcnt(15)
v_mfma_f32_16x16x32_bf16 v[212:215], v[52:55], v[96:99], v[212:215]
ds_read2_b32 v[16:17], v2 offset0:16 offset1:17
s_waitcnt lgkmcnt(15)
v_mfma_f32_16x16x32_bf16 v[216:219], v[56:59], v[96:99], v[216:219]
ds_read2_b32 v[18:19], v2 offset0:18 offset1:19
s_waitcnt lgkmcnt(14)
v_mfma_f32_16x16x32_bf16 v[220:223], v[60:63], v[96:99], v[220:223]
ds_read2_b32 v[20:21], v2 offset0:144 offset1:145
s_waitcnt lgkmcnt(13)
v_mfma_f32_16x16x32_bf16 v[224:227], v[64:67], v[96:99], v[224:227]
ds_read2_b32 v[22:23], v2 offset0:146 offset1:147
s_waitcnt lgkmcnt(12)
v_mfma_f32_16x16x32_bf16 v[228:231], v[68:71], v[96:99], v[228:231]
s_waitcnt lgkmcnt(10)
v_mfma_f32_16x16x32_bf16 v[232:235], v[72:75], v[96:99], v[232:235]
ds_read2_b32 v[24:25], v3 offset0:16 offset1:17
s_waitcnt lgkmcnt(9)
v_mfma_f32_16x16x32_bf16 v[236:239], v[76:79], v[96:99], v[236:239]
ds_read2_b32 v[26:27], v3 offset0:18 offset1:19
s_waitcnt lgkmcnt(9)
v_mfma_f32_16x16x32_bf16 v[212:215], v[48:51], v[100:103], v[212:215]
ds_read2_b32 v[28:29], v3 offset0:144 offset1:145
v_mfma_f32_16x16x32_bf16 v[216:219], v[52:55], v[100:103], v[216:219]
ds_read2_b32 v[30:31], v3 offset0:146 offset1:147
v_mfma_f32_16x16x32_bf16 v[220:223], v[56:59], v[100:103], v[220:223]
ds_read2_b32 v[32:33], v4 offset0:16 offset1:17
v_mfma_f32_16x16x32_bf16 v[224:227], v[60:63], v[100:103], v[224:227]
v_mfma_f32_16x16x32_bf16 v[228:231], v[64:67], v[100:103], v[228:231]
ds_read2_b32 v[34:35], v4 offset0:18 offset1:19
v_mfma_f32_16x16x32_bf16 v[232:235], v[68:71], v[100:103], v[232:235]
ds_read2_b32 v[36:37], v4 offset0:144 offset1:145
v_mfma_f32_16x16x32_bf16 v[236:239], v[72:75], v[100:103], v[236:239]
ds_read2_b32 v[38:39], v4 offset0:146 offset1:147
s_waitcnt lgkmcnt(14)
v_mfma_f32_16x16x32_bf16 v[216:219], v[48:51], v[104:107], v[216:219]
ds_read2_b32 v[40:41], v5 offset0:16 offset1:17
v_mfma_f32_16x16x32_bf16 v[220:223], v[52:55], v[104:107], v[220:223]
ds_read2_b32 v[42:43], v5 offset0:18 offset1:19
v_mfma_f32_16x16x32_bf16 v[224:227], v[56:59], v[104:107], v[224:227]
v_mfma_f32_16x16x32_bf16 v[228:231], v[60:63], v[104:107], v[228:231]
ds_read2_b32 v[44:45], v5 offset0:144 offset1:145
v_mfma_f32_16x16x32_bf16 v[232:235], v[64:67], v[104:107], v[232:235]
ds_read2_b32 v[46:47], v5 offset0:146 offset1:147
v_mfma_f32_16x16x32_bf16 v[236:239], v[68:71], v[104:107], v[236:239]
ds_read_b128 v[84:87], v6 offset:17152
s_waitcnt lgkmcnt(15)
v_mfma_f32_16x16x32_bf16 v[220:223], v[48:51], v[108:111], v[220:223]
ds_read_b128 v[88:91], v6 offset:16640
v_mfma_f32_16x16x32_bf16 v[224:227], v[52:55], v[108:111], v[224:227]
ds_read_b128 v[92:95], v6 offset:16128
v_mfma_f32_16x16x32_bf16 v[228:231], v[56:59], v[108:111], v[228:231]
v_mfma_f32_16x16x32_bf16 v[232:235], v[60:63], v[108:111], v[232:235]
v_mfma_f32_16x16x32_bf16 v[236:239], v[64:67], v[108:111], v[236:239]
v_mfma_f32_16x16x32_bf16 v[208:211], v[16:19], v[80:83], v[208:211]
ds_read_b128 v[96:99], v6 offset:17600
s_waitcnt lgkmcnt(15)
v_mfma_f32_16x16x32_bf16 v[212:215], v[20:23], v[80:83], v[212:215]
ds_read2_b32 v[48:49], v2 offset0:0 offset1:1
s_waitcnt lgkmcnt(15)
v_mfma_f32_16x16x32_bf16 v[216:219], v[24:27], v[80:83], v[216:219]
ds_read2_b32 v[50:51], v2 offset0:2 offset1:3
s_waitcnt lgkmcnt(14)
v_mfma_f32_16x16x32_bf16 v[220:223], v[28:31], v[80:83], v[220:223]
ds_read2_b32 v[52:53], v2 offset0:128 offset1:129
s_waitcnt lgkmcnt(13)
v_mfma_f32_16x16x32_bf16 v[224:227], v[32:35], v[80:83], v[224:227]
ds_read2_b32 v[54:55], v2 offset0:130 offset1:131
s_waitcnt lgkmcnt(12)
v_mfma_f32_16x16x32_bf16 v[228:231], v[36:39], v[80:83], v[228:231]
s_waitcnt lgkmcnt(10)
v_mfma_f32_16x16x32_bf16 v[232:235], v[40:43], v[80:83], v[232:235]
ds_read2_b32 v[56:57], v3 offset0:0 offset1:1
s_waitcnt lgkmcnt(9)
v_mfma_f32_16x16x32_bf16 v[236:239], v[44:47], v[80:83], v[236:239]
ds_read2_b32 v[58:59], v3 offset0:2 offset1:3
s_waitcnt lgkmcnt(9)
v_mfma_f32_16x16x32_bf16 v[212:215], v[16:19], v[84:87], v[212:215]
ds_read2_b32 v[60:61], v3 offset0:128 offset1:129
v_mfma_f32_16x16x32_bf16 v[216:219], v[20:23], v[84:87], v[216:219]
ds_read2_b32 v[62:63], v3 offset0:130 offset1:131
v_mfma_f32_16x16x32_bf16 v[220:223], v[24:27], v[84:87], v[220:223]
ds_read2_b32 v[64:65], v4 offset0:0 offset1:1
v_mfma_f32_16x16x32_bf16 v[224:227], v[28:31], v[84:87], v[224:227]
v_mfma_f32_16x16x32_bf16 v[228:231], v[32:35], v[84:87], v[228:231]
ds_read2_b32 v[66:67], v4 offset0:2 offset1:3
v_mfma_f32_16x16x32_bf16 v[232:235], v[36:39], v[84:87], v[232:235]
ds_read2_b32 v[68:69], v4 offset0:128 offset1:129
v_mfma_f32_16x16x32_bf16 v[236:239], v[40:43], v[84:87], v[236:239]
ds_read2_b32 v[70:71], v4 offset0:130 offset1:131
s_waitcnt lgkmcnt(14)
v_mfma_f32_16x16x32_bf16 v[216:219], v[16:19], v[88:91], v[216:219]
ds_read2_b32 v[72:73], v5 offset0:0 offset1:1
v_mfma_f32_16x16x32_bf16 v[220:223], v[20:23], v[88:91], v[220:223]
ds_read2_b32 v[74:75], v5 offset0:2 offset1:3
v_mfma_f32_16x16x32_bf16 v[224:227], v[24:27], v[88:91], v[224:227]
v_mfma_f32_16x16x32_bf16 v[228:231], v[28:31], v[88:91], v[228:231]
ds_read2_b32 v[76:77], v5 offset0:128 offset1:129
v_mfma_f32_16x16x32_bf16 v[232:235], v[32:35], v[88:91], v[232:235]
ds_read2_b32 v[78:79], v5 offset0:130 offset1:131
v_mfma_f32_16x16x32_bf16 v[236:239], v[36:39], v[88:91], v[236:239]
ds_read_b128 v[100:103], v6 offset:17088
s_waitcnt lgkmcnt(15)
v_mfma_f32_16x16x32_bf16 v[220:223], v[16:19], v[92:95], v[220:223]
ds_read_b128 v[104:107], v6 offset:16576
v_mfma_f32_16x16x32_bf16 v[224:227], v[20:23], v[92:95], v[224:227]
ds_read_b128 v[108:111], v6 offset:16064
v_mfma_f32_16x16x32_bf16 v[228:231], v[24:27], v[92:95], v[228:231]
v_mfma_f32_16x16x32_bf16 v[232:235], v[28:31], v[92:95], v[232:235]
v_mfma_f32_16x16x32_bf16 v[236:239], v[32:35], v[92:95], v[236:239]
v_mfma_f32_16x16x32_bf16 v[208:211], v[48:51], v[96:99], v[208:211]
s_waitcnt lgkmcnt(15)
v_mfma_f32_16x16x32_bf16 v[212:215], v[52:55], v[96:99], v[212:215]
s_waitcnt lgkmcnt(13)
v_mfma_f32_16x16x32_bf16 v[216:219], v[56:59], v[96:99], v[216:219]
s_waitcnt lgkmcnt(11)
v_mfma_f32_16x16x32_bf16 v[220:223], v[60:63], v[96:99], v[220:223]
s_waitcnt lgkmcnt(9)
v_mfma_f32_16x16x32_bf16 v[224:227], v[64:67], v[96:99], v[224:227]
s_waitcnt lgkmcnt(7)
v_mfma_f32_16x16x32_bf16 v[228:231], v[68:71], v[96:99], v[228:231]
s_waitcnt lgkmcnt(5)
v_mfma_f32_16x16x32_bf16 v[232:235], v[72:75], v[96:99], v[232:235]
s_waitcnt lgkmcnt(3)
v_mfma_f32_16x16x32_bf16 v[236:239], v[76:79], v[96:99], v[236:239]
s_waitcnt lgkmcnt(2)
v_mfma_f32_16x16x32_bf16 v[212:215], v[48:51], v[100:103], v[212:215]
v_mfma_f32_16x16x32_bf16 v[216:219], v[52:55], v[100:103], v[216:219]
v_mfma_f32_16x16x32_bf16 v[220:223], v[56:59], v[100:103], v[220:223]
v_mfma_f32_16x16x32_bf16 v[224:227], v[60:63], v[100:103], v[224:227]
v_mfma_f32_16x16x32_bf16 v[228:231], v[64:67], v[100:103], v[228:231]
v_mfma_f32_16x16x32_bf16 v[232:235], v[68:71], v[100:103], v[232:235]
v_mfma_f32_16x16x32_bf16 v[236:239], v[72:75], v[100:103], v[236:239]
s_waitcnt lgkmcnt(1)
v_mfma_f32_16x16x32_bf16 v[216:219], v[48:51], v[104:107], v[216:219]
v_mfma_f32_16x16x32_bf16 v[220:223], v[52:55], v[104:107], v[220:223]
v_mfma_f32_16x16x32_bf16 v[224:227], v[56:59], v[104:107], v[224:227]
v_mfma_f32_16x16x32_bf16 v[228:231], v[60:63], v[104:107], v[228:231]
v_mfma_f32_16x16x32_bf16 v[232:235], v[64:67], v[104:107], v[232:235]
v_mfma_f32_16x16x32_bf16 v[236:239], v[68:71], v[104:107], v[236:239]
s_waitcnt lgkmcnt(0)
v_mfma_f32_16x16x32_bf16 v[220:223], v[48:51], v[108:111], v[220:223]
v_mfma_f32_16x16x32_bf16 v[224:227], v[52:55], v[108:111], v[224:227]
v_mfma_f32_16x16x32_bf16 v[228:231], v[56:59], v[108:111], v[228:231]
v_mfma_f32_16x16x32_bf16 v[232:235], v[60:63], v[108:111], v[232:235]
v_mfma_f32_16x16x32_bf16 v[236:239], v[64:67], v[108:111], v[236:239]
Lcpoll1:
ds_read_b32 v252, v240 offset:4
s_waitcnt lgkmcnt(0)
v_readfirstlane_b32 s7, v252
s_cmp_ge_u32 s7, 4
s_cbranch_scc1 Lcpoll1_ok
s_sleep 2
s_branch Lcpoll1
Lcpoll1_ok:
ds_read_b128 v[80:83], v6 offset:16000
ds_read2_b32 v[16:17], v2 offset0:112 offset1:113
ds_read2_b32 v[18:19], v2 offset0:114 offset1:115
ds_read2_b32 v[20:21], v2 offset0:240 offset1:241
ds_read2_b32 v[22:23], v2 offset0:242 offset1:243
ds_read2_b32 v[24:25], v3 offset0:112 offset1:113
ds_read2_b32 v[26:27], v3 offset0:114 offset1:115
ds_read2_b32 v[28:29], v3 offset0:240 offset1:241
ds_read2_b32 v[30:31], v3 offset0:242 offset1:243
ds_read_b128 v[84:87], v6 offset:15488
ds_read_b128 v[88:91], v6 offset:14976
ds_read_b128 v[92:95], v6 offset:14464
s_waitcnt lgkmcnt(9)
v_mfma_f32_16x16x32_bf16 v[224:227], v[16:19], v[80:83], v[224:227]
ds_read_b128 v[96:99], v6 offset:15936
ds_read2_b32 v[48:49], v2 offset0:96 offset1:97
s_waitcnt lgkmcnt(9)
v_mfma_f32_16x16x32_bf16 v[228:231], v[20:23], v[80:83], v[228:231]
ds_read2_b32 v[50:51], v2 offset0:98 offset1:99
s_waitcnt lgkmcnt(8)
v_mfma_f32_16x16x32_bf16 v[232:235], v[24:27], v[80:83], v[232:235]
ds_read2_b32 v[52:53], v2 offset0:224 offset1:225
ds_read2_b32 v[54:55], v2 offset0:226 offset1:227
s_waitcnt lgkmcnt(8)
v_mfma_f32_16x16x32_bf16 v[236:239], v[28:31], v[80:83], v[236:239]
ds_read2_b32 v[56:57], v3 offset0:96 offset1:97
s_waitcnt lgkmcnt(8)
v_mfma_f32_16x16x32_bf16 v[228:231], v[16:19], v[84:87], v[228:231]
ds_read2_b32 v[58:59], v3 offset0:98 offset1:99
ds_read2_b32 v[60:61], v3 offset0:224 offset1:225
v_mfma_f32_16x16x32_bf16 v[232:235], v[20:23], v[84:87], v[232:235]
ds_read2_b32 v[62:63], v3 offset0:226 offset1:227
v_mfma_f32_16x16x32_bf16 v[236:239], v[24:27], v[84:87], v[236:239]
ds_read_b128 v[100:103], v6 offset:15424
ds_read_b128 v[104:107], v6 offset:14912
s_waitcnt lgkmcnt(12)
v_mfma_f32_16x16x32_bf16 v[232:235], v[16:19], v[88:91], v[232:235]
ds_read_b128 v[108:111], v6 offset:14400
v_mfma_f32_16x16x32_bf16 v[236:239], v[20:23], v[88:91], v[236:239]
s_waitcnt lgkmcnt(12)
v_mfma_f32_16x16x32_bf16 v[236:239], v[16:19], v[92:95], v[236:239]
s_waitcnt lgkmcnt(9)
v_mfma_f32_16x16x32_bf16 v[224:227], v[48:51], v[96:99], v[224:227]
ds_read_b128 v[80:83], v6 offset:15872
ds_read2_b32 v[16:17], v2 offset0:80 offset1:81
s_waitcnt lgkmcnt(9)
v_mfma_f32_16x16x32_bf16 v[228:231], v[52:55], v[96:99], v[228:231]
ds_read2_b32 v[18:19], v2 offset0:82 offset1:83
s_waitcnt lgkmcnt(8)
v_mfma_f32_16x16x32_bf16 v[232:235], v[56:59], v[96:99], v[232:235]
ds_read2_b32 v[20:21], v2 offset0:208 offset1:209
ds_read2_b32 v[22:23], v2 offset0:210 offset1:211
s_waitcnt lgkmcnt(8)
v_mfma_f32_16x16x32_bf16 v[236:239], v[60:63], v[96:99], v[236:239]
ds_read2_b32 v[24:25], v3 offset0:80 offset1:81
s_waitcnt lgkmcnt(8)
v_mfma_f32_16x16x32_bf16 v[228:231], v[48:51], v[100:103], v[228:231]
ds_read2_b32 v[26:27], v3 offset0:82 offset1:83
ds_read2_b32 v[28:29], v3 offset0:208 offset1:209
v_mfma_f32_16x16x32_bf16 v[232:235], v[52:55], v[100:103], v[232:235]
ds_read2_b32 v[30:31], v3 offset0:210 offset1:211
v_mfma_f32_16x16x32_bf16 v[236:239], v[56:59], v[100:103], v[236:239]
ds_read_b128 v[84:87], v6 offset:15360
ds_read_b128 v[88:91], v6 offset:14848
s_waitcnt lgkmcnt(12)
v_mfma_f32_16x16x32_bf16 v[232:235], v[48:51], v[104:107], v[232:235]
ds_read_b128 v[92:95], v6 offset:14336
v_mfma_f32_16x16x32_bf16 v[236:239], v[52:55], v[104:107], v[236:239]
s_waitcnt lgkmcnt(12)
v_mfma_f32_16x16x32_bf16 v[236:239], v[48:51], v[108:111], v[236:239]
s_waitcnt lgkmcnt(9)
v_mfma_f32_16x16x32_bf16 v[224:227], v[16:19], v[80:83], v[224:227]
ds_read_b128 v[96:99], v6 offset:15808
ds_read2_b32 v[48:49], v2 offset0:64 offset1:65
s_waitcnt lgkmcnt(9)
v_mfma_f32_16x16x32_bf16 v[228:231], v[20:23], v[80:83], v[228:231]
ds_read2_b32 v[50:51], v2 offset0:66 offset1:67
s_waitcnt lgkmcnt(8)
v_mfma_f32_16x16x32_bf16 v[232:235], v[24:27], v[80:83], v[232:235]
ds_read2_b32 v[52:53], v2 offset0:192 offset1:193
ds_read2_b32 v[54:55], v2 offset0:194 offset1:195
s_waitcnt lgkmcnt(8)
v_mfma_f32_16x16x32_bf16 v[236:239], v[28:31], v[80:83], v[236:239]
ds_read2_b32 v[56:57], v3 offset0:64 offset1:65
s_waitcnt lgkmcnt(8)
v_mfma_f32_16x16x32_bf16 v[228:231], v[16:19], v[84:87], v[228:231]
ds_read2_b32 v[58:59], v3 offset0:66 offset1:67
ds_read2_b32 v[60:61], v3 offset0:192 offset1:193
v_mfma_f32_16x16x32_bf16 v[232:235], v[20:23], v[84:87], v[232:235]
ds_read2_b32 v[62:63], v3 offset0:194 offset1:195
v_mfma_f32_16x16x32_bf16 v[236:239], v[24:27], v[84:87], v[236:239]
ds_read_b128 v[100:103], v6 offset:15296
ds_read_b128 v[104:107], v6 offset:14784
s_waitcnt lgkmcnt(12)
v_mfma_f32_16x16x32_bf16 v[232:235], v[16:19], v[88:91], v[232:235]
ds_read_b128 v[108:111], v6 offset:14272
v_mfma_f32_16x16x32_bf16 v[236:239], v[20:23], v[88:91], v[236:239]
s_waitcnt lgkmcnt(12)
v_mfma_f32_16x16x32_bf16 v[236:239], v[16:19], v[92:95], v[236:239]
s_waitcnt lgkmcnt(9)
v_mfma_f32_16x16x32_bf16 v[224:227], v[48:51], v[96:99], v[224:227]
ds_read_b128 v[80:83], v6 offset:15744
ds_read2_b32 v[16:17], v2 offset0:48 offset1:49
s_waitcnt lgkmcnt(9)
v_mfma_f32_16x16x32_bf16 v[228:231], v[52:55], v[96:99], v[228:231]
ds_read2_b32 v[18:19], v2 offset0:50 offset1:51
s_waitcnt lgkmcnt(8)
v_mfma_f32_16x16x32_bf16 v[232:235], v[56:59], v[96:99], v[232:235]
ds_read2_b32 v[20:21], v2 offset0:176 offset1:177
ds_read2_b32 v[22:23], v2 offset0:178 offset1:179
s_waitcnt lgkmcnt(8)
v_mfma_f32_16x16x32_bf16 v[236:239], v[60:63], v[96:99], v[236:239]
ds_read2_b32 v[24:25], v3 offset0:48 offset1:49
s_waitcnt lgkmcnt(8)
v_mfma_f32_16x16x32_bf16 v[228:231], v[48:51], v[100:103], v[228:231]
ds_read2_b32 v[26:27], v3 offset0:50 offset1:51
ds_read2_b32 v[28:29], v3 offset0:176 offset1:177
v_mfma_f32_16x16x32_bf16 v[232:235], v[52:55], v[100:103], v[232:235]
ds_read2_b32 v[30:31], v3 offset0:178 offset1:179
v_mfma_f32_16x16x32_bf16 v[236:239], v[56:59], v[100:103], v[236:239]
ds_read_b128 v[84:87], v6 offset:15232
ds_read_b128 v[88:91], v6 offset:14720
s_waitcnt lgkmcnt(12)
v_mfma_f32_16x16x32_bf16 v[232:235], v[48:51], v[104:107], v[232:235]
ds_read_b128 v[92:95], v6 offset:14208
v_mfma_f32_16x16x32_bf16 v[236:239], v[52:55], v[104:107], v[236:239]
s_waitcnt lgkmcnt(12)
v_mfma_f32_16x16x32_bf16 v[236:239], v[48:51], v[108:111], v[236:239]
s_waitcnt lgkmcnt(9)
v_mfma_f32_16x16x32_bf16 v[224:227], v[16:19], v[80:83], v[224:227]
ds_read_b128 v[96:99], v6 offset:15680
ds_read2_b32 v[48:49], v2 offset0:32 offset1:33
s_waitcnt lgkmcnt(9)
v_mfma_f32_16x16x32_bf16 v[228:231], v[20:23], v[80:83], v[228:231]
ds_read2_b32 v[50:51], v2 offset0:34 offset1:35
s_waitcnt lgkmcnt(8)
v_mfma_f32_16x16x32_bf16 v[232:235], v[24:27], v[80:83], v[232:235]
ds_read2_b32 v[52:53], v2 offset0:160 offset1:161
ds_read2_b32 v[54:55], v2 offset0:162 offset1:163
s_waitcnt lgkmcnt(8)
v_mfma_f32_16x16x32_bf16 v[236:239], v[28:31], v[80:83], v[236:239]
ds_read2_b32 v[56:57], v3 offset0:32 offset1:33
s_waitcnt lgkmcnt(8)
v_mfma_f32_16x16x32_bf16 v[228:231], v[16:19], v[84:87], v[228:231]
ds_read2_b32 v[58:59], v3 offset0:34 offset1:35
ds_read2_b32 v[60:61], v3 offset0:160 offset1:161
v_mfma_f32_16x16x32_bf16 v[232:235], v[20:23], v[84:87], v[232:235]
ds_read2_b32 v[62:63], v3 offset0:162 offset1:163
v_mfma_f32_16x16x32_bf16 v[236:239], v[24:27], v[84:87], v[236:239]
ds_read_b128 v[100:103], v6 offset:15168
ds_read_b128 v[104:107], v6 offset:14656
s_waitcnt lgkmcnt(12)
v_mfma_f32_16x16x32_bf16 v[232:235], v[16:19], v[88:91], v[232:235]
ds_read_b128 v[108:111], v6 offset:14144
v_mfma_f32_16x16x32_bf16 v[236:239], v[20:23], v[88:91], v[236:239]
s_waitcnt lgkmcnt(12)
v_mfma_f32_16x16x32_bf16 v[236:239], v[16:19], v[92:95], v[236:239]
s_waitcnt lgkmcnt(9)
v_mfma_f32_16x16x32_bf16 v[224:227], v[48:51], v[96:99], v[224:227]
ds_read_b128 v[80:83], v6 offset:15616
ds_read2_b32 v[16:17], v2 offset0:16 offset1:17
s_waitcnt lgkmcnt(9)
v_mfma_f32_16x16x32_bf16 v[228:231], v[52:55], v[96:99], v[228:231]
ds_read2_b32 v[18:19], v2 offset0:18 offset1:19
s_waitcnt lgkmcnt(8)
v_mfma_f32_16x16x32_bf16 v[232:235], v[56:59], v[96:99], v[232:235]
ds_read2_b32 v[20:21], v2 offset0:144 offset1:145
ds_read2_b32 v[22:23], v2 offset0:146 offset1:147
s_waitcnt lgkmcnt(8)
v_mfma_f32_16x16x32_bf16 v[236:239], v[60:63], v[96:99], v[236:239]
ds_read2_b32 v[24:25], v3 offset0:16 offset1:17
s_waitcnt lgkmcnt(8)
v_mfma_f32_16x16x32_bf16 v[228:231], v[48:51], v[100:103], v[228:231]
ds_read2_b32 v[26:27], v3 offset0:18 offset1:19
ds_read2_b32 v[28:29], v3 offset0:144 offset1:145
v_mfma_f32_16x16x32_bf16 v[232:235], v[52:55], v[100:103], v[232:235]
ds_read2_b32 v[30:31], v3 offset0:146 offset1:147
v_mfma_f32_16x16x32_bf16 v[236:239], v[56:59], v[100:103], v[236:239]
ds_read_b128 v[84:87], v6 offset:15104
ds_read_b128 v[88:91], v6 offset:14592
s_waitcnt lgkmcnt(12)
v_mfma_f32_16x16x32_bf16 v[232:235], v[48:51], v[104:107], v[232:235]
ds_read_b128 v[92:95], v6 offset:14080
v_mfma_f32_16x16x32_bf16 v[236:239], v[52:55], v[104:107], v[236:239]
s_waitcnt lgkmcnt(12)
v_mfma_f32_16x16x32_bf16 v[236:239], v[48:51], v[108:111], v[236:239]
s_waitcnt lgkmcnt(9)
v_mfma_f32_16x16x32_bf16 v[224:227], v[16:19], v[80:83], v[224:227]
ds_read_b128 v[96:99], v6 offset:15552
ds_read2_b32 v[48:49], v2 offset0:0 offset1:1
s_waitcnt lgkmcnt(9)
v_mfma_f32_16x16x32_bf16 v[228:231], v[20:23], v[80:83], v[228:231]
ds_read2_b32 v[50:51], v2 offset0:2 offset1:3
s_waitcnt lgkmcnt(8)
v_mfma_f32_16x16x32_bf16 v[232:235], v[24:27], v[80:83], v[232:235]
ds_read2_b32 v[52:53], v2 offset0:128 offset1:129
ds_read2_b32 v[54:55], v2 offset0:130 offset1:131
s_waitcnt lgkmcnt(8)
v_mfma_f32_16x16x32_bf16 v[236:239], v[28:31], v[80:83], v[236:239]
ds_read2_b32 v[56:57], v3 offset0:0 offset1:1
s_waitcnt lgkmcnt(8)
v_mfma_f32_16x16x32_bf16 v[228:231], v[16:19], v[84:87], v[228:231]
ds_read2_b32 v[58:59], v3 offset0:2 offset1:3
ds_read2_b32 v[60:61], v3 offset0:128 offset1:129
v_mfma_f32_16x16x32_bf16 v[232:235], v[20:23], v[84:87], v[232:235]
ds_read2_b32 v[62:63], v3 offset0:130 offset1:131
v_mfma_f32_16x16x32_bf16 v[236:239], v[24:27], v[84:87], v[236:239]
ds_read_b128 v[100:103], v6 offset:15040
ds_read_b128 v[104:107], v6 offset:14528
s_waitcnt lgkmcnt(12)
v_mfma_f32_16x16x32_bf16 v[232:235], v[16:19], v[88:91], v[232:235]
ds_read_b128 v[108:111], v6 offset:14016
v_mfma_f32_16x16x32_bf16 v[236:239], v[20:23], v[88:91], v[236:239]
s_waitcnt lgkmcnt(12)
v_mfma_f32_16x16x32_bf16 v[236:239], v[16:19], v[92:95], v[236:239]
s_waitcnt lgkmcnt(9)
v_mfma_f32_16x16x32_bf16 v[224:227], v[48:51], v[96:99], v[224:227]
s_waitcnt lgkmcnt(7)
v_mfma_f32_16x16x32_bf16 v[228:231], v[52:55], v[96:99], v[228:231]
s_waitcnt lgkmcnt(5)
v_mfma_f32_16x16x32_bf16 v[232:235], v[56:59], v[96:99], v[232:235]
s_waitcnt lgkmcnt(3)
v_mfma_f32_16x16x32_bf16 v[236:239], v[60:63], v[96:99], v[236:239]
s_waitcnt lgkmcnt(2)
v_mfma_f32_16x16x32_bf16 v[228:231], v[48:51], v[100:103], v[228:231]
v_mfma_f32_16x16x32_bf16 v[232:235], v[52:55], v[100:103], v[232:235]
v_mfma_f32_16x16x32_bf16 v[236:239], v[56:59], v[100:103], v[236:239]
s_waitcnt lgkmcnt(1)
v_mfma_f32_16x16x32_bf16 v[232:235], v[48:51], v[104:107], v[232:235]
v_mfma_f32_16x16x32_bf16 v[236:239], v[52:55], v[104:107], v[236:239]
s_waitcnt lgkmcnt(0)
v_mfma_f32_16x16x32_bf16 v[236:239], v[48:51], v[108:111], v[236:239]
v_and_b32 v10, 0xffff0000, v249
ds_read_b64 v[16:17], v7 offset:17600
ds_read_b64 v[18:19], v7 offset:17088
ds_read_b64 v[20:21], v7 offset:16576
ds_read_b64 v[22:23], v7 offset:16064
ds_read_b64 v[24:25], v7 offset:15552
ds_read_b64 v[26:27], v7 offset:15040
ds_read_b64 v[28:29], v7 offset:14528
ds_read_b64 v[30:31], v7 offset:14016
s_nop 3
s_waitcnt lgkmcnt(7)
v_lshlrev_b32 v43, 16, v16
v_and_b32 v42, 0xffff0000, v16
v_lshlrev_b32 v41, 16, v17
v_and_b32 v40, 0xffff0000, v17
v_fmac_f32 v208, v40, v10
v_fmac_f32 v209, v41, v10
v_fmac_f32 v210, v42, v10
v_fmac_f32 v211, v43, v10
v_cvt_pk_bf16_f32 v16, v211, v210
v_cvt_pk_bf16_f32 v17, v209, v208
ds_write_b64 v7, v[16:17] offset:17600
s_waitcnt lgkmcnt(7)
v_lshlrev_b32 v47, 16, v18
v_and_b32 v46, 0xffff0000, v18
v_lshlrev_b32 v45, 16, v19
v_and_b32 v44, 0xffff0000, v19
v_fmac_f32 v212, v44, v10
v_fmac_f32 v213, v45, v10
v_fmac_f32 v214, v46, v10
v_fmac_f32 v215, v47, v10
v_cvt_pk_bf16_f32 v18, v215, v214
v_cvt_pk_bf16_f32 v19, v213, v212
ds_write_b64 v7, v[18:19] offset:17088
s_waitcnt lgkmcnt(7)
v_lshlrev_b32 v43, 16, v20
v_and_b32 v42, 0xffff0000, v20
v_lshlrev_b32 v41, 16, v21
v_and_b32 v40, 0xffff0000, v21
v_fmac_f32 v216, v40, v10
v_fmac_f32 v217, v41, v10
v_fmac_f32 v218, v42, v10
v_fmac_f32 v219, v43, v10
v_cvt_pk_bf16_f32 v20, v219, v218
v_cvt_pk_bf16_f32 v21, v217, v216
ds_write_b64 v7, v[20:21] offset:16576
s_waitcnt lgkmcnt(7)
v_lshlrev_b32 v47, 16, v22
v_and_b32 v46, 0xffff0000, v22
v_lshlrev_b32 v45, 16, v23
v_and_b32 v44, 0xffff0000, v23
v_fmac_f32 v220, v44, v10
v_fmac_f32 v221, v45, v10
v_fmac_f32 v222, v46, v10
v_fmac_f32 v223, v47, v10
v_cvt_pk_bf16_f32 v22, v223, v222
v_cvt_pk_bf16_f32 v23, v221, v220
ds_write_b64 v7, v[22:23] offset:16064
s_waitcnt lgkmcnt(7)
v_lshlrev_b32 v43, 16, v24
v_and_b32 v42, 0xffff0000, v24
v_lshlrev_b32 v41, 16, v25
v_and_b32 v40, 0xffff0000, v25
v_fmac_f32 v224, v40, v10
v_fmac_f32 v225, v41, v10
v_fmac_f32 v226, v42, v10
v_fmac_f32 v227, v43, v10
v_cvt_pk_bf16_f32 v24, v227, v226
v_cvt_pk_bf16_f32 v25, v225, v224
ds_write_b64 v7, v[24:25] offset:15552
s_waitcnt lgkmcnt(7)
v_lshlrev_b32 v47, 16, v26
v_and_b32 v46, 0xffff0000, v26
v_lshlrev_b32 v45, 16, v27
v_and_b32 v44, 0xffff0000, v27
v_fmac_f32 v228, v44, v10
v_fmac_f32 v229, v45, v10
v_fmac_f32 v230, v46, v10
v_fmac_f32 v231, v47, v10
v_cvt_pk_bf16_f32 v26, v231, v230
v_cvt_pk_bf16_f32 v27, v229, v228
ds_write_b64 v7, v[26:27] offset:15040
s_waitcnt lgkmcnt(7)
v_lshlrev_b32 v43, 16, v28
v_and_b32 v42, 0xffff0000, v28
v_lshlrev_b32 v41, 16, v29
v_and_b32 v40, 0xffff0000, v29
v_fmac_f32 v232, v40, v10
v_fmac_f32 v233, v41, v10
v_fmac_f32 v234, v42, v10
v_fmac_f32 v235, v43, v10
v_cvt_pk_bf16_f32 v28, v235, v234
v_cvt_pk_bf16_f32 v29, v233, v232
ds_write_b64 v7, v[28:29] offset:14528
s_waitcnt lgkmcnt(7)
v_lshlrev_b32 v47, 16, v30
v_and_b32 v46, 0xffff0000, v30
v_lshlrev_b32 v45, 16, v31
v_and_b32 v44, 0xffff0000, v31
v_fmac_f32 v236, v44, v10
v_fmac_f32 v237, v45, v10
v_fmac_f32 v238, v46, v10
v_fmac_f32 v239, v47, v10
v_cvt_pk_bf16_f32 v30, v239, v238
v_cvt_pk_bf16_f32 v31, v237, v236
ds_write_b64 v7, v[30:31] offset:14016
s_cmp_lg_u32 s12, 0
s_cbranch_scc1 LcAe2
LcAe0:
Lcpe0:
ds_read_b32 v252, v243 offset:16
s_waitcnt lgkmcnt(0)
v_readfirstlane_b32 s7, v252
s_cmp_ge_u32 s7, 1
s_cbranch_scc1 Lcpe0_ok
s_sleep 2
s_branch Lcpe0
Lcpe0_ok:
v_lshlrev_b32 v10, 16, v248
ds_read_b64 v[16:17], v7 offset:3584
ds_read_b64 v[18:19], v7 offset:3072
ds_read_b64 v[20:21], v7 offset:2560
ds_read_b64 v[22:23], v7 offset:2048
ds_read_b64 v[24:25], v7 offset:1536
ds_read_b64 v[26:27], v7 offset:1024
ds_read_b64 v[28:29], v7 offset:512
ds_read_b64 v[30:31], v7 offset:0
s_nop 3
s_waitcnt lgkmcnt(7)
v_lshlrev_b32 v43, 16, v16
v_and_b32 v42, 0xffff0000, v16
v_lshlrev_b32 v41, 16, v17
v_and_b32 v40, 0xffff0000, v17
v_fmac_f32 v112, v40, v10
v_fmac_f32 v113, v41, v10
v_fmac_f32 v114, v42, v10
v_fmac_f32 v115, v43, v10
v_cvt_pk_bf16_f32 v16, v115, v114
v_cvt_pk_bf16_f32 v17, v113, v112
ds_write_b64 v7, v[16:17] offset:3584
s_waitcnt lgkmcnt(7)
v_lshlrev_b32 v47, 16, v18
v_and_b32 v46, 0xffff0000, v18
v_lshlrev_b32 v45, 16, v19
v_and_b32 v44, 0xffff0000, v19
v_fmac_f32 v116, v44, v10
v_fmac_f32 v117, v45, v10
v_fmac_f32 v118, v46, v10
v_fmac_f32 v119, v47, v10
v_cvt_pk_bf16_f32 v18, v119, v118
v_cvt_pk_bf16_f32 v19, v117, v116
ds_write_b64 v7, v[18:19] offset:3072
s_waitcnt lgkmcnt(7)
v_lshlrev_b32 v43, 16, v20
v_and_b32 v42, 0xffff0000, v20
v_lshlrev_b32 v41, 16, v21
v_and_b32 v40, 0xffff0000, v21
v_fmac_f32 v120, v40, v10
v_fmac_f32 v121, v41, v10
v_fmac_f32 v122, v42, v10
v_fmac_f32 v123, v43, v10
v_cvt_pk_bf16_f32 v20, v123, v122
v_cvt_pk_bf16_f32 v21, v121, v120
ds_write_b64 v7, v[20:21] offset:2560
s_waitcnt lgkmcnt(7)
v_lshlrev_b32 v47, 16, v22
v_and_b32 v46, 0xffff0000, v22
v_lshlrev_b32 v45, 16, v23
v_and_b32 v44, 0xffff0000, v23
v_fmac_f32 v124, v44, v10
v_fmac_f32 v125, v45, v10
v_fmac_f32 v126, v46, v10
v_fmac_f32 v127, v47, v10
v_cvt_pk_bf16_f32 v22, v127, v126
v_cvt_pk_bf16_f32 v23, v125, v124
ds_write_b64 v7, v[22:23] offset:2048
s_waitcnt lgkmcnt(7)
v_lshlrev_b32 v43, 16, v24
v_and_b32 v42, 0xffff0000, v24
v_lshlrev_b32 v41, 16, v25
v_and_b32 v40, 0xffff0000, v25
v_add_f32 v128, v128, v40
v_add_f32 v129, v129, v41
v_add_f32 v130, v130, v42
v_add_f32 v131, v131, v43
v_cvt_pk_bf16_f32 v24, v131, v130
v_cvt_pk_bf16_f32 v25, v129, v128
ds_write_b64 v7, v[24:25] offset:1536
s_waitcnt lgkmcnt(7)
v_lshlrev_b32 v47, 16, v26
v_and_b32 v46, 0xffff0000, v26
v_lshlrev_b32 v45, 16, v27
v_and_b32 v44, 0xffff0000, v27
v_add_f32 v132, v132, v44
v_add_f32 v133, v133, v45
v_add_f32 v134, v134, v46
v_add_f32 v135, v135, v47
v_cvt_pk_bf16_f32 v26, v135, v134
v_cvt_pk_bf16_f32 v27, v133, v132
ds_write_b64 v7, v[26:27] offset:1024
s_waitcnt lgkmcnt(7)
v_lshlrev_b32 v43, 16, v28
v_and_b32 v42, 0xffff0000, v28
v_lshlrev_b32 v41, 16, v29
v_and_b32 v40, 0xffff0000, v29
v_add_f32 v136, v136, v40
v_add_f32 v137, v137, v41
v_add_f32 v138, v138, v42
v_add_f32 v139, v139, v43
v_cvt_pk_bf16_f32 v28, v139, v138
v_cvt_pk_bf16_f32 v29, v137, v136
ds_write_b64 v7, v[28:29] offset:512
s_waitcnt lgkmcnt(7)
v_lshlrev_b32 v47, 16, v30
v_and_b32 v46, 0xffff0000, v30
v_lshlrev_b32 v45, 16, v31
v_and_b32 v44, 0xffff0000, v31
v_add_f32 v140, v140, v44
v_add_f32 v141, v141, v45
v_add_f32 v142, v142, v46
v_add_f32 v143, v143, v47
v_cvt_pk_bf16_f32 v30, v143, v142
v_cvt_pk_bf16_f32 v31, v141, v140
ds_write_b64 v7, v[30:31] offset:0
LcAe1:
Lcpe1:
ds_read_b32 v252, v243 offset:16
s_waitcnt lgkmcnt(0)
v_readfirstlane_b32 s7, v252
s_cmp_ge_u32 s7, 2
s_cbranch_scc1 Lcpe1_ok
s_sleep 2
s_branch Lcpe1
Lcpe1_ok:
v_and_b32 v10, 0xffff0000, v248
ds_read_b64 v[16:17], v7 offset:8256
ds_read_b64 v[18:19], v7 offset:7744
ds_read_b64 v[20:21], v7 offset:7232
ds_read_b64 v[22:23], v7 offset:6720
ds_read_b64 v[24:25], v7 offset:6208
ds_read_b64 v[26:27], v7 offset:5696
ds_read_b64 v[28:29], v7 offset:5184
ds_read_b64 v[30:31], v7 offset:4672
s_nop 3
s_waitcnt lgkmcnt(7)
v_lshlrev_b32 v43, 16, v16
v_and_b32 v42, 0xffff0000, v16
v_lshlrev_b32 v41, 16, v17
v_and_b32 v40, 0xffff0000, v17
v_fmac_f32 v144, v40, v10
v_fmac_f32 v145, v41, v10
v_fmac_f32 v146, v42, v10
v_fmac_f32 v147, v43, v10
v_cvt_pk_bf16_f32 v16, v147, v146
v_cvt_pk_bf16_f32 v17, v145, v144
ds_write_b64 v7, v[16:17] offset:8256
s_waitcnt lgkmcnt(7)
v_lshlrev_b32 v47, 16, v18
v_and_b32 v46, 0xffff0000, v18
v_lshlrev_b32 v45, 16, v19
v_and_b32 v44, 0xffff0000, v19
v_fmac_f32 v148, v44, v10
v_fmac_f32 v149, v45, v10
v_fmac_f32 v150, v46, v10
v_fmac_f32 v151, v47, v10
v_cvt_pk_bf16_f32 v18, v151, v150
v_cvt_pk_bf16_f32 v19, v149, v148
ds_write_b64 v7, v[18:19] offset:7744
s_waitcnt lgkmcnt(7)
v_lshlrev_b32 v43, 16, v20
v_and_b32 v42, 0xffff0000, v20
v_lshlrev_b32 v41, 16, v21
v_and_b32 v40, 0xffff0000, v21
v_fmac_f32 v152, v40, v10
v_fmac_f32 v153, v41, v10
v_fmac_f32 v154, v42, v10
v_fmac_f32 v155, v43, v10
v_cvt_pk_bf16_f32 v20, v155, v154
v_cvt_pk_bf16_f32 v21, v153, v152
ds_write_b64 v7, v[20:21] offset:7232
s_waitcnt lgkmcnt(7)
v_lshlrev_b32 v47, 16, v22
v_and_b32 v46, 0xffff0000, v22
v_lshlrev_b32 v45, 16, v23
v_and_b32 v44, 0xffff0000, v23
v_fmac_f32 v156, v44, v10
v_fmac_f32 v157, v45, v10
v_fmac_f32 v158, v46, v10
v_fmac_f32 v159, v47, v10
v_cvt_pk_bf16_f32 v22, v159, v158
v_cvt_pk_bf16_f32 v23, v157, v156
ds_write_b64 v7, v[22:23] offset:6720
s_waitcnt lgkmcnt(7)
v_lshlrev_b32 v43, 16, v24
v_and_b32 v42, 0xffff0000, v24
v_lshlrev_b32 v41, 16, v25
v_and_b32 v40, 0xffff0000, v25
v_add_f32 v160, v160, v40
v_add_f32 v161, v161, v41
v_add_f32 v162, v162, v42
v_add_f32 v163, v163, v43
v_cvt_pk_bf16_f32 v24, v163, v162
v_cvt_pk_bf16_f32 v25, v161, v160
ds_write_b64 v7, v[24:25] offset:6208
s_waitcnt lgkmcnt(7)
v_lshlrev_b32 v47, 16, v26
v_and_b32 v46, 0xffff0000, v26
v_lshlrev_b32 v45, 16, v27
v_and_b32 v44, 0xffff0000, v27
v_add_f32 v164, v164, v44
v_add_f32 v165, v165, v45
v_add_f32 v166, v166, v46
v_add_f32 v167, v167, v47
v_cvt_pk_bf16_f32 v26, v167, v166
v_cvt_pk_bf16_f32 v27, v165, v164
ds_write_b64 v7, v[26:27] offset:5696
s_waitcnt lgkmcnt(7)
v_lshlrev_b32 v43, 16, v28
v_and_b32 v42, 0xffff0000, v28
v_lshlrev_b32 v41, 16, v29
v_and_b32 v40, 0xffff0000, v29
v_add_f32 v168, v168, v40
v_add_f32 v169, v169, v41
v_add_f32 v170, v170, v42
v_add_f32 v171, v171, v43
v_cvt_pk_bf16_f32 v28, v171, v170
v_cvt_pk_bf16_f32 v29, v169, v168
ds_write_b64 v7, v[28:29] offset:5184
s_waitcnt lgkmcnt(7)
v_lshlrev_b32 v47, 16, v30
v_and_b32 v46, 0xffff0000, v30
v_lshlrev_b32 v45, 16, v31
v_and_b32 v44, 0xffff0000, v31
v_add_f32 v172, v172, v44
v_add_f32 v173, v173, v45
v_add_f32 v174, v174, v46
v_add_f32 v175, v175, v47
v_cvt_pk_bf16_f32 v30, v175, v174
v_cvt_pk_bf16_f32 v31, v173, v172
ds_write_b64 v7, v[30:31] offset:4672
LcAe2:
Lcpe2:
ds_read_b32 v252, v243 offset:16
s_waitcnt lgkmcnt(0)
v_readfirstlane_b32 s7, v252
s_cmp_ge_u32 s7, 3
s_cbranch_scc1 Lcpe2_ok
s_sleep 2
s_branch Lcpe2
Lcpe2_ok:
v_lshlrev_b32 v10, 16, v249
ds_read_b64 v[16:17], v7 offset:12928
ds_read_b64 v[18:19], v7 offset:12416
ds_read_b64 v[20:21], v7 offset:11904
ds_read_b64 v[22:23], v7 offset:11392
ds_read_b64 v[24:25], v7 offset:10880
ds_read_b64 v[26:27], v7 offset:10368
ds_read_b64 v[28:29], v7 offset:9856
ds_read_b64 v[30:31], v7 offset:9344
s_nop 3
s_waitcnt lgkmcnt(7)
v_lshlrev_b32 v43, 16, v16
v_and_b32 v42, 0xffff0000, v16
v_lshlrev_b32 v41, 16, v17
v_and_b32 v40, 0xffff0000, v17
v_fmac_f32 v176, v40, v10
v_fmac_f32 v177, v41, v10
v_fmac_f32 v178, v42, v10
v_fmac_f32 v179, v43, v10
v_cvt_pk_bf16_f32 v16, v179, v178
v_cvt_pk_bf16_f32 v17, v177, v176
ds_write_b64 v7, v[16:17] offset:12928
s_waitcnt lgkmcnt(7)
v_lshlrev_b32 v47, 16, v18
v_and_b32 v46, 0xffff0000, v18
v_lshlrev_b32 v45, 16, v19
v_and_b32 v44, 0xffff0000, v19
v_fmac_f32 v180, v44, v10
v_fmac_f32 v181, v45, v10
v_fmac_f32 v182, v46, v10
v_fmac_f32 v183, v47, v10
v_cvt_pk_bf16_f32 v18, v183, v182
v_cvt_pk_bf16_f32 v19, v181, v180
ds_write_b64 v7, v[18:19] offset:12416
s_waitcnt lgkmcnt(7)
v_lshlrev_b32 v43, 16, v20
v_and_b32 v42, 0xffff0000, v20
v_lshlrev_b32 v41, 16, v21
v_and_b32 v40, 0xffff0000, v21
v_fmac_f32 v184, v40, v10
v_fmac_f32 v185, v41, v10
v_fmac_f32 v186, v42, v10
v_fmac_f32 v187, v43, v10
v_cvt_pk_bf16_f32 v20, v187, v186
v_cvt_pk_bf16_f32 v21, v185, v184
ds_write_b64 v7, v[20:21] offset:11904
s_waitcnt lgkmcnt(7)
v_lshlrev_b32 v47, 16, v22
v_and_b32 v46, 0xffff0000, v22
v_lshlrev_b32 v45, 16, v23
v_and_b32 v44, 0xffff0000, v23
v_fmac_f32 v188, v44, v10
v_fmac_f32 v189, v45, v10
v_fmac_f32 v190, v46, v10
v_fmac_f32 v191, v47, v10
v_cvt_pk_bf16_f32 v22, v191, v190
v_cvt_pk_bf16_f32 v23, v189, v188
ds_write_b64 v7, v[22:23] offset:11392
s_waitcnt lgkmcnt(7)
v_lshlrev_b32 v43, 16, v24
v_and_b32 v42, 0xffff0000, v24
v_lshlrev_b32 v41, 16, v25
v_and_b32 v40, 0xffff0000, v25
v_add_f32 v192, v192, v40
v_add_f32 v193, v193, v41
v_add_f32 v194, v194, v42
v_add_f32 v195, v195, v43
v_cvt_pk_bf16_f32 v24, v195, v194
v_cvt_pk_bf16_f32 v25, v193, v192
ds_write_b64 v7, v[24:25] offset:10880
s_waitcnt lgkmcnt(7)
v_lshlrev_b32 v47, 16, v26
v_and_b32 v46, 0xffff0000, v26
v_lshlrev_b32 v45, 16, v27
v_and_b32 v44, 0xffff0000, v27
v_add_f32 v196, v196, v44
v_add_f32 v197, v197, v45
v_add_f32 v198, v198, v46
v_add_f32 v199, v199, v47
v_cvt_pk_bf16_f32 v26, v199, v198
v_cvt_pk_bf16_f32 v27, v197, v196
ds_write_b64 v7, v[26:27] offset:10368
s_waitcnt lgkmcnt(7)
v_lshlrev_b32 v43, 16, v28
v_and_b32 v42, 0xffff0000, v28
v_lshlrev_b32 v41, 16, v29
v_and_b32 v40, 0xffff0000, v29
v_add_f32 v200, v200, v40
v_add_f32 v201, v201, v41
v_add_f32 v202, v202, v42
v_add_f32 v203, v203, v43
v_cvt_pk_bf16_f32 v28, v203, v202
v_cvt_pk_bf16_f32 v29, v201, v200
ds_write_b64 v7, v[28:29] offset:9856
s_waitcnt lgkmcnt(7)
v_lshlrev_b32 v47, 16, v30
v_and_b32 v46, 0xffff0000, v30
v_lshlrev_b32 v45, 16, v31
v_and_b32 v44, 0xffff0000, v31
v_add_f32 v204, v204, v44
v_add_f32 v205, v205, v45
v_add_f32 v206, v206, v46
v_add_f32 v207, v207, v47
v_cvt_pk_bf16_f32 v30, v207, v206
v_cvt_pk_bf16_f32 v31, v205, v204
ds_write_b64 v7, v[30:31] offset:9344
s_branch Lconv_fin
Lconv_B:
Lcpoll2:
ds_read_b32 v252, v240 offset:4
s_waitcnt lgkmcnt(0)
v_readfirstlane_b32 s7, v252
s_cmp_ge_u32 s7, 4
s_cbranch_scc1 Lcpoll2_ok
s_sleep 2
s_branch Lcpoll2
Lcpoll2_ok:
s_setprio 1
s_lshl_b32 s9, s12, 1
LcB:
s_waitcnt vmcnt(0) lgkmcnt(0)
ds_write_b16 v12, v9 offset:30
v_lshlrev_b32 v10, 16, v248
v_alignbit_b32 v248, v249, v248, 16
v_lshrrev_b32 v249, 16, v249
s_waitcnt lgkmcnt(0)
ds_read_b128 v[80:83], v6 offset:1984
ds_read2_b32 v[16:17], v2 offset0:112 offset1:113
ds_read2_b32 v[18:19], v2 offset0:114 offset1:115
ds_read2_b32 v[20:21], v2 offset0:240 offset1:241
ds_read2_b32 v[22:23], v2 offset0:242 offset1:243
ds_read2_b32 v[24:25], v3 offset0:112 offset1:113
ds_read2_b32 v[26:27], v3 offset0:114 offset1:115
ds_read2_b32 v[28:29], v3 offset0:240 offset1:241
ds_read2_b32 v[30:31], v3 offset0:242 offset1:243
ds_read_b128 v[84:87], v6 offset:1472
ds_read_b128 v[88:91], v6 offset:960
ds_read_b128 v[92:95], v6 offset:448
s_waitcnt lgkmcnt(9)
v_mfma_f32_16x16x32_bf16 v[128:131], v[16:19], v[80:83], 0
ds_read_b128 v[96:99], v6 offset:1920
ds_read2_b32 v[48:49], v2 offset0:96 offset1:97
s_waitcnt lgkmcnt(9)
v_mfma_f32_16x16x32_bf16 v[132:135], v[20:23], v[80:83], 0
ds_read2_b32 v[50:51], v2 offset0:98 offset1:99
s_waitcnt lgkmcnt(8)
v_mfma_f32_16x16x32_bf16 v[136:139], v[24:27], v[80:83], 0
ds_read2_b32 v[52:53], v2 offset0:224 offset1:225
ds_read2_b32 v[54:55], v2 offset0:226 offset1:227
s_waitcnt lgkmcnt(8)
v_mfma_f32_16x16x32_bf16 v[140:143], v[28:31], v[80:83], 0
ds_read2_b32 v[56:57], v3 offset0:96 offset1:97
s_waitcnt lgkmcnt(8)
v_mfma_f32_16x16x32_bf16 v[132:135], v[16:19], v[84:87], v[132:135]
ds_read2_b32 v[58:59], v3 offset0:98 offset1:99
ds_read2_b32 v[60:61], v3 offset0:224 offset1:225
v_mfma_f32_16x16x32_bf16 v[136:139], v[20:23], v[84:87], v[136:139]
ds_read2_b32 v[62:63], v3 offset0:226 offset1:227
v_mfma_f32_16x16x32_bf16 v[140:143], v[24:27], v[84:87], v[140:143]
ds_read_b128 v[100:103], v6 offset:1408
ds_read_b128 v[104:107], v6 offset:896
s_waitcnt lgkmcnt(12)
v_mfma_f32_16x16x32_bf16 v[136:139], v[16:19], v[88:91], v[136:139]
ds_read_b128 v[108:111], v6 offset:384
v_mfma_f32_16x16x32_bf16 v[140:143], v[20:23], v[88:91], v[140:143]
s_waitcnt lgkmcnt(12)
v_mfma_f32_16x16x32_bf16 v[140:143], v[16:19], v[92:95], v[140:143]
s_waitcnt lgkmcnt(9)
v_mfma_f32_16x16x32_bf16 v[128:131], v[48:51], v[96:99], v[128:131]
ds_read_b128 v[80:83], v6 offset:1856
ds_read2_b32 v[16:17], v2 offset0:80 offset1:81
s_waitcnt lgkmcnt(9)
v_mfma_f32_16x16x32_bf16 v[132:135], v[52:55], v[96:99], v[132:135]
ds_read2_b32 v[18:19], v2 offset0:82 offset1:83
s_waitcnt lgkmcnt(8)
v_mfma_f32_16x16x32_bf16 v[136:139], v[56:59], v[96:99], v[136:139]
ds_read2_b32 v[20:21], v2 offset0:208 offset1:209
ds_read2_b32 v[22:23], v2 offset0:210 offset1:211
s_waitcnt lgkmcnt(8)
v_mfma_f32_16x16x32_bf16 v[140:143], v[60:63], v[96:99], v[140:143]
ds_read2_b32 v[24:25], v3 offset0:80 offset1:81
s_waitcnt lgkmcnt(8)
v_mfma_f32_16x16x32_bf16 v[132:135], v[48:51], v[100:103], v[132:135]
ds_read2_b32 v[26:27], v3 offset0:82 offset1:83
ds_read2_b32 v[28:29], v3 offset0:208 offset1:209
v_mfma_f32_16x16x32_bf16 v[136:139], v[52:55], v[100:103], v[136:139]
ds_read2_b32 v[30:31], v3 offset0:210 offset1:211
v_mfma_f32_16x16x32_bf16 v[140:143], v[56:59], v[100:103], v[140:143]
ds_read_b128 v[84:87], v6 offset:1344
ds_read_b128 v[88:91], v6 offset:832
s_waitcnt lgkmcnt(12)
v_mfma_f32_16x16x32_bf16 v[136:139], v[48:51], v[104:107], v[136:139]
ds_read_b128 v[92:95], v6 offset:320
v_mfma_f32_16x16x32_bf16 v[140:143], v[52:55], v[104:107], v[140:143]
s_waitcnt lgkmcnt(12)
v_mfma_f32_16x16x32_bf16 v[140:143], v[48:51], v[108:111], v[140:143]
s_waitcnt lgkmcnt(9)
v_mfma_f32_16x16x32_bf16 v[128:131], v[16:19], v[80:83], v[128:131]
ds_read_b128 v[96:99], v6 offset:1792
ds_read2_b32 v[48:49], v2 offset0:64 offset1:65
s_waitcnt lgkmcnt(9)
v_mfma_f32_16x16x32_bf16 v[132:135], v[20:23], v[80:83], v[132:135]
ds_read2_b32 v[50:51], v2 offset0:66 offset1:67
s_waitcnt lgkmcnt(8)
v_mfma_f32_16x16x32_bf16 v[136:139], v[24:27], v[80:83], v[136:139]
ds_read2_b32 v[52:53], v2 offset0:192 offset1:193
ds_read2_b32 v[54:55], v2 offset0:194 offset1:195
s_waitcnt lgkmcnt(8)
v_mfma_f32_16x16x32_bf16 v[140:143], v[28:31], v[80:83], v[140:143]
ds_read2_b32 v[56:57], v3 offset0:64 offset1:65
s_waitcnt lgkmcnt(8)
v_mfma_f32_16x16x32_bf16 v[132:135], v[16:19], v[84:87], v[132:135]
ds_read2_b32 v[58:59], v3 offset0:66 offset1:67
ds_read2_b32 v[60:61], v3 offset0:192 offset1:193
v_mfma_f32_16x16x32_bf16 v[136:139], v[20:23], v[84:87], v[136:139]
ds_read2_b32 v[62:63], v3 offset0:194 offset1:195
v_mfma_f32_16x16x32_bf16 v[140:143], v[24:27], v[84:87], v[140:143]
ds_read_b128 v[100:103], v6 offset:1280
ds_read_b128 v[104:107], v6 offset:768
s_waitcnt lgkmcnt(12)
v_mfma_f32_16x16x32_bf16 v[136:139], v[16:19], v[88:91], v[136:139]
ds_read_b128 v[108:111], v6 offset:256
v_mfma_f32_16x16x32_bf16 v[140:143], v[20:23], v[88:91], v[140:143]
s_waitcnt lgkmcnt(12)
v_mfma_f32_16x16x32_bf16 v[140:143], v[16:19], v[92:95], v[140:143]
s_waitcnt lgkmcnt(9)
v_mfma_f32_16x16x32_bf16 v[128:131], v[48:51], v[96:99], v[128:131]
ds_read_b128 v[80:83], v6 offset:1728
ds_read2_b32 v[16:17], v2 offset0:48 offset1:49
s_waitcnt lgkmcnt(9)
v_mfma_f32_16x16x32_bf16 v[132:135], v[52:55], v[96:99], v[132:135]
ds_read2_b32 v[18:19], v2 offset0:50 offset1:51
s_waitcnt lgkmcnt(8)
v_mfma_f32_16x16x32_bf16 v[136:139], v[56:59], v[96:99], v[136:139]
ds_read2_b32 v[20:21], v2 offset0:176 offset1:177
ds_read2_b32 v[22:23], v2 offset0:178 offset1:179
s_waitcnt lgkmcnt(8)
v_mfma_f32_16x16x32_bf16 v[140:143], v[60:63], v[96:99], v[140:143]
ds_read2_b32 v[24:25], v3 offset0:48 offset1:49
s_waitcnt lgkmcnt(8)
v_mfma_f32_16x16x32_bf16 v[132:135], v[48:51], v[100:103], v[132:135]
ds_read2_b32 v[26:27], v3 offset0:50 offset1:51
ds_read2_b32 v[28:29], v3 offset0:176 offset1:177
v_mfma_f32_16x16x32_bf16 v[136:139], v[52:55], v[100:103], v[136:139]
ds_read2_b32 v[30:31], v3 offset0:178 offset1:179
v_mfma_f32_16x16x32_bf16 v[140:143], v[56:59], v[100:103], v[140:143]
ds_read_b128 v[84:87], v6 offset:1216
ds_read_b128 v[88:91], v6 offset:704
s_waitcnt lgkmcnt(12)
v_mfma_f32_16x16x32_bf16 v[136:139], v[48:51], v[104:107], v[136:139]
ds_read_b128 v[92:95], v6 offset:192
v_mfma_f32_16x16x32_bf16 v[140:143], v[52:55], v[104:107], v[140:143]
s_waitcnt lgkmcnt(12)
v_mfma_f32_16x16x32_bf16 v[140:143], v[48:51], v[108:111], v[140:143]
s_waitcnt lgkmcnt(9)
v_mfma_f32_16x16x32_bf16 v[128:131], v[16:19], v[80:83], v[128:131]
ds_read_b128 v[96:99], v6 offset:1664
ds_read2_b32 v[48:49], v2 offset0:32 offset1:33
s_waitcnt lgkmcnt(9)
v_mfma_f32_16x16x32_bf16 v[132:135], v[20:23], v[80:83], v[132:135]
ds_read2_b32 v[50:51], v2 offset0:34 offset1:35
s_waitcnt lgkmcnt(8)
v_mfma_f32_16x16x32_bf16 v[136:139], v[24:27], v[80:83], v[136:139]
ds_read2_b32 v[52:53], v2 offset0:160 offset1:161
ds_read2_b32 v[54:55], v2 offset0:162 offset1:163
s_waitcnt lgkmcnt(8)
v_mfma_f32_16x16x32_bf16 v[140:143], v[28:31], v[80:83], v[140:143]
ds_read2_b32 v[56:57], v3 offset0:32 offset1:33
s_waitcnt lgkmcnt(8)
v_mfma_f32_16x16x32_bf16 v[132:135], v[16:19], v[84:87], v[132:135]
ds_read2_b32 v[58:59], v3 offset0:34 offset1:35
ds_read2_b32 v[60:61], v3 offset0:160 offset1:161
v_mfma_f32_16x16x32_bf16 v[136:139], v[20:23], v[84:87], v[136:139]
ds_read2_b32 v[62:63], v3 offset0:162 offset1:163
v_mfma_f32_16x16x32_bf16 v[140:143], v[24:27], v[84:87], v[140:143]
ds_read_b128 v[100:103], v6 offset:1152
ds_read_b128 v[104:107], v6 offset:640
s_waitcnt lgkmcnt(12)
v_mfma_f32_16x16x32_bf16 v[136:139], v[16:19], v[88:91], v[136:139]
ds_read_b128 v[108:111], v6 offset:128
v_mfma_f32_16x16x32_bf16 v[140:143], v[20:23], v[88:91], v[140:143]
s_waitcnt lgkmcnt(12)
v_mfma_f32_16x16x32_bf16 v[140:143], v[16:19], v[92:95], v[140:143]
s_waitcnt lgkmcnt(9)
v_mfma_f32_16x16x32_bf16 v[128:131], v[48:51], v[96:99], v[128:131]
ds_read_b128 v[80:83], v6 offset:1600
ds_read2_b32 v[16:17], v2 offset0:16 offset1:17
s_waitcnt lgkmcnt(9)
v_mfma_f32_16x16x32_bf16 v[132:135], v[52:55], v[96:99], v[132:135]
ds_read2_b32 v[18:19], v2 offset0:18 offset1:19
s_waitcnt lgkmcnt(8)
v_mfma_f32_16x16x32_bf16 v[136:139], v[56:59], v[96:99], v[136:139]
ds_read2_b32 v[20:21], v2 offset0:144 offset1:145
ds_read2_b32 v[22:23], v2 offset0:146 offset1:147
s_waitcnt lgkmcnt(8)
v_mfma_f32_16x16x32_bf16 v[140:143], v[60:63], v[96:99], v[140:143]
ds_read2_b32 v[24:25], v3 offset0:16 offset1:17
s_waitcnt lgkmcnt(8)
v_mfma_f32_16x16x32_bf16 v[132:135], v[48:51], v[100:103], v[132:135]
ds_read2_b32 v[26:27], v3 offset0:18 offset1:19
ds_read2_b32 v[28:29], v3 offset0:144 offset1:145
v_mfma_f32_16x16x32_bf16 v[136:139], v[52:55], v[100:103], v[136:139]
ds_read2_b32 v[30:31], v3 offset0:146 offset1:147
v_mfma_f32_16x16x32_bf16 v[140:143], v[56:59], v[100:103], v[140:143]
ds_read_b128 v[84:87], v6 offset:1088
ds_read_b128 v[88:91], v6 offset:576
s_waitcnt lgkmcnt(12)
v_mfma_f32_16x16x32_bf16 v[136:139], v[48:51], v[104:107], v[136:139]
ds_read_b128 v[92:95], v6 offset:64
v_mfma_f32_16x16x32_bf16 v[140:143], v[52:55], v[104:107], v[140:143]
s_waitcnt lgkmcnt(12)
v_mfma_f32_16x16x32_bf16 v[140:143], v[48:51], v[108:111], v[140:143]
s_waitcnt lgkmcnt(9)
v_mfma_f32_16x16x32_bf16 v[128:131], v[16:19], v[80:83], v[128:131]
ds_read_b128 v[96:99], v6 offset:1536
ds_read2_b32 v[48:49], v2 offset0:0 offset1:1
s_waitcnt lgkmcnt(9)
v_mfma_f32_16x16x32_bf16 v[132:135], v[20:23], v[80:83], v[132:135]
ds_read2_b32 v[50:51], v2 offset0:2 offset1:3
s_waitcnt lgkmcnt(8)
v_mfma_f32_16x16x32_bf16 v[136:139], v[24:27], v[80:83], v[136:139]
ds_read2_b32 v[52:53], v2 offset0:128 offset1:129
ds_read2_b32 v[54:55], v2 offset0:130 offset1:131
s_waitcnt lgkmcnt(8)
v_mfma_f32_16x16x32_bf16 v[140:143], v[28:31], v[80:83], v[140:143]
ds_read2_b32 v[56:57], v3 offset0:0 offset1:1
s_waitcnt lgkmcnt(8)
v_mfma_f32_16x16x32_bf16 v[132:135], v[16:19], v[84:87], v[132:135]
ds_read2_b32 v[58:59], v3 offset0:2 offset1:3
ds_read2_b32 v[60:61], v3 offset0:128 offset1:129
v_mfma_f32_16x16x32_bf16 v[136:139], v[20:23], v[84:87], v[136:139]
ds_read2_b32 v[62:63], v3 offset0:130 offset1:131
v_mfma_f32_16x16x32_bf16 v[140:143], v[24:27], v[84:87], v[140:143]
ds_read_b128 v[100:103], v6 offset:1024
ds_read_b128 v[104:107], v6 offset:512
s_waitcnt lgkmcnt(12)
v_mfma_f32_16x16x32_bf16 v[136:139], v[16:19], v[88:91], v[136:139]
ds_read_b128 v[108:111], v6 offset:0
v_mfma_f32_16x16x32_bf16 v[140:143], v[20:23], v[88:91], v[140:143]
s_waitcnt lgkmcnt(12)
v_mfma_f32_16x16x32_bf16 v[140:143], v[16:19], v[92:95], v[140:143]
s_waitcnt lgkmcnt(9)
v_mfma_f32_16x16x32_bf16 v[128:131], v[48:51], v[96:99], v[128:131]
s_waitcnt lgkmcnt(7)
v_mfma_f32_16x16x32_bf16 v[132:135], v[52:55], v[96:99], v[132:135]
s_waitcnt lgkmcnt(5)
v_mfma_f32_16x16x32_bf16 v[136:139], v[56:59], v[96:99], v[136:139]
s_waitcnt lgkmcnt(3)
v_mfma_f32_16x16x32_bf16 v[140:143], v[60:63], v[96:99], v[140:143]
s_waitcnt lgkmcnt(2)
v_mfma_f32_16x16x32_bf16 v[132:135], v[48:51], v[100:103], v[132:135]
s_cmp_ge_u32 s9, 2
s_cbranch_scc1 LcB_nr
s_add_u32 s11, s11, 1
s_lshl_b32 s7, s11, 12
s_add_u32 m0, s6, 32
s_add_u32 s8, s7, 2
buffer_load_dwordx4 v8, s[56:59], s7 offen offset:0 lds
buffer_load_dwordx4 v8, s[56:59], s7 offen offset:1024 lds
s_add_u32 m0, m0, 2112
s_nop 0
buffer_load_dwordx4 v8, s[56:59], s8 offen offset:0 lds
buffer_load_dwordx4 v8, s[56:59], s8 offen offset:1024 lds
buffer_load_ushort v9, v244, s[56:59], s7 offen
LcB_nr:
v_mfma_f32_16x16x32_bf16 v[136:139], v[52:55], v[100:103], v[136:139]
v_mfma_f32_16x16x32_bf16 v[140:143], v[56:59], v[100:103], v[140:143]
s_waitcnt lgkmcnt(1)
v_mfma_f32_16x16x32_bf16 v[136:139], v[48:51], v[104:107], v[136:139]
v_mfma_f32_16x16x32_bf16 v[140:143], v[52:55], v[104:107], v[140:143]
s_waitcnt lgkmcnt(0)
v_mfma_f32_16x16x32_bf16 v[140:143], v[48:51], v[108:111], v[140:143]
ds_read_b64 v[24:25], v7 offset:1536
ds_read_b64 v[26:27], v7 offset:1024
ds_read_b64 v[28:29], v7 offset:512
ds_read_b64 v[30:31], v7 offset:0
s_nop 3
s_waitcnt lgkmcnt(3)
v_lshlrev_b32 v43, 16, v24
v_and_b32 v42, 0xffff0000, v24
v_lshlrev_b32 v41, 16, v25
v_and_b32 v40, 0xffff0000, v25
v_fmac_f32 v128, v40, v10
v_fmac_f32 v129, v41, v10
v_fmac_f32 v130, v42, v10
v_fmac_f32 v131, v43, v10
v_cvt_pk_bf16_f32 v24, v131, v130
v_cvt_pk_bf16_f32 v25, v129, v128
ds_write_b64 v7, v[24:25] offset:1536
s_waitcnt lgkmcnt(3)
v_lshlrev_b32 v47, 16, v26
v_and_b32 v46, 0xffff0000, v26
v_lshlrev_b32 v45, 16, v27
v_and_b32 v44, 0xffff0000, v27
v_fmac_f32 v132, v44, v10
v_fmac_f32 v133, v45, v10
v_fmac_f32 v134, v46, v10
v_fmac_f32 v135, v47, v10
v_cvt_pk_bf16_f32 v26, v135, v134
v_cvt_pk_bf16_f32 v27, v133, v132
ds_write_b64 v7, v[26:27] offset:1024
s_waitcnt lgkmcnt(3)
v_lshlrev_b32 v43, 16, v28
v_and_b32 v42, 0xffff0000, v28
v_lshlrev_b32 v41, 16, v29
v_and_b32 v40, 0xffff0000, v29
v_fmac_f32 v136, v40, v10
v_fmac_f32 v137, v41, v10
v_fmac_f32 v138, v42, v10
v_fmac_f32 v139, v43, v10
v_cvt_pk_bf16_f32 v28, v139, v138
v_cvt_pk_bf16_f32 v29, v137, v136
ds_write_b64 v7, v[28:29] offset:512
s_waitcnt lgkmcnt(3)
v_lshlrev_b32 v47, 16, v30
v_and_b32 v46, 0xffff0000, v30
v_lshlrev_b32 v45, 16, v31
v_and_b32 v44, 0xffff0000, v31
v_fmac_f32 v140, v44, v10
v_fmac_f32 v141, v45, v10
v_fmac_f32 v142, v46, v10
v_fmac_f32 v143, v47, v10
v_cvt_pk_bf16_f32 v30, v143, v142
v_cvt_pk_bf16_f32 v31, v141, v140
ds_write_b64 v7, v[30:31] offset:0
s_add_u32 s9, s9, 1
v_mov_b32 v14, s9
s_waitcnt lgkmcnt(0)
ds_write_b32 v243, v14 offset:16
v_add_u32 v6, 4672, v6
v_add_u32 v7, 4672, v7
s_cmp_lt_u32 s9, 3
s_cbranch_scc1 LcB
Lconv_fin:
s_waitcnt vmcnt(0) lgkmcnt(0)
s_barrier
v_lshrrev_b32 v2, 5, v1
v_lshrrev_b32 v3, 2, v1
v_and_b32 v3, 3, v3
v_lshl_add_u32 v3, v2, 3, v3
v_mul_u32_u24 v3, 4672, v3
v_and_b32 v4, 16, v1
v_lshl_add_u32 v3, v4, 1, v3
v_and_b32 v5, 3, v1
v_lshl_add_u32 v3, v5, 3, v3
s_lshl_b32 s7, s3, 9
s_add_u32 s7, s7, 83456
v_add_u32 v3, s7, v3
v_and_b32 v5, 31, v1
s_lshl_b32 s7, s3, 8
v_add_u32 v5, s7, v5
v_sub_u32 v5, 1823, v5
v_lshlrev_b32 v5, 4, v5
v_lshl_add_u32 v5, v2, 15, v5
s_lshl_b32 s7, s10, 16
s_add_u32 s7, s7, 20971520
s_add_u32 s8, s7, 4096
ds_read_b64_tr_b16 v[16:17], v3 offset:0
ds_read_b64_tr_b16 v[18:19], v3 offset:18688
ds_read_b64_tr_b16 v[20:21], v3 offset:64
ds_read_b64_tr_b16 v[22:23], v3 offset:18752
ds_read_b64_tr_b16 v[24:25], v3 offset:128
ds_read_b64_tr_b16 v[26:27], v3 offset:18816
ds_read_b64_tr_b16 v[28:29], v3 offset:192
ds_read_b64_tr_b16 v[30:31], v3 offset:18880
ds_read_b64_tr_b16 v[32:33], v3 offset:256
ds_read_b64_tr_b16 v[34:35], v3 offset:18944
ds_read_b64_tr_b16 v[36:37], v3 offset:320
ds_read_b64_tr_b16 v[38:39], v3 offset:19008
ds_read_b64_tr_b16 v[40:41], v3 offset:384
ds_read_b64_tr_b16 v[42:43], v3 offset:19072
ds_read_b64_tr_b16 v[44:45], v3 offset:448
ds_read_b64_tr_b16 v[46:47], v3 offset:19136
s_waitcnt lgkmcnt(0)
s_cmp_eq_u32 s12, 0
s_cbranch_scc1 Lconv_st
s_sub_u32 exec_lo, s14, 1
s_sub_u32 exec_hi, 0, s14
Lconv_st:
buffer_store_dwordx4 v[16:19], v5, s[60:63], s7 offen offset:3584 sc1
buffer_store_dwordx4 v[20:23], v5, s[60:63], s7 offen offset:3072 sc1
buffer_store_dwordx4 v[24:27], v5, s[60:63], s7 offen offset:2560 sc1
buffer_store_dwordx4 v[28:31], v5, s[60:63], s7 offen offset:2048 sc1
buffer_store_dwordx4 v[32:35], v5, s[60:63], s7 offen offset:1536 sc1
buffer_store_dwordx4 v[36:39], v5, s[60:63], s7 offen offset:1024 sc1
buffer_store_dwordx4 v[40:43], v5, s[60:63], s7 offen offset:512 sc1
buffer_store_dwordx4 v[44:47], v5, s[60:63], s7 offen offset:0 sc1
s_mov_b64 exec, -1
s_waitcnt vmcnt(0)
s_barrier
s_cmp_lg_u32 s3, 7
s_cbranch_scc1 Lconv_end
v_add_u32 v241, 1, v241
s_mov_b64 exec, 67108863
buffer_store_dword v241, v242, s[60:63], 0 offen sc1
s_mov_b64 exec, -1
Lconv_end:
s_endpgm
Lhelper:
s_mov_b32 s52, s34
s_and_b32 s53, s35, 0xffff
s_mov_b32 s54, 5308416
s_mov_b32 s55, 0x20000
s_mul_i32 s7, s4, 663552
s_and_b32 s10, s4, 1
s_xor_b32 s10, s10, 1
s_lshl_b32 s10, s10, 2
s_mov_b32 s60, s40
s_and_b32 s61, s41, 0xffff
s_mov_b32 s62, 33554432
s_mov_b32 s63, 0x20000
s_mov_b32 s56, s36
s_and_b32 s57, s37, 0xffff
s_mov_b32 s58, 2359296
s_mov_b32 s59, 0x20000
v_lshlrev_b32 v2, 16, v0
buffer_load_dword v14, v2, s[60:63], 0 offen sc1
s_waitcnt vmcnt(0)
s_barrier
buffer_load_dword v15, v2, s[56:59], 0 offen
s_waitcnt vmcnt(0)
s_barrier
v_add_u32 v2, 0, v0
v_mul_u32_u24 v3, 13108, v2
v_lshrrev_b32 v3, 16, v3
v_mul_u32_u24 v4, 5, v3
v_sub_u32 v4, v2, v4
v_cmp_eq_u32 vcc, 4, v4
v_add_u32 v4, s10, v4
v_min_u32 v3, 575, v3
v_cndmask_b32 v4, v4, 8, vcc
v_mul_u32_u24 v3, 1152, v3
v_lshl_add_u32 v3, v4, 7, v3
buffer_load_dword v8, v3, s[52:55], s7 offen
s_barrier
v_add_u32 v2, 512, v0
v_mul_u32_u24 v3, 13108, v2
v_lshrrev_b32 v3, 16, v3
v_mul_u32_u24 v4, 5, v3
v_sub_u32 v4, v2, v4
v_cmp_eq_u32 vcc, 4, v4
v_add_u32 v4, s10, v4
v_min_u32 v3, 575, v3
v_cndmask_b32 v4, v4, 8, vcc
v_mul_u32_u24 v3, 1152, v3
v_lshl_add_u32 v3, v4, 7, v3
buffer_load_dword v8, v3, s[52:55], s7 offen
s_barrier
v_add_u32 v2, 1024, v0
v_mul_u32_u24 v3, 13108, v2
v_lshrrev_b32 v3, 16, v3
v_mul_u32_u24 v4, 5, v3
v_sub_u32 v4, v2, v4
v_cmp_eq_u32 vcc, 4, v4
v_add_u32 v4, s10, v4
v_min_u32 v3, 575, v3
v_cndmask_b32 v4, v4, 8, vcc
v_mul_u32_u24 v3, 1152, v3
v_lshl_add_u32 v3, v4, 7, v3
buffer_load_dword v8, v3, s[52:55], s7 offen
s_barrier
v_add_u32 v2, 1536, v0
v_mul_u32_u24 v3, 13108, v2
v_lshrrev_b32 v3, 16, v3
v_mul_u32_u24 v4, 5, v3
v_sub_u32 v4, v2, v4
v_cmp_eq_u32 vcc, 4, v4
v_add_u32 v4, s10, v4
v_min_u32 v3, 575, v3
v_cndmask_b32 v4, v4, 8, vcc
v_mul_u32_u24 v3, 1152, v3
v_lshl_add_u32 v3, v4, 7, v3
buffer_load_dword v8, v3, s[52:55], s7 offen
s_barrier
v_add_u32 v2, 2048, v0
v_mul_u32_u24 v3, 13108, v2
v_lshrrev_b32 v3, 16, v3
v_mul_u32_u24 v4, 5, v3
v_sub_u32 v4, v2, v4
v_cmp_eq_u32 vcc, 4, v4
v_add_u32 v4, s10, v4
v_min_u32 v3, 575, v3
v_cndmask_b32 v4, v4, 8, vcc
v_mul_u32_u24 v3, 1152, v3
v_lshl_add_u32 v3, v4, 7, v3
buffer_load_dword v8, v3, s[52:55], s7 offen
s_barrier
v_add_u32 v2, 2560, v0
v_mul_u32_u24 v3, 13108, v2
v_lshrrev_b32 v3, 16, v3
v_mul_u32_u24 v4, 5, v3
v_sub_u32 v4, v2, v4
v_cmp_eq_u32 vcc, 4, v4
v_add_u32 v4, s10, v4
v_min_u32 v3, 575, v3
v_cndmask_b32 v4, v4, 8, vcc
v_mul_u32_u24 v3, 1152, v3
v_lshl_add_u32 v3, v4, 7, v3
buffer_load_dword v8, v3, s[52:55], s7 offen
s_barrier
s_waitcnt vmcnt(0)
s_endpgm
Lk1_exit:
s_endpgm
.section .rodata,"a"
.p2align 6
.amdhsa_kernel parallel_sum__ssm_conv_h3__dense_activation_mish__prompt_kernel
  .amdhsa_next_free_vgpr 256
  .amdhsa_next_free_sgpr 102
  .amdhsa_accum_offset 256
  .amdhsa_group_segment_fixed_size 0
  .amdhsa_kernarg_size 104
  .amdhsa_user_sgpr_count 2
  .amdhsa_user_sgpr_kernarg_segment_ptr 1
  .amdhsa_system_sgpr_workgroup_id_x 1
.end_amdhsa_kernel
```
